```python
import torch

def _softmax(x, axis=-1):
    return torch.softmax(x, dim=axis)
def _gelu(x):
    return torch.nn.functional.gelu(x, approximate="tanh")
def _silu(x):
    return torch.nn.functional.silu(x)
def _sigmoid(x):
    return torch.sigmoid(x)
def _layernorm(x, axis=-1, eps=1e-5):
    m = x.mean(dim=axis, keepdim=True)
    v = x.var(dim=axis, keepdim=True, unbiased=False)
    return (x - m) / torch.sqrt(v + eps)
def _scatter_add(tgt, idx, src, axis=0):
    return tgt.clone().index_add_(axis, idx, src)
def _segment_sum(src, seg, n):
    out = torch.zeros((n,) + src.shape[1:], dtype=src.dtype)
    return out.index_add_(0, seg, src)
def _pad(x, pw):
    flat = tuple(v for pair in reversed(pw) for v in pair)
    return torch.nn.functional.pad(x, flat)

kernel_name = 'standalone__gqa_softmax__near_ridge'

def setup_inputs():

    _w = (lambda a: (lambda t: t.to(torch.bfloat16) if t.is_floating_point() else t)(torch.as_tensor(a)))
    B, Hq, Hkv, Sq, Sk, D = 8, 32, 32, 736, 736, 128
    return {
        "q": _w((lambda *s: torch.randn(*s, dtype=torch.bfloat16) * 0.8)(B, Hq, Sq, D)),
        "k": _w((lambda *s: torch.randn(*s, dtype=torch.bfloat16) * 0.8)(B, Hkv, Sk, D)),
        "v": _w((lambda *s: torch.randn(*s, dtype=torch.bfloat16) * 0.05)(B, Hkv, Sk, D)),
    }

def reference(q, k, v):
    B, Hq, Sq, D = q.shape
    Hkv = k.shape[1]
    rep = Hq // Hkv
    k = (lambda x, n, axis: torch.repeat_interleave(x, n, dim=axis))(k, rep, axis=1)
    v = (lambda x, n, axis: torch.repeat_interleave(x, n, dim=axis))(v, rep, axis=1)
    scale = D ** -0.5
    scores = torch.einsum("bhqd,bhkd->bhqk", q, k) * scale
    p = _softmax(scores, axis=-1)
    return torch.einsum("bhqk,bhkd->bhqd", p, v)
```

```asm
; @launch grid=(256,1,1) block=(256,1,1) lds=163840
.amdgcn_target "amdgcn-amd-amdhsa--gfx950"
.text
.globl standalone__gqa_softmax__near_ridge_kernel
.p2align 8
.type standalone__gqa_softmax__near_ridge_kernel,@function
standalone__gqa_softmax__near_ridge_kernel:
  s_cmp_ge_u32 s2, 256
  s_cbranch_scc1 L_exit
  s_load_dwordx4 s[4:7], s[0:1], 0
  s_load_dwordx4 s[8:11], s[0:1], 16
  v_lshrrev_b32 v1, 6, v0
  v_and_b32 v2, 63, v0
  v_readfirstlane_b32 s32, v1
  s_getpc_b64 s[62:63]
L_pc:
  s_lshr_b32 s3, s2, 3
  s_and_b32 s3, s3, 31
  s_lshl_b32 s3, s3, 12
  v_lshlrev_b32 v3, 4, v0
  v_add_u32 v3, s3, v3
  v_min_u32 v3, L_end-L_pc-16, v3
  global_load_dwordx4 v[28:31], v3, s[62:63]
  v_bfe_u32 v6, v2, 4, 2
  v_and_b32 v7, 7, v2
  v_xor_b32 v6, v6, v7
  v_lshlrev_b32 v6, 4, v6
  v_lshrrev_b32 v8, 3, v0
  v_lshl_add_u32 v252, v8, 8, v6
  s_lshl_b32 s38, s32, 10
  s_mul_i32 s49, s32, 24576
  s_add_u32 s49, s49, 65536
  s_and_b32 s45, s2, 7
  s_lshl_b32 s45, s45, 5
  s_lshr_b32 s55, s2, 4
  s_add_u32 s45, s45, s55
  s_mul_i32 s56, s45, 188416
  s_add_u32 s58, s56, 3014656
  s_bfe_u32 s55, s2, 0x10003
  s_mul_i32 s57, s32, 96
  s_and_b32 s35, s32, 1
  s_mul_i32 s59, s32, 11
  s_add_u32 s59, s59, s35
  s_lshl_b32 s59, s59, 3
  s_add_u32 s59, s59, 384
  s_sub_u32 s39, 0, s35
  s_lshl_b32 s48, s55, s35
  s_xor_b32 s52, s55, 1
  s_lshl_b32 s52, s52, s35
  s_cmp_eq_u32 s55, 0
  s_cselect_b32 s45, s57, s59
  s_cselect_b32 s59, s59, s57
  s_mov_b32 s57, s45
  s_cselect_b32 s35, 0, s39
  s_cselect_b32 s39, s39, 0
  s_mov_b32 s18, 48234496
  s_mov_b32 s19, 0x20000
  s_mov_b32 s22, 48234496
  s_mov_b32 s23, 0x20000
  s_mov_b32 s26, 188416
  s_mov_b32 s27, 0x20000
  s_mov_b32 s30, 188416
  s_mov_b32 s31, 0x20000
  s_mov_b32 s33, s56
  s_mov_b32 s34, 0
  s_waitcnt lgkmcnt(0)
  s_mov_b32 s16, s6
  s_mov_b32 s17, s7
  s_mov_b32 s20, s8
  s_mov_b32 s21, s9
  s_add_u32 m0, s38, 0
  s_nop 0
  buffer_load_dwordx4 v252, s[16:19], s33 offen nt lds
  s_add_u32 m0, s38, 3968
  s_nop 0
  buffer_load_dwordx4 v252, s[16:19], s33 offen offset:128 nt lds
  s_add_u32 s24, s4, s56
  s_addc_u32 s25, s5, 0
  s_lshl_b32 s45, s32, 3
  s_sub_u32 s45, s57, s45
  s_lshl_b32 s36, s45, 8
  s_mov_b32 s37, s49
  s_mov_b32 m0, s37
  s_nop 0
  buffer_load_dwordx4 v252, s[24:27], s36 offen nt lds
  s_add_u32 m0, s37, 12160
  s_nop 0
  buffer_load_dwordx4 v252, s[24:27], s36 offen offset:128 nt lds
  s_add_u32 s37, s37, 1024
  s_add_u32 s36, s36, 2048
  s_mov_b32 m0, s37
  s_nop 0
  buffer_load_dwordx4 v252, s[24:27], s36 offen nt lds
  s_add_u32 m0, s37, 12160
  s_nop 0
  buffer_load_dwordx4 v252, s[24:27], s36 offen offset:128 nt lds
  s_add_u32 s37, s37, 1024
  s_add_u32 s36, s36, 2048
  s_add_u32 m0, s38, 8192
  s_nop 0
  buffer_load_dwordx4 v252, s[20:23], s33 offen nt lds
  s_add_u32 m0, s38, 12160
  s_nop 0
  buffer_load_dwordx4 v252, s[20:23], s33 offen offset:128 nt lds
  s_add_u32 s34, s34, 1
  s_add_u32 s33, s33, 8192
  s_add_u32 m0, s38, 16384
  s_nop 0
  buffer_load_dwordx4 v252, s[16:19], s33 offen nt lds
  s_add_u32 m0, s38, 20352
  s_nop 0
  buffer_load_dwordx4 v252, s[16:19], s33 offen offset:128 nt lds
  s_add_u32 m0, s38, 24576
  s_nop 0
  buffer_load_dwordx4 v252, s[20:23], s33 offen nt lds
  s_add_u32 m0, s38, 28544
  s_nop 0
  buffer_load_dwordx4 v252, s[20:23], s33 offen offset:128 nt lds
  s_add_u32 s34, s34, 1
  s_add_u32 s33, s33, 8192
  s_mov_b32 m0, s37
  s_nop 0
  buffer_load_dwordx4 v252, s[24:27], s36 offen nt lds
  s_add_u32 m0, s37, 12160
  s_nop 0
  buffer_load_dwordx4 v252, s[24:27], s36 offen offset:128 nt lds
  s_add_u32 s37, s37, 1024
  s_add_u32 s36, s36, 2048
  s_mov_b32 m0, s37
  s_nop 0
  buffer_load_dwordx4 v252, s[24:27], s36 offen nt lds
  s_add_u32 m0, s37, 12160
  s_nop 0
  buffer_load_dwordx4 v252, s[24:27], s36 offen offset:128 nt lds
  s_add_u32 s37, s37, 1024
  s_add_u32 s36, s36, 2048
  v_and_b32 v3, 15, v2
  v_lshrrev_b32 v4, 4, v2
  v_lshlrev_b32 v255, 4, v2
  v_add_u32 v255, s49, v255
  v_and_b32 v5, 1, v4
  v_lshlrev_b32 v5, 2, v5
  v_and_b32 v6, 2, v4
  v_or_b32 v5, v5, v6
  v_bfe_u32 v6, v3, 1, 2
  v_xor_b32 v6, v5, v6
  v_lshlrev_b32 v6, 4, v6
  v_lshl_add_u32 v246, v3, 7, v6
  v_xor_b32 v247, 16, v246
  v_add_u32 v244, s49, v246
  v_add_u32 v245, s49, v247
  v_lshrrev_b32 v5, 2, v2
  v_bfe_u32 v6, v2, 3, 2
  v_lshlrev_b32 v6, 4, v6
  v_lshl_add_u32 v6, v5, 7, v6
  v_and_b32 v7, 1, v2
  v_lshl_add_u32 v6, v7, 3, v6
  v_bfe_u32 v7, v2, 1, 1
  v_lshl_add_u32 v248, v7, 6, v6
  v_xor_b32 v249, 16, v248
  v_xor_b32 v250, 32, v248
  v_xor_b32 v251, 48, v248
  v_mov_b32 v5, 0x3f803f80
  v_bfe_u32 v6, v2, 1, 1
  v_lshrrev_b32 v7, 5, v2
  v_cmp_eq_u32 vcc, v6, v7
  s_nop 1
  v_cndmask_b32 v8, 0, v5, vcc
  v_accvgpr_write_b32 a224, v8
  v_accvgpr_write_b32 a225, v8
  v_accvgpr_write_b32 a226, v8
  v_accvgpr_write_b32 a227, v8
  v_cmp_eq_u32 vcc, 0, v6
  s_nop 1
  v_cndmask_b32 v8, 0, v5, vcc
  v_xor_b32 v7, v8, v5
  v_accvgpr_write_b32 a228, v8
  v_accvgpr_write_b32 a232, v7
  v_accvgpr_write_b32 a229, v8
  v_accvgpr_write_b32 a233, v7
  v_accvgpr_write_b32 a230, v8
  v_accvgpr_write_b32 a234, v7
  v_accvgpr_write_b32 a231, v8
  v_accvgpr_write_b32 a235, v7
  v_and_b32 v6, 1, v2
  v_mul_u32_u24 v6, 0xaaaa, v6
  v_add_u32 v253, 0x4444, v6
  v_accvgpr_write_b32 a236, 0
  v_accvgpr_write_b32 a237, 0
  v_accvgpr_write_b32 a238, 0
  v_accvgpr_write_b32 a239, 0
  v_accvgpr_write_b32 a240, 0
  v_accvgpr_write_b32 a241, 0
  v_accvgpr_write_b32 a242, 0
  v_accvgpr_write_b32 a243, 0
  v_accvgpr_write_b32 a244, 0
  v_accvgpr_write_b32 a245, 0
  v_accvgpr_write_b32 a246, 0
  v_accvgpr_write_b32 a247, 0
  s_mov_b32 s40, 0x3e0293ee
  s_mov_b32 s41, 0x3e0293ee
  s_mov_b32 s43, 0x5f800000
  s_mov_b64 s[46:47], 0
  s_mov_b32 s51, 0
  s_mov_b32 s55, 0x7f800000
  s_cmp_eq_u32 s35, 0
  s_cselect_b32 s44, s55, 0xf149f2ca
  s_cmp_eq_u32 s39, 0
  s_cselect_b32 s60, s55, 0xf149f2ca
  s_and_b32 s100, s39, 24576
  s_add_u32 s28, s10, s56
  s_addc_u32 s29, s11, 0
  s_lshl_b32 s42, s57, 8
  s_waitcnt vmcnt(10)
  ds_read_b128 v[0:3], v244 offset:0
  ds_read_b128 v[4:7], v245 offset:0
  ds_read_b128 v[8:11], v244 offset:12288
  ds_read_b128 v[12:15], v245 offset:12288
  s_mov_b32 m0, s37
  s_nop 0
  buffer_load_dwordx4 v252, s[24:27], s36 offen nt lds
  s_waitcnt lgkmcnt(3)
  v_lshlrev_b32 v16, 16, v0
  v_and_b32 v17, 0xffff0000, v0
  v_pk_mul_f32 v[16:17], v[16:17], s[40:41]
  v_cvt_pk_bf16_f32 v0, v16, v17
  v_accvgpr_write_b32 a0, v0
  s_add_u32 m0, s37, 12160
  s_nop 0
  buffer_load_dwordx4 v252, s[24:27], s36 offen offset:128 nt lds
  s_add_u32 s37, s37, 1024
  s_add_u32 s36, s36, 2048
  v_lshlrev_b32 v16, 16, v1
  v_and_b32 v17, 0xffff0000, v1
  v_pk_mul_f32 v[16:17], v[16:17], s[40:41]
  v_cvt_pk_bf16_f32 v1, v16, v17
  v_accvgpr_write_b32 a1, v1
  v_lshlrev_b32 v16, 16, v2
  v_and_b32 v17, 0xffff0000, v2
  v_pk_mul_f32 v[16:17], v[16:17], s[40:41]
  v_cvt_pk_bf16_f32 v2, v16, v17
  v_accvgpr_write_b32 a2, v2
  s_mov_b32 m0, s37
  s_nop 0
  buffer_load_dwordx4 v252, s[24:27], s36 offen nt lds
  v_lshlrev_b32 v16, 16, v3
  v_and_b32 v17, 0xffff0000, v3
  v_pk_mul_f32 v[16:17], v[16:17], s[40:41]
  v_cvt_pk_bf16_f32 v3, v16, v17
  v_accvgpr_write_b32 a3, v3
  s_add_u32 m0, s37, 12160
  s_nop 0
  buffer_load_dwordx4 v252, s[24:27], s36 offen offset:128 nt lds
  s_add_u32 s37, s37, 1024
  s_add_u32 s36, s36, 2048
  s_waitcnt lgkmcnt(2)
  v_lshlrev_b32 v16, 16, v4
  v_and_b32 v17, 0xffff0000, v4
  v_pk_mul_f32 v[16:17], v[16:17], s[40:41]
  v_cvt_pk_bf16_f32 v4, v16, v17
  v_accvgpr_write_b32 a4, v4
  v_lshlrev_b32 v16, 16, v5
  v_and_b32 v17, 0xffff0000, v5
  v_pk_mul_f32 v[16:17], v[16:17], s[40:41]
  v_cvt_pk_bf16_f32 v5, v16, v17
  v_accvgpr_write_b32 a5, v5
  v_lshlrev_b32 v16, 16, v6
  v_and_b32 v17, 0xffff0000, v6
  v_pk_mul_f32 v[16:17], v[16:17], s[40:41]
  v_cvt_pk_bf16_f32 v6, v16, v17
  v_accvgpr_write_b32 a6, v6
  v_lshlrev_b32 v16, 16, v7
  v_and_b32 v17, 0xffff0000, v7
  v_pk_mul_f32 v[16:17], v[16:17], s[40:41]
  v_cvt_pk_bf16_f32 v7, v16, v17
  v_accvgpr_write_b32 a7, v7
  s_waitcnt lgkmcnt(1)
  v_lshlrev_b32 v16, 16, v8
  v_and_b32 v17, 0xffff0000, v8
  v_pk_mul_f32 v[16:17], v[16:17], s[40:41]
  v_cvt_pk_bf16_f32 v8, v16, v17
  v_accvgpr_write_b32 a8, v8
  v_lshlrev_b32 v16, 16, v9
  v_and_b32 v17, 0xffff0000, v9
  v_pk_mul_f32 v[16:17], v[16:17], s[40:41]
  v_cvt_pk_bf16_f32 v9, v16, v17
  v_accvgpr_write_b32 a9, v9
  v_lshlrev_b32 v16, 16, v10
  v_and_b32 v17, 0xffff0000, v10
  v_pk_mul_f32 v[16:17], v[16:17], s[40:41]
  v_cvt_pk_bf16_f32 v10, v16, v17
  v_accvgpr_write_b32 a10, v10
  v_lshlrev_b32 v16, 16, v11
  v_and_b32 v17, 0xffff0000, v11
  v_pk_mul_f32 v[16:17], v[16:17], s[40:41]
  v_cvt_pk_bf16_f32 v11, v16, v17
  v_accvgpr_write_b32 a11, v11
  s_waitcnt lgkmcnt(0)
  v_lshlrev_b32 v16, 16, v12
  v_and_b32 v17, 0xffff0000, v12
  v_pk_mul_f32 v[16:17], v[16:17], s[40:41]
  v_cvt_pk_bf16_f32 v12, v16, v17
  v_accvgpr_write_b32 a12, v12
  v_lshlrev_b32 v16, 16, v13
  v_and_b32 v17, 0xffff0000, v13
  v_pk_mul_f32 v[16:17], v[16:17], s[40:41]
  v_cvt_pk_bf16_f32 v13, v16, v17
  v_accvgpr_write_b32 a13, v13
  v_lshlrev_b32 v16, 16, v14
  v_and_b32 v17, 0xffff0000, v14
  v_pk_mul_f32 v[16:17], v[16:17], s[40:41]
  v_cvt_pk_bf16_f32 v14, v16, v17
  v_accvgpr_write_b32 a14, v14
  v_lshlrev_b32 v16, 16, v15
  v_and_b32 v17, 0xffff0000, v15
  v_pk_mul_f32 v[16:17], v[16:17], s[40:41]
  v_cvt_pk_bf16_f32 v15, v16, v17
  v_accvgpr_write_b32 a15, v15
  s_waitcnt vmcnt(12)
  s_barrier
  ds_read_b128 a[96:99], v246 offset:0
  ds_read_b128 a[100:103], v247 offset:0
  ds_read_b128 a[104:107], v246 offset:4096
  ds_read_b128 a[108:111], v247 offset:4096
  ds_read_b128 a[112:115], v246 offset:2048
  ds_read_b128 a[116:119], v247 offset:2048
  ds_read_b128 a[120:123], v246 offset:6144
  ds_read_b128 a[124:127], v247 offset:6144
  ds_read_b64_tr_b16 a[160:161], v248 offset:8192
  ds_read_b64_tr_b16 a[162:163], v248 offset:10240
  ds_read_b64_tr_b16 a[164:165], v249 offset:8192
  ds_read_b64_tr_b16 a[166:167], v249 offset:10240
  ds_read_b64_tr_b16 a[168:169], v250 offset:8192
  ds_read_b64_tr_b16 a[170:171], v250 offset:10240
  ds_read_b64_tr_b16 a[172:173], v251 offset:8192
  ds_read_b64_tr_b16 a[174:175], v251 offset:10240
  ds_read_b64_tr_b16 a[176:177], v248 offset:12288
  ds_read_b64_tr_b16 a[178:179], v248 offset:14336
  ds_read_b64_tr_b16 a[180:181], v249 offset:12288
  ds_read_b64_tr_b16 a[182:183], v249 offset:14336
  ds_read_b64_tr_b16 a[184:185], v250 offset:12288
  ds_read_b64_tr_b16 a[186:187], v250 offset:14336
  ds_read_b64_tr_b16 a[188:189], v251 offset:12288
  ds_read_b64_tr_b16 a[190:191], v251 offset:14336
  s_waitcnt lgkmcnt(13)
  v_mfma_f32_16x16x32_bf16 v[216:219], a[96:99], a[0:3], 0
  v_mfma_f32_16x16x32_bf16 v[216:219], a[100:103], a[4:7], v[216:219]
  v_mfma_f32_16x16x32_bf16 v[216:219], a[104:107], a[8:11], v[216:219]
  v_mfma_f32_16x16x32_bf16 v[216:219], a[108:111], a[12:15], v[216:219]
  s_nop 7
  v_max3_f32 v216, v216, v217, v218
  v_max_f32 v216, v216, v219
  v_mov_b32 v217, v216
  s_nop 1
  v_permlane16_swap_b32 v216, v217
  v_max_f32 v216, v216, v217
  v_mov_b32 v217, v216
  s_nop 1
  v_permlane32_swap_b32 v216, v217
  v_min_f32 v219, -v216, -v217
  v_subrev_f32 v216, 0x40a00000, v219
  v_subrev_f32 v217, 0x40a00000, v219
  v_subrev_f32 v218, 0x40a00000, v219
  v_subrev_f32 v219, 0x40a00000, v219
  s_nop 1
  v_mfma_f32_16x16x32_bf16 v[192:195], a[96:99], a[0:3], v[216:219]
  v_mfma_f32_16x16x32_bf16 v[192:195], a[100:103], a[4:7], v[192:195]
  v_mfma_f32_16x16x32_bf16 v[192:195], a[104:107], a[8:11], v[192:195]
  v_mfma_f32_16x16x32_bf16 v[192:195], a[108:111], a[12:15], v[192:195]
  v_mfma_f32_16x16x32_bf16 v[196:199], a[124:127], a[12:15], v[216:219]
  v_mfma_f32_16x16x32_bf16 v[196:199], a[120:123], a[8:11], v[196:199]
  v_mfma_f32_16x16x32_bf16 v[196:199], a[116:119], a[4:7], v[196:199]
  v_mfma_f32_16x16x32_bf16 v[196:199], a[112:115], a[0:3], v[196:199]
  s_nop 3
  v_exp_f32 v192, v192
  v_exp_f32 v193, v193
  s_nop 0
  v_cvt_pk_bf16_f32 v192, v192, v193
  v_exp_f32 v194, v194
  v_exp_f32 v195, v195
  s_nop 0
  v_cvt_pk_bf16_f32 v193, v194, v195
  v_exp_f32 v196, v196
  v_mov_b32 v160, 0
  v_mov_b32 v161, 0
  v_mov_b32 v162, 0
  v_mov_b32 v163, 0
  v_mov_b32 v164, 0
  v_mov_b32 v165, 0
  v_mov_b32 v166, 0
  v_mov_b32 v167, 0
  v_mov_b32 v168, 0
  v_mov_b32 v169, 0
  v_mov_b32 v170, 0
  v_mov_b32 v171, 0
  v_mov_b32 v172, 0
  v_mov_b32 v173, 0
  v_mov_b32 v174, 0
  v_mov_b32 v175, 0
  v_mov_b32 v176, 0
  v_mov_b32 v177, 0
  v_mov_b32 v178, 0
  v_mov_b32 v179, 0
  v_mov_b32 v180, 0
  v_mov_b32 v181, 0
  v_mov_b32 v182, 0
  v_mov_b32 v183, 0
  v_mov_b32 v184, 0
  v_mov_b32 v185, 0
  v_mov_b32 v186, 0
  v_mov_b32 v187, 0
  v_mov_b32 v188, 0
  v_mov_b32 v189, 0
  v_mov_b32 v190, 0
  v_mov_b32 v191, 0
  s_waitcnt vmcnt(8)
  s_barrier
  ds_read_b128 a[128:131], v246 offset:16384
  ds_read_b128 a[132:135], v247 offset:16384
  ds_read_b128 a[136:139], v246 offset:20480
  ds_read_b128 a[140:143], v247 offset:20480
  ds_read_b128 a[144:147], v246 offset:18432
  ds_read_b128 a[148:151], v247 offset:18432
  ds_read_b128 a[152:155], v246 offset:22528
  ds_read_b128 a[156:159], v247 offset:22528
  ds_read_b64_tr_b16 a[192:193], v248 offset:24576
  ds_read_b64_tr_b16 a[194:195], v248 offset:26624
  ds_read_b64_tr_b16 a[196:197], v249 offset:24576
  ds_read_b64_tr_b16 a[198:199], v249 offset:26624
  ds_read_b64_tr_b16 a[200:201], v250 offset:24576
  ds_read_b64_tr_b16 a[202:203], v250 offset:26624
  ds_read_b64_tr_b16 a[204:205], v251 offset:24576
  ds_read_b64_tr_b16 a[206:207], v251 offset:26624
  ds_read_b64_tr_b16 a[208:209], v248 offset:28672
  ds_read_b64_tr_b16 a[210:211], v248 offset:30720
  ds_read_b64_tr_b16 a[212:213], v249 offset:28672
  ds_read_b64_tr_b16 a[214:215], v249 offset:30720
  ds_read_b64_tr_b16 a[216:217], v250 offset:28672
  ds_read_b64_tr_b16 a[218:219], v250 offset:30720
  ds_read_b64_tr_b16 a[220:221], v251 offset:28672
  ds_read_b64_tr_b16 a[222:223], v251 offset:30720
  s_mov_b32 m0, s37
  s_nop 0
  buffer_load_dwordx4 v252, s[24:27], s36 offen nt lds
  s_add_u32 m0, s37, 12160
  s_nop 0
  buffer_load_dwordx4 v252, s[24:27], s36 offen offset:128 nt lds
  s_add_u32 s37, s37, 1024
  s_add_u32 s36, s36, 2048
  s_waitcnt lgkmcnt(13)
  v_mfma_f32_16x16x32_bf16 v[208:211], a[128:131], a[0:3], v[216:219]
  s_mov_b32 m0, s37
  s_nop 0
  buffer_load_dwordx4 v252, s[24:27], s36 offen nt lds
  v_mfma_f32_16x16x32_bf16 v[208:211], a[132:135], a[4:7], v[208:211]
  v_exp_f32 v197, v197
  s_add_u32 m0, s37, 12160
  s_nop 0
  buffer_load_dwordx4 v252, s[24:27], s36 offen offset:128 nt lds
  s_add_u32 s37, s37, 1024
  s_add_u32 s36, s36, 2048
  v_mfma_f32_16x16x32_bf16 v[208:211], a[136:139], a[8:11], v[208:211]
  v_cvt_pk_bf16_f32 v194, v196, v197
  v_mfma_f32_16x16x32_bf16 v[208:211], a[140:143], a[12:15], v[208:211]
  v_exp_f32 v198, v198
  v_mfma_f32_16x16x32_bf16 v[212:215], a[156:159], a[12:15], v[216:219]
  v_mfma_f32_16x16x32_bf16 v[212:215], a[152:155], a[8:11], v[212:215]
  v_exp_f32 v199, v199
  v_mfma_f32_16x16x32_bf16 v[212:215], a[148:151], a[4:7], v[212:215]
  v_cvt_pk_bf16_f32 v195, v198, v199
  v_mfma_f32_16x16x32_bf16 v[212:215], a[144:147], a[0:3], v[212:215]
  s_nop 0
  v_exp_f32 v208, v208
  v_exp_f32 v209, v209
  s_nop 0
  v_cvt_pk_bf16_f32 v196, v208, v209
  v_exp_f32 v210, v210
  v_exp_f32 v211, v211
  s_nop 0
  v_cvt_pk_bf16_f32 v197, v210, v211
  v_exp_f32 v212, v212
  s_waitcnt vmcnt(8)
  ds_read_b128 v[32:35], v244 offset:2048
  ds_read_b128 v[36:39], v245 offset:2048
  ds_read_b128 v[40:43], v244 offset:14336
  ds_read_b128 v[44:47], v245 offset:14336
  s_mov_b32 m0, s37
  s_nop 0
  buffer_load_dwordx4 v252, s[24:27], s36 offen nt lds
  s_waitcnt lgkmcnt(3)
  v_lshlrev_b32 v48, 16, v32
  v_and_b32 v49, 0xffff0000, v32
  v_pk_mul_f32 v[48:49], v[48:49], s[40:41]
  v_cvt_pk_bf16_f32 v32, v48, v49
  v_accvgpr_write_b32 a16, v32
  v_lshlrev_b32 v48, 16, v33
  v_and_b32 v49, 0xffff0000, v33
  v_pk_mul_f32 v[48:49], v[48:49], s[40:41]
  v_cvt_pk_bf16_f32 v33, v48, v49
  v_accvgpr_write_b32 a17, v33
  v_lshlrev_b32 v48, 16, v34
  v_and_b32 v49, 0xffff0000, v34
  v_pk_mul_f32 v[48:49], v[48:49], s[40:41]
  v_cvt_pk_bf16_f32 v34, v48, v49
  v_accvgpr_write_b32 a18, v34
  v_lshlrev_b32 v48, 16, v35
  v_and_b32 v49, 0xffff0000, v35
  v_pk_mul_f32 v[48:49], v[48:49], s[40:41]
  v_cvt_pk_bf16_f32 v35, v48, v49
  v_accvgpr_write_b32 a19, v35
  s_waitcnt lgkmcnt(2)
  v_lshlrev_b32 v48, 16, v36
  v_and_b32 v49, 0xffff0000, v36
  v_pk_mul_f32 v[48:49], v[48:49], s[40:41]
  v_cvt_pk_bf16_f32 v36, v48, v49
  v_accvgpr_write_b32 a20, v36
  s_add_u32 m0, s37, 12160
  s_nop 0
  buffer_load_dwordx4 v252, s[24:27], s36 offen offset:128 nt lds
  s_add_u32 s37, s37, 1024
  s_add_u32 s36, s36, 2048
  v_lshlrev_b32 v48, 16, v37
  v_and_b32 v49, 0xffff0000, v37
  v_pk_mul_f32 v[48:49], v[48:49], s[40:41]
  v_cvt_pk_bf16_f32 v37, v48, v49
  v_accvgpr_write_b32 a21, v37
  v_lshlrev_b32 v48, 16, v38
  v_and_b32 v49, 0xffff0000, v38
  v_pk_mul_f32 v[48:49], v[48:49], s[40:41]
  v_cvt_pk_bf16_f32 v38, v48, v49
  v_accvgpr_write_b32 a22, v38
  v_lshlrev_b32 v48, 16, v39
  v_and_b32 v49, 0xffff0000, v39
  v_pk_mul_f32 v[48:49], v[48:49], s[40:41]
  v_cvt_pk_bf16_f32 v39, v48, v49
  v_accvgpr_write_b32 a23, v39
  s_waitcnt lgkmcnt(1)
  v_lshlrev_b32 v48, 16, v40
  v_and_b32 v49, 0xffff0000, v40
  v_pk_mul_f32 v[48:49], v[48:49], s[40:41]
  v_cvt_pk_bf16_f32 v40, v48, v49
  v_accvgpr_write_b32 a24, v40
  v_lshlrev_b32 v48, 16, v41
  v_and_b32 v49, 0xffff0000, v41
  v_pk_mul_f32 v[48:49], v[48:49], s[40:41]
  v_cvt_pk_bf16_f32 v41, v48, v49
  v_accvgpr_write_b32 a25, v41
  s_mov_b32 m0, s37
  s_nop 0
  buffer_load_dwordx4 v252, s[24:27], s36 offen nt lds
  v_lshlrev_b32 v48, 16, v42
  v_and_b32 v49, 0xffff0000, v42
  v_pk_mul_f32 v[48:49], v[48:49], s[40:41]
  v_cvt_pk_bf16_f32 v42, v48, v49
  v_accvgpr_write_b32 a26, v42
  v_lshlrev_b32 v48, 16, v43
  v_and_b32 v49, 0xffff0000, v43
  v_pk_mul_f32 v[48:49], v[48:49], s[40:41]
  v_cvt_pk_bf16_f32 v43, v48, v49
  v_accvgpr_write_b32 a27, v43
  s_waitcnt lgkmcnt(0)
  v_lshlrev_b32 v48, 16, v44
  v_and_b32 v49, 0xffff0000, v44
  v_pk_mul_f32 v[48:49], v[48:49], s[40:41]
  v_cvt_pk_bf16_f32 v44, v48, v49
  v_accvgpr_write_b32 a28, v44
  v_lshlrev_b32 v48, 16, v45
  v_and_b32 v49, 0xffff0000, v45
  v_pk_mul_f32 v[48:49], v[48:49], s[40:41]
  v_cvt_pk_bf16_f32 v45, v48, v49
  v_accvgpr_write_b32 a29, v45
  v_lshlrev_b32 v48, 16, v46
  v_and_b32 v49, 0xffff0000, v46
  v_pk_mul_f32 v[48:49], v[48:49], s[40:41]
  v_cvt_pk_bf16_f32 v46, v48, v49
  v_accvgpr_write_b32 a30, v46
  s_add_u32 m0, s37, 12160
  s_nop 0
  buffer_load_dwordx4 v252, s[24:27], s36 offen offset:128 nt lds
  s_add_u32 s37, s37, 1024
  s_add_u32 s36, s36, 2048
  v_lshlrev_b32 v48, 16, v47
  v_and_b32 v49, 0xffff0000, v47
  v_pk_mul_f32 v[48:49], v[48:49], s[40:41]
  v_cvt_pk_bf16_f32 v47, v48, v49
  v_accvgpr_write_b32 a31, v47
  v_mfma_f32_16x16x32_bf16 v[220:223], a[96:99], a[16:19], 0
  v_mfma_f32_16x16x32_bf16 v[220:223], a[100:103], a[20:23], v[220:223]
  v_mfma_f32_16x16x32_bf16 v[220:223], a[104:107], a[24:27], v[220:223]
  v_mfma_f32_16x16x32_bf16 v[220:223], a[108:111], a[28:31], v[220:223]
  s_nop 7
  v_max3_f32 v220, v220, v221, v222
  v_max_f32 v220, v220, v223
  v_mov_b32 v221, v220
  s_nop 1
  v_permlane16_swap_b32 v220, v221
  v_max_f32 v220, v220, v221
  v_mov_b32 v221, v220
  s_nop 1
  v_permlane32_swap_b32 v220, v221
  v_min_f32 v223, -v220, -v221
  v_subrev_f32 v220, 0x40a00000, v223
  v_subrev_f32 v221, 0x40a00000, v223
  v_subrev_f32 v222, 0x40a00000, v223
  v_subrev_f32 v223, 0x40a00000, v223
  s_nop 1
  v_mfma_f32_16x16x32_bf16 v[200:203], a[96:99], a[16:19], v[220:223]
  v_mfma_f32_16x16x32_bf16 v[200:203], a[100:103], a[20:23], v[200:203]
  v_exp_f32 v213, v213
  v_mfma_f32_16x16x32_bf16 v[200:203], a[104:107], a[24:27], v[200:203]
  v_cvt_pk_bf16_f32 v198, v212, v213
  v_mfma_f32_16x16x32_bf16 v[200:203], a[108:111], a[28:31], v[200:203]
  v_exp_f32 v214, v214
  v_mfma_f32_16x16x32_bf16 v[204:207], a[124:127], a[28:31], v[220:223]
  v_mfma_f32_16x16x32_bf16 v[204:207], a[120:123], a[24:27], v[204:207]
  v_exp_f32 v215, v215
  v_mfma_f32_16x16x32_bf16 v[204:207], a[116:119], a[20:23], v[204:207]
  v_cvt_pk_bf16_f32 v199, v214, v215
  v_mfma_f32_16x16x32_bf16 v[204:207], a[112:115], a[16:19], v[204:207]
  s_nop 0
  v_exp_f32 v200, v200
  v_smfmac_f32_16x16x64_bf16 a[236:239], a[228:231], v[192:199], v253
  v_mfma_f32_16x16x32_bf16 v[0:3], v[192:195], a[160:163], 0
  v_mfma_f32_16x16x32_bf16 v[0:3], v[196:199], a[192:195], v[0:3]
  v_exp_f32 v201, v201
  v_mfma_f32_16x16x32_bf16 v[4:7], v[196:199], a[196:199], 0
  v_cvt_pk_bf16_f32 v200, v200, v201
  v_mfma_f32_16x16x32_bf16 v[4:7], v[192:195], a[164:167], v[4:7]
  v_exp_f32 v202, v202
  v_mfma_f32_16x16x32_bf16 v[8:11], v[192:195], a[168:171], 0
  v_mfma_f32_16x16x32_bf16 v[8:11], v[196:199], a[200:203], v[8:11]
  v_exp_f32 v203, v203
  v_mfma_f32_16x16x32_bf16 v[12:15], v[196:199], a[204:207], 0
  v_cvt_pk_bf16_f32 v201, v202, v203
  v_mfma_f32_16x16x32_bf16 v[12:15], v[192:195], a[172:175], v[12:15]
  v_exp_f32 v204, v204
  v_mfma_f32_16x16x32_bf16 v[208:211], a[128:131], a[16:19], v[220:223]
  v_mfma_f32_16x16x32_bf16 v[208:211], a[132:135], a[20:23], v[208:211]
  v_exp_f32 v205, v205
  v_mfma_f32_16x16x32_bf16 v[208:211], a[136:139], a[24:27], v[208:211]
  v_cvt_pk_bf16_f32 v202, v204, v205
  v_mfma_f32_16x16x32_bf16 v[208:211], a[140:143], a[28:31], v[208:211]
  v_exp_f32 v206, v206
  v_mfma_f32_16x16x32_bf16 v[212:215], a[156:159], a[28:31], v[220:223]
  v_mfma_f32_16x16x32_bf16 v[212:215], a[152:155], a[24:27], v[212:215]
  v_exp_f32 v207, v207
  v_mfma_f32_16x16x32_bf16 v[212:215], a[148:151], a[20:23], v[212:215]
  v_cvt_pk_bf16_f32 v203, v206, v207
  v_mfma_f32_16x16x32_bf16 v[212:215], a[144:147], a[16:19], v[212:215]
  s_nop 0
  v_exp_f32 v208, v208
  v_mfma_f32_16x16x32_bf16 v[16:19], v[192:195], a[176:179], 0
  v_mfma_f32_16x16x32_bf16 v[16:19], v[196:199], a[208:211], v[16:19]
  v_exp_f32 v209, v209
  v_mfma_f32_16x16x32_bf16 v[20:23], v[196:199], a[212:215], 0
  v_cvt_pk_bf16_f32 v204, v208, v209
  v_mfma_f32_16x16x32_bf16 v[20:23], v[192:195], a[180:183], v[20:23]
  v_exp_f32 v210, v210
  v_mfma_f32_16x16x32_bf16 v[24:27], v[192:195], a[184:187], 0
  v_mfma_f32_16x16x32_bf16 v[24:27], v[196:199], a[216:219], v[24:27]
  v_exp_f32 v211, v211
  v_mfma_f32_16x16x32_bf16 v[28:31], v[196:199], a[220:223], 0
  v_cvt_pk_bf16_f32 v205, v210, v211
  v_mfma_f32_16x16x32_bf16 v[28:31], v[192:195], a[188:191], v[28:31]
  v_exp_f32 v212, v212
  s_waitcnt vmcnt(8)
  ds_read_b128 v[64:67], v244 offset:4096
  ds_read_b128 v[68:71], v245 offset:4096
  ds_read_b128 v[72:75], v244 offset:16384
  ds_read_b128 v[76:79], v245 offset:16384
  s_and_b32 s45, s35, 24576
  s_sub_u32 s36, s36, s45
  s_waitcnt lgkmcnt(3)
  v_lshlrev_b32 v80, 16, v64
  v_and_b32 v81, 0xffff0000, v64
  v_pk_mul_f32 v[80:81], v[80:81], s[40:41]
  v_cvt_pk_bf16_f32 v64, v80, v81
  v_accvgpr_write_b32 a32, v64
  v_lshlrev_b32 v80, 16, v65
  v_and_b32 v81, 0xffff0000, v65
  v_pk_mul_f32 v[80:81], v[80:81], s[40:41]
  v_cvt_pk_bf16_f32 v65, v80, v81
  v_accvgpr_write_b32 a33, v65
  v_lshlrev_b32 v80, 16, v66
  v_and_b32 v81, 0xffff0000, v66
  v_pk_mul_f32 v[80:81], v[80:81], s[40:41]
  v_cvt_pk_bf16_f32 v66, v80, v81
  v_accvgpr_write_b32 a34, v66
  v_lshlrev_b32 v80, 16, v67
  v_and_b32 v81, 0xffff0000, v67
  v_pk_mul_f32 v[80:81], v[80:81], s[40:41]
  v_cvt_pk_bf16_f32 v67, v80, v81
  v_accvgpr_write_b32 a35, v67
  s_mov_b32 m0, s37
  s_nop 0
  buffer_load_dwordx4 v252, s[24:27], s36 offen nt lds
  s_waitcnt lgkmcnt(2)
  v_lshlrev_b32 v80, 16, v68
  v_and_b32 v81, 0xffff0000, v68
  v_pk_mul_f32 v[80:81], v[80:81], s[40:41]
  v_cvt_pk_bf16_f32 v68, v80, v81
  v_accvgpr_write_b32 a36, v68
  v_lshlrev_b32 v80, 16, v69
  v_and_b32 v81, 0xffff0000, v69
  v_pk_mul_f32 v[80:81], v[80:81], s[40:41]
  v_cvt_pk_bf16_f32 v69, v80, v81
  v_accvgpr_write_b32 a37, v69
  v_lshlrev_b32 v80, 16, v70
  v_and_b32 v81, 0xffff0000, v70
  v_pk_mul_f32 v[80:81], v[80:81], s[40:41]
  v_cvt_pk_bf16_f32 v70, v80, v81
  v_accvgpr_write_b32 a38, v70
  v_lshlrev_b32 v80, 16, v71
  v_and_b32 v81, 0xffff0000, v71
  v_pk_mul_f32 v[80:81], v[80:81], s[40:41]
  v_cvt_pk_bf16_f32 v71, v80, v81
  v_accvgpr_write_b32 a39, v71
  s_add_u32 m0, s37, 12160
  s_nop 0
  buffer_load_dwordx4 v252, s[24:27], s36 offen offset:128 nt lds
  s_add_u32 s37, s37, 1024
  s_add_u32 s36, s36, 2048
  s_waitcnt lgkmcnt(1)
  v_lshlrev_b32 v80, 16, v72
  v_and_b32 v81, 0xffff0000, v72
  v_pk_mul_f32 v[80:81], v[80:81], s[40:41]
  v_cvt_pk_bf16_f32 v72, v80, v81
  v_accvgpr_write_b32 a40, v72
  v_lshlrev_b32 v80, 16, v73
  v_and_b32 v81, 0xffff0000, v73
  v_pk_mul_f32 v[80:81], v[80:81], s[40:41]
  v_cvt_pk_bf16_f32 v73, v80, v81
  v_accvgpr_write_b32 a41, v73
  v_lshlrev_b32 v80, 16, v74
  v_and_b32 v81, 0xffff0000, v74
  v_pk_mul_f32 v[80:81], v[80:81], s[40:41]
  v_cvt_pk_bf16_f32 v74, v80, v81
  v_accvgpr_write_b32 a42, v74
  v_lshlrev_b32 v80, 16, v75
  v_and_b32 v81, 0xffff0000, v75
  v_pk_mul_f32 v[80:81], v[80:81], s[40:41]
  v_cvt_pk_bf16_f32 v75, v80, v81
  v_accvgpr_write_b32 a43, v75
  s_mov_b32 m0, s37
  s_nop 0
  buffer_load_dwordx4 v252, s[24:27], s36 offen nt lds
  s_waitcnt lgkmcnt(0)
  v_lshlrev_b32 v80, 16, v76
  v_and_b32 v81, 0xffff0000, v76
  v_pk_mul_f32 v[80:81], v[80:81], s[40:41]
  v_cvt_pk_bf16_f32 v76, v80, v81
  v_accvgpr_write_b32 a44, v76
  v_lshlrev_b32 v80, 16, v77
  v_and_b32 v81, 0xffff0000, v77
  v_pk_mul_f32 v[80:81], v[80:81], s[40:41]
  v_cvt_pk_bf16_f32 v77, v80, v81
  v_accvgpr_write_b32 a45, v77
  v_lshlrev_b32 v80, 16, v78
  v_and_b32 v81, 0xffff0000, v78
  v_pk_mul_f32 v[80:81], v[80:81], s[40:41]
  v_cvt_pk_bf16_f32 v78, v80, v81
  v_accvgpr_write_b32 a46, v78
  v_lshlrev_b32 v80, 16, v79
  v_and_b32 v81, 0xffff0000, v79
  v_pk_mul_f32 v[80:81], v[80:81], s[40:41]
  v_cvt_pk_bf16_f32 v79, v80, v81
  v_accvgpr_write_b32 a47, v79
  s_add_u32 m0, s37, 12160
  s_nop 0
  buffer_load_dwordx4 v252, s[24:27], s36 offen offset:128 nt lds
  s_add_u32 s37, s37, 1024
  s_add_u32 s36, s36, 2048
  v_mfma_f32_16x16x32_bf16 v[224:227], a[96:99], a[32:35], 0
  v_mfma_f32_16x16x32_bf16 v[224:227], a[100:103], a[36:39], v[224:227]
  v_mfma_f32_16x16x32_bf16 v[224:227], a[104:107], a[40:43], v[224:227]
  v_mfma_f32_16x16x32_bf16 v[224:227], a[108:111], a[44:47], v[224:227]
  s_nop 7
  v_max3_f32 v224, v224, v225, v226
  v_max_f32 v224, v224, v227
  v_mov_b32 v225, v224
  s_nop 1
  v_permlane16_swap_b32 v224, v225
  v_max_f32 v224, v224, v225
  v_mov_b32 v225, v224
  s_nop 1
  v_permlane32_swap_b32 v224, v225
  v_min_f32 v227, -v224, -v225
  v_subrev_f32 v224, 0x40a00000, v227
  v_subrev_f32 v225, 0x40a00000, v227
  v_subrev_f32 v226, 0x40a00000, v227
  v_subrev_f32 v227, 0x40a00000, v227
  s_nop 1
  v_mfma_f32_16x16x32_bf16 v[192:195], a[96:99], a[32:35], v[224:227]
  v_mfma_f32_16x16x32_bf16 v[192:195], a[100:103], a[36:39], v[192:195]
  v_exp_f32 v213, v213
  v_mfma_f32_16x16x32_bf16 v[192:195], a[104:107], a[40:43], v[192:195]
  v_cvt_pk_bf16_f32 v206, v212, v213
  v_mfma_f32_16x16x32_bf16 v[192:195], a[108:111], a[44:47], v[192:195]
  v_exp_f32 v214, v214
  v_mfma_f32_16x16x32_bf16 v[196:199], a[124:127], a[44:47], v[224:227]
  v_mfma_f32_16x16x32_bf16 v[196:199], a[120:123], a[40:43], v[196:199]
  v_exp_f32 v215, v215
  v_mfma_f32_16x16x32_bf16 v[196:199], a[116:119], a[36:39], v[196:199]
  v_cvt_pk_bf16_f32 v207, v214, v215
  v_mfma_f32_16x16x32_bf16 v[196:199], a[112:115], a[32:35], v[196:199]
  s_nop 0
  v_exp_f32 v192, v192
  v_smfmac_f32_16x16x64_bf16 a[236:239], a[232:235], v[200:207], v253
  v_mfma_f32_16x16x32_bf16 v[32:35], v[200:203], a[160:163], 0
  v_mfma_f32_16x16x32_bf16 v[32:35], v[204:207], a[192:195], v[32:35]
  v_exp_f32 v193, v193
  v_mfma_f32_16x16x32_bf16 v[36:39], v[204:207], a[196:199], 0
  v_cvt_pk_bf16_f32 v192, v192, v193
  v_mfma_f32_16x16x32_bf16 v[36:39], v[200:203], a[164:167], v[36:39]
  v_exp_f32 v194, v194
  v_mfma_f32_16x16x32_bf16 v[40:43], v[200:203], a[168:171], 0
  v_mfma_f32_16x16x32_bf16 v[40:43], v[204:207], a[200:203], v[40:43]
  v_exp_f32 v195, v195
  v_mfma_f32_16x16x32_bf16 v[44:47], v[204:207], a[204:207], 0
  v_cvt_pk_bf16_f32 v193, v194, v195
  v_mfma_f32_16x16x32_bf16 v[44:47], v[200:203], a[172:175], v[44:47]
  v_exp_f32 v196, v196
  v_mfma_f32_16x16x32_bf16 v[208:211], a[128:131], a[32:35], v[224:227]
  v_mfma_f32_16x16x32_bf16 v[208:211], a[132:135], a[36:39], v[208:211]
  v_exp_f32 v197, v197
  v_mfma_f32_16x16x32_bf16 v[208:211], a[136:139], a[40:43], v[208:211]
  v_cvt_pk_bf16_f32 v194, v196, v197
  v_mfma_f32_16x16x32_bf16 v[208:211], a[140:143], a[44:47], v[208:211]
  v_exp_f32 v198, v198
  v_mfma_f32_16x16x32_bf16 v[212:215], a[156:159], a[44:47], v[224:227]
  v_mfma_f32_16x16x32_bf16 v[212:215], a[152:155], a[40:43], v[212:215]
  v_exp_f32 v199, v199
  v_mfma_f32_16x16x32_bf16 v[212:215], a[148:151], a[36:39], v[212:215]
  v_cvt_pk_bf16_f32 v195, v198, v199
  v_mfma_f32_16x16x32_bf16 v[212:215], a[144:147], a[32:35], v[212:215]
  s_nop 0
  v_exp_f32 v208, v208
  v_mfma_f32_16x16x32_bf16 v[48:51], v[200:203], a[176:179], 0
  v_mfma_f32_16x16x32_bf16 v[48:51], v[204:207], a[208:211], v[48:51]
  v_exp_f32 v209, v209
  v_mfma_f32_16x16x32_bf16 v[52:55], v[204:207], a[212:215], 0
  v_cvt_pk_bf16_f32 v196, v208, v209
  v_mfma_f32_16x16x32_bf16 v[52:55], v[200:203], a[180:183], v[52:55]
  v_exp_f32 v210, v210
  v_mfma_f32_16x16x32_bf16 v[56:59], v[200:203], a[184:187], 0
  v_mfma_f32_16x16x32_bf16 v[56:59], v[204:207], a[216:219], v[56:59]
  v_exp_f32 v211, v211
  v_mfma_f32_16x16x32_bf16 v[60:63], v[204:207], a[220:223], 0
  v_cvt_pk_bf16_f32 v197, v210, v211
  v_mfma_f32_16x16x32_bf16 v[60:63], v[200:203], a[188:191], v[60:63]
  v_exp_f32 v212, v212
  s_waitcnt vmcnt(8)
  ds_read_b128 v[96:99], v244 offset:6144
  ds_read_b128 v[100:103], v245 offset:6144
  ds_read_b128 v[104:107], v244 offset:18432
  ds_read_b128 v[108:111], v245 offset:18432
  s_add_u32 m0, s38, 32768
  s_nop 0
  buffer_load_dwordx4 v252, s[16:19], s33 offen nt lds
  s_waitcnt lgkmcnt(3)
  v_lshlrev_b32 v112, 16, v96
  v_and_b32 v113, 0xffff0000, v96
  v_pk_mul_f32 v[112:113], v[112:113], s[40:41]
  v_cvt_pk_bf16_f32 v96, v112, v113
  v_accvgpr_write_b32 a48, v96
  v_lshlrev_b32 v112, 16, v97
  v_and_b32 v113, 0xffff0000, v97
  v_pk_mul_f32 v[112:113], v[112:113], s[40:41]
  v_cvt_pk_bf16_f32 v97, v112, v113
  v_accvgpr_write_b32 a49, v97
  v_lshlrev_b32 v112, 16, v98
  v_and_b32 v113, 0xffff0000, v98
  v_pk_mul_f32 v[112:113], v[112:113], s[40:41]
  v_cvt_pk_bf16_f32 v98, v112, v113
  v_accvgpr_write_b32 a50, v98
  v_lshlrev_b32 v112, 16, v99
  v_and_b32 v113, 0xffff0000, v99
  v_pk_mul_f32 v[112:113], v[112:113], s[40:41]
  v_cvt_pk_bf16_f32 v99, v112, v113
  v_accvgpr_write_b32 a51, v99
  s_waitcnt lgkmcnt(2)
  v_lshlrev_b32 v112, 16, v100
  v_and_b32 v113, 0xffff0000, v100
  v_pk_mul_f32 v[112:113], v[112:113], s[40:41]
  v_cvt_pk_bf16_f32 v100, v112, v113
  v_accvgpr_write_b32 a52, v100
  s_add_u32 m0, s38, 36736
  s_nop 0
  buffer_load_dwordx4 v252, s[16:19], s33 offen offset:128 nt lds
  v_lshlrev_b32 v112, 16, v101
  v_and_b32 v113, 0xffff0000, v101
  v_pk_mul_f32 v[112:113], v[112:113], s[40:41]
  v_cvt_pk_bf16_f32 v101, v112, v113
  v_accvgpr_write_b32 a53, v101
  v_lshlrev_b32 v112, 16, v102
  v_and_b32 v113, 0xffff0000, v102
  v_pk_mul_f32 v[112:113], v[112:113], s[40:41]
  v_cvt_pk_bf16_f32 v102, v112, v113
  v_accvgpr_write_b32 a54, v102
  v_lshlrev_b32 v112, 16, v103
  v_and_b32 v113, 0xffff0000, v103
  v_pk_mul_f32 v[112:113], v[112:113], s[40:41]
  v_cvt_pk_bf16_f32 v103, v112, v113
  v_accvgpr_write_b32 a55, v103
  s_waitcnt lgkmcnt(1)
  v_lshlrev_b32 v112, 16, v104
  v_and_b32 v113, 0xffff0000, v104
  v_pk_mul_f32 v[112:113], v[112:113], s[40:41]
  v_cvt_pk_bf16_f32 v104, v112, v113
  v_accvgpr_write_b32 a56, v104
  v_lshlrev_b32 v112, 16, v105
  v_and_b32 v113, 0xffff0000, v105
  v_pk_mul_f32 v[112:113], v[112:113], s[40:41]
  v_cvt_pk_bf16_f32 v105, v112, v113
  v_accvgpr_write_b32 a57, v105
  s_add_u32 m0, s38, 40960
  s_nop 0
  buffer_load_dwordx4 v252, s[20:23], s33 offen nt lds
  v_lshlrev_b32 v112, 16, v106
  v_and_b32 v113, 0xffff0000, v106
  v_pk_mul_f32 v[112:113], v[112:113], s[40:41]
  v_cvt_pk_bf16_f32 v106, v112, v113
  v_accvgpr_write_b32 a58, v106
  v_lshlrev_b32 v112, 16, v107
  v_and_b32 v113, 0xffff0000, v107
  v_pk_mul_f32 v[112:113], v[112:113], s[40:41]
  v_cvt_pk_bf16_f32 v107, v112, v113
  v_accvgpr_write_b32 a59, v107
  s_waitcnt lgkmcnt(0)
  v_lshlrev_b32 v112, 16, v108
  v_and_b32 v113, 0xffff0000, v108
  v_pk_mul_f32 v[112:113], v[112:113], s[40:41]
  v_cvt_pk_bf16_f32 v108, v112, v113
  v_accvgpr_write_b32 a60, v108
  v_lshlrev_b32 v112, 16, v109
  v_and_b32 v113, 0xffff0000, v109
  v_pk_mul_f32 v[112:113], v[112:113], s[40:41]
  v_cvt_pk_bf16_f32 v109, v112, v113
  v_accvgpr_write_b32 a61, v109
  v_lshlrev_b32 v112, 16, v110
  v_and_b32 v113, 0xffff0000, v110
  v_pk_mul_f32 v[112:113], v[112:113], s[40:41]
  v_cvt_pk_bf16_f32 v110, v112, v113
  v_accvgpr_write_b32 a62, v110
  s_add_u32 m0, s38, 44928
  s_nop 0
  buffer_load_dwordx4 v252, s[20:23], s33 offen offset:128 nt lds
  s_add_u32 s34, s34, 1
  s_add_u32 s33, s33, 8192
  v_lshlrev_b32 v112, 16, v111
  v_and_b32 v113, 0xffff0000, v111
  v_pk_mul_f32 v[112:113], v[112:113], s[40:41]
  v_cvt_pk_bf16_f32 v111, v112, v113
  v_accvgpr_write_b32 a63, v111
  v_mfma_f32_16x16x32_bf16 v[228:231], a[96:99], a[48:51], 0
  v_mfma_f32_16x16x32_bf16 v[228:231], a[100:103], a[52:55], v[228:231]
  v_mfma_f32_16x16x32_bf16 v[228:231], a[104:107], a[56:59], v[228:231]
  v_mfma_f32_16x16x32_bf16 v[228:231], a[108:111], a[60:63], v[228:231]
  s_nop 7
  v_max3_f32 v228, v228, v229, v230
  v_max_f32 v228, v228, v231
  v_mov_b32 v229, v228
  s_nop 1
  v_permlane16_swap_b32 v228, v229
  v_max_f32 v228, v228, v229
  v_mov_b32 v229, v228
  s_nop 1
  v_permlane32_swap_b32 v228, v229
  v_min_f32 v231, -v228, -v229
  v_subrev_f32 v228, 0x40a00000, v231
  v_subrev_f32 v229, 0x40a00000, v231
  v_subrev_f32 v230, 0x40a00000, v231
  v_subrev_f32 v231, 0x40a00000, v231
  s_nop 1
  v_mfma_f32_16x16x32_bf16 v[200:203], a[96:99], a[48:51], v[228:231]
  v_mfma_f32_16x16x32_bf16 v[200:203], a[100:103], a[52:55], v[200:203]
  v_exp_f32 v213, v213
  v_mfma_f32_16x16x32_bf16 v[200:203], a[104:107], a[56:59], v[200:203]
  v_cvt_pk_bf16_f32 v198, v212, v213
  v_mfma_f32_16x16x32_bf16 v[200:203], a[108:111], a[60:63], v[200:203]
  v_exp_f32 v214, v214
  v_mfma_f32_16x16x32_bf16 v[204:207], a[124:127], a[60:63], v[228:231]
  v_mfma_f32_16x16x32_bf16 v[204:207], a[120:123], a[56:59], v[204:207]
  v_exp_f32 v215, v215
  v_mfma_f32_16x16x32_bf16 v[204:207], a[116:119], a[52:55], v[204:207]
  v_cvt_pk_bf16_f32 v199, v214, v215
  v_mfma_f32_16x16x32_bf16 v[204:207], a[112:115], a[48:51], v[204:207]
  s_nop 0
  v_exp_f32 v200, v200
  v_smfmac_f32_16x16x64_bf16 a[240:243], a[228:231], v[192:199], v253
  v_mfma_f32_16x16x32_bf16 v[64:67], v[192:195], a[160:163], 0
  v_mfma_f32_16x16x32_bf16 v[64:67], v[196:199], a[192:195], v[64:67]
  v_exp_f32 v201, v201
  v_mfma_f32_16x16x32_bf16 v[68:71], v[196:199], a[196:199], 0
  v_cvt_pk_bf16_f32 v200, v200, v201
  v_mfma_f32_16x16x32_bf16 v[68:71], v[192:195], a[164:167], v[68:71]
  v_exp_f32 v202, v202
  v_mfma_f32_16x16x32_bf16 v[72:75], v[192:195], a[168:171], 0
  v_mfma_f32_16x16x32_bf16 v[72:75], v[196:199], a[200:203], v[72:75]
  v_exp_f32 v203, v203
  v_mfma_f32_16x16x32_bf16 v[76:79], v[196:199], a[204:207], 0
  v_cvt_pk_bf16_f32 v201, v202, v203
  v_mfma_f32_16x16x32_bf16 v[76:79], v[192:195], a[172:175], v[76:79]
  v_exp_f32 v204, v204
  v_mfma_f32_16x16x32_bf16 v[208:211], a[128:131], a[48:51], v[228:231]
  v_mfma_f32_16x16x32_bf16 v[208:211], a[132:135], a[52:55], v[208:211]
  v_exp_f32 v205, v205
  v_mfma_f32_16x16x32_bf16 v[208:211], a[136:139], a[56:59], v[208:211]
  v_cvt_pk_bf16_f32 v202, v204, v205
  v_mfma_f32_16x16x32_bf16 v[208:211], a[140:143], a[60:63], v[208:211]
  v_exp_f32 v206, v206
  v_mfma_f32_16x16x32_bf16 v[212:215], a[156:159], a[60:63], v[228:231]
  v_mfma_f32_16x16x32_bf16 v[212:215], a[152:155], a[56:59], v[212:215]
  v_exp_f32 v207, v207
  v_mfma_f32_16x16x32_bf16 v[212:215], a[148:151], a[52:55], v[212:215]
  v_cvt_pk_bf16_f32 v203, v206, v207
  v_mfma_f32_16x16x32_bf16 v[212:215], a[144:147], a[48:51], v[212:215]
  s_nop 0
  v_exp_f32 v208, v208
  v_mfma_f32_16x16x32_bf16 v[80:83], v[192:195], a[176:179], 0
  v_mfma_f32_16x16x32_bf16 v[80:83], v[196:199], a[208:211], v[80:83]
  v_exp_f32 v209, v209
  v_mfma_f32_16x16x32_bf16 v[84:87], v[196:199], a[212:215], 0
  v_cvt_pk_bf16_f32 v204, v208, v209
  v_mfma_f32_16x16x32_bf16 v[84:87], v[192:195], a[180:183], v[84:87]
  v_exp_f32 v210, v210
  v_mfma_f32_16x16x32_bf16 v[88:91], v[192:195], a[184:187], 0
  v_mfma_f32_16x16x32_bf16 v[88:91], v[196:199], a[216:219], v[88:91]
  v_exp_f32 v211, v211
  v_mfma_f32_16x16x32_bf16 v[92:95], v[196:199], a[220:223], 0
  v_cvt_pk_bf16_f32 v205, v210, v211
  v_mfma_f32_16x16x32_bf16 v[92:95], v[192:195], a[188:191], v[92:95]
  v_exp_f32 v212, v212
  s_waitcnt vmcnt(8)
  ds_read_b128 v[128:131], v244 offset:8192
  ds_read_b128 v[132:135], v245 offset:8192
  ds_read_b128 v[136:139], v244 offset:20480
  ds_read_b128 v[140:143], v245 offset:20480
  s_barrier
  s_add_u32 s24, s4, s58
  s_addc_u32 s25, s5, 0
  s_lshl_b32 s45, s32, 3
  s_sub_u32 s45, s59, s45
  s_lshl_b32 s36, s45, 8
  s_mov_b32 s37, s49
  s_mov_b32 m0, s37
  s_nop 0
  buffer_load_dwordx4 v252, s[24:27], s36 offen nt lds
  s_waitcnt lgkmcnt(3)
  v_lshlrev_b32 v144, 16, v128
  v_and_b32 v145, 0xffff0000, v128
  v_pk_mul_f32 v[144:145], v[144:145], s[40:41]
  v_cvt_pk_bf16_f32 v128, v144, v145
  v_accvgpr_write_b32 a64, v128
  v_lshlrev_b32 v144, 16, v129
  v_and_b32 v145, 0xffff0000, v129
  v_pk_mul_f32 v[144:145], v[144:145], s[40:41]
  v_cvt_pk_bf16_f32 v129, v144, v145
  v_accvgpr_write_b32 a65, v129
  v_lshlrev_b32 v144, 16, v130
  v_and_b32 v145, 0xffff0000, v130
  v_pk_mul_f32 v[144:145], v[144:145], s[40:41]
  v_cvt_pk_bf16_f32 v130, v144, v145
  v_accvgpr_write_b32 a66, v130
  s_add_u32 m0, s37, 12160
  s_nop 0
  buffer_load_dwordx4 v252, s[24:27], s36 offen offset:128 nt lds
  s_add_u32 s37, s37, 1024
  s_add_u32 s36, s36, 2048
  v_lshlrev_b32 v144, 16, v131
  v_and_b32 v145, 0xffff0000, v131
  v_pk_mul_f32 v[144:145], v[144:145], s[40:41]
  v_cvt_pk_bf16_f32 v131, v144, v145
  v_accvgpr_write_b32 a67, v131
  s_waitcnt lgkmcnt(2)
  v_lshlrev_b32 v144, 16, v132
  v_and_b32 v145, 0xffff0000, v132
  v_pk_mul_f32 v[144:145], v[144:145], s[40:41]
  v_cvt_pk_bf16_f32 v132, v144, v145
  v_accvgpr_write_b32 a68, v132
  v_lshlrev_b32 v144, 16, v133
  v_and_b32 v145, 0xffff0000, v133
  v_pk_mul_f32 v[144:145], v[144:145], s[40:41]
  v_cvt_pk_bf16_f32 v133, v144, v145
  v_accvgpr_write_b32 a69, v133
  s_add_u32 m0, s38, 49152
  s_nop 0
  buffer_load_dwordx4 v252, s[16:19], s33 offen nt lds
  v_lshlrev_b32 v144, 16, v134
  v_and_b32 v145, 0xffff0000, v134
  v_pk_mul_f32 v[144:145], v[144:145], s[40:41]
  v_cvt_pk_bf16_f32 v134, v144, v145
  v_accvgpr_write_b32 a70, v134
  v_lshlrev_b32 v144, 16, v135
  v_and_b32 v145, 0xffff0000, v135
  v_pk_mul_f32 v[144:145], v[144:145], s[40:41]
  v_cvt_pk_bf16_f32 v135, v144, v145
  v_accvgpr_write_b32 a71, v135
  s_waitcnt lgkmcnt(1)
  v_lshlrev_b32 v144, 16, v136
  v_and_b32 v145, 0xffff0000, v136
  v_pk_mul_f32 v[144:145], v[144:145], s[40:41]
  v_cvt_pk_bf16_f32 v136, v144, v145
  v_accvgpr_write_b32 a72, v136
  v_lshlrev_b32 v144, 16, v137
  v_and_b32 v145, 0xffff0000, v137
  v_pk_mul_f32 v[144:145], v[144:145], s[40:41]
  v_cvt_pk_bf16_f32 v137, v144, v145
  v_accvgpr_write_b32 a73, v137
  s_add_u32 m0, s38, 53120
  s_nop 0
  buffer_load_dwordx4 v252, s[16:19], s33 offen offset:128 nt lds
  v_lshlrev_b32 v144, 16, v138
  v_and_b32 v145, 0xffff0000, v138
  v_pk_mul_f32 v[144:145], v[144:145], s[40:41]
  v_cvt_pk_bf16_f32 v138, v144, v145
  v_accvgpr_write_b32 a74, v138
  v_lshlrev_b32 v144, 16, v139
  v_and_b32 v145, 0xffff0000, v139
  v_pk_mul_f32 v[144:145], v[144:145], s[40:41]
  v_cvt_pk_bf16_f32 v139, v144, v145
  v_accvgpr_write_b32 a75, v139
  s_waitcnt lgkmcnt(0)
  v_lshlrev_b32 v144, 16, v140
  v_and_b32 v145, 0xffff0000, v140
  v_pk_mul_f32 v[144:145], v[144:145], s[40:41]
  v_cvt_pk_bf16_f32 v140, v144, v145
  v_accvgpr_write_b32 a76, v140
  s_add_u32 m0, s38, 57344
  s_nop 0
  buffer_load_dwordx4 v252, s[20:23], s33 offen nt lds
  v_lshlrev_b32 v144, 16, v141
  v_and_b32 v145, 0xffff0000, v141
  v_pk_mul_f32 v[144:145], v[144:145], s[40:41]
  v_cvt_pk_bf16_f32 v141, v144, v145
  v_accvgpr_write_b32 a77, v141
  v_lshlrev_b32 v144, 16, v142
  v_and_b32 v145, 0xffff0000, v142
  v_pk_mul_f32 v[144:145], v[144:145], s[40:41]
  v_cvt_pk_bf16_f32 v142, v144, v145
  v_accvgpr_write_b32 a78, v142
  v_lshlrev_b32 v144, 16, v143
  v_and_b32 v145, 0xffff0000, v143
  v_pk_mul_f32 v[144:145], v[144:145], s[40:41]
  v_cvt_pk_bf16_f32 v143, v144, v145
  v_accvgpr_write_b32 a79, v143
  v_mfma_f32_16x16x32_bf16 v[232:235], a[96:99], a[64:67], 0
  s_add_u32 m0, s38, 61312
  s_nop 0
  buffer_load_dwordx4 v252, s[20:23], s33 offen offset:128 nt lds
  s_add_u32 s34, s34, 1
  s_add_u32 s33, s33, 8192
  v_mfma_f32_16x16x32_bf16 v[232:235], a[100:103], a[68:71], v[232:235]
  v_mfma_f32_16x16x32_bf16 v[232:235], a[104:107], a[72:75], v[232:235]
  v_mfma_f32_16x16x32_bf16 v[232:235], a[108:111], a[76:79], v[232:235]
  s_nop 7
  v_max3_f32 v232, v232, v233, v234
  v_max_f32 v232, v232, v235
  v_mov_b32 v233, v232
  s_nop 1
  v_permlane16_swap_b32 v232, v233
  v_max_f32 v232, v232, v233
  v_mov_b32 v233, v232
  s_nop 1
  v_permlane32_swap_b32 v232, v233
  v_min_f32 v235, -v232, -v233
  v_subrev_f32 v232, 0x40a00000, v235
  v_subrev_f32 v233, 0x40a00000, v235
  v_subrev_f32 v234, 0x40a00000, v235
  v_subrev_f32 v235, 0x40a00000, v235
  s_nop 1
  v_mfma_f32_16x16x32_bf16 v[192:195], a[96:99], a[64:67], v[232:235]
  v_mfma_f32_16x16x32_bf16 v[192:195], a[100:103], a[68:71], v[192:195]
  v_exp_f32 v213, v213
  v_mfma_f32_16x16x32_bf16 v[192:195], a[104:107], a[72:75], v[192:195]
  v_cvt_pk_bf16_f32 v206, v212, v213
  v_mfma_f32_16x16x32_bf16 v[192:195], a[108:111], a[76:79], v[192:195]
  v_exp_f32 v214, v214
  v_mfma_f32_16x16x32_bf16 v[196:199], a[124:127], a[76:79], v[232:235]
  v_mfma_f32_16x16x32_bf16 v[196:199], a[120:123], a[72:75], v[196:199]
  v_exp_f32 v215, v215
  v_mfma_f32_16x16x32_bf16 v[196:199], a[116:119], a[68:71], v[196:199]
  v_cvt_pk_bf16_f32 v207, v214, v215
  v_mfma_f32_16x16x32_bf16 v[196:199], a[112:115], a[64:67], v[196:199]
  s_nop 0
  v_exp_f32 v192, v192
  v_smfmac_f32_16x16x64_bf16 a[240:243], a[232:235], v[200:207], v253
  v_mfma_f32_16x16x32_bf16 v[96:99], v[200:203], a[160:163], 0
  v_mfma_f32_16x16x32_bf16 v[96:99], v[204:207], a[192:195], v[96:99]
  v_exp_f32 v193, v193
  v_mfma_f32_16x16x32_bf16 v[100:103], v[204:207], a[196:199], 0
  v_cvt_pk_bf16_f32 v192, v192, v193
  v_mfma_f32_16x16x32_bf16 v[100:103], v[200:203], a[164:167], v[100:103]
  v_exp_f32 v194, v194
  v_mfma_f32_16x16x32_bf16 v[104:107], v[200:203], a[168:171], 0
  v_mfma_f32_16x16x32_bf16 v[104:107], v[204:207], a[200:203], v[104:107]
  v_exp_f32 v195, v195
  v_mfma_f32_16x16x32_bf16 v[108:111], v[204:207], a[204:207], 0
  v_cvt_pk_bf16_f32 v193, v194, v195
  v_mfma_f32_16x16x32_bf16 v[108:111], v[200:203], a[172:175], v[108:111]
  v_exp_f32 v196, v196
  v_mfma_f32_16x16x32_bf16 v[208:211], a[128:131], a[64:67], v[232:235]
  v_mfma_f32_16x16x32_bf16 v[208:211], a[132:135], a[68:71], v[208:211]
  v_exp_f32 v197, v197
  v_mfma_f32_16x16x32_bf16 v[208:211], a[136:139], a[72:75], v[208:211]
  v_cvt_pk_bf16_f32 v194, v196, v197
  v_mfma_f32_16x16x32_bf16 v[208:211], a[140:143], a[76:79], v[208:211]
  v_exp_f32 v198, v198
  v_mfma_f32_16x16x32_bf16 v[212:215], a[156:159], a[76:79], v[232:235]
  v_mfma_f32_16x16x32_bf16 v[212:215], a[152:155], a[72:75], v[212:215]
  v_exp_f32 v199, v199
  v_mfma_f32_16x16x32_bf16 v[212:215], a[148:151], a[68:71], v[212:215]
  v_cvt_pk_bf16_f32 v195, v198, v199
  v_mfma_f32_16x16x32_bf16 v[212:215], a[144:147], a[64:67], v[212:215]
  s_nop 0
  v_exp_f32 v208, v208
  v_mfma_f32_16x16x32_bf16 v[112:115], v[200:203], a[176:179], 0
  v_mfma_f32_16x16x32_bf16 v[112:115], v[204:207], a[208:211], v[112:115]
  v_exp_f32 v209, v209
  v_mfma_f32_16x16x32_bf16 v[116:119], v[204:207], a[212:215], 0
  v_cvt_pk_bf16_f32 v196, v208, v209
  v_mfma_f32_16x16x32_bf16 v[116:119], v[200:203], a[180:183], v[116:119]
  v_exp_f32 v210, v210
  v_mfma_f32_16x16x32_bf16 v[120:123], v[200:203], a[184:187], 0
  v_mfma_f32_16x16x32_bf16 v[120:123], v[204:207], a[216:219], v[120:123]
  v_exp_f32 v211, v211
  v_mfma_f32_16x16x32_bf16 v[124:127], v[204:207], a[220:223], 0
  v_cvt_pk_bf16_f32 v197, v210, v211
  v_mfma_f32_16x16x32_bf16 v[124:127], v[200:203], a[188:191], v[124:127]
  v_exp_f32 v212, v212
  s_waitcnt vmcnt(10)
  ds_read_b128 v[128:131], v244 offset:10240
  ds_read_b128 v[132:135], v245 offset:10240
  ds_read_b128 v[136:139], v244 offset:22528
  ds_read_b128 v[140:143], v245 offset:22528
  s_add_u32 m0, s38, 0
  s_nop 0
  buffer_load_dwordx4 v252, s[16:19], s33 offen nt lds
  s_waitcnt lgkmcnt(3)
  v_lshlrev_b32 v144, 16, v128
  v_and_b32 v145, 0xffff0000, v128
  v_pk_mul_f32 v[144:145], v[144:145], s[40:41]
  v_cvt_pk_bf16_f32 v128, v144, v145
  v_accvgpr_write_b32 a80, v128
  s_add_u32 m0, s38, 3968
  s_nop 0
  buffer_load_dwordx4 v252, s[16:19], s33 offen offset:128 nt lds
  v_lshlrev_b32 v144, 16, v129
  v_and_b32 v145, 0xffff0000, v129
  v_pk_mul_f32 v[144:145], v[144:145], s[40:41]
  v_cvt_pk_bf16_f32 v129, v144, v145
  v_accvgpr_write_b32 a81, v129
  v_lshlrev_b32 v144, 16, v130
  v_and_b32 v145, 0xffff0000, v130
  v_pk_mul_f32 v[144:145], v[144:145], s[40:41]
  v_cvt_pk_bf16_f32 v130, v144, v145
  v_accvgpr_write_b32 a82, v130
  s_add_u32 m0, s38, 8192
  s_nop 0
  buffer_load_dwordx4 v252, s[20:23], s33 offen nt lds
  v_lshlrev_b32 v144, 16, v131
  v_and_b32 v145, 0xffff0000, v131
  v_pk_mul_f32 v[144:145], v[144:145], s[40:41]
  v_cvt_pk_bf16_f32 v131, v144, v145
  v_accvgpr_write_b32 a83, v131
  s_add_u32 m0, s38, 12160
  s_nop 0
  buffer_load_dwordx4 v252, s[20:23], s33 offen offset:128 nt lds
  s_add_u32 s34, s34, 1
  s_add_u32 s33, s33, 8192
  s_waitcnt lgkmcnt(2)
  v_lshlrev_b32 v144, 16, v132
  v_and_b32 v145, 0xffff0000, v132
  v_pk_mul_f32 v[144:145], v[144:145], s[40:41]
  v_cvt_pk_bf16_f32 v132, v144, v145
  v_accvgpr_write_b32 a84, v132
  v_lshlrev_b32 v144, 16, v133
  v_and_b32 v145, 0xffff0000, v133
  v_pk_mul_f32 v[144:145], v[144:145], s[40:41]
  v_cvt_pk_bf16_f32 v133, v144, v145
  v_accvgpr_write_b32 a85, v133
  v_lshlrev_b32 v144, 16, v134
  v_and_b32 v145, 0xffff0000, v134
  v_pk_mul_f32 v[144:145], v[144:145], s[40:41]
  v_cvt_pk_bf16_f32 v134, v144, v145
  v_accvgpr_write_b32 a86, v134
  v_lshlrev_b32 v144, 16, v135
  v_and_b32 v145, 0xffff0000, v135
  v_pk_mul_f32 v[144:145], v[144:145], s[40:41]
  v_cvt_pk_bf16_f32 v135, v144, v145
  v_accvgpr_write_b32 a87, v135
  s_waitcnt lgkmcnt(1)
  v_lshlrev_b32 v144, 16, v136
  v_and_b32 v145, 0xffff0000, v136
  v_pk_mul_f32 v[144:145], v[144:145], s[40:41]
  v_cvt_pk_bf16_f32 v136, v144, v145
  v_accvgpr_write_b32 a88, v136
  v_lshlrev_b32 v144, 16, v137
  v_and_b32 v145, 0xffff0000, v137
  v_pk_mul_f32 v[144:145], v[144:145], s[40:41]
  v_cvt_pk_bf16_f32 v137, v144, v145
  v_accvgpr_write_b32 a89, v137
  v_lshlrev_b32 v144, 16, v138
  v_and_b32 v145, 0xffff0000, v138
  v_pk_mul_f32 v[144:145], v[144:145], s[40:41]
  v_cvt_pk_bf16_f32 v138, v144, v145
  v_accvgpr_write_b32 a90, v138
  v_lshlrev_b32 v144, 16, v139
  v_and_b32 v145, 0xffff0000, v139
  v_pk_mul_f32 v[144:145], v[144:145], s[40:41]
  v_cvt_pk_bf16_f32 v139, v144, v145
  v_accvgpr_write_b32 a91, v139
  s_waitcnt lgkmcnt(0)
  v_lshlrev_b32 v144, 16, v140
  v_and_b32 v145, 0xffff0000, v140
  v_pk_mul_f32 v[144:145], v[144:145], s[40:41]
  v_cvt_pk_bf16_f32 v140, v144, v145
  v_accvgpr_write_b32 a92, v140
  v_lshlrev_b32 v144, 16, v141
  v_and_b32 v145, 0xffff0000, v141
  v_pk_mul_f32 v[144:145], v[144:145], s[40:41]
  v_cvt_pk_bf16_f32 v141, v144, v145
  v_accvgpr_write_b32 a93, v141
  v_lshlrev_b32 v144, 16, v142
  v_and_b32 v145, 0xffff0000, v142
  v_pk_mul_f32 v[144:145], v[144:145], s[40:41]
  v_cvt_pk_bf16_f32 v142, v144, v145
  v_accvgpr_write_b32 a94, v142
  v_lshlrev_b32 v144, 16, v143
  v_and_b32 v145, 0xffff0000, v143
  v_pk_mul_f32 v[144:145], v[144:145], s[40:41]
  v_cvt_pk_bf16_f32 v143, v144, v145
  v_accvgpr_write_b32 a95, v143
  v_mfma_f32_16x16x32_bf16 v[236:239], a[96:99], a[80:83], 0
  v_mfma_f32_16x16x32_bf16 v[236:239], a[100:103], a[84:87], v[236:239]
  v_mfma_f32_16x16x32_bf16 v[236:239], a[104:107], a[88:91], v[236:239]
  v_mfma_f32_16x16x32_bf16 v[236:239], a[108:111], a[92:95], v[236:239]
  s_nop 7
  v_max3_f32 v236, v236, v237, v238
  v_max_f32 v236, v236, v239
  v_mov_b32 v237, v236
  s_nop 1
  v_permlane16_swap_b32 v236, v237
  v_max_f32 v236, v236, v237
  v_mov_b32 v237, v236
  s_nop 1
  v_permlane32_swap_b32 v236, v237
  v_min_f32 v238, -v236, -v237
  v_accvgpr_write_b32 a255, v238
  v_min_f32 v239, s44, v238
  v_subrev_f32 v236, 0x40a00000, v239
  v_subrev_f32 v237, 0x40a00000, v239
  v_subrev_f32 v238, 0x40a00000, v239
  v_subrev_f32 v239, 0x40a00000, v239
  s_nop 1
  v_mfma_f32_16x16x32_bf16 v[200:203], a[96:99], a[80:83], v[236:239]
  v_mfma_f32_16x16x32_bf16 v[200:203], a[100:103], a[84:87], v[200:203]
  s_add_u32 m0, s38, 16384
  v_exp_f32 v213, v213
  v_mfma_f32_16x16x32_bf16 v[200:203], a[104:107], a[88:91], v[200:203]
  buffer_load_dwordx4 v252, s[16:19], s33 offen nt lds
  v_cvt_pk_bf16_f32 v198, v212, v213
  v_mfma_f32_16x16x32_bf16 v[200:203], a[108:111], a[92:95], v[200:203]
  s_waitcnt vmcnt(5)
  v_exp_f32 v214, v214
  v_mfma_f32_16x16x32_bf16 v[204:207], a[124:127], a[92:95], v[236:239]
  s_barrier
  v_mfma_f32_16x16x32_bf16 v[204:207], a[120:123], a[88:91], v[204:207]
  v_exp_f32 v215, v215
  v_mfma_f32_16x16x32_bf16 v[204:207], a[116:119], a[84:87], v[204:207]
  v_cvt_pk_bf16_f32 v199, v214, v215
  v_mfma_f32_16x16x32_bf16 v[204:207], a[112:115], a[80:83], v[204:207]
  v_exp_f32 v200, v200
  v_smfmac_f32_16x16x64_bf16 a[244:247], a[228:231], v[192:199], v253
  s_add_u32 m0, s38, 20352
  ds_read_b128 a[96:99], v246 offset:32768
  v_mfma_f32_16x16x32_bf16 v[128:131], v[192:195], a[160:163], 0
  buffer_load_dwordx4 v252, s[16:19], s33 offen offset:128 nt lds
  v_mfma_f32_16x16x32_bf16 v[128:131], v[196:199], a[192:195], v[128:131]
  v_exp_f32 v201, v201
  v_mfma_f32_16x16x32_bf16 v[132:135], v[196:199], a[196:199], 0
  ds_read_b128 a[100:103], v247 offset:32768
  v_cvt_pk_bf16_f32 v200, v200, v201
  v_mfma_f32_16x16x32_bf16 v[132:135], v[192:195], a[164:167], v[132:135]
  s_add_u32 m0, s38, 24576
  v_exp_f32 v202, v202
  v_mfma_f32_16x16x32_bf16 v[136:139], v[192:195], a[168:171], 0
  buffer_load_dwordx4 v252, s[20:23], s33 offen nt lds
  v_mfma_f32_16x16x32_bf16 v[136:139], v[196:199], a[200:203], v[136:139]
  v_exp_f32 v203, v203
  v_mfma_f32_16x16x32_bf16 v[140:143], v[196:199], a[204:207], 0
  ds_read_b128 a[104:107], v246 offset:36864
  v_cvt_pk_bf16_f32 v201, v202, v203
  v_mfma_f32_16x16x32_bf16 v[140:143], v[192:195], a[172:175], v[140:143]
  s_add_u32 m0, s38, 28544
  v_exp_f32 v204, v204
  v_mfma_f32_16x16x32_bf16 v[208:211], a[128:131], a[80:83], v[236:239]
  buffer_load_dwordx4 v252, s[20:23], s33 offen offset:128 nt lds
  ds_read_b128 a[108:111], v247 offset:36864
  v_mfma_f32_16x16x32_bf16 v[208:211], a[132:135], a[84:87], v[208:211]
  s_add_u32 s34, s34, 1
  v_exp_f32 v205, v205
  v_mfma_f32_16x16x32_bf16 v[208:211], a[136:139], a[88:91], v[208:211]
  s_add_u32 s33, s33, 8192
  ds_read_b128 a[112:115], v246 offset:34816
  v_cvt_pk_bf16_f32 v202, v204, v205
  v_mfma_f32_16x16x32_bf16 v[208:211], a[140:143], a[92:95], v[208:211]
  v_exp_f32 v206, v206
  v_mfma_f32_16x16x32_bf16 v[212:215], a[156:159], a[92:95], v[236:239]
  s_mov_b32 m0, s37
  ds_read_b128 a[116:119], v247 offset:34816
  v_mfma_f32_16x16x32_bf16 v[212:215], a[152:155], a[88:91], v[212:215]
  buffer_load_dwordx4 v252, s[24:27], s36 offen nt lds
  v_exp_f32 v207, v207
  v_mfma_f32_16x16x32_bf16 v[212:215], a[148:151], a[84:87], v[212:215]
  ds_read_b128 a[120:123], v246 offset:38912
  v_cvt_pk_bf16_f32 v203, v206, v207
  v_mfma_f32_16x16x32_bf16 v[212:215], a[144:147], a[80:83], v[212:215]
  v_exp_f32 v208, v208
  v_mfma_f32_16x16x32_bf16 v[144:147], v[192:195], a[176:179], 0
  s_add_u32 m0, s37, 12160
  ds_read_b128 a[124:127], v247 offset:38912
  v_mfma_f32_16x16x32_bf16 v[144:147], v[196:199], a[208:211], v[144:147]
  buffer_load_dwordx4 v252, s[24:27], s36 offen offset:128 nt lds
  v_exp_f32 v209, v209
  v_mfma_f32_16x16x32_bf16 v[148:151], v[196:199], a[212:215], 0
  s_add_u32 s37, s37, 1024
  v_cvt_pk_bf16_f32 v204, v208, v209
  v_mfma_f32_16x16x32_bf16 v[148:151], v[192:195], a[180:183], v[148:151]
  s_add_u32 s36, s36, 2048
  v_exp_f32 v210, v210
  v_mfma_f32_16x16x32_bf16 v[152:155], v[192:195], a[184:187], 0
  v_mfma_f32_16x16x32_bf16 v[152:155], v[196:199], a[216:219], v[152:155]
  v_exp_f32 v211, v211
  v_mfma_f32_16x16x32_bf16 v[156:159], v[196:199], a[220:223], 0
  v_cvt_pk_bf16_f32 v205, v210, v211
  v_mfma_f32_16x16x32_bf16 v[156:159], v[192:195], a[188:191], v[156:159]
  v_exp_f32 v212, v212
  s_waitcnt lgkmcnt(7)
  v_mfma_f32_16x16x32_bf16 v[192:195], a[96:99], a[0:3], v[216:219]
L_loopA:
  s_waitcnt lgkmcnt(6)
  v_mfma_f32_16x16x32_bf16 v[192:195], a[100:103], a[4:7], v[192:195]
  s_waitcnt lgkmcnt(5)
  v_exp_f32 v213, v213
  v_mfma_f32_16x16x32_bf16 v[192:195], a[104:107], a[8:11], v[192:195]
  s_waitcnt lgkmcnt(4)
  ds_read_b128 a[128:131], v246 offset:49152
  v_cvt_pk_bf16_f32 v206, v212, v213
  v_mfma_f32_16x16x32_bf16 v[192:195], a[108:111], a[12:15], v[192:195]
  s_waitcnt lgkmcnt(1)
  v_exp_f32 v214, v214
  v_mfma_f32_16x16x32_bf16 v[196:199], a[124:127], a[12:15], v[216:219]
  ds_read_b128 a[132:135], v247 offset:49152
  ds_read_b128 a[136:139], v246 offset:53248
  v_mfma_f32_16x16x32_bf16 v[196:199], a[120:123], a[8:11], v[196:199]
  v_exp_f32 v215, v215
  v_mfma_f32_16x16x32_bf16 v[196:199], a[116:119], a[4:7], v[196:199]
  ds_read_b128 a[140:143], v247 offset:53248
  v_cvt_pk_bf16_f32 v207, v214, v215
  v_mfma_f32_16x16x32_bf16 v[196:199], a[112:115], a[0:3], v[196:199]
  v_exp_f32 v192, v192
  v_smfmac_f32_16x16x64_bf16 a[244:247], a[232:235], v[200:207], v253
  ds_read_b128 a[144:147], v246 offset:51200
  v_mfma_f32_16x16x32_bf16 v[160:163], v[200:203], a[160:163], v[160:163]
  ds_read_b128 a[148:151], v247 offset:51200
  ds_read_b128 a[152:155], v246 offset:55296
  v_mfma_f32_16x16x32_bf16 v[160:163], v[204:207], a[192:195], v[160:163]
  v_exp_f32 v193, v193
  v_mfma_f32_16x16x32_bf16 v[164:167], v[204:207], a[196:199], v[164:167]
  ds_read_b128 a[156:159], v247 offset:55296
  v_cvt_pk_bf16_f32 v192, v192, v193
  v_mfma_f32_16x16x32_bf16 v[164:167], v[200:203], a[164:167], v[164:167]
  v_exp_f32 v194, v194
  v_mfma_f32_16x16x32_bf16 v[168:171], v[200:203], a[168:171], v[168:171]
  ds_read_b64_tr_b16 a[160:161], v248 offset:40960
  ds_read_b64_tr_b16 a[162:163], v248 offset:43008
  v_mfma_f32_16x16x32_bf16 v[168:171], v[204:207], a[200:203], v[168:171]
  v_exp_f32 v195, v195
  v_mfma_f32_16x16x32_bf16 v[172:175], v[204:207], a[204:207], v[172:175]
  ds_read_b64_tr_b16 a[192:193], v248 offset:57344
  v_cvt_pk_bf16_f32 v193, v194, v195
  v_mfma_f32_16x16x32_bf16 v[172:175], v[200:203], a[172:175], v[172:175]
  s_waitcnt lgkmcnt(6)
  v_exp_f32 v196, v196
  v_mfma_f32_16x16x32_bf16 v[208:211], a[128:131], a[0:3], v[216:219]
  ds_read_b64_tr_b16 a[194:195], v248 offset:59392
  ds_read_b64_tr_b16 a[164:165], v249 offset:40960
  v_mfma_f32_16x16x32_bf16 v[208:211], a[132:135], a[4:7], v[208:211]
  v_exp_f32 v197, v197
  v_mfma_f32_16x16x32_bf16 v[208:211], a[136:139], a[8:11], v[208:211]
  ds_read_b64_tr_b16 a[166:167], v249 offset:43008
  v_cvt_pk_bf16_f32 v194, v196, v197
  v_mfma_f32_16x16x32_bf16 v[208:211], a[140:143], a[12:15], v[208:211]
  s_waitcnt lgkmcnt(6)
  v_exp_f32 v198, v198
  v_mfma_f32_16x16x32_bf16 v[212:215], a[156:159], a[12:15], v[216:219]
  ds_read_b64_tr_b16 a[196:197], v249 offset:57344
  ds_read_b64_tr_b16 a[198:199], v249 offset:59392
  v_mfma_f32_16x16x32_bf16 v[212:215], a[152:155], a[8:11], v[212:215]
  v_exp_f32 v199, v199
  v_mfma_f32_16x16x32_bf16 v[212:215], a[148:151], a[4:7], v[212:215]
  ds_read_b64_tr_b16 a[168:169], v250 offset:40960
  v_cvt_pk_bf16_f32 v195, v198, v199
  v_mfma_f32_16x16x32_bf16 v[212:215], a[144:147], a[0:3], v[212:215]
  v_exp_f32 v208, v208
  v_mfma_f32_16x16x32_bf16 v[176:179], v[200:203], a[176:179], v[176:179]
  ds_read_b64_tr_b16 a[170:171], v250 offset:43008
  ds_read_b64_tr_b16 a[200:201], v250 offset:57344
  v_mfma_f32_16x16x32_bf16 v[176:179], v[204:207], a[208:211], v[176:179]
  v_exp_f32 v209, v209
  v_mfma_f32_16x16x32_bf16 v[180:183], v[204:207], a[212:215], v[180:183]
  ds_read_b64_tr_b16 a[202:203], v250 offset:59392
  v_cvt_pk_bf16_f32 v196, v208, v209
  v_mfma_f32_16x16x32_bf16 v[180:183], v[200:203], a[180:183], v[180:183]
  v_exp_f32 v210, v210
  v_mfma_f32_16x16x32_bf16 v[184:187], v[200:203], a[184:187], v[184:187]
  ds_read_b64_tr_b16 a[172:173], v251 offset:40960
  ds_read_b64_tr_b16 a[174:175], v251 offset:43008
  v_mfma_f32_16x16x32_bf16 v[184:187], v[204:207], a[216:219], v[184:187]
  v_exp_f32 v211, v211
  v_mfma_f32_16x16x32_bf16 v[188:191], v[204:207], a[220:223], v[188:191]
  ds_read_b64_tr_b16 a[204:205], v251 offset:57344
  v_cvt_pk_bf16_f32 v197, v210, v211
  v_mfma_f32_16x16x32_bf16 v[188:191], v[200:203], a[188:191], v[188:191]
  v_exp_f32 v212, v212
  v_mfma_f32_16x16x32_bf16 v[200:203], a[96:99], a[16:19], v[220:223]
  ds_read_b64_tr_b16 a[206:207], v251 offset:59392
  ds_read_b64_tr_b16 a[176:177], v248 offset:45056
  v_mfma_f32_16x16x32_bf16 v[200:203], a[100:103], a[20:23], v[200:203]
  v_exp_f32 v213, v213
  v_mfma_f32_16x16x32_bf16 v[200:203], a[104:107], a[24:27], v[200:203]
  ds_read_b64_tr_b16 a[178:179], v248 offset:47104
  v_cvt_pk_bf16_f32 v198, v212, v213
  v_mfma_f32_16x16x32_bf16 v[200:203], a[108:111], a[28:31], v[200:203]
  v_exp_f32 v214, v214
  v_mfma_f32_16x16x32_bf16 v[204:207], a[124:127], a[28:31], v[220:223]
  ds_read_b64_tr_b16 a[208:209], v248 offset:61440
  ds_read_b64_tr_b16 a[210:211], v248 offset:63488
  v_mfma_f32_16x16x32_bf16 v[204:207], a[120:123], a[24:27], v[204:207]
  v_exp_f32 v215, v215
  v_mfma_f32_16x16x32_bf16 v[204:207], a[116:119], a[20:23], v[204:207]
  ds_read_b64_tr_b16 a[180:181], v249 offset:45056
  v_cvt_pk_bf16_f32 v199, v214, v215
  v_mfma_f32_16x16x32_bf16 v[204:207], a[112:115], a[16:19], v[204:207]
  v_exp_f32 v200, v200
  v_smfmac_f32_16x16x64_bf16 a[236:239], a[228:231], v[192:199], v253
  s_waitcnt lgkmcnt(4)
  ds_read_b64_tr_b16 a[182:183], v249 offset:47104
  v_mfma_f32_16x16x32_bf16 v[0:3], v[192:195], a[160:163], v[0:3]
  ds_read_b64_tr_b16 a[212:213], v249 offset:61440
  ds_read_b64_tr_b16 a[214:215], v249 offset:63488
  v_mfma_f32_16x16x32_bf16 v[0:3], v[196:199], a[192:195], v[0:3]
  v_exp_f32 v201, v201
  v_mfma_f32_16x16x32_bf16 v[4:7], v[196:199], a[196:199], v[4:7]
  ds_read_b64_tr_b16 a[184:185], v250 offset:45056
  v_cvt_pk_bf16_f32 v200, v200, v201
  v_mfma_f32_16x16x32_bf16 v[4:7], v[192:195], a[164:167], v[4:7]
  v_exp_f32 v202, v202
  v_mfma_f32_16x16x32_bf16 v[8:11], v[192:195], a[168:171], v[8:11]
  ds_read_b64_tr_b16 a[186:187], v250 offset:47104
  ds_read_b64_tr_b16 a[216:217], v250 offset:61440
  v_mfma_f32_16x16x32_bf16 v[8:11], v[196:199], a[200:203], v[8:11]
  v_exp_f32 v203, v203
  v_mfma_f32_16x16x32_bf16 v[12:15], v[196:199], a[204:207], v[12:15]
  ds_read_b64_tr_b16 a[218:219], v250 offset:63488
  v_cvt_pk_bf16_f32 v201, v202, v203
  v_mfma_f32_16x16x32_bf16 v[12:15], v[192:195], a[172:175], v[12:15]
  v_exp_f32 v204, v204
  v_mfma_f32_16x16x32_bf16 v[208:211], a[128:131], a[16:19], v[220:223]
  ds_read_b64_tr_b16 a[188:189], v251 offset:45056
  ds_read_b64_tr_b16 a[190:191], v251 offset:47104
  v_mfma_f32_16x16x32_bf16 v[208:211], a[132:135], a[20:23], v[208:211]
  v_exp_f32 v205, v205
  v_mfma_f32_16x16x32_bf16 v[208:211], a[136:139], a[24:27], v[208:211]
  ds_read_b64_tr_b16 a[220:221], v251 offset:61440
  v_cvt_pk_bf16_f32 v202, v204, v205
  v_mfma_f32_16x16x32_bf16 v[208:211], a[140:143], a[28:31], v[208:211]
  v_exp_f32 v206, v206
  v_mfma_f32_16x16x32_bf16 v[212:215], a[156:159], a[28:31], v[220:223]
  ds_read_b64_tr_b16 a[222:223], v251 offset:63488
  v_mfma_f32_16x16x32_bf16 v[212:215], a[152:155], a[24:27], v[212:215]
  v_exp_f32 v207, v207
  v_mfma_f32_16x16x32_bf16 v[212:215], a[148:151], a[20:23], v[212:215]
  v_cvt_pk_bf16_f32 v203, v206, v207
  v_mfma_f32_16x16x32_bf16 v[212:215], a[144:147], a[16:19], v[212:215]
  s_waitcnt lgkmcnt(4)
  v_exp_f32 v208, v208
  v_mfma_f32_16x16x32_bf16 v[16:19], v[192:195], a[176:179], v[16:19]
  v_mfma_f32_16x16x32_bf16 v[16:19], v[196:199], a[208:211], v[16:19]
  v_exp_f32 v209, v209
  v_mfma_f32_16x16x32_bf16 v[20:23], v[196:199], a[212:215], v[20:23]
  s_cmp_lg_u32 s48, 0
  v_cvt_pk_bf16_f32 v204, v208, v209
  v_mfma_f32_16x16x32_bf16 v[20:23], v[192:195], a[180:183], v[20:23]
  s_waitcnt vmcnt(2) lgkmcnt(0)
  v_exp_f32 v210, v210
  v_mfma_f32_16x16x32_bf16 v[24:27], v[192:195], a[184:187], v[24:27]
  s_barrier
  s_cbranch_scc1 L_hA
  L_cutA:
  v_mfma_f32_16x16x32_bf16 v[24:27], v[196:199], a[216:219], v[24:27]
  v_exp_f32 v211, v211
  v_mfma_f32_16x16x32_bf16 v[28:31], v[196:199], a[220:223], v[28:31]
  v_cvt_pk_bf16_f32 v205, v210, v211
  v_mfma_f32_16x16x32_bf16 v[28:31], v[192:195], a[188:191], v[28:31]
  v_exp_f32 v212, v212
  v_mfma_f32_16x16x32_bf16 v[192:195], a[96:99], a[32:35], v[224:227]
  ds_read_b128 v[240:243], v255 offset:0
  v_mfma_f32_16x16x32_bf16 v[192:195], a[100:103], a[36:39], v[192:195]
  v_exp_f32 v213, v213
  v_mfma_f32_16x16x32_bf16 v[192:195], a[104:107], a[40:43], v[192:195]
  v_cvt_pk_bf16_f32 v206, v212, v213
  v_mfma_f32_16x16x32_bf16 v[192:195], a[108:111], a[44:47], v[192:195]
  s_add_u32 m0, s38, 32768
  v_exp_f32 v214, v214
  v_mfma_f32_16x16x32_bf16 v[196:199], a[124:127], a[44:47], v[224:227]
  buffer_load_dwordx4 v252, s[16:19], s33 offen nt lds
  v_mfma_f32_16x16x32_bf16 v[196:199], a[120:123], a[40:43], v[196:199]
  s_cmp_eq_u32 s34, 22
  v_exp_f32 v215, v215
  v_mfma_f32_16x16x32_bf16 v[196:199], a[116:119], a[36:39], v[196:199]
  s_cselect_b32 s45, s100, 0
  v_cvt_pk_bf16_f32 v207, v214, v215
  v_mfma_f32_16x16x32_bf16 v[196:199], a[112:115], a[32:35], v[196:199]
  s_sub_u32 s36, s36, s45
  v_exp_f32 v192, v192
  v_smfmac_f32_16x16x64_bf16 a[236:239], a[232:235], v[200:207], v253
  s_waitcnt lgkmcnt(0)
  v_lshlrev_b32 v254, 16, v240
  v_mfma_f32_16x16x32_bf16 v[32:35], v[200:203], a[160:163], v[32:35]
  v_and_b32 v240, 0xffff0000, v240
  v_mul_f32 v254, s40, v254
  v_mfma_f32_16x16x32_bf16 v[32:35], v[204:207], a[192:195], v[32:35]
  v_exp_f32 v193, v193
  v_mfma_f32_16x16x32_bf16 v[36:39], v[204:207], a[196:199], v[36:39]
  v_cvt_pk_bf16_f32 v192, v192, v193
  v_mul_f32 v240, s40, v240
  v_mfma_f32_16x16x32_bf16 v[36:39], v[200:203], a[164:167], v[36:39]
  s_add_u32 m0, s38, 36736
  v_exp_f32 v194, v194
  v_mfma_f32_16x16x32_bf16 v[40:43], v[200:203], a[168:171], v[40:43]
  buffer_load_dwordx4 v252, s[16:19], s33 offen offset:128 nt lds
  v_mfma_f32_16x16x32_bf16 v[40:43], v[204:207], a[200:203], v[40:43]
  v_exp_f32 v195, v195
  v_mfma_f32_16x16x32_bf16 v[44:47], v[204:207], a[204:207], v[44:47]
  v_cvt_pk_bf16_f32 v193, v194, v195
  v_cvt_pk_bf16_f32 v240, v254, v240
  v_mfma_f32_16x16x32_bf16 v[44:47], v[200:203], a[172:175], v[44:47]
  v_exp_f32 v196, v196
  v_mfma_f32_16x16x32_bf16 v[208:211], a[128:131], a[32:35], v[224:227]
  v_lshlrev_b32 v254, 16, v241
  v_and_b32 v241, 0xffff0000, v241
  v_mfma_f32_16x16x32_bf16 v[208:211], a[132:135], a[36:39], v[208:211]
  v_exp_f32 v197, v197
  v_mfma_f32_16x16x32_bf16 v[208:211], a[136:139], a[40:43], v[208:211]
  v_cvt_pk_bf16_f32 v194, v196, v197
  v_mul_f32 v254, s40, v254
  v_mfma_f32_16x16x32_bf16 v[208:211], a[140:143], a[44:47], v[208:211]
  s_add_u32 m0, s38, 40960
  v_exp_f32 v198, v198
  v_mfma_f32_16x16x32_bf16 v[212:215], a[156:159], a[44:47], v[224:227]
  buffer_load_dwordx4 v252, s[20:23], s33 offen nt lds
  v_mfma_f32_16x16x32_bf16 v[212:215], a[152:155], a[40:43], v[212:215]
  v_exp_f32 v199, v199
  v_mfma_f32_16x16x32_bf16 v[212:215], a[148:151], a[36:39], v[212:215]
  v_cvt_pk_bf16_f32 v195, v198, v199
  v_mul_f32 v241, s40, v241
  v_mfma_f32_16x16x32_bf16 v[212:215], a[144:147], a[32:35], v[212:215]
  v_exp_f32 v208, v208
  v_mfma_f32_16x16x32_bf16 v[48:51], v[200:203], a[176:179], v[48:51]
  v_cvt_pk_bf16_f32 v241, v254, v241
  v_lshlrev_b32 v254, 16, v242
  v_mfma_f32_16x16x32_bf16 v[48:51], v[204:207], a[208:211], v[48:51]
  v_exp_f32 v209, v209
  v_mfma_f32_16x16x32_bf16 v[52:55], v[204:207], a[212:215], v[52:55]
  v_cvt_pk_bf16_f32 v196, v208, v209
  v_and_b32 v242, 0xffff0000, v242
  v_mfma_f32_16x16x32_bf16 v[52:55], v[200:203], a[180:183], v[52:55]
  s_add_u32 m0, s38, 44928
  v_exp_f32 v210, v210
  v_mfma_f32_16x16x32_bf16 v[56:59], v[200:203], a[184:187], v[56:59]
  buffer_load_dwordx4 v252, s[20:23], s33 offen offset:128 nt lds
  v_mfma_f32_16x16x32_bf16 v[56:59], v[204:207], a[216:219], v[56:59]
  s_add_u32 s34, s34, 1
  v_exp_f32 v211, v211
  v_mfma_f32_16x16x32_bf16 v[60:63], v[204:207], a[220:223], v[60:63]
  s_add_u32 s33, s33, 8192
  v_cvt_pk_bf16_f32 v197, v210, v211
  v_mul_f32 v254, s40, v254
  v_mfma_f32_16x16x32_bf16 v[60:63], v[200:203], a[188:191], v[60:63]
  s_cmp_eq_u32 s34, 23
  v_exp_f32 v212, v212
  v_mfma_f32_16x16x32_bf16 v[200:203], a[96:99], a[48:51], v[228:231]
  s_cselect_b32 s33, s58, s33
  v_mul_f32 v242, s40, v242
  v_cvt_pk_bf16_f32 v242, v254, v242
  v_mfma_f32_16x16x32_bf16 v[200:203], a[100:103], a[52:55], v[200:203]
  v_exp_f32 v213, v213
  v_mfma_f32_16x16x32_bf16 v[200:203], a[104:107], a[56:59], v[200:203]
  v_cvt_pk_bf16_f32 v198, v212, v213
  v_lshlrev_b32 v254, 16, v243
  v_mfma_f32_16x16x32_bf16 v[200:203], a[108:111], a[60:63], v[200:203]
  s_add_u32 m0, s38, 49152
  v_exp_f32 v214, v214
  v_mfma_f32_16x16x32_bf16 v[204:207], a[124:127], a[60:63], v[228:231]
  buffer_load_dwordx4 v252, s[16:19], s33 offen nt lds
  v_mfma_f32_16x16x32_bf16 v[204:207], a[120:123], a[56:59], v[204:207]
  v_exp_f32 v215, v215
  v_mfma_f32_16x16x32_bf16 v[204:207], a[116:119], a[52:55], v[204:207]
  v_cvt_pk_bf16_f32 v199, v214, v215
  v_and_b32 v243, 0xffff0000, v243
  v_mfma_f32_16x16x32_bf16 v[204:207], a[112:115], a[48:51], v[204:207]
  v_exp_f32 v200, v200
  v_smfmac_f32_16x16x64_bf16 a[240:243], a[228:231], v[192:199], v253
  v_mul_f32 v254, s40, v254
  v_mfma_f32_16x16x32_bf16 v[64:67], v[192:195], a[160:163], v[64:67]
  v_mul_f32 v243, s40, v243
  v_cvt_pk_bf16_f32 v243, v254, v243
  v_mfma_f32_16x16x32_bf16 v[64:67], v[196:199], a[192:195], v[64:67]
  v_exp_f32 v201, v201
  v_mfma_f32_16x16x32_bf16 v[68:71], v[196:199], a[196:199], v[68:71]
  ds_write_b128 v255, v[240:243] offset:0
  v_cvt_pk_bf16_f32 v200, v200, v201
  v_mfma_f32_16x16x32_bf16 v[68:71], v[192:195], a[164:167], v[68:71]
  s_add_u32 m0, s38, 53120
  v_exp_f32 v202, v202
  v_mfma_f32_16x16x32_bf16 v[72:75], v[192:195], a[168:171], v[72:75]
  buffer_load_dwordx4 v252, s[16:19], s33 offen offset:128 nt lds
  v_mfma_f32_16x16x32_bf16 v[72:75], v[196:199], a[200:203], v[72:75]
  v_exp_f32 v203, v203
  v_mfma_f32_16x16x32_bf16 v[76:79], v[196:199], a[204:207], v[76:79]
  ds_read_b128 v[240:243], v255 offset:12288
  v_cvt_pk_bf16_f32 v201, v202, v203
  v_mfma_f32_16x16x32_bf16 v[76:79], v[192:195], a[172:175], v[76:79]
  v_exp_f32 v204, v204
  v_mfma_f32_16x16x32_bf16 v[208:211], a[128:131], a[48:51], v[228:231]
  v_mfma_f32_16x16x32_bf16 v[208:211], a[132:135], a[52:55], v[208:211]
  v_exp_f32 v205, v205
  v_mfma_f32_16x16x32_bf16 v[208:211], a[136:139], a[56:59], v[208:211]
  v_cvt_pk_bf16_f32 v202, v204, v205
  v_mfma_f32_16x16x32_bf16 v[208:211], a[140:143], a[60:63], v[208:211]
  s_add_u32 m0, s38, 57344
  v_exp_f32 v206, v206
  v_mfma_f32_16x16x32_bf16 v[212:215], a[156:159], a[60:63], v[228:231]
  buffer_load_dwordx4 v252, s[20:23], s33 offen nt lds
  v_mfma_f32_16x16x32_bf16 v[212:215], a[152:155], a[56:59], v[212:215]
  v_exp_f32 v207, v207
  v_mfma_f32_16x16x32_bf16 v[212:215], a[148:151], a[52:55], v[212:215]
  v_cvt_pk_bf16_f32 v203, v206, v207
  s_waitcnt lgkmcnt(0)
  v_lshlrev_b32 v254, 16, v240
  v_mfma_f32_16x16x32_bf16 v[212:215], a[144:147], a[48:51], v[212:215]
  v_exp_f32 v208, v208
  v_mfma_f32_16x16x32_bf16 v[80:83], v[192:195], a[176:179], v[80:83]
  v_and_b32 v240, 0xffff0000, v240
  v_mul_f32 v254, s40, v254
  v_mfma_f32_16x16x32_bf16 v[80:83], v[196:199], a[208:211], v[80:83]
  v_exp_f32 v209, v209
  v_mfma_f32_16x16x32_bf16 v[84:87], v[196:199], a[212:215], v[84:87]
  v_cvt_pk_bf16_f32 v204, v208, v209
  v_mul_f32 v240, s40, v240
  v_mfma_f32_16x16x32_bf16 v[84:87], v[192:195], a[180:183], v[84:87]
  s_add_u32 m0, s38, 61312
  v_exp_f32 v210, v210
  v_mfma_f32_16x16x32_bf16 v[88:91], v[192:195], a[184:187], v[88:91]
  buffer_load_dwordx4 v252, s[20:23], s33 offen offset:128 nt lds
  v_mfma_f32_16x16x32_bf16 v[88:91], v[196:199], a[216:219], v[88:91]
  s_add_u32 s34, s34, 1
  v_exp_f32 v211, v211
  v_mfma_f32_16x16x32_bf16 v[92:95], v[196:199], a[220:223], v[92:95]
  s_add_u32 s33, s33, 8192
  v_cvt_pk_bf16_f32 v205, v210, v211
  v_cvt_pk_bf16_f32 v240, v254, v240
  v_mfma_f32_16x16x32_bf16 v[92:95], v[192:195], a[188:191], v[92:95]
  v_exp_f32 v212, v212
  v_mfma_f32_16x16x32_bf16 v[192:195], a[96:99], a[64:67], v[232:235]
  v_lshlrev_b32 v254, 16, v241
  v_and_b32 v241, 0xffff0000, v241
  v_mfma_f32_16x16x32_bf16 v[192:195], a[100:103], a[68:71], v[192:195]
  v_exp_f32 v213, v213
  v_mfma_f32_16x16x32_bf16 v[192:195], a[104:107], a[72:75], v[192:195]
  v_cvt_pk_bf16_f32 v206, v212, v213
  v_mul_f32 v254, s40, v254
  v_mfma_f32_16x16x32_bf16 v[192:195], a[108:111], a[76:79], v[192:195]
  s_mov_b32 m0, s37
  v_exp_f32 v214, v214
  v_mfma_f32_16x16x32_bf16 v[196:199], a[124:127], a[76:79], v[232:235]
  buffer_load_dwordx4 v252, s[24:27], s36 offen nt lds
  v_mfma_f32_16x16x32_bf16 v[196:199], a[120:123], a[72:75], v[196:199]
  v_exp_f32 v215, v215
  v_mfma_f32_16x16x32_bf16 v[196:199], a[116:119], a[68:71], v[196:199]
  v_cvt_pk_bf16_f32 v207, v214, v215
  v_mul_f32 v241, s40, v241
  v_mfma_f32_16x16x32_bf16 v[196:199], a[112:115], a[64:67], v[196:199]
  v_exp_f32 v192, v192
  v_smfmac_f32_16x16x64_bf16 a[240:243], a[232:235], v[200:207], v253
  v_cvt_pk_bf16_f32 v241, v254, v241
  v_mfma_f32_16x16x32_bf16 v[96:99], v[200:203], a[160:163], v[96:99]
  v_lshlrev_b32 v254, 16, v242
  v_and_b32 v242, 0xffff0000, v242
  v_mfma_f32_16x16x32_bf16 v[96:99], v[204:207], a[192:195], v[96:99]
  v_exp_f32 v193, v193
  v_mfma_f32_16x16x32_bf16 v[100:103], v[204:207], a[196:199], v[100:103]
  v_cvt_pk_bf16_f32 v192, v192, v193
  v_mul_f32 v254, s40, v254
  v_mfma_f32_16x16x32_bf16 v[100:103], v[200:203], a[164:167], v[100:103]
  s_add_u32 m0, s37, 12160
  v_exp_f32 v194, v194
  v_mfma_f32_16x16x32_bf16 v[104:107], v[200:203], a[168:171], v[104:107]
  buffer_load_dwordx4 v252, s[24:27], s36 offen offset:128 nt lds
  v_mfma_f32_16x16x32_bf16 v[104:107], v[204:207], a[200:203], v[104:107]
  s_add_u32 s37, s37, 1024
  v_exp_f32 v195, v195
  v_mfma_f32_16x16x32_bf16 v[108:111], v[204:207], a[204:207], v[108:111]
  s_add_u32 s36, s36, 2048
  v_cvt_pk_bf16_f32 v193, v194, v195
  v_mul_f32 v242, s40, v242
  v_mfma_f32_16x16x32_bf16 v[108:111], v[200:203], a[172:175], v[108:111]
  v_exp_f32 v196, v196
  v_mfma_f32_16x16x32_bf16 v[208:211], a[128:131], a[64:67], v[232:235]
  v_cvt_pk_bf16_f32 v242, v254, v242
  v_lshlrev_b32 v254, 16, v243
  v_mfma_f32_16x16x32_bf16 v[208:211], a[132:135], a[68:71], v[208:211]
  v_exp_f32 v197, v197
  v_mfma_f32_16x16x32_bf16 v[208:211], a[136:139], a[72:75], v[208:211]
  v_cvt_pk_bf16_f32 v194, v196, v197
  v_and_b32 v243, 0xffff0000, v243
  v_mfma_f32_16x16x32_bf16 v[208:211], a[140:143], a[76:79], v[208:211]
  v_exp_f32 v198, v198
  v_mfma_f32_16x16x32_bf16 v[212:215], a[156:159], a[76:79], v[232:235]
  v_mul_f32 v254, s40, v254
  v_mul_f32 v243, s40, v243
  v_mfma_f32_16x16x32_bf16 v[212:215], a[152:155], a[72:75], v[212:215]
  v_exp_f32 v199, v199
  v_mfma_f32_16x16x32_bf16 v[212:215], a[148:151], a[68:71], v[212:215]
  v_cvt_pk_bf16_f32 v195, v198, v199
  v_cvt_pk_bf16_f32 v243, v254, v243
  v_mfma_f32_16x16x32_bf16 v[212:215], a[144:147], a[64:67], v[212:215]
  v_exp_f32 v208, v208
  v_mfma_f32_16x16x32_bf16 v[112:115], v[200:203], a[176:179], v[112:115]
  ds_write_b128 v255, v[240:243] offset:12288
  v_mfma_f32_16x16x32_bf16 v[112:115], v[204:207], a[208:211], v[112:115]
  v_exp_f32 v209, v209
  v_mfma_f32_16x16x32_bf16 v[116:119], v[204:207], a[212:215], v[116:119]
  v_cvt_pk_bf16_f32 v196, v208, v209
  v_add_u32 v255, 1024, v255
  v_mfma_f32_16x16x32_bf16 v[116:119], v[200:203], a[180:183], v[116:119]
  v_exp_f32 v210, v210
  v_mfma_f32_16x16x32_bf16 v[120:123], v[200:203], a[184:187], v[120:123]
  v_mfma_f32_16x16x32_bf16 v[120:123], v[204:207], a[216:219], v[120:123]
  v_exp_f32 v211, v211
  v_mfma_f32_16x16x32_bf16 v[124:127], v[204:207], a[220:223], v[124:127]
  v_cvt_pk_bf16_f32 v197, v210, v211
  v_mfma_f32_16x16x32_bf16 v[124:127], v[200:203], a[188:191], v[124:127]
  v_exp_f32 v212, v212
  v_mfma_f32_16x16x32_bf16 v[200:203], a[96:99], a[80:83], v[236:239]
  v_mfma_f32_16x16x32_bf16 v[200:203], a[100:103], a[84:87], v[200:203]
  v_exp_f32 v213, v213
  v_mfma_f32_16x16x32_bf16 v[200:203], a[104:107], a[88:91], v[200:203]
  v_cvt_pk_bf16_f32 v198, v212, v213
  v_mfma_f32_16x16x32_bf16 v[200:203], a[108:111], a[92:95], v[200:203]
  v_exp_f32 v214, v214
  v_mfma_f32_16x16x32_bf16 v[204:207], a[124:127], a[92:95], v[236:239]
  v_mfma_f32_16x16x32_bf16 v[204:207], a[120:123], a[88:91], v[204:207]
  v_exp_f32 v215, v215
  v_mfma_f32_16x16x32_bf16 v[204:207], a[116:119], a[84:87], v[204:207]
  v_cvt_pk_bf16_f32 v199, v214, v215
  v_mfma_f32_16x16x32_bf16 v[204:207], a[112:115], a[80:83], v[204:207]
  s_nop 0
  v_exp_f32 v200, v200
  v_smfmac_f32_16x16x64_bf16 a[244:247], a[228:231], v[192:199], v253
  ds_read_b128 a[96:99], v246 offset:0
  v_mfma_f32_16x16x32_bf16 v[128:131], v[192:195], a[160:163], v[128:131]
  ds_read_b128 a[100:103], v247 offset:0
  v_mfma_f32_16x16x32_bf16 v[128:131], v[196:199], a[192:195], v[128:131]
  v_exp_f32 v201, v201
  v_mfma_f32_16x16x32_bf16 v[132:135], v[196:199], a[196:199], v[132:135]
  ds_read_b128 a[104:107], v246 offset:4096
  v_cvt_pk_bf16_f32 v200, v200, v201
  v_mfma_f32_16x16x32_bf16 v[132:135], v[192:195], a[164:167], v[132:135]
  v_exp_f32 v202, v202
  v_mfma_f32_16x16x32_bf16 v[136:139], v[192:195], a[168:171], v[136:139]
  ds_read_b128 a[108:111], v247 offset:4096
  v_mfma_f32_16x16x32_bf16 v[136:139], v[196:199], a[200:203], v[136:139]
  v_exp_f32 v203, v203
  v_mfma_f32_16x16x32_bf16 v[140:143], v[196:199], a[204:207], v[140:143]
  ds_read_b128 a[112:115], v246 offset:2048
  v_cvt_pk_bf16_f32 v201, v202, v203
  v_mfma_f32_16x16x32_bf16 v[140:143], v[192:195], a[172:175], v[140:143]
  v_exp_f32 v204, v204
  v_mfma_f32_16x16x32_bf16 v[208:211], a[128:131], a[80:83], v[236:239]
  ds_read_b128 a[116:119], v247 offset:2048
  v_mfma_f32_16x16x32_bf16 v[208:211], a[132:135], a[84:87], v[208:211]
  v_exp_f32 v205, v205
  v_mfma_f32_16x16x32_bf16 v[208:211], a[136:139], a[88:91], v[208:211]
  ds_read_b128 a[120:123], v246 offset:6144
  v_cvt_pk_bf16_f32 v202, v204, v205
  v_mfma_f32_16x16x32_bf16 v[208:211], a[140:143], a[92:95], v[208:211]
  v_exp_f32 v206, v206
  v_mfma_f32_16x16x32_bf16 v[212:215], a[156:159], a[92:95], v[236:239]
  ds_read_b128 a[124:127], v247 offset:6144
  v_mfma_f32_16x16x32_bf16 v[212:215], a[152:155], a[88:91], v[212:215]
  v_exp_f32 v207, v207
  v_mfma_f32_16x16x32_bf16 v[212:215], a[148:151], a[84:87], v[212:215]
  v_cvt_pk_bf16_f32 v203, v206, v207
  v_mfma_f32_16x16x32_bf16 v[212:215], a[144:147], a[80:83], v[212:215]
  v_exp_f32 v208, v208
  v_mfma_f32_16x16x32_bf16 v[144:147], v[192:195], a[176:179], v[144:147]
  v_mfma_f32_16x16x32_bf16 v[144:147], v[196:199], a[208:211], v[144:147]
  v_exp_f32 v209, v209
  v_mfma_f32_16x16x32_bf16 v[148:151], v[196:199], a[212:215], v[148:151]
  v_cvt_pk_bf16_f32 v204, v208, v209
  v_mfma_f32_16x16x32_bf16 v[148:151], v[192:195], a[180:183], v[148:151]
  v_exp_f32 v210, v210
  v_mfma_f32_16x16x32_bf16 v[152:155], v[192:195], a[184:187], v[152:155]
  v_mfma_f32_16x16x32_bf16 v[152:155], v[196:199], a[216:219], v[152:155]
  v_exp_f32 v211, v211
  v_mfma_f32_16x16x32_bf16 v[156:159], v[196:199], a[220:223], v[156:159]
  v_cvt_pk_bf16_f32 v205, v210, v211
  v_mfma_f32_16x16x32_bf16 v[156:159], v[192:195], a[188:191], v[156:159]
  s_waitcnt lgkmcnt(0)
  v_exp_f32 v212, v212
  v_mfma_f32_16x16x32_bf16 v[192:195], a[96:99], a[0:3], v[216:219]
  ds_read_b128 a[128:131], v246 offset:16384
  v_mfma_f32_16x16x32_bf16 v[192:195], a[100:103], a[4:7], v[192:195]
  v_exp_f32 v213, v213
  v_mfma_f32_16x16x32_bf16 v[192:195], a[104:107], a[8:11], v[192:195]
  ds_read_b128 a[132:135], v247 offset:16384
  v_cvt_pk_bf16_f32 v206, v212, v213
  v_mfma_f32_16x16x32_bf16 v[192:195], a[108:111], a[12:15], v[192:195]
  v_exp_f32 v214, v214
  v_mfma_f32_16x16x32_bf16 v[196:199], a[124:127], a[12:15], v[216:219]
  ds_read_b128 a[136:139], v246 offset:20480
  v_mfma_f32_16x16x32_bf16 v[196:199], a[120:123], a[8:11], v[196:199]
  v_exp_f32 v215, v215
  v_mfma_f32_16x16x32_bf16 v[196:199], a[116:119], a[4:7], v[196:199]
  ds_read_b128 a[140:143], v247 offset:20480
  v_cvt_pk_bf16_f32 v207, v214, v215
  v_mfma_f32_16x16x32_bf16 v[196:199], a[112:115], a[0:3], v[196:199]
  v_exp_f32 v192, v192
  v_smfmac_f32_16x16x64_bf16 a[244:247], a[232:235], v[200:207], v253
  ds_read_b128 a[144:147], v246 offset:18432
  v_mfma_f32_16x16x32_bf16 v[160:163], v[200:203], a[160:163], v[160:163]
  ds_read_b128 a[148:151], v247 offset:18432
  ds_read_b128 a[152:155], v246 offset:22528
  v_mfma_f32_16x16x32_bf16 v[160:163], v[204:207], a[192:195], v[160:163]
  v_exp_f32 v193, v193
  v_mfma_f32_16x16x32_bf16 v[164:167], v[204:207], a[196:199], v[164:167]
  ds_read_b128 a[156:159], v247 offset:22528
  v_cvt_pk_bf16_f32 v192, v192, v193
  v_mfma_f32_16x16x32_bf16 v[164:167], v[200:203], a[164:167], v[164:167]
  v_exp_f32 v194, v194
  v_mfma_f32_16x16x32_bf16 v[168:171], v[200:203], a[168:171], v[168:171]
  ds_read_b64_tr_b16 a[160:161], v248 offset:8192
  ds_read_b64_tr_b16 a[162:163], v248 offset:10240
  v_mfma_f32_16x16x32_bf16 v[168:171], v[204:207], a[200:203], v[168:171]
  v_exp_f32 v195, v195
  v_mfma_f32_16x16x32_bf16 v[172:175], v[204:207], a[204:207], v[172:175]
  ds_read_b64_tr_b16 a[192:193], v248 offset:24576
  v_cvt_pk_bf16_f32 v193, v194, v195
  v_mfma_f32_16x16x32_bf16 v[172:175], v[200:203], a[172:175], v[172:175]
  s_waitcnt lgkmcnt(6)
  v_exp_f32 v196, v196
  v_mfma_f32_16x16x32_bf16 v[208:211], a[128:131], a[0:3], v[216:219]
  ds_read_b64_tr_b16 a[194:195], v248 offset:26624
  ds_read_b64_tr_b16 a[164:165], v249 offset:8192
  v_mfma_f32_16x16x32_bf16 v[208:211], a[132:135], a[4:7], v[208:211]
  v_exp_f32 v197, v197
  v_mfma_f32_16x16x32_bf16 v[208:211], a[136:139], a[8:11], v[208:211]
  ds_read_b64_tr_b16 a[166:167], v249 offset:10240
  v_cvt_pk_bf16_f32 v194, v196, v197
  v_mfma_f32_16x16x32_bf16 v[208:211], a[140:143], a[12:15], v[208:211]
  s_waitcnt lgkmcnt(6)
  v_exp_f32 v198, v198
  v_mfma_f32_16x16x32_bf16 v[212:215], a[156:159], a[12:15], v[216:219]
  ds_read_b64_tr_b16 a[196:197], v249 offset:24576
  ds_read_b64_tr_b16 a[198:199], v249 offset:26624
  v_mfma_f32_16x16x32_bf16 v[212:215], a[152:155], a[8:11], v[212:215]
  v_exp_f32 v199, v199
  v_mfma_f32_16x16x32_bf16 v[212:215], a[148:151], a[4:7], v[212:215]
  ds_read_b64_tr_b16 a[168:169], v250 offset:8192
  v_cvt_pk_bf16_f32 v195, v198, v199
  v_mfma_f32_16x16x32_bf16 v[212:215], a[144:147], a[0:3], v[212:215]
  v_exp_f32 v208, v208
  v_mfma_f32_16x16x32_bf16 v[176:179], v[200:203], a[176:179], v[176:179]
  ds_read_b64_tr_b16 a[170:171], v250 offset:10240
  ds_read_b64_tr_b16 a[200:201], v250 offset:24576
  v_mfma_f32_16x16x32_bf16 v[176:179], v[204:207], a[208:211], v[176:179]
  v_exp_f32 v209, v209
  v_mfma_f32_16x16x32_bf16 v[180:183], v[204:207], a[212:215], v[180:183]
  ds_read_b64_tr_b16 a[202:203], v250 offset:26624
  v_cvt_pk_bf16_f32 v196, v208, v209
  v_mfma_f32_16x16x32_bf16 v[180:183], v[200:203], a[180:183], v[180:183]
  v_exp_f32 v210, v210
  v_mfma_f32_16x16x32_bf16 v[184:187], v[200:203], a[184:187], v[184:187]
  ds_read_b64_tr_b16 a[172:173], v251 offset:8192
  ds_read_b64_tr_b16 a[174:175], v251 offset:10240
  v_mfma_f32_16x16x32_bf16 v[184:187], v[204:207], a[216:219], v[184:187]
  v_exp_f32 v211, v211
  v_mfma_f32_16x16x32_bf16 v[188:191], v[204:207], a[220:223], v[188:191]
  ds_read_b64_tr_b16 a[204:205], v251 offset:24576
  v_cvt_pk_bf16_f32 v197, v210, v211
  v_mfma_f32_16x16x32_bf16 v[188:191], v[200:203], a[188:191], v[188:191]
  v_exp_f32 v212, v212
  v_mfma_f32_16x16x32_bf16 v[200:203], a[96:99], a[16:19], v[220:223]
  ds_read_b64_tr_b16 a[206:207], v251 offset:26624
  ds_read_b64_tr_b16 a[176:177], v248 offset:12288
  v_mfma_f32_16x16x32_bf16 v[200:203], a[100:103], a[20:23], v[200:203]
  v_exp_f32 v213, v213
  v_mfma_f32_16x16x32_bf16 v[200:203], a[104:107], a[24:27], v[200:203]
  ds_read_b64_tr_b16 a[178:179], v248 offset:14336
  v_cvt_pk_bf16_f32 v198, v212, v213
  v_mfma_f32_16x16x32_bf16 v[200:203], a[108:111], a[28:31], v[200:203]
  v_exp_f32 v214, v214
  v_mfma_f32_16x16x32_bf16 v[204:207], a[124:127], a[28:31], v[220:223]
  ds_read_b64_tr_b16 a[208:209], v248 offset:28672
  ds_read_b64_tr_b16 a[210:211], v248 offset:30720
  v_mfma_f32_16x16x32_bf16 v[204:207], a[120:123], a[24:27], v[204:207]
  v_exp_f32 v215, v215
  v_mfma_f32_16x16x32_bf16 v[204:207], a[116:119], a[20:23], v[204:207]
  ds_read_b64_tr_b16 a[180:181], v249 offset:12288
  v_cvt_pk_bf16_f32 v199, v214, v215
  v_mfma_f32_16x16x32_bf16 v[204:207], a[112:115], a[16:19], v[204:207]
  v_exp_f32 v200, v200
  v_smfmac_f32_16x16x64_bf16 a[236:239], a[228:231], v[192:199], v253
  s_waitcnt lgkmcnt(4)
  ds_read_b64_tr_b16 a[182:183], v249 offset:14336
  v_mfma_f32_16x16x32_bf16 v[0:3], v[192:195], a[160:163], v[0:3]
  ds_read_b64_tr_b16 a[212:213], v249 offset:28672
  ds_read_b64_tr_b16 a[214:215], v249 offset:30720
  v_mfma_f32_16x16x32_bf16 v[0:3], v[196:199], a[192:195], v[0:3]
  v_exp_f32 v201, v201
  v_mfma_f32_16x16x32_bf16 v[4:7], v[196:199], a[196:199], v[4:7]
  ds_read_b64_tr_b16 a[184:185], v250 offset:12288
  v_cvt_pk_bf16_f32 v200, v200, v201
  v_mfma_f32_16x16x32_bf16 v[4:7], v[192:195], a[164:167], v[4:7]
  v_exp_f32 v202, v202
  v_mfma_f32_16x16x32_bf16 v[8:11], v[192:195], a[168:171], v[8:11]
  ds_read_b64_tr_b16 a[186:187], v250 offset:14336
  ds_read_b64_tr_b16 a[216:217], v250 offset:28672
  v_mfma_f32_16x16x32_bf16 v[8:11], v[196:199], a[200:203], v[8:11]
  v_exp_f32 v203, v203
  v_mfma_f32_16x16x32_bf16 v[12:15], v[196:199], a[204:207], v[12:15]
  ds_read_b64_tr_b16 a[218:219], v250 offset:30720
  v_cvt_pk_bf16_f32 v201, v202, v203
  v_mfma_f32_16x16x32_bf16 v[12:15], v[192:195], a[172:175], v[12:15]
  v_exp_f32 v204, v204
  v_mfma_f32_16x16x32_bf16 v[208:211], a[128:131], a[16:19], v[220:223]
  ds_read_b64_tr_b16 a[188:189], v251 offset:12288
  ds_read_b64_tr_b16 a[190:191], v251 offset:14336
  v_mfma_f32_16x16x32_bf16 v[208:211], a[132:135], a[20:23], v[208:211]
  v_exp_f32 v205, v205
  v_mfma_f32_16x16x32_bf16 v[208:211], a[136:139], a[24:27], v[208:211]
  ds_read_b64_tr_b16 a[220:221], v251 offset:28672
  v_cvt_pk_bf16_f32 v202, v204, v205
  v_mfma_f32_16x16x32_bf16 v[208:211], a[140:143], a[28:31], v[208:211]
  v_exp_f32 v206, v206
  v_mfma_f32_16x16x32_bf16 v[212:215], a[156:159], a[28:31], v[220:223]
  ds_read_b64_tr_b16 a[222:223], v251 offset:30720
  v_mfma_f32_16x16x32_bf16 v[212:215], a[152:155], a[24:27], v[212:215]
  v_exp_f32 v207, v207
  v_mfma_f32_16x16x32_bf16 v[212:215], a[148:151], a[20:23], v[212:215]
  v_cvt_pk_bf16_f32 v203, v206, v207
  v_mfma_f32_16x16x32_bf16 v[212:215], a[144:147], a[16:19], v[212:215]
  s_waitcnt lgkmcnt(4)
  v_exp_f32 v208, v208
  v_mfma_f32_16x16x32_bf16 v[16:19], v[192:195], a[176:179], v[16:19]
  v_mfma_f32_16x16x32_bf16 v[16:19], v[196:199], a[208:211], v[16:19]
  v_exp_f32 v209, v209
  v_mfma_f32_16x16x32_bf16 v[20:23], v[196:199], a[212:215], v[20:23]
  v_cvt_pk_bf16_f32 v204, v208, v209
  v_mfma_f32_16x16x32_bf16 v[20:23], v[192:195], a[180:183], v[20:23]
  s_waitcnt vmcnt(2) lgkmcnt(0)
  v_exp_f32 v210, v210
  v_mfma_f32_16x16x32_bf16 v[24:27], v[192:195], a[184:187], v[24:27]
  s_barrier
  v_mfma_f32_16x16x32_bf16 v[24:27], v[196:199], a[216:219], v[24:27]
  v_exp_f32 v211, v211
  v_mfma_f32_16x16x32_bf16 v[28:31], v[196:199], a[220:223], v[28:31]
  v_cvt_pk_bf16_f32 v205, v210, v211
  v_mfma_f32_16x16x32_bf16 v[28:31], v[192:195], a[188:191], v[28:31]
  v_exp_f32 v212, v212
  v_mfma_f32_16x16x32_bf16 v[192:195], a[96:99], a[32:35], v[224:227]
  ds_read_b128 v[240:243], v255 offset:0
  v_mfma_f32_16x16x32_bf16 v[192:195], a[100:103], a[36:39], v[192:195]
  v_exp_f32 v213, v213
  v_mfma_f32_16x16x32_bf16 v[192:195], a[104:107], a[40:43], v[192:195]
  v_cvt_pk_bf16_f32 v206, v212, v213
  v_mfma_f32_16x16x32_bf16 v[192:195], a[108:111], a[44:47], v[192:195]
  s_add_u32 m0, s38, 0
  v_exp_f32 v214, v214
  v_mfma_f32_16x16x32_bf16 v[196:199], a[124:127], a[44:47], v[224:227]
  buffer_load_dwordx4 v252, s[16:19], s33 offen nt lds
  v_mfma_f32_16x16x32_bf16 v[196:199], a[120:123], a[40:43], v[196:199]
  v_exp_f32 v215, v215
  v_mfma_f32_16x16x32_bf16 v[196:199], a[116:119], a[36:39], v[196:199]
  v_cvt_pk_bf16_f32 v207, v214, v215
  v_mfma_f32_16x16x32_bf16 v[196:199], a[112:115], a[32:35], v[196:199]
  v_exp_f32 v192, v192
  v_smfmac_f32_16x16x64_bf16 a[236:239], a[232:235], v[200:207], v253
  s_waitcnt lgkmcnt(0)
  v_lshlrev_b32 v254, 16, v240
  v_mfma_f32_16x16x32_bf16 v[32:35], v[200:203], a[160:163], v[32:35]
  v_and_b32 v240, 0xffff0000, v240
  v_mul_f32 v254, s40, v254
  v_mfma_f32_16x16x32_bf16 v[32:35], v[204:207], a[192:195], v[32:35]
  v_exp_f32 v193, v193
  v_mfma_f32_16x16x32_bf16 v[36:39], v[204:207], a[196:199], v[36:39]
  v_cvt_pk_bf16_f32 v192, v192, v193
  v_mul_f32 v240, s40, v240
  v_mfma_f32_16x16x32_bf16 v[36:39], v[200:203], a[164:167], v[36:39]
  s_add_u32 m0, s38, 3968
  v_exp_f32 v194, v194
  v_mfma_f32_16x16x32_bf16 v[40:43], v[200:203], a[168:171], v[40:43]
  buffer_load_dwordx4 v252, s[16:19], s33 offen offset:128 nt lds
  v_mfma_f32_16x16x32_bf16 v[40:43], v[204:207], a[200:203], v[40:43]
  v_exp_f32 v195, v195
  v_mfma_f32_16x16x32_bf16 v[44:47], v[204:207], a[204:207], v[44:47]
  v_cvt_pk_bf16_f32 v193, v194, v195
  v_cvt_pk_bf16_f32 v240, v254, v240
  v_mfma_f32_16x16x32_bf16 v[44:47], v[200:203], a[172:175], v[44:47]
  v_exp_f32 v196, v196
  v_mfma_f32_16x16x32_bf16 v[208:211], a[128:131], a[32:35], v[224:227]
  v_lshlrev_b32 v254, 16, v241
  v_and_b32 v241, 0xffff0000, v241
  v_mfma_f32_16x16x32_bf16 v[208:211], a[132:135], a[36:39], v[208:211]
  v_exp_f32 v197, v197
  v_mfma_f32_16x16x32_bf16 v[208:211], a[136:139], a[40:43], v[208:211]
  v_cvt_pk_bf16_f32 v194, v196, v197
  v_mul_f32 v254, s40, v254
  v_mfma_f32_16x16x32_bf16 v[208:211], a[140:143], a[44:47], v[208:211]
  s_add_u32 m0, s38, 8192
  v_exp_f32 v198, v198
  v_mfma_f32_16x16x32_bf16 v[212:215], a[156:159], a[44:47], v[224:227]
  buffer_load_dwordx4 v252, s[20:23], s33 offen nt lds
  v_mfma_f32_16x16x32_bf16 v[212:215], a[152:155], a[40:43], v[212:215]
  v_exp_f32 v199, v199
  v_mfma_f32_16x16x32_bf16 v[212:215], a[148:151], a[36:39], v[212:215]
  v_cvt_pk_bf16_f32 v195, v198, v199
  v_mul_f32 v241, s40, v241
  v_mfma_f32_16x16x32_bf16 v[212:215], a[144:147], a[32:35], v[212:215]
  v_exp_f32 v208, v208
  v_mfma_f32_16x16x32_bf16 v[48:51], v[200:203], a[176:179], v[48:51]
  v_cvt_pk_bf16_f32 v241, v254, v241
  v_lshlrev_b32 v254, 16, v242
  v_mfma_f32_16x16x32_bf16 v[48:51], v[204:207], a[208:211], v[48:51]
  v_exp_f32 v209, v209
  v_mfma_f32_16x16x32_bf16 v[52:55], v[204:207], a[212:215], v[52:55]
  v_cvt_pk_bf16_f32 v196, v208, v209
  v_and_b32 v242, 0xffff0000, v242
  v_mfma_f32_16x16x32_bf16 v[52:55], v[200:203], a[180:183], v[52:55]
  s_add_u32 m0, s38, 12160
  v_exp_f32 v210, v210
  v_mfma_f32_16x16x32_bf16 v[56:59], v[200:203], a[184:187], v[56:59]
  buffer_load_dwordx4 v252, s[20:23], s33 offen offset:128 nt lds
  v_mfma_f32_16x16x32_bf16 v[56:59], v[204:207], a[216:219], v[56:59]
  s_add_u32 s34, s34, 1
  v_exp_f32 v211, v211
  v_mfma_f32_16x16x32_bf16 v[60:63], v[204:207], a[220:223], v[60:63]
  s_add_u32 s33, s33, 8192
  v_cvt_pk_bf16_f32 v197, v210, v211
  v_mul_f32 v254, s40, v254
  v_mfma_f32_16x16x32_bf16 v[60:63], v[200:203], a[188:191], v[60:63]
  s_cmp_eq_u32 s34, 23
  v_exp_f32 v212, v212
  v_mfma_f32_16x16x32_bf16 v[200:203], a[96:99], a[48:51], v[228:231]
  s_cselect_b32 s33, s58, s33
  v_mul_f32 v242, s40, v242
  v_cvt_pk_bf16_f32 v242, v254, v242
  v_mfma_f32_16x16x32_bf16 v[200:203], a[100:103], a[52:55], v[200:203]
  v_exp_f32 v213, v213
  v_mfma_f32_16x16x32_bf16 v[200:203], a[104:107], a[56:59], v[200:203]
  v_cvt_pk_bf16_f32 v198, v212, v213
  v_lshlrev_b32 v254, 16, v243
  v_mfma_f32_16x16x32_bf16 v[200:203], a[108:111], a[60:63], v[200:203]
  s_add_u32 m0, s38, 16384
  v_exp_f32 v214, v214
  v_mfma_f32_16x16x32_bf16 v[204:207], a[124:127], a[60:63], v[228:231]
  buffer_load_dwordx4 v252, s[16:19], s33 offen nt lds
  v_mfma_f32_16x16x32_bf16 v[204:207], a[120:123], a[56:59], v[204:207]
  v_exp_f32 v215, v215
  v_mfma_f32_16x16x32_bf16 v[204:207], a[116:119], a[52:55], v[204:207]
  v_cvt_pk_bf16_f32 v199, v214, v215
  v_and_b32 v243, 0xffff0000, v243
  v_mfma_f32_16x16x32_bf16 v[204:207], a[112:115], a[48:51], v[204:207]
  v_exp_f32 v200, v200
  v_smfmac_f32_16x16x64_bf16 a[240:243], a[228:231], v[192:199], v253
  v_mul_f32 v254, s40, v254
  v_mfma_f32_16x16x32_bf16 v[64:67], v[192:195], a[160:163], v[64:67]
  v_mul_f32 v243, s40, v243
  v_cvt_pk_bf16_f32 v243, v254, v243
  v_mfma_f32_16x16x32_bf16 v[64:67], v[196:199], a[192:195], v[64:67]
  v_exp_f32 v201, v201
  v_mfma_f32_16x16x32_bf16 v[68:71], v[196:199], a[196:199], v[68:71]
  ds_write_b128 v255, v[240:243] offset:0
  v_cvt_pk_bf16_f32 v200, v200, v201
  v_mfma_f32_16x16x32_bf16 v[68:71], v[192:195], a[164:167], v[68:71]
  s_add_u32 m0, s38, 20352
  v_exp_f32 v202, v202
  v_mfma_f32_16x16x32_bf16 v[72:75], v[192:195], a[168:171], v[72:75]
  buffer_load_dwordx4 v252, s[16:19], s33 offen offset:128 nt lds
  v_mfma_f32_16x16x32_bf16 v[72:75], v[196:199], a[200:203], v[72:75]
  v_exp_f32 v203, v203
  v_mfma_f32_16x16x32_bf16 v[76:79], v[196:199], a[204:207], v[76:79]
  ds_read_b128 v[240:243], v255 offset:12288
  v_cvt_pk_bf16_f32 v201, v202, v203
  v_mfma_f32_16x16x32_bf16 v[76:79], v[192:195], a[172:175], v[76:79]
  v_exp_f32 v204, v204
  v_mfma_f32_16x16x32_bf16 v[208:211], a[128:131], a[48:51], v[228:231]
  v_mfma_f32_16x16x32_bf16 v[208:211], a[132:135], a[52:55], v[208:211]
  v_exp_f32 v205, v205
  v_mfma_f32_16x16x32_bf16 v[208:211], a[136:139], a[56:59], v[208:211]
  v_cvt_pk_bf16_f32 v202, v204, v205
  v_mfma_f32_16x16x32_bf16 v[208:211], a[140:143], a[60:63], v[208:211]
  s_add_u32 m0, s38, 24576
  v_exp_f32 v206, v206
  v_mfma_f32_16x16x32_bf16 v[212:215], a[156:159], a[60:63], v[228:231]
  buffer_load_dwordx4 v252, s[20:23], s33 offen nt lds
  v_mfma_f32_16x16x32_bf16 v[212:215], a[152:155], a[56:59], v[212:215]
  v_exp_f32 v207, v207
  v_mfma_f32_16x16x32_bf16 v[212:215], a[148:151], a[52:55], v[212:215]
  v_cvt_pk_bf16_f32 v203, v206, v207
  s_waitcnt lgkmcnt(0)
  v_lshlrev_b32 v254, 16, v240
  v_mfma_f32_16x16x32_bf16 v[212:215], a[144:147], a[48:51], v[212:215]
  v_exp_f32 v208, v208
  v_mfma_f32_16x16x32_bf16 v[80:83], v[192:195], a[176:179], v[80:83]
  v_and_b32 v240, 0xffff0000, v240
  v_mul_f32 v254, s40, v254
  v_mfma_f32_16x16x32_bf16 v[80:83], v[196:199], a[208:211], v[80:83]
  v_exp_f32 v209, v209
  v_mfma_f32_16x16x32_bf16 v[84:87], v[196:199], a[212:215], v[84:87]
  v_cvt_pk_bf16_f32 v204, v208, v209
  v_mul_f32 v240, s40, v240
  v_mfma_f32_16x16x32_bf16 v[84:87], v[192:195], a[180:183], v[84:87]
  s_add_u32 m0, s38, 28544
  v_exp_f32 v210, v210
  v_mfma_f32_16x16x32_bf16 v[88:91], v[192:195], a[184:187], v[88:91]
  buffer_load_dwordx4 v252, s[20:23], s33 offen offset:128 nt lds
  v_mfma_f32_16x16x32_bf16 v[88:91], v[196:199], a[216:219], v[88:91]
  s_add_u32 s34, s34, 1
  v_exp_f32 v211, v211
  v_mfma_f32_16x16x32_bf16 v[92:95], v[196:199], a[220:223], v[92:95]
  s_add_u32 s33, s33, 8192
  v_cvt_pk_bf16_f32 v205, v210, v211
  v_cvt_pk_bf16_f32 v240, v254, v240
  v_mfma_f32_16x16x32_bf16 v[92:95], v[192:195], a[188:191], v[92:95]
  v_exp_f32 v212, v212
  v_mfma_f32_16x16x32_bf16 v[192:195], a[96:99], a[64:67], v[232:235]
  v_lshlrev_b32 v254, 16, v241
  v_and_b32 v241, 0xffff0000, v241
  v_mfma_f32_16x16x32_bf16 v[192:195], a[100:103], a[68:71], v[192:195]
  v_exp_f32 v213, v213
  v_mfma_f32_16x16x32_bf16 v[192:195], a[104:107], a[72:75], v[192:195]
  v_cvt_pk_bf16_f32 v206, v212, v213
  v_mul_f32 v254, s40, v254
  v_mfma_f32_16x16x32_bf16 v[192:195], a[108:111], a[76:79], v[192:195]
  s_mov_b32 m0, s37
  v_exp_f32 v214, v214
  v_mfma_f32_16x16x32_bf16 v[196:199], a[124:127], a[76:79], v[232:235]
  buffer_load_dwordx4 v252, s[24:27], s36 offen nt lds
  v_mfma_f32_16x16x32_bf16 v[196:199], a[120:123], a[72:75], v[196:199]
  v_exp_f32 v215, v215
  v_mfma_f32_16x16x32_bf16 v[196:199], a[116:119], a[68:71], v[196:199]
  v_cvt_pk_bf16_f32 v207, v214, v215
  v_mul_f32 v241, s40, v241
  v_mfma_f32_16x16x32_bf16 v[196:199], a[112:115], a[64:67], v[196:199]
  v_exp_f32 v192, v192
  v_smfmac_f32_16x16x64_bf16 a[240:243], a[232:235], v[200:207], v253
  v_cvt_pk_bf16_f32 v241, v254, v241
  v_mfma_f32_16x16x32_bf16 v[96:99], v[200:203], a[160:163], v[96:99]
  v_lshlrev_b32 v254, 16, v242
  v_and_b32 v242, 0xffff0000, v242
  v_mfma_f32_16x16x32_bf16 v[96:99], v[204:207], a[192:195], v[96:99]
  v_exp_f32 v193, v193
  v_mfma_f32_16x16x32_bf16 v[100:103], v[204:207], a[196:199], v[100:103]
  v_cvt_pk_bf16_f32 v192, v192, v193
  v_mul_f32 v254, s40, v254
  v_mfma_f32_16x16x32_bf16 v[100:103], v[200:203], a[164:167], v[100:103]
  s_add_u32 m0, s37, 12160
  v_exp_f32 v194, v194
  v_mfma_f32_16x16x32_bf16 v[104:107], v[200:203], a[168:171], v[104:107]
  buffer_load_dwordx4 v252, s[24:27], s36 offen offset:128 nt lds
  v_mfma_f32_16x16x32_bf16 v[104:107], v[204:207], a[200:203], v[104:107]
  s_add_u32 s37, s37, 1024
  v_exp_f32 v195, v195
  v_mfma_f32_16x16x32_bf16 v[108:111], v[204:207], a[204:207], v[108:111]
  s_add_u32 s36, s36, 2048
  v_cvt_pk_bf16_f32 v193, v194, v195
  v_mul_f32 v242, s40, v242
  v_mfma_f32_16x16x32_bf16 v[108:111], v[200:203], a[172:175], v[108:111]
  v_exp_f32 v196, v196
  v_mfma_f32_16x16x32_bf16 v[208:211], a[128:131], a[64:67], v[232:235]
  v_cvt_pk_bf16_f32 v242, v254, v242
  v_lshlrev_b32 v254, 16, v243
  v_mfma_f32_16x16x32_bf16 v[208:211], a[132:135], a[68:71], v[208:211]
  v_exp_f32 v197, v197
  v_mfma_f32_16x16x32_bf16 v[208:211], a[136:139], a[72:75], v[208:211]
  v_cvt_pk_bf16_f32 v194, v196, v197
  v_and_b32 v243, 0xffff0000, v243
  v_mfma_f32_16x16x32_bf16 v[208:211], a[140:143], a[76:79], v[208:211]
  v_exp_f32 v198, v198
  v_mfma_f32_16x16x32_bf16 v[212:215], a[156:159], a[76:79], v[232:235]
  v_mul_f32 v254, s40, v254
  v_mul_f32 v243, s40, v243
  v_mfma_f32_16x16x32_bf16 v[212:215], a[152:155], a[72:75], v[212:215]
  v_exp_f32 v199, v199
  v_mfma_f32_16x16x32_bf16 v[212:215], a[148:151], a[68:71], v[212:215]
  v_cvt_pk_bf16_f32 v195, v198, v199
  v_cvt_pk_bf16_f32 v243, v254, v243
  v_mfma_f32_16x16x32_bf16 v[212:215], a[144:147], a[64:67], v[212:215]
  v_exp_f32 v208, v208
  v_mfma_f32_16x16x32_bf16 v[112:115], v[200:203], a[176:179], v[112:115]
  ds_write_b128 v255, v[240:243] offset:12288
  v_mfma_f32_16x16x32_bf16 v[112:115], v[204:207], a[208:211], v[112:115]
  v_exp_f32 v209, v209
  v_mfma_f32_16x16x32_bf16 v[116:119], v[204:207], a[212:215], v[116:119]
  v_cvt_pk_bf16_f32 v196, v208, v209
  v_add_u32 v255, 1024, v255
  v_mfma_f32_16x16x32_bf16 v[116:119], v[200:203], a[180:183], v[116:119]
  v_exp_f32 v210, v210
  v_mfma_f32_16x16x32_bf16 v[120:123], v[200:203], a[184:187], v[120:123]
  v_mfma_f32_16x16x32_bf16 v[120:123], v[204:207], a[216:219], v[120:123]
  v_exp_f32 v211, v211
  v_mfma_f32_16x16x32_bf16 v[124:127], v[204:207], a[220:223], v[124:127]
  v_cvt_pk_bf16_f32 v197, v210, v211
  v_mfma_f32_16x16x32_bf16 v[124:127], v[200:203], a[188:191], v[124:127]
  v_exp_f32 v212, v212
  v_mfma_f32_16x16x32_bf16 v[200:203], a[96:99], a[80:83], v[236:239]
  v_mfma_f32_16x16x32_bf16 v[200:203], a[100:103], a[84:87], v[200:203]
  v_exp_f32 v213, v213
  v_mfma_f32_16x16x32_bf16 v[200:203], a[104:107], a[88:91], v[200:203]
  v_cvt_pk_bf16_f32 v198, v212, v213
  v_mfma_f32_16x16x32_bf16 v[200:203], a[108:111], a[92:95], v[200:203]
  v_exp_f32 v214, v214
  v_mfma_f32_16x16x32_bf16 v[204:207], a[124:127], a[92:95], v[236:239]
  v_mfma_f32_16x16x32_bf16 v[204:207], a[120:123], a[88:91], v[204:207]
  v_exp_f32 v215, v215
  v_mfma_f32_16x16x32_bf16 v[204:207], a[116:119], a[84:87], v[204:207]
  v_cvt_pk_bf16_f32 v199, v214, v215
  v_mfma_f32_16x16x32_bf16 v[204:207], a[112:115], a[80:83], v[204:207]
  s_nop 0
  v_exp_f32 v200, v200
  v_smfmac_f32_16x16x64_bf16 a[244:247], a[228:231], v[192:199], v253
  ds_read_b128 a[96:99], v246 offset:32768
  v_mfma_f32_16x16x32_bf16 v[128:131], v[192:195], a[160:163], v[128:131]
  ds_read_b128 a[100:103], v247 offset:32768
  v_mfma_f32_16x16x32_bf16 v[128:131], v[196:199], a[192:195], v[128:131]
  v_exp_f32 v201, v201
  v_mfma_f32_16x16x32_bf16 v[132:135], v[196:199], a[196:199], v[132:135]
  ds_read_b128 a[104:107], v246 offset:36864
  v_cvt_pk_bf16_f32 v200, v200, v201
  v_mfma_f32_16x16x32_bf16 v[132:135], v[192:195], a[164:167], v[132:135]
  v_exp_f32 v202, v202
  v_mfma_f32_16x16x32_bf16 v[136:139], v[192:195], a[168:171], v[136:139]
  ds_read_b128 a[108:111], v247 offset:36864
  v_mfma_f32_16x16x32_bf16 v[136:139], v[196:199], a[200:203], v[136:139]
  v_exp_f32 v203, v203
  v_mfma_f32_16x16x32_bf16 v[140:143], v[196:199], a[204:207], v[140:143]
  ds_read_b128 a[112:115], v246 offset:34816
  v_cvt_pk_bf16_f32 v201, v202, v203
  v_mfma_f32_16x16x32_bf16 v[140:143], v[192:195], a[172:175], v[140:143]
  v_exp_f32 v204, v204
  v_mfma_f32_16x16x32_bf16 v[208:211], a[128:131], a[80:83], v[236:239]
  ds_read_b128 a[116:119], v247 offset:34816
  v_mfma_f32_16x16x32_bf16 v[208:211], a[132:135], a[84:87], v[208:211]
  v_exp_f32 v205, v205
  v_mfma_f32_16x16x32_bf16 v[208:211], a[136:139], a[88:91], v[208:211]
  ds_read_b128 a[120:123], v246 offset:38912
  v_cvt_pk_bf16_f32 v202, v204, v205
  v_mfma_f32_16x16x32_bf16 v[208:211], a[140:143], a[92:95], v[208:211]
  v_exp_f32 v206, v206
  v_mfma_f32_16x16x32_bf16 v[212:215], a[156:159], a[92:95], v[236:239]
  ds_read_b128 a[124:127], v247 offset:38912
  v_mfma_f32_16x16x32_bf16 v[212:215], a[152:155], a[88:91], v[212:215]
  v_exp_f32 v207, v207
  v_mfma_f32_16x16x32_bf16 v[212:215], a[148:151], a[84:87], v[212:215]
  v_cvt_pk_bf16_f32 v203, v206, v207
  v_mfma_f32_16x16x32_bf16 v[212:215], a[144:147], a[80:83], v[212:215]
  v_exp_f32 v208, v208
  v_mfma_f32_16x16x32_bf16 v[144:147], v[192:195], a[176:179], v[144:147]
  v_mfma_f32_16x16x32_bf16 v[144:147], v[196:199], a[208:211], v[144:147]
  v_exp_f32 v209, v209
  v_mfma_f32_16x16x32_bf16 v[148:151], v[196:199], a[212:215], v[148:151]
  v_cvt_pk_bf16_f32 v204, v208, v209
  v_mfma_f32_16x16x32_bf16 v[148:151], v[192:195], a[180:183], v[148:151]
  v_exp_f32 v210, v210
  v_mfma_f32_16x16x32_bf16 v[152:155], v[192:195], a[184:187], v[152:155]
  v_mfma_f32_16x16x32_bf16 v[152:155], v[196:199], a[216:219], v[152:155]
  v_exp_f32 v211, v211
  v_mfma_f32_16x16x32_bf16 v[156:159], v[196:199], a[220:223], v[156:159]
  v_cvt_pk_bf16_f32 v205, v210, v211
  v_mfma_f32_16x16x32_bf16 v[156:159], v[192:195], a[188:191], v[156:159]
  s_cmp_eq_u32 s34, 26
  v_exp_f32 v212, v212
  s_waitcnt lgkmcnt(7)
  v_mfma_f32_16x16x32_bf16 v[192:195], a[96:99], a[0:3], v[216:219]
  s_cbranch_scc0 L_loopA
  s_waitcnt lgkmcnt(7)
  s_waitcnt lgkmcnt(6)
  ds_read_b128 a[128:131], v246 offset:49152
  v_mfma_f32_16x16x32_bf16 v[192:195], a[100:103], a[4:7], v[192:195]
  s_waitcnt lgkmcnt(6)
  v_exp_f32 v213, v213
  v_mfma_f32_16x16x32_bf16 v[192:195], a[104:107], a[8:11], v[192:195]
  s_waitcnt lgkmcnt(5)
  s_waitcnt vmcnt(10)
  ds_read_b128 a[132:135], v247 offset:49152
  v_cvt_pk_bf16_f32 v206, v212, v213
  v_mfma_f32_16x16x32_bf16 v[192:195], a[108:111], a[12:15], v[192:195]
  s_waitcnt lgkmcnt(2)
  v_exp_f32 v214, v214
  v_mfma_f32_16x16x32_bf16 v[196:199], a[124:127], a[12:15], v[216:219]
  ds_read_b128 a[136:139], v246 offset:53248
  ds_read_b128 v[240:243], v255 offset:0
  v_mfma_f32_16x16x32_bf16 v[196:199], a[120:123], a[8:11], v[196:199]
  v_exp_f32 v215, v215
  v_mfma_f32_16x16x32_bf16 v[196:199], a[116:119], a[4:7], v[196:199]
  ds_read_b128 a[140:143], v247 offset:53248
  v_cvt_pk_bf16_f32 v207, v214, v215
  v_mfma_f32_16x16x32_bf16 v[196:199], a[112:115], a[0:3], v[196:199]
  v_exp_f32 v192, v192
  v_smfmac_f32_16x16x64_bf16 a[244:247], a[232:235], v[200:207], v253
  ds_read_b128 a[144:147], v246 offset:51200
  v_mfma_f32_16x16x32_bf16 v[160:163], v[200:203], a[160:163], v[160:163]
  ds_read_b128 a[148:151], v247 offset:51200
  v_mfma_f32_16x16x32_bf16 v[160:163], v[204:207], a[192:195], v[160:163]
  v_exp_f32 v193, v193
  v_mfma_f32_16x16x32_bf16 v[164:167], v[204:207], a[196:199], v[164:167]
  ds_read_b128 a[152:155], v246 offset:55296
  v_cvt_pk_bf16_f32 v192, v192, v193
  s_waitcnt lgkmcnt(4)
  v_lshlrev_b32 v254, 16, v240
  v_and_b32 v240, 0xffff0000, v240
  v_mfma_f32_16x16x32_bf16 v[164:167], v[200:203], a[164:167], v[164:167]
  v_exp_f32 v194, v194
  v_mul_f32 v254, s40, v254
  v_mul_f32 v240, s40, v240
  v_mfma_f32_16x16x32_bf16 v[168:171], v[200:203], a[168:171], v[168:171]
  ds_read_b128 a[156:159], v247 offset:55296
  v_cvt_pk_bf16_f32 v240, v254, v240
  v_lshlrev_b32 v254, 16, v241
  v_and_b32 v241, 0xffff0000, v241
  v_mfma_f32_16x16x32_bf16 v[168:171], v[204:207], a[200:203], v[168:171]
  v_exp_f32 v195, v195
  v_mul_f32 v254, s40, v254
  v_mul_f32 v241, s40, v241
  v_cvt_pk_bf16_f32 v241, v254, v241
  v_mfma_f32_16x16x32_bf16 v[172:175], v[204:207], a[204:207], v[172:175]
  ds_read_b128 a[0:3], v244 offset:0
  v_cvt_pk_bf16_f32 v193, v194, v195
  v_lshlrev_b32 v254, 16, v242
  v_and_b32 v242, 0xffff0000, v242
  v_mul_f32 v254, s40, v254
  v_mfma_f32_16x16x32_bf16 v[172:175], v[200:203], a[172:175], v[172:175]
  v_exp_f32 v196, v196
  v_mul_f32 v242, s40, v242
  v_cvt_pk_bf16_f32 v242, v254, v242
  v_mfma_f32_16x16x32_bf16 v[208:211], a[96:99], a[16:19], v[220:223]
  ds_read_b64_tr_b16 a[160:161], v248 offset:40960
  ds_read_b64_tr_b16 a[162:163], v248 offset:43008
  v_lshlrev_b32 v254, 16, v243
  v_and_b32 v243, 0xffff0000, v243
  v_mfma_f32_16x16x32_bf16 v[208:211], a[100:103], a[20:23], v[208:211]
  v_exp_f32 v197, v197
  v_mul_f32 v254, s40, v254
  v_mul_f32 v243, s40, v243
  v_cvt_pk_bf16_f32 v243, v254, v243
  v_mfma_f32_16x16x32_bf16 v[208:211], a[104:107], a[24:27], v[208:211]
  ds_read_b64_tr_b16 a[164:165], v249 offset:40960
  ds_write_b128 v255, v[240:243] offset:0
  v_cvt_pk_bf16_f32 v194, v196, v197
  v_mfma_f32_16x16x32_bf16 v[208:211], a[108:111], a[28:31], v[208:211]
  v_exp_f32 v198, v198
  v_mfma_f32_16x16x32_bf16 v[212:215], a[124:127], a[28:31], v[220:223]
  ds_read_b64_tr_b16 a[166:167], v249 offset:43008
  ds_read_b64_tr_b16 a[168:169], v250 offset:40960
  ds_read_b128 v[240:243], v255 offset:12288
  v_mfma_f32_16x16x32_bf16 v[212:215], a[120:123], a[24:27], v[212:215]
  ds_read_b128 a[4:7], v245 offset:0
  v_exp_f32 v199, v199
  v_mfma_f32_16x16x32_bf16 v[212:215], a[116:119], a[20:23], v[212:215]
  ds_read_b64_tr_b16 a[170:171], v250 offset:43008
  v_cvt_pk_bf16_f32 v195, v198, v199
  v_mfma_f32_16x16x32_bf16 v[212:215], a[112:115], a[16:19], v[212:215]
  v_exp_f32 v208, v208
  v_mfma_f32_16x16x32_bf16 v[176:179], v[200:203], a[176:179], v[176:179]
  ds_read_b64_tr_b16 a[172:173], v251 offset:40960
  ds_read_b64_tr_b16 a[174:175], v251 offset:43008
  v_mfma_f32_16x16x32_bf16 v[176:179], v[204:207], a[208:211], v[176:179]
  v_exp_f32 v209, v209
  v_mfma_f32_16x16x32_bf16 v[180:183], v[204:207], a[212:215], v[180:183]
  ds_read_b128 a[8:11], v244 offset:12288
  v_cvt_pk_bf16_f32 v196, v208, v209
  v_mfma_f32_16x16x32_bf16 v[180:183], v[200:203], a[180:183], v[180:183]
  ds_read_b128 a[12:15], v245 offset:12288
  v_exp_f32 v210, v210
  s_waitcnt lgkmcnt(6)
  v_lshlrev_b32 v254, 16, v240
  v_mfma_f32_16x16x32_bf16 v[184:187], v[200:203], a[184:187], v[184:187]
  v_and_b32 v240, 0xffff0000, v240
  v_mul_f32 v254, s40, v254
  v_mul_f32 v240, s40, v240
  v_mfma_f32_16x16x32_bf16 v[184:187], v[204:207], a[216:219], v[184:187]
  ds_read_b128 a[16:19], v244 offset:2048
  v_exp_f32 v211, v211
  v_cvt_pk_bf16_f32 v240, v254, v240
  v_lshlrev_b32 v254, 16, v241
  v_mfma_f32_16x16x32_bf16 v[188:191], v[204:207], a[220:223], v[188:191]
  v_cvt_pk_bf16_f32 v197, v210, v211
  v_and_b32 v241, 0xffff0000, v241
  v_mul_f32 v254, s40, v254
  v_mfma_f32_16x16x32_bf16 v[188:191], v[200:203], a[188:191], v[188:191]
  v_exp_f32 v212, v212
  v_mul_f32 v241, s40, v241
  v_cvt_pk_bf16_f32 v241, v254, v241
  v_mfma_f32_16x16x32_bf16 v[200:203], a[96:99], a[32:35], v[224:227]
  ds_read_b64_tr_b16 a[176:177], v248 offset:45056
  ds_read_b64_tr_b16 a[178:179], v248 offset:47104
  v_lshlrev_b32 v254, 16, v242
  v_mfma_f32_16x16x32_bf16 v[200:203], a[100:103], a[36:39], v[200:203]
  v_exp_f32 v213, v213
  v_and_b32 v242, 0xffff0000, v242
  v_mul_f32 v254, s40, v254
  v_mfma_f32_16x16x32_bf16 v[200:203], a[104:107], a[40:43], v[200:203]
  ds_read_b64_tr_b16 a[180:181], v249 offset:45056
  ds_read_b128 a[20:23], v245 offset:2048
  v_cvt_pk_bf16_f32 v198, v212, v213
  v_mul_f32 v242, s40, v242
  v_mfma_f32_16x16x32_bf16 v[200:203], a[108:111], a[44:47], v[200:203]
  v_exp_f32 v214, v214
  v_cvt_pk_bf16_f32 v242, v254, v242
  v_lshlrev_b32 v254, 16, v243
  v_mfma_f32_16x16x32_bf16 v[204:207], a[124:127], a[44:47], v[224:227]
  ds_read_b64_tr_b16 a[182:183], v249 offset:47104
  ds_read_b64_tr_b16 a[184:185], v250 offset:45056
  v_and_b32 v243, 0xffff0000, v243
  v_mfma_f32_16x16x32_bf16 v[204:207], a[120:123], a[40:43], v[204:207]
  v_exp_f32 v215, v215
  v_mul_f32 v254, s40, v254
  v_mfma_f32_16x16x32_bf16 v[204:207], a[116:119], a[36:39], v[204:207]
  ds_read_b64_tr_b16 a[186:187], v250 offset:47104
  ds_read_b64_tr_b16 a[188:189], v251 offset:45056
  v_cvt_pk_bf16_f32 v199, v214, v215
  v_mul_f32 v243, s40, v243
  v_cvt_pk_bf16_f32 v243, v254, v243
  v_mfma_f32_16x16x32_bf16 v[204:207], a[112:115], a[32:35], v[204:207]
  ds_read_b128 a[24:27], v244 offset:14336
  ds_write_b128 v255, v[240:243] offset:12288
  v_exp_f32 v200, v200
  v_smfmac_f32_16x16x64_bf16 a[236:239], a[224:227], v[192:199], v253
  ds_read_b64_tr_b16 a[190:191], v251 offset:47104
  v_mfma_f32_16x16x32_bf16 v[0:3], v[192:195], a[160:163], v[0:3]
  s_waitcnt vmcnt(0)
  ds_read_b64_tr_b16 a[192:193], v248 offset:57344
  ds_read_b64_tr_b16 a[194:195], v248 offset:59392
  ds_read_b64_tr_b16 a[196:197], v249 offset:57344
  v_mfma_f32_16x16x32_bf16 v[4:7], v[192:195], a[164:167], v[4:7]
  s_waitcnt lgkmcnt(10)
  ds_read_b128 v[240:243], v255 offset:1024
  v_exp_f32 v201, v201
  v_mfma_f32_16x16x32_bf16 v[8:11], v[192:195], a[168:171], v[8:11]
  ds_read_b64_tr_b16 a[198:199], v249 offset:59392
  v_cvt_pk_bf16_f32 v200, v200, v201
  v_mfma_f32_16x16x32_bf16 v[12:15], v[192:195], a[172:175], v[12:15]
  ds_read_b64_tr_b16 a[200:201], v250 offset:57344
  ds_read_b128 a[28:31], v245 offset:14336
  v_exp_f32 v202, v202
  v_mfma_f32_16x16x32_bf16 v[16:19], v[192:195], a[176:179], v[16:19]
  s_waitcnt lgkmcnt(12)
  ds_read_b64_tr_b16 a[202:203], v250 offset:59392
  ds_read_b64_tr_b16 a[204:205], v251 offset:57344
  ds_read_b128 a[32:35], v244 offset:4096
  v_mfma_f32_16x16x32_bf16 v[20:23], v[192:195], a[180:183], v[20:23]
  s_waitcnt lgkmcnt(13)
  v_exp_f32 v203, v203
  v_mfma_f32_16x16x32_bf16 v[24:27], v[192:195], a[184:187], v[24:27]
  s_waitcnt lgkmcnt(10)
  ds_read_b64_tr_b16 a[206:207], v251 offset:59392
  ds_read_b64_tr_b16 a[208:209], v248 offset:61440
  v_cvt_pk_bf16_f32 v201, v202, v203
  v_mfma_f32_16x16x32_bf16 v[28:31], v[192:195], a[188:191], v[28:31]
  v_exp_f32 v204, v204
  v_mfma_f32_16x16x32_bf16 v[208:211], a[96:99], a[48:51], v[228:231]
  ds_read_b64_tr_b16 a[210:211], v248 offset:63488
  ds_read_b64_tr_b16 a[212:213], v249 offset:61440
  s_waitcnt lgkmcnt(10)
  v_lshlrev_b32 v254, 16, v240
  v_mfma_f32_16x16x32_bf16 v[208:211], a[100:103], a[52:55], v[208:211]
  ds_read_b128 a[36:39], v245 offset:4096
  v_exp_f32 v205, v205
  v_and_b32 v240, 0xffff0000, v240
  v_mul_f32 v254, s40, v254
  v_mfma_f32_16x16x32_bf16 v[208:211], a[104:107], a[56:59], v[208:211]
  ds_read_b64_tr_b16 a[214:215], v249 offset:63488
  ds_read_b64_tr_b16 a[216:217], v250 offset:61440
  v_cvt_pk_bf16_f32 v202, v204, v205
  v_mul_f32 v240, s40, v240
  v_mfma_f32_16x16x32_bf16 v[208:211], a[108:111], a[60:63], v[208:211]
  v_exp_f32 v206, v206
  v_cvt_pk_bf16_f32 v240, v254, v240
  v_lshlrev_b32 v254, 16, v241
  v_mfma_f32_16x16x32_bf16 v[212:215], a[124:127], a[60:63], v[228:231]
  ds_read_b64_tr_b16 a[218:219], v250 offset:63488
  ds_read_b64_tr_b16 a[220:221], v251 offset:61440
  v_and_b32 v241, 0xffff0000, v241
  v_mfma_f32_16x16x32_bf16 v[212:215], a[120:123], a[56:59], v[212:215]
  ds_read_b64_tr_b16 a[222:223], v251 offset:63488
  v_exp_f32 v207, v207
  v_mul_f32 v254, s40, v254
  v_mul_f32 v241, s40, v241
  v_mfma_f32_16x16x32_bf16 v[212:215], a[116:119], a[52:55], v[212:215]
  ds_read_b128 a[40:43], v244 offset:16384
  v_cvt_pk_bf16_f32 v203, v206, v207
  v_cvt_pk_bf16_f32 v241, v254, v241
  v_lshlrev_b32 v254, 16, v242
  v_mfma_f32_16x16x32_bf16 v[212:215], a[112:115], a[48:51], v[212:215]
  v_exp_f32 v208, v208
  v_and_b32 v242, 0xffff0000, v242
  v_mul_f32 v254, s40, v254
  v_mfma_f32_16x16x32_bf16 v[32:35], v[196:199], a[160:163], v[32:35]
  v_mul_f32 v242, s40, v242
  v_cvt_pk_bf16_f32 v242, v254, v242
  v_lshlrev_b32 v254, 16, v243
  v_mfma_f32_16x16x32_bf16 v[36:39], v[196:199], a[164:167], v[36:39]
  v_exp_f32 v209, v209
  v_and_b32 v243, 0xffff0000, v243
  v_mul_f32 v254, s40, v254
  v_mfma_f32_16x16x32_bf16 v[40:43], v[196:199], a[168:171], v[40:43]
  v_cvt_pk_bf16_f32 v204, v208, v209
  v_mul_f32 v243, s40, v243
  v_cvt_pk_bf16_f32 v243, v254, v243
  v_mfma_f32_16x16x32_bf16 v[44:47], v[196:199], a[172:175], v[44:47]
  s_waitcnt vmcnt(2) lgkmcnt(1)
  ds_read_b128 a[44:47], v245 offset:16384
  v_exp_f32 v210, v210
  v_mfma_f32_16x16x32_bf16 v[48:51], v[196:199], a[176:179], v[48:51]
  s_barrier
  v_mfma_f32_16x16x32_bf16 v[52:55], v[196:199], a[180:183], v[52:55]
  v_exp_f32 v211, v211
  v_mfma_f32_16x16x32_bf16 v[56:59], v[196:199], a[184:187], v[56:59]
  ds_write_b128 v255, v[240:243] offset:1024
  v_cvt_pk_bf16_f32 v205, v210, v211
  v_mfma_f32_16x16x32_bf16 v[60:63], v[196:199], a[188:191], v[60:63]
  v_exp_f32 v212, v212
  v_mfma_f32_16x16x32_bf16 v[216:219], a[128:131], a[0:3], 0
  ds_read_b128 v[240:243], v255 offset:13312
  v_mfma_f32_16x16x32_bf16 v[216:219], a[132:135], a[4:7], v[216:219]
  ds_read_b128 a[48:51], v244 offset:6144
  v_mfma_f32_16x16x32_bf16 v[216:219], a[136:139], a[8:11], v[216:219]
  ds_read_b128 a[52:55], v245 offset:6144
  v_mfma_f32_16x16x32_bf16 v[216:219], a[140:143], a[12:15], v[216:219]
  ds_read_b128 a[56:59], v244 offset:18432
  v_mfma_f32_16x16x32_bf16 v[220:223], a[128:131], a[16:19], 0
  ds_read_b128 a[60:63], v245 offset:18432
  v_mfma_f32_16x16x32_bf16 v[220:223], a[132:135], a[20:23], v[220:223]
  v_mfma_f32_16x16x32_bf16 v[220:223], a[136:139], a[24:27], v[220:223]
  v_mfma_f32_16x16x32_bf16 v[220:223], a[140:143], a[28:31], v[220:223]
  s_waitcnt lgkmcnt(4)
  v_lshlrev_b32 v254, 16, v240
  v_and_b32 v240, 0xffff0000, v240
  v_mfma_f32_16x16x32_bf16 v[192:195], a[96:99], a[64:67], v[232:235]
  v_mul_f32 v254, s40, v254
  v_mul_f32 v240, s40, v240
  v_cvt_pk_bf16_f32 v240, v254, v240
  v_mfma_f32_16x16x32_bf16 v[192:195], a[100:103], a[68:71], v[192:195]
  v_exp_f32 v213, v213
  v_lshlrev_b32 v254, 16, v241
  v_max3_f32 v216, v216, v217, v218
  v_mfma_f32_16x16x32_bf16 v[192:195], a[104:107], a[72:75], v[192:195]
  v_cvt_pk_bf16_f32 v206, v212, v213
  v_and_b32 v241, 0xffff0000, v241
  v_mul_f32 v254, s40, v254
  v_max_f32 v216, v216, v219
  v_mfma_f32_16x16x32_bf16 v[192:195], a[108:111], a[76:79], v[192:195]
  s_add_u32 m0, s38, 32768
  v_exp_f32 v214, v214
  v_mul_f32 v241, s40, v241
  v_mov_b32 v217, v216
  v_mfma_f32_16x16x32_bf16 v[196:199], a[124:127], a[76:79], v[232:235]
  buffer_load_dwordx4 v252, s[16:19], s33 offen nt lds
  v_cvt_pk_bf16_f32 v241, v254, v241
  v_mfma_f32_16x16x32_bf16 v[196:199], a[120:123], a[72:75], v[196:199]
  v_exp_f32 v215, v215
  v_lshlrev_b32 v254, 16, v242
  v_permlane16_swap_b32 v216, v217
  v_mfma_f32_16x16x32_bf16 v[196:199], a[116:119], a[68:71], v[196:199]
  v_cvt_pk_bf16_f32 v207, v214, v215
  v_and_b32 v242, 0xffff0000, v242
  v_mul_f32 v254, s40, v254
  v_max_f32 v216, v216, v217
  v_mfma_f32_16x16x32_bf16 v[196:199], a[112:115], a[64:67], v[196:199]
  v_exp_f32 v192, v192
  v_mul_f32 v242, s40, v242
  v_mov_b32 v217, v216
  v_smfmac_f32_16x16x64_bf16 a[240:243], a[224:227], v[200:207], v253
  v_cvt_pk_bf16_f32 v242, v254, v242
  v_lshlrev_b32 v254, 16, v243
  v_mfma_f32_16x16x32_bf16 v[64:67], v[200:203], a[160:163], v[64:67]
  v_and_b32 v243, 0xffff0000, v243
  v_mul_f32 v254, s40, v254
  v_mul_f32 v243, s40, v243
  v_permlane32_swap_b32 v216, v217
  v_mfma_f32_16x16x32_bf16 v[68:71], v[200:203], a[164:167], v[68:71]
  v_exp_f32 v193, v193
  v_cvt_pk_bf16_f32 v243, v254, v243
  v_min_f32 v219, -v216, -v217
  v_mfma_f32_16x16x32_bf16 v[72:75], v[200:203], a[168:171], v[72:75]
  ds_write_b128 v255, v[240:243] offset:13312
  v_cvt_pk_bf16_f32 v192, v192, v193
  v_subrev_f32 v216, 0x40a00000, v219
  v_mfma_f32_16x16x32_bf16 v[76:79], v[200:203], a[172:175], v[76:79]
  s_add_u32 m0, s38, 36736
  v_exp_f32 v194, v194
  v_subrev_f32 v217, 0x40a00000, v219
  v_mfma_f32_16x16x32_bf16 v[80:83], v[200:203], a[176:179], v[80:83]
  buffer_load_dwordx4 v252, s[16:19], s33 offen offset:128 nt lds
  v_subrev_f32 v218, 0x40a00000, v219
  v_mfma_f32_16x16x32_bf16 v[84:87], v[200:203], a[180:183], v[84:87]
  v_exp_f32 v195, v195
  v_subrev_f32 v219, 0x40a00000, v219
  v_mfma_f32_16x16x32_bf16 v[88:91], v[200:203], a[184:187], v[88:91]
  v_cvt_pk_bf16_f32 v193, v194, v195
  v_and_b32 v240, 0xf0, v255
  v_max3_f32 v220, v220, v221, v222
  v_mfma_f32_16x16x32_bf16 v[92:95], v[200:203], a[188:191], v[92:95]
  v_exp_f32 v196, v196
  v_max_f32 v220, v220, v223
  v_mfma_f32_16x16x32_bf16 v[208:211], a[96:99], a[80:83], v[236:239]
  v_bfe_u32 v241, v255, 8, 2
  v_lshl_add_u32 v240, v241, 9, v240
  v_add_u32 v255, s49, v240
  v_mov_b32 v221, v220
  v_mfma_f32_16x16x32_bf16 v[208:211], a[100:103], a[84:87], v[208:211]
  v_exp_f32 v197, v197
  v_accvgpr_read_b32 v254, a236
  v_accvgpr_read_b32 v240, a237
  v_mfma_f32_16x16x32_bf16 v[208:211], a[104:107], a[88:91], v[208:211]
  ds_read_b128 a[64:67], v244 offset:8192
  v_cvt_pk_bf16_f32 v194, v196, v197
  v_add_f32 v254, v240, v254
  v_cmp_nge_f32 vcc, s43, v254
  v_mfma_f32_16x16x32_bf16 v[208:211], a[108:111], a[92:95], v[208:211]
  s_add_u32 m0, s38, 40960
  v_exp_f32 v198, v198
  v_permlane16_swap_b32 v220, v221
  v_rcp_f32 v254, v254
  s_or_b64 s[46:47], s[46:47], vcc
  v_mov_b32 v243, v254
  v_accvgpr_write_b32 a236, 0
  v_mfma_f32_16x16x32_bf16 v[212:215], a[124:127], a[92:95], v[236:239]
  buffer_load_dwordx4 v252, s[20:23], s33 offen nt lds
  v_max_f32 v220, v220, v221
  v_accvgpr_write_b32 a237, 0
  v_mov_b32_dpp v243, v254 row_ror:12 row_mask:0x2 bank_mask:0xf
  v_mfma_f32_16x16x32_bf16 v[212:215], a[120:123], a[88:91], v[212:215]
  v_exp_f32 v199, v199
  v_mov_b32 v221, v220
  v_mov_b32_dpp v243, v254 row_ror:8 row_mask:0x4 bank_mask:0xf
  s_nop 1
  v_mov_b32_dpp v243, v254 row_ror:4 row_mask:0x8 bank_mask:0xf
  s_nop 1
  v_mov_b32_dpp v240, v243 row_newbcast:0 row_mask:0xf bank_mask:0xf
  v_mfma_f32_16x16x32_bf16 v[212:215], a[116:119], a[84:87], v[212:215]
  ds_read_b128 a[68:71], v245 offset:8192
  v_cvt_pk_bf16_f32 v195, v198, v199
  v_mov_b32_dpp v241, v243 row_newbcast:1 row_mask:0xf bank_mask:0xf
  v_mov_b32_dpp v242, v243 row_newbcast:2 row_mask:0xf bank_mask:0xf
  v_mov_b32_dpp v243, v243 row_newbcast:3 row_mask:0xf bank_mask:0xf
  v_mfma_f32_16x16x32_bf16 v[212:215], a[112:115], a[80:83], v[212:215]
  v_exp_f32 v208, v208
  v_pk_mul_f32 v[0:1], v[0:1], v[240:241]
  v_pk_mul_f32 v[2:3], v[2:3], v[242:243]
  v_pk_mul_f32 v[4:5], v[4:5], v[240:241]
  v_pk_mul_f32 v[6:7], v[6:7], v[242:243]
  v_pk_mul_f32 v[8:9], v[8:9], v[240:241]
  v_pk_mul_f32 v[10:11], v[10:11], v[242:243]
  v_pk_mul_f32 v[12:13], v[12:13], v[240:241]
  v_pk_mul_f32 v[14:15], v[14:15], v[242:243]
  v_pk_mul_f32 v[16:17], v[16:17], v[240:241]
  v_pk_mul_f32 v[18:19], v[18:19], v[242:243]
  v_pk_mul_f32 v[20:21], v[20:21], v[240:241]
  v_pk_mul_f32 v[22:23], v[22:23], v[242:243]
  v_pk_mul_f32 v[24:25], v[24:25], v[240:241]
  v_pk_mul_f32 v[26:27], v[26:27], v[242:243]
  v_pk_mul_f32 v[28:29], v[28:29], v[240:241]
  v_pk_mul_f32 v[30:31], v[30:31], v[242:243]
  v_mfma_f32_16x16x32_bf16 v[96:99], v[204:207], a[160:163], v[96:99]
  ds_read_b128 a[72:75], v244 offset:20480
  v_permlane32_swap_b32 v220, v221
  v_min_f32 v223, -v220, -v221
  v_accvgpr_read_b32 v254, a238
  v_mfma_f32_16x16x32_bf16 v[100:103], v[204:207], a[164:167], v[100:103]
  v_exp_f32 v209, v209
  v_subrev_f32 v220, 0x40a00000, v223
  v_cvt_pk_bf16_f32 v13, v9, v13
  v_mfma_f32_16x16x32_bf16 v[104:107], v[204:207], a[168:171], v[104:107]
  ds_read_b128 a[76:79], v245 offset:20480
  v_cvt_pk_bf16_f32 v196, v208, v209
  v_subrev_f32 v221, 0x40a00000, v223
  v_accvgpr_read_b32 v240, a239
  v_mfma_f32_16x16x32_bf16 v[108:111], v[204:207], a[172:175], v[108:111]
  s_add_u32 m0, s38, 44928
  v_exp_f32 v210, v210
  v_subrev_f32 v222, 0x40a00000, v223
  v_cvt_pk_bf16_f32 v9, v8, v12
  v_add_f32 v254, v240, v254
  v_mfma_f32_16x16x32_bf16 v[112:115], v[204:207], a[176:179], v[112:115]
  buffer_load_dwordx4 v252, s[20:23], s33 offen offset:128 nt lds
  v_cvt_pk_bf16_f32 v8, v0, v4
  v_mfma_f32_16x16x32_bf16 v[116:119], v[204:207], a[180:183], v[116:119]
  s_add_u32 s34, s34, 1
  v_exp_f32 v211, v211
  v_subrev_f32 v223, 0x40a00000, v223
  v_cmp_nge_f32 vcc, s43, v254
  v_mfma_f32_16x16x32_bf16 v[120:123], v[204:207], a[184:187], v[120:123]
  s_add_u32 s33, s33, 8192
  ds_read_b128 a[80:83], v244 offset:10240
  v_cvt_pk_bf16_f32 v197, v210, v211
  v_cvt_pk_bf16_f32 v12, v1, v5
  v_mfma_f32_16x16x32_bf16 v[124:127], v[204:207], a[188:191], v[124:127]
  v_exp_f32 v212, v212
  v_mfma_f32_16x16x32_bf16 v[224:227], a[128:131], a[32:35], 0
  ds_read_b128 a[84:87], v245 offset:10240
  v_rcp_f32 v254, v254
  v_cvt_pk_bf16_f32 v15, v11, v15
  s_or_b64 s[46:47], s[46:47], vcc
  v_cvt_pk_bf16_f32 v11, v10, v14
  v_mfma_f32_16x16x32_bf16 v[224:227], a[132:135], a[36:39], v[224:227]
  ds_read_b128 a[88:91], v244 offset:22528
  v_mov_b32 v243, v254
  v_cvt_pk_bf16_f32 v10, v2, v6
  v_mfma_f32_16x16x32_bf16 v[224:227], a[136:139], a[40:43], v[224:227]
  ds_read_b128 a[92:95], v245 offset:22528
  v_accvgpr_write_b32 a238, 0
  v_mfma_f32_16x16x32_bf16 v[224:227], a[140:143], a[44:47], v[224:227]
  s_waitcnt lgkmcnt(4)
  ds_write_b128 v255, v[8:11] offset:0
  v_accvgpr_write_b32 a239, 0
  v_cvt_pk_bf16_f32 v14, v3, v7
  v_mfma_f32_16x16x32_bf16 v[228:231], a[128:131], a[48:51], 0
  v_mov_b32_dpp v243, v254 row_ror:12 row_mask:0x2 bank_mask:0xf
  v_cvt_pk_bf16_f32 v29, v25, v29
  s_nop 0
  v_mov_b32_dpp v243, v254 row_ror:8 row_mask:0x4 bank_mask:0xf
  v_mfma_f32_16x16x32_bf16 v[228:231], a[132:135], a[52:55], v[228:231]
  v_cvt_pk_bf16_f32 v25, v24, v28
  v_mov_b32_dpp v243, v254 row_ror:4 row_mask:0x8 bank_mask:0xf
  v_cvt_pk_bf16_f32 v24, v16, v20
  s_nop 0
  v_mov_b32_dpp v240, v243 row_newbcast:0 row_mask:0xf bank_mask:0xf
  v_mfma_f32_16x16x32_bf16 v[228:231], a[136:139], a[56:59], v[228:231]
  ds_write_b128 v255, v[12:15] offset:256
  v_mov_b32_dpp v241, v243 row_newbcast:1 row_mask:0xf bank_mask:0xf
  v_mfma_f32_16x16x32_bf16 v[228:231], a[140:143], a[60:63], v[228:231]
  v_cvt_pk_bf16_f32 v28, v17, v21
  v_mov_b32_dpp v242, v243 row_newbcast:2 row_mask:0xf bank_mask:0xf
  v_cvt_pk_bf16_f32 v31, v27, v31
  v_mfma_f32_16x16x32_bf16 v[200:203], a[128:131], a[0:3], v[216:219]
  v_max3_f32 v224, v224, v225, v226
  v_max_f32 v224, v224, v227
  v_mov_b32_dpp v243, v243 row_newbcast:3 row_mask:0xf bank_mask:0xf
  v_mfma_f32_16x16x32_bf16 v[200:203], a[132:135], a[4:7], v[200:203]
  v_exp_f32 v213, v213
  v_cvt_pk_bf16_f32 v27, v26, v30
  v_mfma_f32_16x16x32_bf16 v[200:203], a[136:139], a[8:11], v[200:203]
  v_cvt_pk_bf16_f32 v198, v212, v213
  v_mov_b32 v225, v224
  v_cvt_pk_bf16_f32 v26, v18, v22
  v_mfma_f32_16x16x32_bf16 v[200:203], a[140:143], a[12:15], v[200:203]
  s_add_u32 m0, s38, 49152
  ds_write_b128 v255, v[24:27] offset:12288
  v_exp_f32 v214, v214
  v_mfma_f32_16x16x32_bf16 v[204:207], a[156:159], a[12:15], v[216:219]
  buffer_load_dwordx4 v252, s[16:19], s33 offen nt lds
  v_permlane16_swap_b32 v224, v225
  v_cvt_pk_bf16_f32 v30, v19, v23
  v_mfma_f32_16x16x32_bf16 v[204:207], a[152:155], a[8:11], v[204:207]
  v_exp_f32 v215, v215
  v_mfma_f32_16x16x32_bf16 v[204:207], a[148:151], a[4:7], v[204:207]
  ds_write_b128 v255, v[28:31] offset:12544
  v_cvt_pk_bf16_f32 v199, v214, v215
  v_max_f32 v224, v224, v225
  v_mov_b32 v225, v224
  v_mfma_f32_16x16x32_bf16 v[204:207], a[144:147], a[0:3], v[204:207]
  v_exp_f32 v200, v200
  v_pk_mul_f32 v[32:33], v[32:33], v[240:241]
  v_pk_mul_f32 v[34:35], v[34:35], v[242:243]
  v_pk_mul_f32 v[36:37], v[36:37], v[240:241]
  v_pk_mul_f32 v[38:39], v[38:39], v[242:243]
  v_pk_mul_f32 v[40:41], v[40:41], v[240:241]
  v_pk_mul_f32 v[42:43], v[42:43], v[242:243]
  v_pk_mul_f32 v[44:45], v[44:45], v[240:241]
  v_pk_mul_f32 v[46:47], v[46:47], v[242:243]
  v_pk_mul_f32 v[48:49], v[48:49], v[240:241]
  v_pk_mul_f32 v[50:51], v[50:51], v[242:243]
  v_pk_mul_f32 v[52:53], v[52:53], v[240:241]
  v_pk_mul_f32 v[54:55], v[54:55], v[242:243]
  v_pk_mul_f32 v[56:57], v[56:57], v[240:241]
  v_pk_mul_f32 v[58:59], v[58:59], v[242:243]
  v_pk_mul_f32 v[60:61], v[60:61], v[240:241]
  v_pk_mul_f32 v[62:63], v[62:63], v[242:243]
  v_smfmac_f32_16x16x64_bf16 a[244:247], a[224:227], v[192:199], v253
  v_permlane32_swap_b32 v224, v225
  v_accvgpr_read_b32 v254, a240
  v_cvt_pk_bf16_f32 v45, v41, v45
  v_mfma_f32_16x16x32_bf16 v[128:131], v[192:195], a[160:163], v[128:131]
  v_min_f32 v227, -v224, -v225
  v_subrev_f32 v224, 0x40a00000, v227
  v_accvgpr_read_b32 v240, a241
  v_cvt_pk_bf16_f32 v41, v40, v44
  v_mfma_f32_16x16x32_bf16 v[132:135], v[192:195], a[164:167], v[132:135]
  v_exp_f32 v201, v201
  v_add_f32 v254, v240, v254
  v_cvt_pk_bf16_f32 v40, v32, v36
  v_mfma_f32_16x16x32_bf16 v[136:139], v[192:195], a[168:171], v[136:139]
  v_cvt_pk_bf16_f32 v200, v200, v201
  v_subrev_f32 v225, 0x40a00000, v227
  v_subrev_f32 v226, 0x40a00000, v227
  v_cmp_nge_f32 vcc, s43, v254
  v_mfma_f32_16x16x32_bf16 v[140:143], v[192:195], a[172:175], v[140:143]
  s_add_u32 m0, s38, 53120
  v_exp_f32 v202, v202
  v_cvt_pk_bf16_f32 v44, v33, v37
  v_mfma_f32_16x16x32_bf16 v[144:147], v[192:195], a[176:179], v[144:147]
  buffer_load_dwordx4 v252, s[16:19], s33 offen offset:128 nt lds
  v_subrev_f32 v227, 0x40a00000, v227
  v_rcp_f32 v254, v254
  v_cvt_pk_bf16_f32 v47, v43, v47
  s_or_b64 s[46:47], s[46:47], vcc
  v_mfma_f32_16x16x32_bf16 v[148:151], v[192:195], a[180:183], v[148:151]
  v_exp_f32 v203, v203
  v_cvt_pk_bf16_f32 v43, v42, v46
  v_mov_b32 v243, v254
  v_mfma_f32_16x16x32_bf16 v[152:155], v[192:195], a[184:187], v[152:155]
  v_cvt_pk_bf16_f32 v201, v202, v203
  v_max3_f32 v228, v228, v229, v230
  v_max_f32 v228, v228, v231
  v_cvt_pk_bf16_f32 v42, v34, v38
  v_mfma_f32_16x16x32_bf16 v[156:159], v[192:195], a[188:191], v[156:159]
  v_exp_f32 v204, v204
  v_accvgpr_write_b32 a240, 0
  v_mfma_f32_16x16x32_bf16 v[208:211], a[128:131], a[16:19], v[220:223]
  ds_write_b128 v255, v[40:43] offset:2048
  v_mov_b32 v229, v228
  s_nop 1
  v_permlane16_swap_b32 v228, v229
  v_accvgpr_write_b32 a241, 0
  v_mfma_f32_16x16x32_bf16 v[208:211], a[132:135], a[20:23], v[208:211]
  v_exp_f32 v205, v205
  v_cvt_pk_bf16_f32 v46, v35, v39
  v_mov_b32_dpp v243, v254 row_ror:12 row_mask:0x2 bank_mask:0xf
  v_mfma_f32_16x16x32_bf16 v[208:211], a[136:139], a[24:27], v[208:211]
  v_cvt_pk_bf16_f32 v202, v204, v205
  v_max_f32 v228, v228, v229
  v_mov_b32 v229, v228
  v_cvt_pk_bf16_f32 v61, v57, v61
  v_mfma_f32_16x16x32_bf16 v[208:211], a[140:143], a[28:31], v[208:211]
  s_add_u32 m0, s38, 57344
  v_exp_f32 v206, v206
  v_mov_b32_dpp v243, v254 row_ror:8 row_mask:0x4 bank_mask:0xf
  v_cvt_pk_bf16_f32 v57, v56, v60
  v_mfma_f32_16x16x32_bf16 v[212:215], a[156:159], a[28:31], v[220:223]
  buffer_load_dwordx4 v252, s[20:23], s33 offen nt lds
  v_mov_b32_dpp v243, v254 row_ror:4 row_mask:0x8 bank_mask:0xf
  v_cvt_pk_bf16_f32 v56, v48, v52
  v_mfma_f32_16x16x32_bf16 v[212:215], a[152:155], a[24:27], v[212:215]
  v_exp_f32 v207, v207
  v_mov_b32_dpp v240, v243 row_newbcast:0 row_mask:0xf bank_mask:0xf
  v_mfma_f32_16x16x32_bf16 v[212:215], a[148:151], a[20:23], v[212:215]
  ds_write_b128 v255, v[44:47] offset:2304
  v_cvt_pk_bf16_f32 v203, v206, v207
  v_permlane32_swap_b32 v228, v229
  v_min_f32 v231, -v228, -v229
  v_mfma_f32_16x16x32_bf16 v[212:215], a[144:147], a[16:19], v[212:215]
  v_exp_f32 v208, v208
  v_mov_b32_dpp v241, v243 row_newbcast:1 row_mask:0xf bank_mask:0xf
  v_cvt_pk_bf16_f32 v60, v49, v53
  v_mfma_f32_16x16x32_bf16 v[160:163], v[196:199], a[160:163], v[160:163]
  v_subrev_f32 v228, 0x40a00000, v231
  v_subrev_f32 v229, 0x40a00000, v231
  v_subrev_f32 v230, 0x40a00000, v231
  v_mov_b32_dpp v242, v243 row_newbcast:2 row_mask:0xf bank_mask:0xf
  v_cvt_pk_bf16_f32 v63, v59, v63
  v_mfma_f32_16x16x32_bf16 v[164:167], v[196:199], a[164:167], v[164:167]
  v_exp_f32 v209, v209
  v_mov_b32_dpp v243, v243 row_newbcast:3 row_mask:0xf bank_mask:0xf
  v_cvt_pk_bf16_f32 v59, v58, v62
  v_mfma_f32_16x16x32_bf16 v[168:171], v[196:199], a[168:171], v[168:171]
  v_cvt_pk_bf16_f32 v204, v208, v209
  v_subrev_f32 v231, 0x40a00000, v231
  v_cvt_pk_bf16_f32 v58, v50, v54
  v_mfma_f32_16x16x32_bf16 v[172:175], v[196:199], a[172:175], v[172:175]
  s_add_u32 m0, s38, 61312
  ds_write_b128 v255, v[56:59] offset:14336
  v_exp_f32 v210, v210
  v_mfma_f32_16x16x32_bf16 v[176:179], v[196:199], a[176:179], v[176:179]
  buffer_load_dwordx4 v252, s[20:23], s33 offen offset:128 nt lds
  v_cvt_pk_bf16_f32 v62, v51, v55
  v_mfma_f32_16x16x32_bf16 v[180:183], v[196:199], a[180:183], v[180:183]
  s_add_u32 s34, s34, 1
  ds_write_b128 v255, v[60:63] offset:14592
  v_exp_f32 v211, v211
  v_mfma_f32_16x16x32_bf16 v[184:187], v[196:199], a[184:187], v[184:187]
  s_add_u32 s33, s33, 8192
  v_cvt_pk_bf16_f32 v205, v210, v211
  v_pk_mul_f32 v[64:65], v[64:65], v[240:241]
  v_pk_mul_f32 v[66:67], v[66:67], v[242:243]
  v_pk_mul_f32 v[68:69], v[68:69], v[240:241]
  v_pk_mul_f32 v[70:71], v[70:71], v[242:243]
  v_pk_mul_f32 v[72:73], v[72:73], v[240:241]
  v_pk_mul_f32 v[74:75], v[74:75], v[242:243]
  v_pk_mul_f32 v[76:77], v[76:77], v[240:241]
  v_pk_mul_f32 v[78:79], v[78:79], v[242:243]
  v_pk_mul_f32 v[80:81], v[80:81], v[240:241]
  v_pk_mul_f32 v[82:83], v[82:83], v[242:243]
  v_pk_mul_f32 v[84:85], v[84:85], v[240:241]
  v_pk_mul_f32 v[86:87], v[86:87], v[242:243]
  v_pk_mul_f32 v[88:89], v[88:89], v[240:241]
  v_pk_mul_f32 v[90:91], v[90:91], v[242:243]
  v_pk_mul_f32 v[92:93], v[92:93], v[240:241]
  v_pk_mul_f32 v[94:95], v[94:95], v[242:243]
  v_accvgpr_read_b32 v254, a242
  v_mfma_f32_16x16x32_bf16 v[188:191], v[196:199], a[188:191], v[188:191]
  v_exp_f32 v212, v212
  v_cvt_pk_bf16_f32 v77, v73, v77
  v_mfma_f32_16x16x32_bf16 v[232:235], a[128:131], a[64:67], 0
  v_accvgpr_read_b32 v240, a243
  v_cvt_pk_bf16_f32 v73, v72, v76
  v_add_f32 v254, v240, v254
  v_mfma_f32_16x16x32_bf16 v[232:235], a[132:135], a[68:71], v[232:235]
  v_cvt_pk_bf16_f32 v72, v64, v68
  v_cmp_nge_f32 vcc, s43, v254
  v_cvt_pk_bf16_f32 v76, v65, v69
  v_mfma_f32_16x16x32_bf16 v[232:235], a[136:139], a[72:75], v[232:235]
  v_rcp_f32 v254, v254
  v_cvt_pk_bf16_f32 v79, v75, v79
  s_or_b64 s[46:47], s[46:47], vcc
  v_mfma_f32_16x16x32_bf16 v[232:235], a[140:143], a[76:79], v[232:235]
  s_waitcnt lgkmcnt(1)
  v_cvt_pk_bf16_f32 v75, v74, v78
  v_mov_b32 v243, v254
  v_cvt_pk_bf16_f32 v74, v66, v70
  v_mfma_f32_16x16x32_bf16 v[236:239], a[128:131], a[80:83], 0
  v_accvgpr_write_b32 a242, 0
  v_mfma_f32_16x16x32_bf16 v[236:239], a[132:135], a[84:87], v[236:239]
  ds_write_b128 v255, v[72:75] offset:4096
  v_accvgpr_write_b32 a243, 0
  v_cvt_pk_bf16_f32 v78, v67, v71
  v_mfma_f32_16x16x32_bf16 v[236:239], a[136:139], a[88:91], v[236:239]
  v_mov_b32_dpp v243, v254 row_ror:12 row_mask:0x2 bank_mask:0xf
  v_cvt_pk_bf16_f32 v93, v89, v93
  s_nop 0
  v_mov_b32_dpp v243, v254 row_ror:8 row_mask:0x4 bank_mask:0xf
  v_mfma_f32_16x16x32_bf16 v[236:239], a[140:143], a[92:95], v[236:239]
  v_cvt_pk_bf16_f32 v89, v88, v92
  v_mov_b32_dpp v243, v254 row_ror:4 row_mask:0x8 bank_mask:0xf
  v_cvt_pk_bf16_f32 v88, v80, v84
  v_mfma_f32_16x16x32_bf16 v[192:195], a[128:131], a[32:35], v[224:227]
  v_max3_f32 v232, v232, v233, v234
  v_max_f32 v232, v232, v235
  v_mov_b32_dpp v240, v243 row_newbcast:0 row_mask:0xf bank_mask:0xf
  v_mfma_f32_16x16x32_bf16 v[192:195], a[132:135], a[36:39], v[192:195]
  v_exp_f32 v213, v213
  v_mfma_f32_16x16x32_bf16 v[192:195], a[136:139], a[40:43], v[192:195]
  ds_write_b128 v255, v[76:79] offset:4352
  v_cvt_pk_bf16_f32 v206, v212, v213
  v_mov_b32 v233, v232
  v_mfma_f32_16x16x32_bf16 v[192:195], a[140:143], a[44:47], v[192:195]
  v_exp_f32 v214, v214
  v_mov_b32_dpp v241, v243 row_newbcast:1 row_mask:0xf bank_mask:0xf
  v_mfma_f32_16x16x32_bf16 v[196:199], a[156:159], a[44:47], v[224:227]
  v_permlane16_swap_b32 v232, v233
  v_max_f32 v232, v232, v233
  v_cvt_pk_bf16_f32 v92, v81, v85
  v_mfma_f32_16x16x32_bf16 v[196:199], a[152:155], a[40:43], v[196:199]
  v_exp_f32 v215, v215
  v_mov_b32_dpp v242, v243 row_newbcast:2 row_mask:0xf bank_mask:0xf
  v_mfma_f32_16x16x32_bf16 v[196:199], a[148:151], a[36:39], v[196:199]
  v_cvt_pk_bf16_f32 v207, v214, v215
  v_mov_b32 v233, v232
  v_cvt_pk_bf16_f32 v95, v91, v95
  v_mfma_f32_16x16x32_bf16 v[196:199], a[144:147], a[32:35], v[196:199]
  v_exp_f32 v192, v192
  v_mov_b32_dpp v243, v243 row_newbcast:3 row_mask:0xf bank_mask:0xf
  v_smfmac_f32_16x16x64_bf16 a[236:239], a[224:227], v[200:207], v253
  v_cvt_pk_bf16_f32 v91, v90, v94
  v_cvt_pk_bf16_f32 v90, v82, v86
  v_mfma_f32_16x16x32_bf16 v[0:3], v[200:203], a[192:195], 0
  v_permlane32_swap_b32 v232, v233
  v_min_f32 v235, -v232, -v233
  v_mfma_f32_16x16x32_bf16 v[4:7], v[200:203], a[196:199], 0
  ds_write_b128 v255, v[88:91] offset:16384
  v_exp_f32 v193, v193
  v_mfma_f32_16x16x32_bf16 v[8:11], v[200:203], a[200:203], 0
  v_cvt_pk_bf16_f32 v192, v192, v193
  v_subrev_f32 v232, 0x40a00000, v235
  v_cvt_pk_bf16_f32 v94, v83, v87
  v_mfma_f32_16x16x32_bf16 v[12:15], v[200:203], a[204:207], 0
  v_exp_f32 v194, v194
  v_mfma_f32_16x16x32_bf16 v[16:19], v[200:203], a[208:211], 0
  ds_write_b128 v255, v[92:95] offset:16640
  v_subrev_f32 v233, 0x40a00000, v235
  v_subrev_f32 v234, 0x40a00000, v235
  v_mfma_f32_16x16x32_bf16 v[20:23], v[200:203], a[212:215], 0
  v_exp_f32 v195, v195
  v_subrev_f32 v235, 0x40a00000, v235
  v_pk_mul_f32 v[96:97], v[96:97], v[240:241]
  v_pk_mul_f32 v[98:99], v[98:99], v[242:243]
  v_pk_mul_f32 v[100:101], v[100:101], v[240:241]
  v_pk_mul_f32 v[102:103], v[102:103], v[242:243]
  v_pk_mul_f32 v[104:105], v[104:105], v[240:241]
  v_pk_mul_f32 v[106:107], v[106:107], v[242:243]
  v_pk_mul_f32 v[108:109], v[108:109], v[240:241]
  v_pk_mul_f32 v[110:111], v[110:111], v[242:243]
  v_pk_mul_f32 v[112:113], v[112:113], v[240:241]
  v_pk_mul_f32 v[114:115], v[114:115], v[242:243]
  v_pk_mul_f32 v[116:117], v[116:117], v[240:241]
  v_pk_mul_f32 v[118:119], v[118:119], v[242:243]
  v_pk_mul_f32 v[120:121], v[120:121], v[240:241]
  v_pk_mul_f32 v[122:123], v[122:123], v[242:243]
  v_pk_mul_f32 v[124:125], v[124:125], v[240:241]
  v_pk_mul_f32 v[126:127], v[126:127], v[242:243]
  v_mfma_f32_16x16x32_bf16 v[24:27], v[200:203], a[216:219], 0
  v_cvt_pk_bf16_f32 v193, v194, v195
  v_max3_f32 v236, v236, v237, v238
  v_accvgpr_read_b32 v254, a244
  v_cvt_pk_bf16_f32 v109, v105, v109
  v_mfma_f32_16x16x32_bf16 v[28:31], v[200:203], a[220:223], 0
  v_exp_f32 v196, v196
  v_accvgpr_read_b32 v240, a245
  v_mfma_f32_16x16x32_bf16 v[208:211], a[128:131], a[48:51], v[228:231]
  v_max_f32 v236, v236, v239
  v_mov_b32 v237, v236
  v_cvt_pk_bf16_f32 v105, v104, v108
  v_add_f32 v254, v240, v254
  v_mfma_f32_16x16x32_bf16 v[208:211], a[132:135], a[52:55], v[208:211]
  v_exp_f32 v197, v197
  v_cvt_pk_bf16_f32 v104, v96, v100
  v_mfma_f32_16x16x32_bf16 v[208:211], a[136:139], a[56:59], v[208:211]
  v_cvt_pk_bf16_f32 v194, v196, v197
  v_permlane16_swap_b32 v236, v237
  v_cmp_nge_f32 vcc, s43, v254
  v_cvt_pk_bf16_f32 v108, v97, v101
  v_mfma_f32_16x16x32_bf16 v[208:211], a[140:143], a[60:63], v[208:211]
  v_exp_f32 v198, v198
  v_mfma_f32_16x16x32_bf16 v[212:215], a[156:159], a[60:63], v[228:231]
  v_max_f32 v236, v236, v237
  v_mov_b32 v237, v236
  v_rcp_f32 v254, v254
  v_cvt_pk_bf16_f32 v111, v107, v111
  s_or_b64 s[46:47], s[46:47], vcc
  v_mfma_f32_16x16x32_bf16 v[212:215], a[152:155], a[56:59], v[212:215]
  v_exp_f32 v199, v199
  v_cvt_pk_bf16_f32 v107, v106, v110
  v_mfma_f32_16x16x32_bf16 v[212:215], a[148:151], a[52:55], v[212:215]
  v_cvt_pk_bf16_f32 v195, v198, v199
  v_permlane32_swap_b32 v236, v237
  v_mov_b32 v243, v254
  v_cvt_pk_bf16_f32 v106, v98, v102
  v_mfma_f32_16x16x32_bf16 v[212:215], a[144:147], a[48:51], v[212:215]
  v_exp_f32 v208, v208
  v_accvgpr_write_b32 a244, 0
  v_mfma_f32_16x16x32_bf16 v[32:35], v[204:207], a[192:195], 0
  ds_write_b128 v255, v[104:107] offset:6144
  v_min_f32 v238, -v236, -v237
  v_accvgpr_write_b32 a255, v238
  v_min_f32 v239, s60, v238
  v_mfma_f32_16x16x32_bf16 v[36:39], v[204:207], a[196:199], 0
  v_exp_f32 v209, v209
  v_accvgpr_write_b32 a245, 0
  v_cvt_pk_bf16_f32 v110, v99, v103
  v_mfma_f32_16x16x32_bf16 v[40:43], v[204:207], a[200:203], 0
  v_cvt_pk_bf16_f32 v196, v208, v209
  v_subrev_f32 v236, 0x40a00000, v239
  v_mov_b32_dpp v243, v254 row_ror:12 row_mask:0x2 bank_mask:0xf
  v_mfma_f32_16x16x32_bf16 v[44:47], v[204:207], a[204:207], 0
  v_exp_f32 v210, v210
  v_cvt_pk_bf16_f32 v125, v121, v125
  v_mov_b32_dpp v243, v254 row_ror:8 row_mask:0x4 bank_mask:0xf
  v_mfma_f32_16x16x32_bf16 v[48:51], v[204:207], a[208:211], 0
  v_subrev_f32 v237, 0x40a00000, v239
  v_subrev_f32 v238, 0x40a00000, v239
  v_subrev_f32 v239, 0x40a00000, v239
  v_cvt_pk_bf16_f32 v121, v120, v124
  v_mfma_f32_16x16x32_bf16 v[52:55], v[204:207], a[212:215], 0
  v_exp_f32 v211, v211
  v_mov_b32_dpp v243, v254 row_ror:4 row_mask:0x8 bank_mask:0xf
  v_cvt_pk_bf16_f32 v120, v112, v116
  v_mfma_f32_16x16x32_bf16 v[56:59], v[204:207], a[216:219], 0
  v_cvt_pk_bf16_f32 v197, v210, v211
  v_mov_b32_dpp v240, v243 row_newbcast:0 row_mask:0xf bank_mask:0xf
  v_mfma_f32_16x16x32_bf16 v[60:63], v[204:207], a[220:223], 0
  ds_write_b128 v255, v[108:111] offset:6400
  v_exp_f32 v212, v212
  v_mov_b32_dpp v241, v243 row_newbcast:1 row_mask:0xf bank_mask:0xf
  v_mfma_f32_16x16x32_bf16 v[200:203], a[128:131], a[64:67], v[232:235]
  v_cvt_pk_bf16_f32 v124, v113, v117
  v_mov_b32_dpp v242, v243 row_newbcast:2 row_mask:0xf bank_mask:0xf
  v_cvt_pk_bf16_f32 v127, v123, v127
  v_mov_b32_dpp v243, v243 row_newbcast:3 row_mask:0xf bank_mask:0xf
  v_mfma_f32_16x16x32_bf16 v[200:203], a[132:135], a[68:71], v[200:203]
  v_exp_f32 v213, v213
  v_cvt_pk_bf16_f32 v123, v122, v126
  v_mfma_f32_16x16x32_bf16 v[200:203], a[136:139], a[72:75], v[200:203]
  v_cvt_pk_bf16_f32 v198, v212, v213
  v_cvt_pk_bf16_f32 v122, v114, v118
  v_mfma_f32_16x16x32_bf16 v[200:203], a[140:143], a[76:79], v[200:203]
  ds_write_b128 v255, v[120:123] offset:18432
  v_exp_f32 v214, v214
  v_cvt_pk_bf16_f32 v126, v115, v119
  v_mfma_f32_16x16x32_bf16 v[204:207], a[156:159], a[76:79], v[232:235]
  ds_write_b128 v255, v[124:127] offset:18688
  v_mfma_f32_16x16x32_bf16 v[204:207], a[152:155], a[72:75], v[204:207]
  v_exp_f32 v215, v215
  v_pk_mul_f32 v[128:129], v[128:129], v[240:241]
  v_pk_mul_f32 v[130:131], v[130:131], v[242:243]
  v_pk_mul_f32 v[132:133], v[132:133], v[240:241]
  v_pk_mul_f32 v[134:135], v[134:135], v[242:243]
  v_pk_mul_f32 v[136:137], v[136:137], v[240:241]
  v_pk_mul_f32 v[138:139], v[138:139], v[242:243]
  v_pk_mul_f32 v[140:141], v[140:141], v[240:241]
  v_pk_mul_f32 v[142:143], v[142:143], v[242:243]
  v_pk_mul_f32 v[144:145], v[144:145], v[240:241]
  v_pk_mul_f32 v[146:147], v[146:147], v[242:243]
  v_pk_mul_f32 v[148:149], v[148:149], v[240:241]
  v_pk_mul_f32 v[150:151], v[150:151], v[242:243]
  v_pk_mul_f32 v[152:153], v[152:153], v[240:241]
  v_pk_mul_f32 v[154:155], v[154:155], v[242:243]
  v_pk_mul_f32 v[156:157], v[156:157], v[240:241]
  v_pk_mul_f32 v[158:159], v[158:159], v[242:243]
  v_mfma_f32_16x16x32_bf16 v[204:207], a[148:151], a[68:71], v[204:207]
  v_cvt_pk_bf16_f32 v199, v214, v215
  v_accvgpr_read_b32 v254, a246
  v_cvt_pk_bf16_f32 v141, v137, v141
  v_mfma_f32_16x16x32_bf16 v[204:207], a[144:147], a[64:67], v[204:207]
  v_exp_f32 v200, v200
  v_accvgpr_read_b32 v240, a247
  v_cvt_pk_bf16_f32 v137, v136, v140
  v_smfmac_f32_16x16x64_bf16 a[240:243], a[224:227], v[192:199], v253
  ds_read_b128 a[96:99], v246 offset:0
  v_add_f32 v254, v240, v254
  v_mfma_f32_16x16x32_bf16 v[64:67], v[192:195], a[192:195], 0
  ds_read_b128 a[100:103], v247 offset:0
  v_cvt_pk_bf16_f32 v136, v128, v132
  v_cmp_nge_f32 vcc, s43, v254
  v_mfma_f32_16x16x32_bf16 v[68:71], v[192:195], a[196:199], 0
  v_exp_f32 v201, v201
  v_cvt_pk_bf16_f32 v140, v129, v133
  v_mfma_f32_16x16x32_bf16 v[72:75], v[192:195], a[200:203], 0
  ds_read_b128 a[104:107], v246 offset:4096
  v_cvt_pk_bf16_f32 v200, v200, v201
  v_rcp_f32 v254, v254
  v_mfma_f32_16x16x32_bf16 v[76:79], v[192:195], a[204:207], 0
  v_exp_f32 v202, v202
  v_cvt_pk_bf16_f32 v143, v139, v143
  s_or_b64 s[46:47], s[46:47], vcc
  v_mfma_f32_16x16x32_bf16 v[80:83], v[192:195], a[208:211], 0
  ds_read_b128 a[108:111], v247 offset:4096
  v_cvt_pk_bf16_f32 v139, v138, v142
  v_mov_b32 v243, v254
  v_cvt_pk_bf16_f32 v138, v130, v134
  v_mfma_f32_16x16x32_bf16 v[84:87], v[192:195], a[212:215], 0
  v_exp_f32 v203, v203
  v_accvgpr_write_b32 a246, 0
  v_mfma_f32_16x16x32_bf16 v[88:91], v[192:195], a[216:219], 0
  ds_read_b128 a[112:115], v246 offset:2048
  v_cvt_pk_bf16_f32 v201, v202, v203
  v_mfma_f32_16x16x32_bf16 v[92:95], v[192:195], a[220:223], 0
  ds_write_b128 v255, v[136:139] offset:8192
  v_exp_f32 v204, v204
  v_accvgpr_write_b32 a247, 0
  v_mfma_f32_16x16x32_bf16 v[208:211], a[128:131], a[80:83], v[236:239]
  ds_read_b128 a[116:119], v247 offset:2048
  v_cvt_pk_bf16_f32 v142, v131, v135
  v_mov_b32_dpp v243, v254 row_ror:12 row_mask:0x2 bank_mask:0xf
  v_mfma_f32_16x16x32_bf16 v[208:211], a[132:135], a[84:87], v[208:211]
  v_exp_f32 v205, v205
  v_cvt_pk_bf16_f32 v157, v153, v157
  v_mfma_f32_16x16x32_bf16 v[208:211], a[136:139], a[88:91], v[208:211]
  ds_read_b128 a[120:123], v246 offset:6144
  v_cvt_pk_bf16_f32 v202, v204, v205
  v_mov_b32_dpp v243, v254 row_ror:8 row_mask:0x4 bank_mask:0xf
  v_cvt_pk_bf16_f32 v153, v152, v156
  v_mfma_f32_16x16x32_bf16 v[208:211], a[140:143], a[92:95], v[208:211]
  v_exp_f32 v206, v206
  v_mov_b32_dpp v243, v254 row_ror:4 row_mask:0x8 bank_mask:0xf
  v_mfma_f32_16x16x32_bf16 v[212:215], a[156:159], a[92:95], v[236:239]
  ds_read_b128 a[124:127], v247 offset:6144
  v_cvt_pk_bf16_f32 v152, v144, v148
  v_mov_b32_dpp v240, v243 row_newbcast:0 row_mask:0xf bank_mask:0xf
  v_mfma_f32_16x16x32_bf16 v[212:215], a[152:155], a[88:91], v[212:215]
  ds_write_b128 v255, v[140:143] offset:8448
  v_exp_f32 v207, v207
  v_mfma_f32_16x16x32_bf16 v[212:215], a[148:151], a[84:87], v[212:215]
  v_cvt_pk_bf16_f32 v203, v206, v207
  v_mov_b32_dpp v241, v243 row_newbcast:1 row_mask:0xf bank_mask:0xf
  v_cvt_pk_bf16_f32 v156, v145, v149
  v_mfma_f32_16x16x32_bf16 v[212:215], a[144:147], a[80:83], v[212:215]
  v_exp_f32 v208, v208
  v_mov_b32_dpp v242, v243 row_newbcast:2 row_mask:0xf bank_mask:0xf
  v_cvt_pk_bf16_f32 v159, v155, v159
  v_mfma_f32_16x16x32_bf16 v[96:99], v[196:199], a[192:195], 0
  v_mov_b32_dpp v243, v243 row_newbcast:3 row_mask:0xf bank_mask:0xf
  v_cvt_pk_bf16_f32 v155, v154, v158
  v_cvt_pk_bf16_f32 v154, v146, v150
  v_mfma_f32_16x16x32_bf16 v[100:103], v[196:199], a[196:199], 0
  v_exp_f32 v209, v209
  v_mfma_f32_16x16x32_bf16 v[104:107], v[196:199], a[200:203], 0
  ds_write_b128 v255, v[152:155] offset:20480
  v_cvt_pk_bf16_f32 v204, v208, v209
  v_cvt_pk_bf16_f32 v158, v147, v151
  v_mfma_f32_16x16x32_bf16 v[108:111], v[196:199], a[204:207], 0
  ds_write_b128 v255, v[156:159] offset:20736
  v_exp_f32 v210, v210
  v_mfma_f32_16x16x32_bf16 v[112:115], v[196:199], a[208:211], 0
  v_pk_mul_f32 v[160:161], v[160:161], v[240:241]
  v_pk_mul_f32 v[162:163], v[162:163], v[242:243]
  v_pk_mul_f32 v[164:165], v[164:165], v[240:241]
  v_pk_mul_f32 v[166:167], v[166:167], v[242:243]
  v_pk_mul_f32 v[168:169], v[168:169], v[240:241]
  v_pk_mul_f32 v[170:171], v[170:171], v[242:243]
  v_pk_mul_f32 v[172:173], v[172:173], v[240:241]
  v_pk_mul_f32 v[174:175], v[174:175], v[242:243]
  v_pk_mul_f32 v[176:177], v[176:177], v[240:241]
  v_pk_mul_f32 v[178:179], v[178:179], v[242:243]
  v_pk_mul_f32 v[180:181], v[180:181], v[240:241]
  v_pk_mul_f32 v[182:183], v[182:183], v[242:243]
  v_pk_mul_f32 v[184:185], v[184:185], v[240:241]
  v_pk_mul_f32 v[186:187], v[186:187], v[242:243]
  v_pk_mul_f32 v[188:189], v[188:189], v[240:241]
  v_pk_mul_f32 v[190:191], v[190:191], v[242:243]
  v_cvt_pk_bf16_f32 v173, v169, v173
  v_mfma_f32_16x16x32_bf16 v[116:119], v[196:199], a[212:215], 0
  v_exp_f32 v211, v211
  v_cvt_pk_bf16_f32 v169, v168, v172
  v_mfma_f32_16x16x32_bf16 v[120:123], v[196:199], a[216:219], 0
  v_cvt_pk_bf16_f32 v205, v210, v211
  v_cvt_pk_bf16_f32 v168, v160, v164
  v_cvt_pk_bf16_f32 v172, v161, v165
  v_mfma_f32_16x16x32_bf16 v[124:127], v[196:199], a[220:223], 0
  s_waitcnt lgkmcnt(2)
  v_exp_f32 v212, v212
  v_cvt_pk_bf16_f32 v175, v171, v175
  v_mfma_f32_16x16x32_bf16 v[192:195], a[96:99], a[0:3], v[216:219]
  ds_read_b128 a[128:131], v246 offset:16384
  v_cvt_pk_bf16_f32 v171, v170, v174
  v_cvt_pk_bf16_f32 v170, v162, v166
  v_mfma_f32_16x16x32_bf16 v[192:195], a[100:103], a[4:7], v[192:195]
  v_exp_f32 v213, v213
  v_mfma_f32_16x16x32_bf16 v[192:195], a[104:107], a[8:11], v[192:195]
  ds_read_b128 a[132:135], v247 offset:16384
  v_cvt_pk_bf16_f32 v206, v212, v213
  v_mfma_f32_16x16x32_bf16 v[192:195], a[108:111], a[12:15], v[192:195]
  ds_write_b128 v255, v[168:171] offset:10240
  v_exp_f32 v214, v214
  v_mfma_f32_16x16x32_bf16 v[196:199], a[124:127], a[12:15], v[216:219]
  ds_read_b128 a[136:139], v246 offset:20480
  v_cvt_pk_bf16_f32 v174, v163, v167
  v_cvt_pk_bf16_f32 v189, v185, v189
  v_mfma_f32_16x16x32_bf16 v[196:199], a[120:123], a[8:11], v[196:199]
  v_exp_f32 v215, v215
  v_cvt_pk_bf16_f32 v185, v184, v188
  v_mfma_f32_16x16x32_bf16 v[196:199], a[116:119], a[4:7], v[196:199]
  ds_read_b128 a[140:143], v247 offset:20480
  v_cvt_pk_bf16_f32 v207, v214, v215
  v_cvt_pk_bf16_f32 v184, v176, v180
  v_mfma_f32_16x16x32_bf16 v[196:199], a[112:115], a[0:3], v[196:199]
  v_exp_f32 v192, v192
  v_smfmac_f32_16x16x64_bf16 a[244:247], a[224:227], v[200:207], v253
  ds_read_b128 a[144:147], v246 offset:18432
  ds_write_b128 v255, v[172:175] offset:10496
  v_mfma_f32_16x16x32_bf16 v[128:131], v[200:203], a[192:195], 0
  ds_read_b128 a[148:151], v247 offset:18432
  ds_read_b128 a[152:155], v246 offset:22528
  v_mfma_f32_16x16x32_bf16 v[132:135], v[200:203], a[196:199], 0
  v_exp_f32 v193, v193
  v_cvt_pk_bf16_f32 v188, v177, v181
  v_mfma_f32_16x16x32_bf16 v[136:139], v[200:203], a[200:203], 0
  ds_read_b128 a[156:159], v247 offset:22528
  v_cvt_pk_bf16_f32 v192, v192, v193
  v_cvt_pk_bf16_f32 v191, v187, v191
  v_mfma_f32_16x16x32_bf16 v[140:143], v[200:203], a[204:207], 0
  ds_read_b64_tr_b16 a[160:161], v248 offset:8192
  v_exp_f32 v194, v194
  v_cvt_pk_bf16_f32 v187, v186, v190
  v_mfma_f32_16x16x32_bf16 v[144:147], v[200:203], a[208:211], 0
  ds_read_b64_tr_b16 a[162:163], v248 offset:10240
  ds_read_b64_tr_b16 a[164:165], v249 offset:8192
  v_cvt_pk_bf16_f32 v186, v178, v182
  v_mfma_f32_16x16x32_bf16 v[148:151], v[200:203], a[212:215], 0
  v_exp_f32 v195, v195
  v_mfma_f32_16x16x32_bf16 v[152:155], v[200:203], a[216:219], 0
  ds_read_b64_tr_b16 a[166:167], v249 offset:10240
  ds_write_b128 v255, v[184:187] offset:22528
  v_cvt_pk_bf16_f32 v193, v194, v195
  v_mfma_f32_16x16x32_bf16 v[156:159], v[200:203], a[220:223], 0
  s_waitcnt lgkmcnt(8)
  v_exp_f32 v196, v196
  v_mfma_f32_16x16x32_bf16 v[208:211], a[128:131], a[0:3], v[216:219]
  ds_read_b64_tr_b16 a[168:169], v250 offset:8192
  ds_read_b64_tr_b16 a[170:171], v250 offset:10240
  ds_read_b64_tr_b16 a[172:173], v251 offset:8192
  v_cvt_pk_bf16_f32 v190, v179, v183
  v_mfma_f32_16x16x32_bf16 v[208:211], a[132:135], a[4:7], v[208:211]
  v_exp_f32 v197, v197
  v_mfma_f32_16x16x32_bf16 v[208:211], a[136:139], a[8:11], v[208:211]
  ds_read_b64_tr_b16 a[174:175], v251 offset:10240
  ds_write_b128 v255, v[188:191] offset:22784
  v_cvt_pk_bf16_f32 v194, v196, v197
  s_cmp_lg_u64 s[46:47], 0
  s_cselect_b32 s45, 1, 0
  s_or_b32 s51, s51, s45
  s_mov_b64 s[46:47], 0
  v_mfma_f32_16x16x32_bf16 v[208:211], a[140:143], a[12:15], v[208:211]
  s_waitcnt lgkmcnt(9)
  v_exp_f32 v198, v198
  v_mfma_f32_16x16x32_bf16 v[212:215], a[156:159], a[12:15], v[216:219]
  ds_read_b64_tr_b16 a[176:177], v248 offset:12288
  ds_read_b64_tr_b16 a[178:179], v248 offset:14336
  v_mfma_f32_16x16x32_bf16 v[212:215], a[152:155], a[8:11], v[212:215]
  ds_read_b64_tr_b16 a[180:181], v249 offset:12288
  v_exp_f32 v199, v199
  v_mfma_f32_16x16x32_bf16 v[212:215], a[148:151], a[4:7], v[212:215]
  ds_read_b64_tr_b16 a[182:183], v249 offset:14336
  v_cvt_pk_bf16_f32 v195, v198, v199
  v_mfma_f32_16x16x32_bf16 v[212:215], a[144:147], a[0:3], v[212:215]
  v_exp_f32 v208, v208
  v_mfma_f32_16x16x32_bf16 v[160:163], v[204:207], a[192:195], 0
  ds_read_b64_tr_b16 a[184:185], v250 offset:12288
  ds_read_b64_tr_b16 a[186:187], v250 offset:14336
  v_mfma_f32_16x16x32_bf16 v[164:167], v[204:207], a[196:199], 0
  v_exp_f32 v209, v209
  v_mfma_f32_16x16x32_bf16 v[168:171], v[204:207], a[200:203], 0
  ds_read_b64_tr_b16 a[188:189], v251 offset:12288
  ds_read_b64_tr_b16 a[190:191], v251 offset:14336
  v_cvt_pk_bf16_f32 v196, v208, v209
  v_mfma_f32_16x16x32_bf16 v[172:175], v[204:207], a[204:207], 0
  v_exp_f32 v210, v210
  v_mfma_f32_16x16x32_bf16 v[176:179], v[204:207], a[208:211], 0
  ds_read_b64_tr_b16 a[192:193], v248 offset:24576
  ds_read_b64_tr_b16 a[194:195], v248 offset:26624
  v_mfma_f32_16x16x32_bf16 v[180:183], v[204:207], a[212:215], 0
  v_exp_f32 v211, v211
  v_mfma_f32_16x16x32_bf16 v[184:187], v[204:207], a[216:219], 0
  ds_read_b64_tr_b16 a[196:197], v249 offset:24576
  v_cvt_pk_bf16_f32 v197, v210, v211
  v_mfma_f32_16x16x32_bf16 v[188:191], v[204:207], a[220:223], 0
  v_exp_f32 v212, v212
  v_mfma_f32_16x16x32_bf16 v[200:203], a[96:99], a[16:19], v[220:223]
  ds_read_b64_tr_b16 a[198:199], v249 offset:26624
  ds_read_b64_tr_b16 a[200:201], v250 offset:24576
  v_mfma_f32_16x16x32_bf16 v[200:203], a[100:103], a[20:23], v[200:203]
  v_exp_f32 v213, v213
  v_mfma_f32_16x16x32_bf16 v[200:203], a[104:107], a[24:27], v[200:203]
  ds_read_b64_tr_b16 a[202:203], v250 offset:26624
  v_cvt_pk_bf16_f32 v198, v212, v213
  v_mfma_f32_16x16x32_bf16 v[200:203], a[108:111], a[28:31], v[200:203]
  v_exp_f32 v214, v214
  v_mfma_f32_16x16x32_bf16 v[204:207], a[124:127], a[28:31], v[220:223]
  ds_read_b64_tr_b16 a[204:205], v251 offset:24576
  ds_read_b64_tr_b16 a[206:207], v251 offset:26624
  v_mfma_f32_16x16x32_bf16 v[204:207], a[120:123], a[24:27], v[204:207]
  v_exp_f32 v215, v215
  v_mfma_f32_16x16x32_bf16 v[204:207], a[116:119], a[20:23], v[204:207]
  ds_read_b64_tr_b16 a[208:209], v248 offset:28672
  v_cvt_pk_bf16_f32 v199, v214, v215
  v_mfma_f32_16x16x32_bf16 v[204:207], a[112:115], a[16:19], v[204:207]
  v_exp_f32 v200, v200
  v_smfmac_f32_16x16x64_bf16 a[236:239], a[228:231], v[192:199], v253
  s_waitcnt lgkmcnt(4)
  ds_read_b64_tr_b16 a[210:211], v248 offset:30720
  v_mfma_f32_16x16x32_bf16 v[0:3], v[192:195], a[160:163], v[0:3]
  ds_read_b64_tr_b16 a[212:213], v249 offset:28672
  ds_read_b64_tr_b16 a[214:215], v249 offset:30720
  v_mfma_f32_16x16x32_bf16 v[0:3], v[196:199], a[192:195], v[0:3]
  v_exp_f32 v201, v201
  v_mfma_f32_16x16x32_bf16 v[4:7], v[196:199], a[196:199], v[4:7]
  ds_read_b64_tr_b16 a[216:217], v250 offset:28672
  v_cvt_pk_bf16_f32 v200, v200, v201
  v_mfma_f32_16x16x32_bf16 v[4:7], v[192:195], a[164:167], v[4:7]
  v_exp_f32 v202, v202
  v_mfma_f32_16x16x32_bf16 v[8:11], v[192:195], a[168:171], v[8:11]
  s_waitcnt lgkmcnt(5)
  ds_read_b64_tr_b16 a[218:219], v250 offset:30720
  ds_read_b64_tr_b16 a[220:221], v251 offset:28672
  v_mfma_f32_16x16x32_bf16 v[8:11], v[196:199], a[200:203], v[8:11]
  v_exp_f32 v203, v203
  v_mfma_f32_16x16x32_bf16 v[12:15], v[196:199], a[204:207], v[12:15]
  ds_read_b64_tr_b16 a[222:223], v251 offset:30720
  v_cvt_pk_bf16_f32 v201, v202, v203
  v_mfma_f32_16x16x32_bf16 v[12:15], v[192:195], a[172:175], v[12:15]
  v_exp_f32 v204, v204
  v_mfma_f32_16x16x32_bf16 v[208:211], a[128:131], a[16:19], v[220:223]
  v_mfma_f32_16x16x32_bf16 v[208:211], a[132:135], a[20:23], v[208:211]
  v_exp_f32 v205, v205
  v_mfma_f32_16x16x32_bf16 v[208:211], a[136:139], a[24:27], v[208:211]
  v_cvt_pk_bf16_f32 v202, v204, v205
  v_mfma_f32_16x16x32_bf16 v[208:211], a[140:143], a[28:31], v[208:211]
  v_exp_f32 v206, v206
  v_mfma_f32_16x16x32_bf16 v[212:215], a[156:159], a[28:31], v[220:223]
  v_mfma_f32_16x16x32_bf16 v[212:215], a[152:155], a[24:27], v[212:215]
  v_exp_f32 v207, v207
  v_mfma_f32_16x16x32_bf16 v[212:215], a[148:151], a[20:23], v[212:215]
  v_cvt_pk_bf16_f32 v203, v206, v207
  v_mfma_f32_16x16x32_bf16 v[212:215], a[144:147], a[16:19], v[212:215]
  s_nop 0
  v_exp_f32 v208, v208
  v_mfma_f32_16x16x32_bf16 v[16:19], v[192:195], a[176:179], v[16:19]
  s_waitcnt lgkmcnt(0)
  v_mfma_f32_16x16x32_bf16 v[16:19], v[196:199], a[208:211], v[16:19]
  v_exp_f32 v209, v209
  v_mfma_f32_16x16x32_bf16 v[20:23], v[196:199], a[212:215], v[20:23]
  v_cvt_pk_bf16_f32 v204, v208, v209
  v_mfma_f32_16x16x32_bf16 v[20:23], v[192:195], a[180:183], v[20:23]
  s_waitcnt vmcnt(0) lgkmcnt(0)
  v_exp_f32 v210, v210
  v_mfma_f32_16x16x32_bf16 v[24:27], v[192:195], a[184:187], v[24:27]
  s_barrier
  v_mfma_f32_16x16x32_bf16 v[24:27], v[196:199], a[216:219], v[24:27]
  v_exp_f32 v211, v211
  v_mfma_f32_16x16x32_bf16 v[28:31], v[196:199], a[220:223], v[28:31]
  v_cvt_pk_bf16_f32 v205, v210, v211
  v_mfma_f32_16x16x32_bf16 v[28:31], v[192:195], a[188:191], v[28:31]
  v_exp_f32 v212, v212
  v_mfma_f32_16x16x32_bf16 v[192:195], a[96:99], a[32:35], v[224:227]
  v_bfe_u32 v240, v255, 9, 2
  v_and_b32 v245, 0x70, v255
  v_mfma_f32_16x16x32_bf16 v[192:195], a[100:103], a[36:39], v[192:195]
  v_exp_f32 v213, v213
  v_mfma_f32_16x16x32_bf16 v[192:195], a[104:107], a[40:43], v[192:195]
  v_cvt_pk_bf16_f32 v206, v212, v213
  v_lshl_add_u32 v245, v240, 9, v245
  v_mfma_f32_16x16x32_bf16 v[192:195], a[108:111], a[44:47], v[192:195]
  s_add_u32 m0, s38, 0
  v_exp_f32 v214, v214
  v_mfma_f32_16x16x32_bf16 v[196:199], a[124:127], a[44:47], v[224:227]
  buffer_load_dwordx4 v252, s[16:19], s33 offen nt lds
  v_mfma_f32_16x16x32_bf16 v[196:199], a[120:123], a[40:43], v[196:199]
  v_exp_f32 v215, v215
  v_mfma_f32_16x16x32_bf16 v[196:199], a[116:119], a[36:39], v[196:199]
  v_cvt_pk_bf16_f32 v207, v214, v215
  v_bfe_u32 v241, v255, 7, 1
  v_mfma_f32_16x16x32_bf16 v[196:199], a[112:115], a[32:35], v[196:199]
  v_exp_f32 v192, v192
  v_smfmac_f32_16x16x64_bf16 a[236:239], a[232:235], v[200:207], v253
  v_lshl_add_u32 v245, v241, 8, v245
  v_mfma_f32_16x16x32_bf16 v[32:35], v[200:203], a[160:163], v[32:35]
  v_bfe_u32 v240, v255, 10, 1
  v_lshlrev_b32 v240, 9, v240
  v_mfma_f32_16x16x32_bf16 v[32:35], v[204:207], a[192:195], v[32:35]
  v_exp_f32 v193, v193
  v_mfma_f32_16x16x32_bf16 v[36:39], v[204:207], a[196:199], v[36:39]
  v_cvt_pk_bf16_f32 v192, v192, v193
  v_bfe_u32 v241, v255, 4, 2
  v_mfma_f32_16x16x32_bf16 v[36:39], v[200:203], a[164:167], v[36:39]
  s_add_u32 m0, s38, 3968
  v_exp_f32 v194, v194
  v_mfma_f32_16x16x32_bf16 v[40:43], v[200:203], a[168:171], v[40:43]
  buffer_load_dwordx4 v252, s[16:19], s33 offen offset:128 nt lds
  v_mfma_f32_16x16x32_bf16 v[40:43], v[204:207], a[200:203], v[40:43]
  v_exp_f32 v195, v195
  v_mfma_f32_16x16x32_bf16 v[44:47], v[204:207], a[204:207], v[44:47]
  v_cvt_pk_bf16_f32 v193, v194, v195
  v_lshl_add_u32 v240, v241, 7, v240
  v_mfma_f32_16x16x32_bf16 v[44:47], v[200:203], a[172:175], v[44:47]
  v_exp_f32 v196, v196
  v_mfma_f32_16x16x32_bf16 v[208:211], a[128:131], a[32:35], v[224:227]
  v_bfe_u32 v241, v255, 6, 2
  v_lshl_add_u32 v240, v241, 4, v240
  v_mfma_f32_16x16x32_bf16 v[208:211], a[132:135], a[36:39], v[208:211]
  v_exp_f32 v197, v197
  v_mfma_f32_16x16x32_bf16 v[208:211], a[136:139], a[40:43], v[208:211]
  v_cvt_pk_bf16_f32 v194, v196, v197
  v_bfe_u32 v241, v255, 9, 1
  v_mfma_f32_16x16x32_bf16 v[208:211], a[140:143], a[44:47], v[208:211]
  s_add_u32 m0, s38, 8192
  v_exp_f32 v198, v198
  v_mfma_f32_16x16x32_bf16 v[212:215], a[156:159], a[44:47], v[224:227]
  buffer_load_dwordx4 v252, s[20:23], s33 offen nt lds
  v_mfma_f32_16x16x32_bf16 v[212:215], a[152:155], a[40:43], v[212:215]
  v_exp_f32 v199, v199
  v_mfma_f32_16x16x32_bf16 v[212:215], a[148:151], a[36:39], v[212:215]
  v_cvt_pk_bf16_f32 v195, v198, v199
  v_lshl_add_u32 v240, v241, 3, v240
  v_mfma_f32_16x16x32_bf16 v[212:215], a[144:147], a[32:35], v[212:215]
  v_exp_f32 v208, v208
  v_mfma_f32_16x16x32_bf16 v[48:51], v[200:203], a[176:179], v[48:51]
  v_add_u32 v244, s49, v240
  v_mfma_f32_16x16x32_bf16 v[48:51], v[204:207], a[208:211], v[48:51]
  v_exp_f32 v209, v209
  v_mfma_f32_16x16x32_bf16 v[52:55], v[204:207], a[212:215], v[52:55]
  ds_read_b64_tr_b16 a[248:249], v244 offset:0
  v_cvt_pk_bf16_f32 v196, v208, v209
  v_mfma_f32_16x16x32_bf16 v[52:55], v[200:203], a[180:183], v[52:55]
  s_add_u32 m0, s38, 12160
  v_exp_f32 v210, v210
  v_mfma_f32_16x16x32_bf16 v[56:59], v[200:203], a[184:187], v[56:59]
  buffer_load_dwordx4 v252, s[20:23], s33 offen offset:128 nt lds
  v_mfma_f32_16x16x32_bf16 v[56:59], v[204:207], a[216:219], v[56:59]
  s_add_u32 s34, s34, 1
  v_exp_f32 v211, v211
  v_mfma_f32_16x16x32_bf16 v[60:63], v[204:207], a[220:223], v[60:63]
  s_add_u32 s33, s33, 8192
  ds_read_b64_tr_b16 a[250:251], v244 offset:64
  v_cvt_pk_bf16_f32 v197, v210, v211
  v_mfma_f32_16x16x32_bf16 v[60:63], v[200:203], a[188:191], v[60:63]
  v_exp_f32 v212, v212
  v_mfma_f32_16x16x32_bf16 v[200:203], a[96:99], a[48:51], v[228:231]
  v_mfma_f32_16x16x32_bf16 v[200:203], a[100:103], a[52:55], v[200:203]
  v_exp_f32 v213, v213
  v_mfma_f32_16x16x32_bf16 v[200:203], a[104:107], a[56:59], v[200:203]
  v_cvt_pk_bf16_f32 v198, v212, v213
  v_mfma_f32_16x16x32_bf16 v[200:203], a[108:111], a[60:63], v[200:203]
  s_add_u32 m0, s38, 16384
  v_exp_f32 v214, v214
  v_mfma_f32_16x16x32_bf16 v[204:207], a[124:127], a[60:63], v[228:231]
  buffer_load_dwordx4 v252, s[16:19], s33 offen nt lds
  v_mfma_f32_16x16x32_bf16 v[204:207], a[120:123], a[56:59], v[204:207]
  v_exp_f32 v215, v215
  v_mfma_f32_16x16x32_bf16 v[204:207], a[116:119], a[52:55], v[204:207]
  v_cvt_pk_bf16_f32 v199, v214, v215
  v_mfma_f32_16x16x32_bf16 v[204:207], a[112:115], a[48:51], v[204:207]
  v_exp_f32 v200, v200
  v_smfmac_f32_16x16x64_bf16 a[240:243], a[228:231], v[192:199], v253
  v_mfma_f32_16x16x32_bf16 v[64:67], v[192:195], a[160:163], v[64:67]
  v_mfma_f32_16x16x32_bf16 v[64:67], v[196:199], a[192:195], v[64:67]
  v_exp_f32 v201, v201
  v_mfma_f32_16x16x32_bf16 v[68:71], v[196:199], a[196:199], v[68:71]
  v_cvt_pk_bf16_f32 v200, v200, v201
  v_mfma_f32_16x16x32_bf16 v[68:71], v[192:195], a[164:167], v[68:71]
  s_add_u32 m0, s38, 20352
  v_exp_f32 v202, v202
  v_mfma_f32_16x16x32_bf16 v[72:75], v[192:195], a[168:171], v[72:75]
  buffer_load_dwordx4 v252, s[16:19], s33 offen offset:128 nt lds
  v_mfma_f32_16x16x32_bf16 v[72:75], v[196:199], a[200:203], v[72:75]
  v_exp_f32 v203, v203
  v_mfma_f32_16x16x32_bf16 v[76:79], v[196:199], a[204:207], v[76:79]
  v_cvt_pk_bf16_f32 v201, v202, v203
  v_mfma_f32_16x16x32_bf16 v[76:79], v[192:195], a[172:175], v[76:79]
  v_exp_f32 v204, v204
  v_mfma_f32_16x16x32_bf16 v[208:211], a[128:131], a[48:51], v[228:231]
  v_mfma_f32_16x16x32_bf16 v[208:211], a[132:135], a[52:55], v[208:211]
  v_exp_f32 v205, v205
  v_mfma_f32_16x16x32_bf16 v[208:211], a[136:139], a[56:59], v[208:211]
  v_cvt_pk_bf16_f32 v202, v204, v205
  v_mfma_f32_16x16x32_bf16 v[208:211], a[140:143], a[60:63], v[208:211]
  s_add_u32 m0, s38, 24576
  v_exp_f32 v206, v206
  v_mfma_f32_16x16x32_bf16 v[212:215], a[156:159], a[60:63], v[228:231]
  buffer_load_dwordx4 v252, s[20:23], s33 offen nt lds
  v_mfma_f32_16x16x32_bf16 v[212:215], a[152:155], a[56:59], v[212:215]
  v_exp_f32 v207, v207
  v_mfma_f32_16x16x32_bf16 v[212:215], a[148:151], a[52:55], v[212:215]
  v_cvt_pk_bf16_f32 v203, v206, v207
  v_mfma_f32_16x16x32_bf16 v[212:215], a[144:147], a[48:51], v[212:215]
  v_exp_f32 v208, v208
  v_mfma_f32_16x16x32_bf16 v[80:83], v[192:195], a[176:179], v[80:83]
  v_mfma_f32_16x16x32_bf16 v[80:83], v[196:199], a[208:211], v[80:83]
  v_exp_f32 v209, v209
  v_mfma_f32_16x16x32_bf16 v[84:87], v[196:199], a[212:215], v[84:87]
  v_cvt_pk_bf16_f32 v204, v208, v209
  v_mfma_f32_16x16x32_bf16 v[84:87], v[192:195], a[180:183], v[84:87]
  s_add_u32 m0, s38, 28544
  v_exp_f32 v210, v210
  v_mfma_f32_16x16x32_bf16 v[88:91], v[192:195], a[184:187], v[88:91]
  buffer_load_dwordx4 v252, s[20:23], s33 offen offset:128 nt lds
  v_mfma_f32_16x16x32_bf16 v[88:91], v[196:199], a[216:219], v[88:91]
  s_add_u32 s34, s34, 1
  v_exp_f32 v211, v211
  v_mfma_f32_16x16x32_bf16 v[92:95], v[196:199], a[220:223], v[92:95]
  s_add_u32 s33, s33, 8192
  v_cvt_pk_bf16_f32 v205, v210, v211
  v_mfma_f32_16x16x32_bf16 v[92:95], v[192:195], a[188:191], v[92:95]
  v_exp_f32 v212, v212
  v_mfma_f32_16x16x32_bf16 v[192:195], a[96:99], a[64:67], v[232:235]
  v_mfma_f32_16x16x32_bf16 v[192:195], a[100:103], a[68:71], v[192:195]
  s_waitcnt lgkmcnt(0)
  buffer_store_dwordx4 a[248:251], v245, s[28:31], s42 offen offset:0 nt
  v_exp_f32 v213, v213
  v_mfma_f32_16x16x32_bf16 v[192:195], a[104:107], a[72:75], v[192:195]
  v_cvt_pk_bf16_f32 v206, v212, v213
  v_mfma_f32_16x16x32_bf16 v[192:195], a[108:111], a[76:79], v[192:195]
  v_exp_f32 v214, v214
  v_mfma_f32_16x16x32_bf16 v[196:199], a[124:127], a[76:79], v[232:235]
  ds_read_b64_tr_b16 a[248:249], v244 offset:12288
  ds_read_b64_tr_b16 a[250:251], v244 offset:12352
  v_mfma_f32_16x16x32_bf16 v[196:199], a[120:123], a[72:75], v[196:199]
  v_exp_f32 v215, v215
  v_mfma_f32_16x16x32_bf16 v[196:199], a[116:119], a[68:71], v[196:199]
  v_cvt_pk_bf16_f32 v207, v214, v215
  v_mfma_f32_16x16x32_bf16 v[196:199], a[112:115], a[64:67], v[196:199]
  v_exp_f32 v192, v192
  v_smfmac_f32_16x16x64_bf16 a[240:243], a[232:235], v[200:207], v253
  v_mfma_f32_16x16x32_bf16 v[96:99], v[200:203], a[160:163], v[96:99]
  v_mfma_f32_16x16x32_bf16 v[96:99], v[204:207], a[192:195], v[96:99]
  v_exp_f32 v193, v193
  v_mfma_f32_16x16x32_bf16 v[100:103], v[204:207], a[196:199], v[100:103]
  v_cvt_pk_bf16_f32 v192, v192, v193
  v_mfma_f32_16x16x32_bf16 v[100:103], v[200:203], a[164:167], v[100:103]
  v_exp_f32 v194, v194
  v_mfma_f32_16x16x32_bf16 v[104:107], v[200:203], a[168:171], v[104:107]
  v_mfma_f32_16x16x32_bf16 v[104:107], v[204:207], a[200:203], v[104:107]
  v_exp_f32 v195, v195
  v_mfma_f32_16x16x32_bf16 v[108:111], v[204:207], a[204:207], v[108:111]
  v_cvt_pk_bf16_f32 v193, v194, v195
  v_mfma_f32_16x16x32_bf16 v[108:111], v[200:203], a[172:175], v[108:111]
  v_exp_f32 v196, v196
  v_mfma_f32_16x16x32_bf16 v[208:211], a[128:131], a[64:67], v[232:235]
  v_mfma_f32_16x16x32_bf16 v[208:211], a[132:135], a[68:71], v[208:211]
  v_exp_f32 v197, v197
  v_mfma_f32_16x16x32_bf16 v[208:211], a[136:139], a[72:75], v[208:211]
  v_cvt_pk_bf16_f32 v194, v196, v197
  v_mfma_f32_16x16x32_bf16 v[208:211], a[140:143], a[76:79], v[208:211]
  s_waitcnt lgkmcnt(0)
  buffer_store_dwordx4 a[248:251], v245, s[28:31], s42 offen offset:128 nt
  v_exp_f32 v198, v198
  v_mfma_f32_16x16x32_bf16 v[212:215], a[156:159], a[76:79], v[232:235]
  v_mfma_f32_16x16x32_bf16 v[212:215], a[152:155], a[72:75], v[212:215]
  v_exp_f32 v199, v199
  v_mfma_f32_16x16x32_bf16 v[212:215], a[148:151], a[68:71], v[212:215]
  ds_read_b64_tr_b16 a[248:249], v244 offset:1024
  v_cvt_pk_bf16_f32 v195, v198, v199
  v_mfma_f32_16x16x32_bf16 v[212:215], a[144:147], a[64:67], v[212:215]
  v_exp_f32 v208, v208
  v_mfma_f32_16x16x32_bf16 v[112:115], v[200:203], a[176:179], v[112:115]
  ds_read_b64_tr_b16 a[250:251], v244 offset:1088
  v_mfma_f32_16x16x32_bf16 v[112:115], v[204:207], a[208:211], v[112:115]
  v_exp_f32 v209, v209
  v_mfma_f32_16x16x32_bf16 v[116:119], v[204:207], a[212:215], v[116:119]
  v_cvt_pk_bf16_f32 v196, v208, v209
  v_mfma_f32_16x16x32_bf16 v[116:119], v[200:203], a[180:183], v[116:119]
  v_exp_f32 v210, v210
  v_mfma_f32_16x16x32_bf16 v[120:123], v[200:203], a[184:187], v[120:123]
  v_mfma_f32_16x16x32_bf16 v[120:123], v[204:207], a[216:219], v[120:123]
  v_exp_f32 v211, v211
  v_mfma_f32_16x16x32_bf16 v[124:127], v[204:207], a[220:223], v[124:127]
  v_cvt_pk_bf16_f32 v197, v210, v211
  v_mfma_f32_16x16x32_bf16 v[124:127], v[200:203], a[188:191], v[124:127]
  v_exp_f32 v212, v212
  v_mfma_f32_16x16x32_bf16 v[200:203], a[96:99], a[80:83], v[236:239]
  v_mfma_f32_16x16x32_bf16 v[200:203], a[100:103], a[84:87], v[200:203]
  v_exp_f32 v213, v213
  v_mfma_f32_16x16x32_bf16 v[200:203], a[104:107], a[88:91], v[200:203]
  v_cvt_pk_bf16_f32 v198, v212, v213
  v_mfma_f32_16x16x32_bf16 v[200:203], a[108:111], a[92:95], v[200:203]
  v_exp_f32 v214, v214
  v_mfma_f32_16x16x32_bf16 v[204:207], a[124:127], a[92:95], v[236:239]
  v_mfma_f32_16x16x32_bf16 v[204:207], a[120:123], a[88:91], v[204:207]
  s_waitcnt lgkmcnt(0)
  buffer_store_dwordx4 a[248:251], v245, s[28:31], s42 offen offset:2048 nt
  v_exp_f32 v215, v215
  v_mfma_f32_16x16x32_bf16 v[204:207], a[116:119], a[84:87], v[204:207]
  v_cvt_pk_bf16_f32 v199, v214, v215
  v_mfma_f32_16x16x32_bf16 v[204:207], a[112:115], a[80:83], v[204:207]
  v_exp_f32 v200, v200
  v_smfmac_f32_16x16x64_bf16 a[244:247], a[228:231], v[192:199], v253
  ds_read_b128 a[96:99], v246 offset:32768
  v_mfma_f32_16x16x32_bf16 v[128:131], v[192:195], a[160:163], v[128:131]
  ds_read_b128 a[100:103], v247 offset:32768
  ds_read_b64_tr_b16 a[248:249], v244 offset:13312
  v_mfma_f32_16x16x32_bf16 v[128:131], v[196:199], a[192:195], v[128:131]
  v_exp_f32 v201, v201
  v_mfma_f32_16x16x32_bf16 v[132:135], v[196:199], a[196:199], v[132:135]
  ds_read_b128 a[104:107], v246 offset:36864
  v_cvt_pk_bf16_f32 v200, v200, v201
  v_mfma_f32_16x16x32_bf16 v[132:135], v[192:195], a[164:167], v[132:135]
  v_exp_f32 v202, v202
  v_mfma_f32_16x16x32_bf16 v[136:139], v[192:195], a[168:171], v[136:139]
  ds_read_b128 a[108:111], v247 offset:36864
  ds_read_b64_tr_b16 a[250:251], v244 offset:13376
  v_mfma_f32_16x16x32_bf16 v[136:139], v[196:199], a[200:203], v[136:139]
  v_exp_f32 v203, v203
  v_mfma_f32_16x16x32_bf16 v[140:143], v[196:199], a[204:207], v[140:143]
  ds_read_b128 a[112:115], v246 offset:34816
  v_cvt_pk_bf16_f32 v201, v202, v203
  v_mfma_f32_16x16x32_bf16 v[140:143], v[192:195], a[172:175], v[140:143]
  v_exp_f32 v204, v204
  v_mfma_f32_16x16x32_bf16 v[208:211], a[128:131], a[80:83], v[236:239]
  ds_read_b128 a[116:119], v247 offset:34816
  v_add_u32 v244, 2048, v244
  v_mfma_f32_16x16x32_bf16 v[208:211], a[132:135], a[84:87], v[208:211]
  v_exp_f32 v205, v205
  v_mfma_f32_16x16x32_bf16 v[208:211], a[136:139], a[88:91], v[208:211]
  ds_read_b128 a[120:123], v246 offset:38912
  v_cvt_pk_bf16_f32 v202, v204, v205
  v_mfma_f32_16x16x32_bf16 v[208:211], a[140:143], a[92:95], v[208:211]
  v_exp_f32 v206, v206
  v_mfma_f32_16x16x32_bf16 v[212:215], a[156:159], a[92:95], v[236:239]
  ds_read_b128 a[124:127], v247 offset:38912
  v_mfma_f32_16x16x32_bf16 v[212:215], a[152:155], a[88:91], v[212:215]
  v_exp_f32 v207, v207
  v_mfma_f32_16x16x32_bf16 v[212:215], a[148:151], a[84:87], v[212:215]
  v_cvt_pk_bf16_f32 v203, v206, v207
  v_mfma_f32_16x16x32_bf16 v[212:215], a[144:147], a[80:83], v[212:215]
  v_exp_f32 v208, v208
  v_mfma_f32_16x16x32_bf16 v[144:147], v[192:195], a[176:179], v[144:147]
  v_mfma_f32_16x16x32_bf16 v[144:147], v[196:199], a[208:211], v[144:147]
  s_waitcnt lgkmcnt(2)
  buffer_store_dwordx4 a[248:251], v245, s[28:31], s42 offen offset:2176 nt
  v_exp_f32 v209, v209
  v_mfma_f32_16x16x32_bf16 v[148:151], v[196:199], a[212:215], v[148:151]
  s_add_u32 s42, s42, 4096
  v_cvt_pk_bf16_f32 v204, v208, v209
  v_mfma_f32_16x16x32_bf16 v[148:151], v[192:195], a[180:183], v[148:151]
  v_exp_f32 v210, v210
  v_mfma_f32_16x16x32_bf16 v[152:155], v[192:195], a[184:187], v[152:155]
  v_mfma_f32_16x16x32_bf16 v[152:155], v[196:199], a[216:219], v[152:155]
  v_exp_f32 v211, v211
  v_mfma_f32_16x16x32_bf16 v[156:159], v[196:199], a[220:223], v[156:159]
  v_cvt_pk_bf16_f32 v205, v210, v211
  v_mfma_f32_16x16x32_bf16 v[156:159], v[192:195], a[188:191], v[156:159]
  v_exp_f32 v212, v212
  s_waitcnt lgkmcnt(7)
  v_mfma_f32_16x16x32_bf16 v[192:195], a[96:99], a[0:3], v[216:219]
L_loopB:
  s_waitcnt lgkmcnt(6)
  v_mfma_f32_16x16x32_bf16 v[192:195], a[100:103], a[4:7], v[192:195]
  s_waitcnt lgkmcnt(5)
  v_exp_f32 v213, v213
  v_mfma_f32_16x16x32_bf16 v[192:195], a[104:107], a[8:11], v[192:195]
  s_waitcnt lgkmcnt(4)
  ds_read_b128 a[128:131], v246 offset:49152
  v_cvt_pk_bf16_f32 v206, v212, v213
  v_mfma_f32_16x16x32_bf16 v[192:195], a[108:111], a[12:15], v[192:195]
  s_waitcnt lgkmcnt(1)
  v_exp_f32 v214, v214
  v_mfma_f32_16x16x32_bf16 v[196:199], a[124:127], a[12:15], v[216:219]
  ds_read_b128 a[132:135], v247 offset:49152
  ds_read_b128 a[136:139], v246 offset:53248
  v_mfma_f32_16x16x32_bf16 v[196:199], a[120:123], a[8:11], v[196:199]
  v_exp_f32 v215, v215
  v_mfma_f32_16x16x32_bf16 v[196:199], a[116:119], a[4:7], v[196:199]
  ds_read_b128 a[140:143], v247 offset:53248
  v_cvt_pk_bf16_f32 v207, v214, v215
  v_mfma_f32_16x16x32_bf16 v[196:199], a[112:115], a[0:3], v[196:199]
  v_exp_f32 v192, v192
  v_smfmac_f32_16x16x64_bf16 a[244:247], a[232:235], v[200:207], v253
  ds_read_b128 a[144:147], v246 offset:51200
  v_mfma_f32_16x16x32_bf16 v[160:163], v[200:203], a[160:163], v[160:163]
  ds_read_b128 a[148:151], v247 offset:51200
  ds_read_b128 a[152:155], v246 offset:55296
  v_mfma_f32_16x16x32_bf16 v[160:163], v[204:207], a[192:195], v[160:163]
  v_exp_f32 v193, v193
  v_mfma_f32_16x16x32_bf16 v[164:167], v[204:207], a[196:199], v[164:167]
  ds_read_b128 a[156:159], v247 offset:55296
  v_cvt_pk_bf16_f32 v192, v192, v193
  v_mfma_f32_16x16x32_bf16 v[164:167], v[200:203], a[164:167], v[164:167]
  v_exp_f32 v194, v194
  v_mfma_f32_16x16x32_bf16 v[168:171], v[200:203], a[168:171], v[168:171]
  ds_read_b64_tr_b16 a[160:161], v248 offset:40960
  ds_read_b64_tr_b16 a[162:163], v248 offset:43008
  v_mfma_f32_16x16x32_bf16 v[168:171], v[204:207], a[200:203], v[168:171]
  v_exp_f32 v195, v195
  v_mfma_f32_16x16x32_bf16 v[172:175], v[204:207], a[204:207], v[172:175]
  ds_read_b64_tr_b16 a[192:193], v248 offset:57344
  v_cvt_pk_bf16_f32 v193, v194, v195
  v_mfma_f32_16x16x32_bf16 v[172:175], v[200:203], a[172:175], v[172:175]
  s_waitcnt lgkmcnt(6)
  v_exp_f32 v196, v196
  v_mfma_f32_16x16x32_bf16 v[208:211], a[128:131], a[0:3], v[216:219]
  ds_read_b64_tr_b16 a[194:195], v248 offset:59392
  ds_read_b64_tr_b16 a[164:165], v249 offset:40960
  v_mfma_f32_16x16x32_bf16 v[208:211], a[132:135], a[4:7], v[208:211]
  v_exp_f32 v197, v197
  v_mfma_f32_16x16x32_bf16 v[208:211], a[136:139], a[8:11], v[208:211]
  ds_read_b64_tr_b16 a[166:167], v249 offset:43008
  v_cvt_pk_bf16_f32 v194, v196, v197
  v_mfma_f32_16x16x32_bf16 v[208:211], a[140:143], a[12:15], v[208:211]
  s_waitcnt lgkmcnt(6)
  v_exp_f32 v198, v198
  v_mfma_f32_16x16x32_bf16 v[212:215], a[156:159], a[12:15], v[216:219]
  ds_read_b64_tr_b16 a[196:197], v249 offset:57344
  ds_read_b64_tr_b16 a[198:199], v249 offset:59392
  v_mfma_f32_16x16x32_bf16 v[212:215], a[152:155], a[8:11], v[212:215]
  v_exp_f32 v199, v199
  v_mfma_f32_16x16x32_bf16 v[212:215], a[148:151], a[4:7], v[212:215]
  ds_read_b64_tr_b16 a[168:169], v250 offset:40960
  v_cvt_pk_bf16_f32 v195, v198, v199
  v_mfma_f32_16x16x32_bf16 v[212:215], a[144:147], a[0:3], v[212:215]
  v_exp_f32 v208, v208
  v_mfma_f32_16x16x32_bf16 v[176:179], v[200:203], a[176:179], v[176:179]
  ds_read_b64_tr_b16 a[170:171], v250 offset:43008
  ds_read_b64_tr_b16 a[200:201], v250 offset:57344
  v_mfma_f32_16x16x32_bf16 v[176:179], v[204:207], a[208:211], v[176:179]
  v_exp_f32 v209, v209
  v_mfma_f32_16x16x32_bf16 v[180:183], v[204:207], a[212:215], v[180:183]
  ds_read_b64_tr_b16 a[202:203], v250 offset:59392
  v_cvt_pk_bf16_f32 v196, v208, v209
  v_mfma_f32_16x16x32_bf16 v[180:183], v[200:203], a[180:183], v[180:183]
  v_exp_f32 v210, v210
  v_mfma_f32_16x16x32_bf16 v[184:187], v[200:203], a[184:187], v[184:187]
  ds_read_b64_tr_b16 a[172:173], v251 offset:40960
  ds_read_b64_tr_b16 a[174:175], v251 offset:43008
  v_mfma_f32_16x16x32_bf16 v[184:187], v[204:207], a[216:219], v[184:187]
  v_exp_f32 v211, v211
  v_mfma_f32_16x16x32_bf16 v[188:191], v[204:207], a[220:223], v[188:191]
  ds_read_b64_tr_b16 a[204:205], v251 offset:57344
  v_cvt_pk_bf16_f32 v197, v210, v211
  v_mfma_f32_16x16x32_bf16 v[188:191], v[200:203], a[188:191], v[188:191]
  v_exp_f32 v212, v212
  v_mfma_f32_16x16x32_bf16 v[200:203], a[96:99], a[16:19], v[220:223]
  ds_read_b64_tr_b16 a[206:207], v251 offset:59392
  ds_read_b64_tr_b16 a[176:177], v248 offset:45056
  v_mfma_f32_16x16x32_bf16 v[200:203], a[100:103], a[20:23], v[200:203]
  v_exp_f32 v213, v213
  v_mfma_f32_16x16x32_bf16 v[200:203], a[104:107], a[24:27], v[200:203]
  ds_read_b64_tr_b16 a[178:179], v248 offset:47104
  v_cvt_pk_bf16_f32 v198, v212, v213
  v_mfma_f32_16x16x32_bf16 v[200:203], a[108:111], a[28:31], v[200:203]
  v_exp_f32 v214, v214
  v_mfma_f32_16x16x32_bf16 v[204:207], a[124:127], a[28:31], v[220:223]
  ds_read_b64_tr_b16 a[208:209], v248 offset:61440
  ds_read_b64_tr_b16 a[210:211], v248 offset:63488
  v_mfma_f32_16x16x32_bf16 v[204:207], a[120:123], a[24:27], v[204:207]
  v_exp_f32 v215, v215
  v_mfma_f32_16x16x32_bf16 v[204:207], a[116:119], a[20:23], v[204:207]
  ds_read_b64_tr_b16 a[180:181], v249 offset:45056
  v_cvt_pk_bf16_f32 v199, v214, v215
  v_mfma_f32_16x16x32_bf16 v[204:207], a[112:115], a[16:19], v[204:207]
  v_exp_f32 v200, v200
  v_smfmac_f32_16x16x64_bf16 a[236:239], a[228:231], v[192:199], v253
  s_waitcnt lgkmcnt(4)
  ds_read_b64_tr_b16 a[182:183], v249 offset:47104
  v_mfma_f32_16x16x32_bf16 v[0:3], v[192:195], a[160:163], v[0:3]
  ds_read_b64_tr_b16 a[212:213], v249 offset:61440
  ds_read_b64_tr_b16 a[214:215], v249 offset:63488
  v_mfma_f32_16x16x32_bf16 v[0:3], v[196:199], a[192:195], v[0:3]
  v_exp_f32 v201, v201
  v_mfma_f32_16x16x32_bf16 v[4:7], v[196:199], a[196:199], v[4:7]
  ds_read_b64_tr_b16 a[184:185], v250 offset:45056
  v_cvt_pk_bf16_f32 v200, v200, v201
  v_mfma_f32_16x16x32_bf16 v[4:7], v[192:195], a[164:167], v[4:7]
  v_exp_f32 v202, v202
  v_mfma_f32_16x16x32_bf16 v[8:11], v[192:195], a[168:171], v[8:11]
  ds_read_b64_tr_b16 a[186:187], v250 offset:47104
  ds_read_b64_tr_b16 a[216:217], v250 offset:61440
  v_mfma_f32_16x16x32_bf16 v[8:11], v[196:199], a[200:203], v[8:11]
  v_exp_f32 v203, v203
  v_mfma_f32_16x16x32_bf16 v[12:15], v[196:199], a[204:207], v[12:15]
  ds_read_b64_tr_b16 a[218:219], v250 offset:63488
  v_cvt_pk_bf16_f32 v201, v202, v203
  v_mfma_f32_16x16x32_bf16 v[12:15], v[192:195], a[172:175], v[12:15]
  v_exp_f32 v204, v204
  v_mfma_f32_16x16x32_bf16 v[208:211], a[128:131], a[16:19], v[220:223]
  ds_read_b64_tr_b16 a[188:189], v251 offset:45056
  ds_read_b64_tr_b16 a[190:191], v251 offset:47104
  v_mfma_f32_16x16x32_bf16 v[208:211], a[132:135], a[20:23], v[208:211]
  v_exp_f32 v205, v205
  v_mfma_f32_16x16x32_bf16 v[208:211], a[136:139], a[24:27], v[208:211]
  ds_read_b64_tr_b16 a[220:221], v251 offset:61440
  v_cvt_pk_bf16_f32 v202, v204, v205
  v_mfma_f32_16x16x32_bf16 v[208:211], a[140:143], a[28:31], v[208:211]
  v_exp_f32 v206, v206
  v_mfma_f32_16x16x32_bf16 v[212:215], a[156:159], a[28:31], v[220:223]
  ds_read_b64_tr_b16 a[222:223], v251 offset:63488
  v_mfma_f32_16x16x32_bf16 v[212:215], a[152:155], a[24:27], v[212:215]
  v_exp_f32 v207, v207
  v_mfma_f32_16x16x32_bf16 v[212:215], a[148:151], a[20:23], v[212:215]
  v_cvt_pk_bf16_f32 v203, v206, v207
  v_mfma_f32_16x16x32_bf16 v[212:215], a[144:147], a[16:19], v[212:215]
  s_waitcnt lgkmcnt(4)
  v_exp_f32 v208, v208
  v_mfma_f32_16x16x32_bf16 v[16:19], v[192:195], a[176:179], v[16:19]
  v_mfma_f32_16x16x32_bf16 v[16:19], v[196:199], a[208:211], v[16:19]
  v_exp_f32 v209, v209
  v_mfma_f32_16x16x32_bf16 v[20:23], v[196:199], a[212:215], v[20:23]
  s_cmp_lg_u32 s52, 0
  v_cvt_pk_bf16_f32 v204, v208, v209
  v_mfma_f32_16x16x32_bf16 v[20:23], v[192:195], a[180:183], v[20:23]
  s_waitcnt vmcnt(2) lgkmcnt(0)
  v_exp_f32 v210, v210
  v_mfma_f32_16x16x32_bf16 v[24:27], v[192:195], a[184:187], v[24:27]
  s_barrier
  s_cbranch_scc1 L_hB
  L_cutB:
  v_mfma_f32_16x16x32_bf16 v[24:27], v[196:199], a[216:219], v[24:27]
  v_exp_f32 v211, v211
  v_mfma_f32_16x16x32_bf16 v[28:31], v[196:199], a[220:223], v[28:31]
  v_cvt_pk_bf16_f32 v205, v210, v211
  v_mfma_f32_16x16x32_bf16 v[28:31], v[192:195], a[188:191], v[28:31]
  v_exp_f32 v212, v212
  v_mfma_f32_16x16x32_bf16 v[192:195], a[96:99], a[32:35], v[224:227]
  v_mfma_f32_16x16x32_bf16 v[192:195], a[100:103], a[36:39], v[192:195]
  v_exp_f32 v213, v213
  v_mfma_f32_16x16x32_bf16 v[192:195], a[104:107], a[40:43], v[192:195]
  v_cvt_pk_bf16_f32 v206, v212, v213
  v_mfma_f32_16x16x32_bf16 v[192:195], a[108:111], a[44:47], v[192:195]
  s_add_u32 m0, s38, 32768
  v_exp_f32 v214, v214
  v_mfma_f32_16x16x32_bf16 v[196:199], a[124:127], a[44:47], v[224:227]
  buffer_load_dwordx4 v252, s[16:19], s33 offen nt lds
  v_mfma_f32_16x16x32_bf16 v[196:199], a[120:123], a[40:43], v[196:199]
  v_exp_f32 v215, v215
  v_mfma_f32_16x16x32_bf16 v[196:199], a[116:119], a[36:39], v[196:199]
  v_cvt_pk_bf16_f32 v207, v214, v215
  v_mfma_f32_16x16x32_bf16 v[196:199], a[112:115], a[32:35], v[196:199]
  v_exp_f32 v192, v192
  v_smfmac_f32_16x16x64_bf16 a[236:239], a[232:235], v[200:207], v253
  v_mfma_f32_16x16x32_bf16 v[32:35], v[200:203], a[160:163], v[32:35]
  v_mfma_f32_16x16x32_bf16 v[32:35], v[204:207], a[192:195], v[32:35]
  v_exp_f32 v193, v193
  v_mfma_f32_16x16x32_bf16 v[36:39], v[204:207], a[196:199], v[36:39]
  v_cvt_pk_bf16_f32 v192, v192, v193
  v_mfma_f32_16x16x32_bf16 v[36:39], v[200:203], a[164:167], v[36:39]
  s_add_u32 m0, s38, 36736
  v_exp_f32 v194, v194
  v_mfma_f32_16x16x32_bf16 v[40:43], v[200:203], a[168:171], v[40:43]
  buffer_load_dwordx4 v252, s[16:19], s33 offen offset:128 nt lds
  v_mfma_f32_16x16x32_bf16 v[40:43], v[204:207], a[200:203], v[40:43]
  v_exp_f32 v195, v195
  v_mfma_f32_16x16x32_bf16 v[44:47], v[204:207], a[204:207], v[44:47]
  v_cvt_pk_bf16_f32 v193, v194, v195
  v_mfma_f32_16x16x32_bf16 v[44:47], v[200:203], a[172:175], v[44:47]
  v_exp_f32 v196, v196
  v_mfma_f32_16x16x32_bf16 v[208:211], a[128:131], a[32:35], v[224:227]
  v_mfma_f32_16x16x32_bf16 v[208:211], a[132:135], a[36:39], v[208:211]
  v_exp_f32 v197, v197
  v_mfma_f32_16x16x32_bf16 v[208:211], a[136:139], a[40:43], v[208:211]
  v_cvt_pk_bf16_f32 v194, v196, v197
  v_mfma_f32_16x16x32_bf16 v[208:211], a[140:143], a[44:47], v[208:211]
  s_add_u32 m0, s38, 40960
  v_exp_f32 v198, v198
  v_mfma_f32_16x16x32_bf16 v[212:215], a[156:159], a[44:47], v[224:227]
  buffer_load_dwordx4 v252, s[20:23], s33 offen nt lds
  v_mfma_f32_16x16x32_bf16 v[212:215], a[152:155], a[40:43], v[212:215]
  v_exp_f32 v199, v199
  v_mfma_f32_16x16x32_bf16 v[212:215], a[148:151], a[36:39], v[212:215]
  v_cvt_pk_bf16_f32 v195, v198, v199
  v_mfma_f32_16x16x32_bf16 v[212:215], a[144:147], a[32:35], v[212:215]
  v_exp_f32 v208, v208
  v_mfma_f32_16x16x32_bf16 v[48:51], v[200:203], a[176:179], v[48:51]
  v_mfma_f32_16x16x32_bf16 v[48:51], v[204:207], a[208:211], v[48:51]
  v_exp_f32 v209, v209
  v_mfma_f32_16x16x32_bf16 v[52:55], v[204:207], a[212:215], v[52:55]
  v_cvt_pk_bf16_f32 v196, v208, v209
  v_mfma_f32_16x16x32_bf16 v[52:55], v[200:203], a[180:183], v[52:55]
  s_add_u32 m0, s38, 44928
  v_exp_f32 v210, v210
  v_mfma_f32_16x16x32_bf16 v[56:59], v[200:203], a[184:187], v[56:59]
  buffer_load_dwordx4 v252, s[20:23], s33 offen offset:128 nt lds
  v_mfma_f32_16x16x32_bf16 v[56:59], v[204:207], a[216:219], v[56:59]
  s_add_u32 s34, s34, 1
  v_exp_f32 v211, v211
  v_mfma_f32_16x16x32_bf16 v[60:63], v[204:207], a[220:223], v[60:63]
  s_add_u32 s33, s33, 8192
  v_cvt_pk_bf16_f32 v197, v210, v211
  v_mfma_f32_16x16x32_bf16 v[60:63], v[200:203], a[188:191], v[60:63]
  v_exp_f32 v212, v212
  v_mfma_f32_16x16x32_bf16 v[200:203], a[96:99], a[48:51], v[228:231]
  v_mfma_f32_16x16x32_bf16 v[200:203], a[100:103], a[52:55], v[200:203]
  v_exp_f32 v213, v213
  v_mfma_f32_16x16x32_bf16 v[200:203], a[104:107], a[56:59], v[200:203]
  v_cvt_pk_bf16_f32 v198, v212, v213
  v_mfma_f32_16x16x32_bf16 v[200:203], a[108:111], a[60:63], v[200:203]
  s_add_u32 m0, s38, 49152
  v_exp_f32 v214, v214
  v_mfma_f32_16x16x32_bf16 v[204:207], a[124:127], a[60:63], v[228:231]
  buffer_load_dwordx4 v252, s[16:19], s33 offen nt lds
  v_mfma_f32_16x16x32_bf16 v[204:207], a[120:123], a[56:59], v[204:207]
  v_exp_f32 v215, v215
  v_mfma_f32_16x16x32_bf16 v[204:207], a[116:119], a[52:55], v[204:207]
  v_cvt_pk_bf16_f32 v199, v214, v215
  v_mfma_f32_16x16x32_bf16 v[204:207], a[112:115], a[48:51], v[204:207]
  v_exp_f32 v200, v200
  v_smfmac_f32_16x16x64_bf16 a[240:243], a[228:231], v[192:199], v253
  ds_read_b64_tr_b16 a[248:249], v244 offset:0
  v_mfma_f32_16x16x32_bf16 v[64:67], v[192:195], a[160:163], v[64:67]
  ds_read_b64_tr_b16 a[250:251], v244 offset:64
  v_mfma_f32_16x16x32_bf16 v[64:67], v[196:199], a[192:195], v[64:67]
  v_exp_f32 v201, v201
  v_mfma_f32_16x16x32_bf16 v[68:71], v[196:199], a[196:199], v[68:71]
  v_cvt_pk_bf16_f32 v200, v200, v201
  v_mfma_f32_16x16x32_bf16 v[68:71], v[192:195], a[164:167], v[68:71]
  s_add_u32 m0, s38, 53120
  v_exp_f32 v202, v202
  v_mfma_f32_16x16x32_bf16 v[72:75], v[192:195], a[168:171], v[72:75]
  buffer_load_dwordx4 v252, s[16:19], s33 offen offset:128 nt lds
  v_mfma_f32_16x16x32_bf16 v[72:75], v[196:199], a[200:203], v[72:75]
  v_exp_f32 v203, v203
  v_mfma_f32_16x16x32_bf16 v[76:79], v[196:199], a[204:207], v[76:79]
  v_cvt_pk_bf16_f32 v201, v202, v203
  v_mfma_f32_16x16x32_bf16 v[76:79], v[192:195], a[172:175], v[76:79]
  v_exp_f32 v204, v204
  v_mfma_f32_16x16x32_bf16 v[208:211], a[128:131], a[48:51], v[228:231]
  v_mfma_f32_16x16x32_bf16 v[208:211], a[132:135], a[52:55], v[208:211]
  v_exp_f32 v205, v205
  v_mfma_f32_16x16x32_bf16 v[208:211], a[136:139], a[56:59], v[208:211]
  v_cvt_pk_bf16_f32 v202, v204, v205
  v_mfma_f32_16x16x32_bf16 v[208:211], a[140:143], a[60:63], v[208:211]
  s_add_u32 m0, s38, 57344
  v_exp_f32 v206, v206
  v_mfma_f32_16x16x32_bf16 v[212:215], a[156:159], a[60:63], v[228:231]
  buffer_load_dwordx4 v252, s[20:23], s33 offen nt lds
  v_mfma_f32_16x16x32_bf16 v[212:215], a[152:155], a[56:59], v[212:215]
  v_exp_f32 v207, v207
  v_mfma_f32_16x16x32_bf16 v[212:215], a[148:151], a[52:55], v[212:215]
  v_cvt_pk_bf16_f32 v203, v206, v207
  v_mfma_f32_16x16x32_bf16 v[212:215], a[144:147], a[48:51], v[212:215]
  v_exp_f32 v208, v208
  v_mfma_f32_16x16x32_bf16 v[80:83], v[192:195], a[176:179], v[80:83]
  v_mfma_f32_16x16x32_bf16 v[80:83], v[196:199], a[208:211], v[80:83]
  v_exp_f32 v209, v209
  v_mfma_f32_16x16x32_bf16 v[84:87], v[196:199], a[212:215], v[84:87]
  v_cvt_pk_bf16_f32 v204, v208, v209
  v_mfma_f32_16x16x32_bf16 v[84:87], v[192:195], a[180:183], v[84:87]
  s_add_u32 m0, s38, 61312
  v_exp_f32 v210, v210
  v_mfma_f32_16x16x32_bf16 v[88:91], v[192:195], a[184:187], v[88:91]
  buffer_load_dwordx4 v252, s[20:23], s33 offen offset:128 nt lds
  v_mfma_f32_16x16x32_bf16 v[88:91], v[196:199], a[216:219], v[88:91]
  s_add_u32 s34, s34, 1
  v_exp_f32 v211, v211
  v_mfma_f32_16x16x32_bf16 v[92:95], v[196:199], a[220:223], v[92:95]
  s_add_u32 s33, s33, 8192
  v_cvt_pk_bf16_f32 v205, v210, v211
  v_mfma_f32_16x16x32_bf16 v[92:95], v[192:195], a[188:191], v[92:95]
  v_exp_f32 v212, v212
  v_mfma_f32_16x16x32_bf16 v[192:195], a[96:99], a[64:67], v[232:235]
  v_mfma_f32_16x16x32_bf16 v[192:195], a[100:103], a[68:71], v[192:195]
  v_exp_f32 v213, v213
  v_mfma_f32_16x16x32_bf16 v[192:195], a[104:107], a[72:75], v[192:195]
  v_cvt_pk_bf16_f32 v206, v212, v213
  v_mfma_f32_16x16x32_bf16 v[192:195], a[108:111], a[76:79], v[192:195]
  v_exp_f32 v214, v214
  v_mfma_f32_16x16x32_bf16 v[196:199], a[124:127], a[76:79], v[232:235]
  v_mfma_f32_16x16x32_bf16 v[196:199], a[120:123], a[72:75], v[196:199]
  v_exp_f32 v215, v215
  v_mfma_f32_16x16x32_bf16 v[196:199], a[116:119], a[68:71], v[196:199]
  v_cvt_pk_bf16_f32 v207, v214, v215
  v_mfma_f32_16x16x32_bf16 v[196:199], a[112:115], a[64:67], v[196:199]
  s_nop 0
  v_exp_f32 v192, v192
  v_smfmac_f32_16x16x64_bf16 a[240:243], a[232:235], v[200:207], v253
  v_mfma_f32_16x16x32_bf16 v[96:99], v[200:203], a[160:163], v[96:99]
  v_mfma_f32_16x16x32_bf16 v[96:99], v[204:207], a[192:195], v[96:99]
  s_waitcnt lgkmcnt(0)
  buffer_store_dwordx4 a[248:251], v245, s[28:31], s42 offen offset:0 nt
  v_exp_f32 v193, v193
  v_mfma_f32_16x16x32_bf16 v[100:103], v[204:207], a[196:199], v[100:103]
  v_cvt_pk_bf16_f32 v192, v192, v193
  v_mfma_f32_16x16x32_bf16 v[100:103], v[200:203], a[164:167], v[100:103]
  v_exp_f32 v194, v194
  v_mfma_f32_16x16x32_bf16 v[104:107], v[200:203], a[168:171], v[104:107]
  ds_read_b64_tr_b16 a[248:249], v244 offset:12288
  ds_read_b64_tr_b16 a[250:251], v244 offset:12352
  v_mfma_f32_16x16x32_bf16 v[104:107], v[204:207], a[200:203], v[104:107]
  v_exp_f32 v195, v195
  v_mfma_f32_16x16x32_bf16 v[108:111], v[204:207], a[204:207], v[108:111]
  v_cvt_pk_bf16_f32 v193, v194, v195
  v_add_u32 v244, 1024, v244
  v_mfma_f32_16x16x32_bf16 v[108:111], v[200:203], a[172:175], v[108:111]
  v_exp_f32 v196, v196
  v_mfma_f32_16x16x32_bf16 v[208:211], a[128:131], a[64:67], v[232:235]
  v_mfma_f32_16x16x32_bf16 v[208:211], a[132:135], a[68:71], v[208:211]
  v_exp_f32 v197, v197
  v_mfma_f32_16x16x32_bf16 v[208:211], a[136:139], a[72:75], v[208:211]
  v_cvt_pk_bf16_f32 v194, v196, v197
  v_mfma_f32_16x16x32_bf16 v[208:211], a[140:143], a[76:79], v[208:211]
  v_exp_f32 v198, v198
  v_mfma_f32_16x16x32_bf16 v[212:215], a[156:159], a[76:79], v[232:235]
  v_mfma_f32_16x16x32_bf16 v[212:215], a[152:155], a[72:75], v[212:215]
  v_exp_f32 v199, v199
  v_mfma_f32_16x16x32_bf16 v[212:215], a[148:151], a[68:71], v[212:215]
  v_cvt_pk_bf16_f32 v195, v198, v199
  v_mfma_f32_16x16x32_bf16 v[212:215], a[144:147], a[64:67], v[212:215]
  s_nop 0
  v_exp_f32 v208, v208
  v_mfma_f32_16x16x32_bf16 v[112:115], v[200:203], a[176:179], v[112:115]
  v_mfma_f32_16x16x32_bf16 v[112:115], v[204:207], a[208:211], v[112:115]
  v_exp_f32 v209, v209
  v_mfma_f32_16x16x32_bf16 v[116:119], v[204:207], a[212:215], v[116:119]
  v_cvt_pk_bf16_f32 v196, v208, v209
  v_mfma_f32_16x16x32_bf16 v[116:119], v[200:203], a[180:183], v[116:119]
  v_exp_f32 v210, v210
  v_mfma_f32_16x16x32_bf16 v[120:123], v[200:203], a[184:187], v[120:123]
  v_mfma_f32_16x16x32_bf16 v[120:123], v[204:207], a[216:219], v[120:123]
  v_exp_f32 v211, v211
  v_mfma_f32_16x16x32_bf16 v[124:127], v[204:207], a[220:223], v[124:127]
  v_cvt_pk_bf16_f32 v197, v210, v211
  v_mfma_f32_16x16x32_bf16 v[124:127], v[200:203], a[188:191], v[124:127]
  v_exp_f32 v212, v212
  v_mfma_f32_16x16x32_bf16 v[200:203], a[96:99], a[80:83], v[236:239]
  v_mfma_f32_16x16x32_bf16 v[200:203], a[100:103], a[84:87], v[200:203]
  v_exp_f32 v213, v213
  v_mfma_f32_16x16x32_bf16 v[200:203], a[104:107], a[88:91], v[200:203]
  v_cvt_pk_bf16_f32 v198, v212, v213
  v_mfma_f32_16x16x32_bf16 v[200:203], a[108:111], a[92:95], v[200:203]
  v_exp_f32 v214, v214
  v_mfma_f32_16x16x32_bf16 v[204:207], a[124:127], a[92:95], v[236:239]
  v_mfma_f32_16x16x32_bf16 v[204:207], a[120:123], a[88:91], v[204:207]
  v_exp_f32 v215, v215
  v_mfma_f32_16x16x32_bf16 v[204:207], a[116:119], a[84:87], v[204:207]
  v_cvt_pk_bf16_f32 v199, v214, v215
  v_mfma_f32_16x16x32_bf16 v[204:207], a[112:115], a[80:83], v[204:207]
  s_nop 0
  v_exp_f32 v200, v200
  v_smfmac_f32_16x16x64_bf16 a[244:247], a[228:231], v[192:199], v253
  ds_read_b128 a[96:99], v246 offset:0
  v_mfma_f32_16x16x32_bf16 v[128:131], v[192:195], a[160:163], v[128:131]
  ds_read_b128 a[100:103], v247 offset:0
  v_mfma_f32_16x16x32_bf16 v[128:131], v[196:199], a[192:195], v[128:131]
  v_exp_f32 v201, v201
  v_mfma_f32_16x16x32_bf16 v[132:135], v[196:199], a[196:199], v[132:135]
  ds_read_b128 a[104:107], v246 offset:4096
  v_cvt_pk_bf16_f32 v200, v200, v201
  v_mfma_f32_16x16x32_bf16 v[132:135], v[192:195], a[164:167], v[132:135]
  v_exp_f32 v202, v202
  v_mfma_f32_16x16x32_bf16 v[136:139], v[192:195], a[168:171], v[136:139]
  ds_read_b128 a[108:111], v247 offset:4096
  v_mfma_f32_16x16x32_bf16 v[136:139], v[196:199], a[200:203], v[136:139]
  v_exp_f32 v203, v203
  v_mfma_f32_16x16x32_bf16 v[140:143], v[196:199], a[204:207], v[140:143]
  ds_read_b128 a[112:115], v246 offset:2048
  v_cvt_pk_bf16_f32 v201, v202, v203
  v_mfma_f32_16x16x32_bf16 v[140:143], v[192:195], a[172:175], v[140:143]
  v_exp_f32 v204, v204
  v_mfma_f32_16x16x32_bf16 v[208:211], a[128:131], a[80:83], v[236:239]
  ds_read_b128 a[116:119], v247 offset:2048
  v_mfma_f32_16x16x32_bf16 v[208:211], a[132:135], a[84:87], v[208:211]
  v_exp_f32 v205, v205
  v_mfma_f32_16x16x32_bf16 v[208:211], a[136:139], a[88:91], v[208:211]
  ds_read_b128 a[120:123], v246 offset:6144
  v_cvt_pk_bf16_f32 v202, v204, v205
  v_mfma_f32_16x16x32_bf16 v[208:211], a[140:143], a[92:95], v[208:211]
  v_exp_f32 v206, v206
  v_mfma_f32_16x16x32_bf16 v[212:215], a[156:159], a[92:95], v[236:239]
  ds_read_b128 a[124:127], v247 offset:6144
  v_mfma_f32_16x16x32_bf16 v[212:215], a[152:155], a[88:91], v[212:215]
  v_exp_f32 v207, v207
  v_mfma_f32_16x16x32_bf16 v[212:215], a[148:151], a[84:87], v[212:215]
  v_cvt_pk_bf16_f32 v203, v206, v207
  v_mfma_f32_16x16x32_bf16 v[212:215], a[144:147], a[80:83], v[212:215]
  v_exp_f32 v208, v208
  v_mfma_f32_16x16x32_bf16 v[144:147], v[192:195], a[176:179], v[144:147]
  v_mfma_f32_16x16x32_bf16 v[144:147], v[196:199], a[208:211], v[144:147]
  s_waitcnt lgkmcnt(2)
  buffer_store_dwordx4 a[248:251], v245, s[28:31], s42 offen offset:128 nt
  v_exp_f32 v209, v209
  v_mfma_f32_16x16x32_bf16 v[148:151], v[196:199], a[212:215], v[148:151]
  s_add_u32 s42, s42, 2048
  v_cvt_pk_bf16_f32 v204, v208, v209
  v_mfma_f32_16x16x32_bf16 v[148:151], v[192:195], a[180:183], v[148:151]
  v_exp_f32 v210, v210
  v_mfma_f32_16x16x32_bf16 v[152:155], v[192:195], a[184:187], v[152:155]
  v_mfma_f32_16x16x32_bf16 v[152:155], v[196:199], a[216:219], v[152:155]
  v_exp_f32 v211, v211
  v_mfma_f32_16x16x32_bf16 v[156:159], v[196:199], a[220:223], v[156:159]
  v_cvt_pk_bf16_f32 v205, v210, v211
  v_mfma_f32_16x16x32_bf16 v[156:159], v[192:195], a[188:191], v[156:159]
  v_exp_f32 v212, v212
  v_mfma_f32_16x16x32_bf16 v[192:195], a[96:99], a[0:3], v[216:219]
  ds_read_b128 a[128:131], v246 offset:16384
  v_mfma_f32_16x16x32_bf16 v[192:195], a[100:103], a[4:7], v[192:195]
  v_exp_f32 v213, v213
  v_mfma_f32_16x16x32_bf16 v[192:195], a[104:107], a[8:11], v[192:195]
  ds_read_b128 a[132:135], v247 offset:16384
  v_cvt_pk_bf16_f32 v206, v212, v213
  v_mfma_f32_16x16x32_bf16 v[192:195], a[108:111], a[12:15], v[192:195]
  s_waitcnt lgkmcnt(2)
  v_exp_f32 v214, v214
  v_mfma_f32_16x16x32_bf16 v[196:199], a[124:127], a[12:15], v[216:219]
  ds_read_b128 a[136:139], v246 offset:20480
  v_mfma_f32_16x16x32_bf16 v[196:199], a[120:123], a[8:11], v[196:199]
  v_exp_f32 v215, v215
  v_mfma_f32_16x16x32_bf16 v[196:199], a[116:119], a[4:7], v[196:199]
  ds_read_b128 a[140:143], v247 offset:20480
  v_cvt_pk_bf16_f32 v207, v214, v215
  v_mfma_f32_16x16x32_bf16 v[196:199], a[112:115], a[0:3], v[196:199]
  v_exp_f32 v192, v192
  v_smfmac_f32_16x16x64_bf16 a[244:247], a[232:235], v[200:207], v253
  ds_read_b128 a[144:147], v246 offset:18432
  v_mfma_f32_16x16x32_bf16 v[160:163], v[200:203], a[160:163], v[160:163]
  ds_read_b128 a[148:151], v247 offset:18432
  ds_read_b128 a[152:155], v246 offset:22528
  v_mfma_f32_16x16x32_bf16 v[160:163], v[204:207], a[192:195], v[160:163]
  v_exp_f32 v193, v193
  v_mfma_f32_16x16x32_bf16 v[164:167], v[204:207], a[196:199], v[164:167]
  ds_read_b128 a[156:159], v247 offset:22528
  v_cvt_pk_bf16_f32 v192, v192, v193
  v_mfma_f32_16x16x32_bf16 v[164:167], v[200:203], a[164:167], v[164:167]
  v_exp_f32 v194, v194
  v_mfma_f32_16x16x32_bf16 v[168:171], v[200:203], a[168:171], v[168:171]
  ds_read_b64_tr_b16 a[160:161], v248 offset:8192
  ds_read_b64_tr_b16 a[162:163], v248 offset:10240
  v_mfma_f32_16x16x32_bf16 v[168:171], v[204:207], a[200:203], v[168:171]
  v_exp_f32 v195, v195
  v_mfma_f32_16x16x32_bf16 v[172:175], v[204:207], a[204:207], v[172:175]
  ds_read_b64_tr_b16 a[192:193], v248 offset:24576
  v_cvt_pk_bf16_f32 v193, v194, v195
  v_mfma_f32_16x16x32_bf16 v[172:175], v[200:203], a[172:175], v[172:175]
  s_waitcnt lgkmcnt(6)
  v_exp_f32 v196, v196
  v_mfma_f32_16x16x32_bf16 v[208:211], a[128:131], a[0:3], v[216:219]
  ds_read_b64_tr_b16 a[194:195], v248 offset:26624
  ds_read_b64_tr_b16 a[164:165], v249 offset:8192
  v_mfma_f32_16x16x32_bf16 v[208:211], a[132:135], a[4:7], v[208:211]
  v_exp_f32 v197, v197
  v_mfma_f32_16x16x32_bf16 v[208:211], a[136:139], a[8:11], v[208:211]
  ds_read_b64_tr_b16 a[166:167], v249 offset:10240
  v_cvt_pk_bf16_f32 v194, v196, v197
  v_mfma_f32_16x16x32_bf16 v[208:211], a[140:143], a[12:15], v[208:211]
  s_waitcnt lgkmcnt(6)
  v_exp_f32 v198, v198
  v_mfma_f32_16x16x32_bf16 v[212:215], a[156:159], a[12:15], v[216:219]
  ds_read_b64_tr_b16 a[196:197], v249 offset:24576
  ds_read_b64_tr_b16 a[198:199], v249 offset:26624
  v_mfma_f32_16x16x32_bf16 v[212:215], a[152:155], a[8:11], v[212:215]
  v_exp_f32 v199, v199
  v_mfma_f32_16x16x32_bf16 v[212:215], a[148:151], a[4:7], v[212:215]
  ds_read_b64_tr_b16 a[168:169], v250 offset:8192
  v_cvt_pk_bf16_f32 v195, v198, v199
  v_mfma_f32_16x16x32_bf16 v[212:215], a[144:147], a[0:3], v[212:215]
  v_exp_f32 v208, v208
  v_mfma_f32_16x16x32_bf16 v[176:179], v[200:203], a[176:179], v[176:179]
  ds_read_b64_tr_b16 a[170:171], v250 offset:10240
  ds_read_b64_tr_b16 a[200:201], v250 offset:24576
  v_mfma_f32_16x16x32_bf16 v[176:179], v[204:207], a[208:211], v[176:179]
  v_exp_f32 v209, v209
  v_mfma_f32_16x16x32_bf16 v[180:183], v[204:207], a[212:215], v[180:183]
  ds_read_b64_tr_b16 a[202:203], v250 offset:26624
  v_cvt_pk_bf16_f32 v196, v208, v209
  v_mfma_f32_16x16x32_bf16 v[180:183], v[200:203], a[180:183], v[180:183]
  v_exp_f32 v210, v210
  v_mfma_f32_16x16x32_bf16 v[184:187], v[200:203], a[184:187], v[184:187]
  ds_read_b64_tr_b16 a[172:173], v251 offset:8192
  ds_read_b64_tr_b16 a[174:175], v251 offset:10240
  v_mfma_f32_16x16x32_bf16 v[184:187], v[204:207], a[216:219], v[184:187]
  v_exp_f32 v211, v211
  v_mfma_f32_16x16x32_bf16 v[188:191], v[204:207], a[220:223], v[188:191]
  ds_read_b64_tr_b16 a[204:205], v251 offset:24576
  v_cvt_pk_bf16_f32 v197, v210, v211
  v_mfma_f32_16x16x32_bf16 v[188:191], v[200:203], a[188:191], v[188:191]
  v_exp_f32 v212, v212
  v_mfma_f32_16x16x32_bf16 v[200:203], a[96:99], a[16:19], v[220:223]
  ds_read_b64_tr_b16 a[206:207], v251 offset:26624
  ds_read_b64_tr_b16 a[176:177], v248 offset:12288
  v_mfma_f32_16x16x32_bf16 v[200:203], a[100:103], a[20:23], v[200:203]
  v_exp_f32 v213, v213
  v_mfma_f32_16x16x32_bf16 v[200:203], a[104:107], a[24:27], v[200:203]
  ds_read_b64_tr_b16 a[178:179], v248 offset:14336
  v_cvt_pk_bf16_f32 v198, v212, v213
  v_mfma_f32_16x16x32_bf16 v[200:203], a[108:111], a[28:31], v[200:203]
  v_exp_f32 v214, v214
  v_mfma_f32_16x16x32_bf16 v[204:207], a[124:127], a[28:31], v[220:223]
  ds_read_b64_tr_b16 a[208:209], v248 offset:28672
  ds_read_b64_tr_b16 a[210:211], v248 offset:30720
  v_mfma_f32_16x16x32_bf16 v[204:207], a[120:123], a[24:27], v[204:207]
  v_exp_f32 v215, v215
  v_mfma_f32_16x16x32_bf16 v[204:207], a[116:119], a[20:23], v[204:207]
  ds_read_b64_tr_b16 a[180:181], v249 offset:12288
  v_cvt_pk_bf16_f32 v199, v214, v215
  v_mfma_f32_16x16x32_bf16 v[204:207], a[112:115], a[16:19], v[204:207]
  v_exp_f32 v200, v200
  v_smfmac_f32_16x16x64_bf16 a[236:239], a[228:231], v[192:199], v253
  s_waitcnt lgkmcnt(4)
  ds_read_b64_tr_b16 a[182:183], v249 offset:14336
  v_mfma_f32_16x16x32_bf16 v[0:3], v[192:195], a[160:163], v[0:3]
  ds_read_b64_tr_b16 a[212:213], v249 offset:28672
  ds_read_b64_tr_b16 a[214:215], v249 offset:30720
  v_mfma_f32_16x16x32_bf16 v[0:3], v[196:199], a[192:195], v[0:3]
  v_exp_f32 v201, v201
  v_mfma_f32_16x16x32_bf16 v[4:7], v[196:199], a[196:199], v[4:7]
  ds_read_b64_tr_b16 a[184:185], v250 offset:12288
  v_cvt_pk_bf16_f32 v200, v200, v201
  v_mfma_f32_16x16x32_bf16 v[4:7], v[192:195], a[164:167], v[4:7]
  v_exp_f32 v202, v202
  v_mfma_f32_16x16x32_bf16 v[8:11], v[192:195], a[168:171], v[8:11]
  ds_read_b64_tr_b16 a[186:187], v250 offset:14336
  ds_read_b64_tr_b16 a[216:217], v250 offset:28672
  v_mfma_f32_16x16x32_bf16 v[8:11], v[196:199], a[200:203], v[8:11]
  v_exp_f32 v203, v203
  v_mfma_f32_16x16x32_bf16 v[12:15], v[196:199], a[204:207], v[12:15]
  ds_read_b64_tr_b16 a[218:219], v250 offset:30720
  v_cvt_pk_bf16_f32 v201, v202, v203
  v_mfma_f32_16x16x32_bf16 v[12:15], v[192:195], a[172:175], v[12:15]
  v_exp_f32 v204, v204
  v_mfma_f32_16x16x32_bf16 v[208:211], a[128:131], a[16:19], v[220:223]
  ds_read_b64_tr_b16 a[188:189], v251 offset:12288
  ds_read_b64_tr_b16 a[190:191], v251 offset:14336
  v_mfma_f32_16x16x32_bf16 v[208:211], a[132:135], a[20:23], v[208:211]
  v_exp_f32 v205, v205
  v_mfma_f32_16x16x32_bf16 v[208:211], a[136:139], a[24:27], v[208:211]
  ds_read_b64_tr_b16 a[220:221], v251 offset:28672
  v_cvt_pk_bf16_f32 v202, v204, v205
  v_mfma_f32_16x16x32_bf16 v[208:211], a[140:143], a[28:31], v[208:211]
  v_exp_f32 v206, v206
  v_mfma_f32_16x16x32_bf16 v[212:215], a[156:159], a[28:31], v[220:223]
  ds_read_b64_tr_b16 a[222:223], v251 offset:30720
  v_mfma_f32_16x16x32_bf16 v[212:215], a[152:155], a[24:27], v[212:215]
  v_exp_f32 v207, v207
  v_mfma_f32_16x16x32_bf16 v[212:215], a[148:151], a[20:23], v[212:215]
  v_cvt_pk_bf16_f32 v203, v206, v207
  v_mfma_f32_16x16x32_bf16 v[212:215], a[144:147], a[16:19], v[212:215]
  s_waitcnt lgkmcnt(4)
  v_exp_f32 v208, v208
  v_mfma_f32_16x16x32_bf16 v[16:19], v[192:195], a[176:179], v[16:19]
  v_mfma_f32_16x16x32_bf16 v[16:19], v[196:199], a[208:211], v[16:19]
  v_exp_f32 v209, v209
  v_mfma_f32_16x16x32_bf16 v[20:23], v[196:199], a[212:215], v[20:23]
  v_cvt_pk_bf16_f32 v204, v208, v209
  v_mfma_f32_16x16x32_bf16 v[20:23], v[192:195], a[180:183], v[20:23]
  s_waitcnt vmcnt(2) lgkmcnt(0)
  v_exp_f32 v210, v210
  v_mfma_f32_16x16x32_bf16 v[24:27], v[192:195], a[184:187], v[24:27]
  s_barrier
  v_mfma_f32_16x16x32_bf16 v[24:27], v[196:199], a[216:219], v[24:27]
  v_exp_f32 v211, v211
  v_mfma_f32_16x16x32_bf16 v[28:31], v[196:199], a[220:223], v[28:31]
  v_cvt_pk_bf16_f32 v205, v210, v211
  v_mfma_f32_16x16x32_bf16 v[28:31], v[192:195], a[188:191], v[28:31]
  v_exp_f32 v212, v212
  v_mfma_f32_16x16x32_bf16 v[192:195], a[96:99], a[32:35], v[224:227]
  v_mfma_f32_16x16x32_bf16 v[192:195], a[100:103], a[36:39], v[192:195]
  v_exp_f32 v213, v213
  v_mfma_f32_16x16x32_bf16 v[192:195], a[104:107], a[40:43], v[192:195]
  v_cvt_pk_bf16_f32 v206, v212, v213
  v_mfma_f32_16x16x32_bf16 v[192:195], a[108:111], a[44:47], v[192:195]
  s_add_u32 m0, s38, 0
  v_exp_f32 v214, v214
  v_mfma_f32_16x16x32_bf16 v[196:199], a[124:127], a[44:47], v[224:227]
  buffer_load_dwordx4 v252, s[16:19], s33 offen nt lds
  v_mfma_f32_16x16x32_bf16 v[196:199], a[120:123], a[40:43], v[196:199]
  v_exp_f32 v215, v215
  v_mfma_f32_16x16x32_bf16 v[196:199], a[116:119], a[36:39], v[196:199]
  v_cvt_pk_bf16_f32 v207, v214, v215
  v_mfma_f32_16x16x32_bf16 v[196:199], a[112:115], a[32:35], v[196:199]
  v_exp_f32 v192, v192
  v_smfmac_f32_16x16x64_bf16 a[236:239], a[232:235], v[200:207], v253
  v_mfma_f32_16x16x32_bf16 v[32:35], v[200:203], a[160:163], v[32:35]
  v_mfma_f32_16x16x32_bf16 v[32:35], v[204:207], a[192:195], v[32:35]
  v_exp_f32 v193, v193
  v_mfma_f32_16x16x32_bf16 v[36:39], v[204:207], a[196:199], v[36:39]
  v_cvt_pk_bf16_f32 v192, v192, v193
  v_mfma_f32_16x16x32_bf16 v[36:39], v[200:203], a[164:167], v[36:39]
  s_add_u32 m0, s38, 3968
  v_exp_f32 v194, v194
  v_mfma_f32_16x16x32_bf16 v[40:43], v[200:203], a[168:171], v[40:43]
  buffer_load_dwordx4 v252, s[16:19], s33 offen offset:128 nt lds
  v_mfma_f32_16x16x32_bf16 v[40:43], v[204:207], a[200:203], v[40:43]
  v_exp_f32 v195, v195
  v_mfma_f32_16x16x32_bf16 v[44:47], v[204:207], a[204:207], v[44:47]
  v_cvt_pk_bf16_f32 v193, v194, v195
  v_mfma_f32_16x16x32_bf16 v[44:47], v[200:203], a[172:175], v[44:47]
  v_exp_f32 v196, v196
  v_mfma_f32_16x16x32_bf16 v[208:211], a[128:131], a[32:35], v[224:227]
  v_mfma_f32_16x16x32_bf16 v[208:211], a[132:135], a[36:39], v[208:211]
  v_exp_f32 v197, v197
  v_mfma_f32_16x16x32_bf16 v[208:211], a[136:139], a[40:43], v[208:211]
  v_cvt_pk_bf16_f32 v194, v196, v197
  v_mfma_f32_16x16x32_bf16 v[208:211], a[140:143], a[44:47], v[208:211]
  s_add_u32 m0, s38, 8192
  v_exp_f32 v198, v198
  v_mfma_f32_16x16x32_bf16 v[212:215], a[156:159], a[44:47], v[224:227]
  buffer_load_dwordx4 v252, s[20:23], s33 offen nt lds
  v_mfma_f32_16x16x32_bf16 v[212:215], a[152:155], a[40:43], v[212:215]
  v_exp_f32 v199, v199
  v_mfma_f32_16x16x32_bf16 v[212:215], a[148:151], a[36:39], v[212:215]
  v_cvt_pk_bf16_f32 v195, v198, v199
  v_mfma_f32_16x16x32_bf16 v[212:215], a[144:147], a[32:35], v[212:215]
  v_exp_f32 v208, v208
  v_mfma_f32_16x16x32_bf16 v[48:51], v[200:203], a[176:179], v[48:51]
  v_mfma_f32_16x16x32_bf16 v[48:51], v[204:207], a[208:211], v[48:51]
  v_exp_f32 v209, v209
  v_mfma_f32_16x16x32_bf16 v[52:55], v[204:207], a[212:215], v[52:55]
  v_cvt_pk_bf16_f32 v196, v208, v209
  v_mfma_f32_16x16x32_bf16 v[52:55], v[200:203], a[180:183], v[52:55]
  s_add_u32 m0, s38, 12160
  v_exp_f32 v210, v210
  v_mfma_f32_16x16x32_bf16 v[56:59], v[200:203], a[184:187], v[56:59]
  buffer_load_dwordx4 v252, s[20:23], s33 offen offset:128 nt lds
  v_mfma_f32_16x16x32_bf16 v[56:59], v[204:207], a[216:219], v[56:59]
  s_add_u32 s34, s34, 1
  v_exp_f32 v211, v211
  v_mfma_f32_16x16x32_bf16 v[60:63], v[204:207], a[220:223], v[60:63]
  s_add_u32 s33, s33, 8192
  v_cvt_pk_bf16_f32 v197, v210, v211
  v_mfma_f32_16x16x32_bf16 v[60:63], v[200:203], a[188:191], v[60:63]
  v_exp_f32 v212, v212
  v_mfma_f32_16x16x32_bf16 v[200:203], a[96:99], a[48:51], v[228:231]
  v_mfma_f32_16x16x32_bf16 v[200:203], a[100:103], a[52:55], v[200:203]
  v_exp_f32 v213, v213
  v_mfma_f32_16x16x32_bf16 v[200:203], a[104:107], a[56:59], v[200:203]
  v_cvt_pk_bf16_f32 v198, v212, v213
  v_mfma_f32_16x16x32_bf16 v[200:203], a[108:111], a[60:63], v[200:203]
  s_add_u32 m0, s38, 16384
  v_exp_f32 v214, v214
  v_mfma_f32_16x16x32_bf16 v[204:207], a[124:127], a[60:63], v[228:231]
  buffer_load_dwordx4 v252, s[16:19], s33 offen nt lds
  v_mfma_f32_16x16x32_bf16 v[204:207], a[120:123], a[56:59], v[204:207]
  v_exp_f32 v215, v215
  v_mfma_f32_16x16x32_bf16 v[204:207], a[116:119], a[52:55], v[204:207]
  v_cvt_pk_bf16_f32 v199, v214, v215
  v_mfma_f32_16x16x32_bf16 v[204:207], a[112:115], a[48:51], v[204:207]
  v_exp_f32 v200, v200
  v_smfmac_f32_16x16x64_bf16 a[240:243], a[228:231], v[192:199], v253
  ds_read_b64_tr_b16 a[248:249], v244 offset:0
  v_mfma_f32_16x16x32_bf16 v[64:67], v[192:195], a[160:163], v[64:67]
  ds_read_b64_tr_b16 a[250:251], v244 offset:64
  v_mfma_f32_16x16x32_bf16 v[64:67], v[196:199], a[192:195], v[64:67]
  v_exp_f32 v201, v201
  v_mfma_f32_16x16x32_bf16 v[68:71], v[196:199], a[196:199], v[68:71]
  v_cvt_pk_bf16_f32 v200, v200, v201
  v_mfma_f32_16x16x32_bf16 v[68:71], v[192:195], a[164:167], v[68:71]
  s_add_u32 m0, s38, 20352
  v_exp_f32 v202, v202
  v_mfma_f32_16x16x32_bf16 v[72:75], v[192:195], a[168:171], v[72:75]
  buffer_load_dwordx4 v252, s[16:19], s33 offen offset:128 nt lds
  v_mfma_f32_16x16x32_bf16 v[72:75], v[196:199], a[200:203], v[72:75]
  v_exp_f32 v203, v203
  v_mfma_f32_16x16x32_bf16 v[76:79], v[196:199], a[204:207], v[76:79]
  v_cvt_pk_bf16_f32 v201, v202, v203
  v_mfma_f32_16x16x32_bf16 v[76:79], v[192:195], a[172:175], v[76:79]
  v_exp_f32 v204, v204
  v_mfma_f32_16x16x32_bf16 v[208:211], a[128:131], a[48:51], v[228:231]
  v_mfma_f32_16x16x32_bf16 v[208:211], a[132:135], a[52:55], v[208:211]
  v_exp_f32 v205, v205
  v_mfma_f32_16x16x32_bf16 v[208:211], a[136:139], a[56:59], v[208:211]
  v_cvt_pk_bf16_f32 v202, v204, v205
  v_mfma_f32_16x16x32_bf16 v[208:211], a[140:143], a[60:63], v[208:211]
  s_add_u32 m0, s38, 24576
  v_exp_f32 v206, v206
  v_mfma_f32_16x16x32_bf16 v[212:215], a[156:159], a[60:63], v[228:231]
  buffer_load_dwordx4 v252, s[20:23], s33 offen nt lds
  v_mfma_f32_16x16x32_bf16 v[212:215], a[152:155], a[56:59], v[212:215]
  v_exp_f32 v207, v207
  v_mfma_f32_16x16x32_bf16 v[212:215], a[148:151], a[52:55], v[212:215]
  v_cvt_pk_bf16_f32 v203, v206, v207
  v_mfma_f32_16x16x32_bf16 v[212:215], a[144:147], a[48:51], v[212:215]
  v_exp_f32 v208, v208
  v_mfma_f32_16x16x32_bf16 v[80:83], v[192:195], a[176:179], v[80:83]
  v_mfma_f32_16x16x32_bf16 v[80:83], v[196:199], a[208:211], v[80:83]
  v_exp_f32 v209, v209
  v_mfma_f32_16x16x32_bf16 v[84:87], v[196:199], a[212:215], v[84:87]
  v_cvt_pk_bf16_f32 v204, v208, v209
  v_mfma_f32_16x16x32_bf16 v[84:87], v[192:195], a[180:183], v[84:87]
  s_add_u32 m0, s38, 28544
  v_exp_f32 v210, v210
  v_mfma_f32_16x16x32_bf16 v[88:91], v[192:195], a[184:187], v[88:91]
  buffer_load_dwordx4 v252, s[20:23], s33 offen offset:128 nt lds
  v_mfma_f32_16x16x32_bf16 v[88:91], v[196:199], a[216:219], v[88:91]
  s_add_u32 s34, s34, 1
  v_exp_f32 v211, v211
  v_mfma_f32_16x16x32_bf16 v[92:95], v[196:199], a[220:223], v[92:95]
  s_add_u32 s33, s33, 8192
  v_cvt_pk_bf16_f32 v205, v210, v211
  v_mfma_f32_16x16x32_bf16 v[92:95], v[192:195], a[188:191], v[92:95]
  v_exp_f32 v212, v212
  v_mfma_f32_16x16x32_bf16 v[192:195], a[96:99], a[64:67], v[232:235]
  v_mfma_f32_16x16x32_bf16 v[192:195], a[100:103], a[68:71], v[192:195]
  v_exp_f32 v213, v213
  v_mfma_f32_16x16x32_bf16 v[192:195], a[104:107], a[72:75], v[192:195]
  v_cvt_pk_bf16_f32 v206, v212, v213
  v_mfma_f32_16x16x32_bf16 v[192:195], a[108:111], a[76:79], v[192:195]
  v_exp_f32 v214, v214
  v_mfma_f32_16x16x32_bf16 v[196:199], a[124:127], a[76:79], v[232:235]
  v_mfma_f32_16x16x32_bf16 v[196:199], a[120:123], a[72:75], v[196:199]
  v_exp_f32 v215, v215
  v_mfma_f32_16x16x32_bf16 v[196:199], a[116:119], a[68:71], v[196:199]
  v_cvt_pk_bf16_f32 v207, v214, v215
  v_mfma_f32_16x16x32_bf16 v[196:199], a[112:115], a[64:67], v[196:199]
  s_nop 0
  v_exp_f32 v192, v192
  v_smfmac_f32_16x16x64_bf16 a[240:243], a[232:235], v[200:207], v253
  v_mfma_f32_16x16x32_bf16 v[96:99], v[200:203], a[160:163], v[96:99]
  v_mfma_f32_16x16x32_bf16 v[96:99], v[204:207], a[192:195], v[96:99]
  s_waitcnt lgkmcnt(0)
  buffer_store_dwordx4 a[248:251], v245, s[28:31], s42 offen offset:0 nt
  v_exp_f32 v193, v193
  v_mfma_f32_16x16x32_bf16 v[100:103], v[204:207], a[196:199], v[100:103]
  v_cvt_pk_bf16_f32 v192, v192, v193
  v_mfma_f32_16x16x32_bf16 v[100:103], v[200:203], a[164:167], v[100:103]
  v_exp_f32 v194, v194
  v_mfma_f32_16x16x32_bf16 v[104:107], v[200:203], a[168:171], v[104:107]
  ds_read_b64_tr_b16 a[248:249], v244 offset:12288
  ds_read_b64_tr_b16 a[250:251], v244 offset:12352
  v_mfma_f32_16x16x32_bf16 v[104:107], v[204:207], a[200:203], v[104:107]
  v_exp_f32 v195, v195
  v_mfma_f32_16x16x32_bf16 v[108:111], v[204:207], a[204:207], v[108:111]
  v_cvt_pk_bf16_f32 v193, v194, v195
  v_add_u32 v244, 1024, v244
  v_mfma_f32_16x16x32_bf16 v[108:111], v[200:203], a[172:175], v[108:111]
  v_exp_f32 v196, v196
  v_mfma_f32_16x16x32_bf16 v[208:211], a[128:131], a[64:67], v[232:235]
  v_mfma_f32_16x16x32_bf16 v[208:211], a[132:135], a[68:71], v[208:211]
  v_exp_f32 v197, v197
  v_mfma_f32_16x16x32_bf16 v[208:211], a[136:139], a[72:75], v[208:211]
  v_cvt_pk_bf16_f32 v194, v196, v197
  v_mfma_f32_16x16x32_bf16 v[208:211], a[140:143], a[76:79], v[208:211]
  v_exp_f32 v198, v198
  v_mfma_f32_16x16x32_bf16 v[212:215], a[156:159], a[76:79], v[232:235]
  v_mfma_f32_16x16x32_bf16 v[212:215], a[152:155], a[72:75], v[212:215]
  v_exp_f32 v199, v199
  v_mfma_f32_16x16x32_bf16 v[212:215], a[148:151], a[68:71], v[212:215]
  v_cvt_pk_bf16_f32 v195, v198, v199
  v_mfma_f32_16x16x32_bf16 v[212:215], a[144:147], a[64:67], v[212:215]
  s_nop 0
  v_exp_f32 v208, v208
  v_mfma_f32_16x16x32_bf16 v[112:115], v[200:203], a[176:179], v[112:115]
  v_mfma_f32_16x16x32_bf16 v[112:115], v[204:207], a[208:211], v[112:115]
  v_exp_f32 v209, v209
  v_mfma_f32_16x16x32_bf16 v[116:119], v[204:207], a[212:215], v[116:119]
  v_cvt_pk_bf16_f32 v196, v208, v209
  v_mfma_f32_16x16x32_bf16 v[116:119], v[200:203], a[180:183], v[116:119]
  v_exp_f32 v210, v210
  v_mfma_f32_16x16x32_bf16 v[120:123], v[200:203], a[184:187], v[120:123]
  v_mfma_f32_16x16x32_bf16 v[120:123], v[204:207], a[216:219], v[120:123]
  v_exp_f32 v211, v211
  v_mfma_f32_16x16x32_bf16 v[124:127], v[204:207], a[220:223], v[124:127]
  v_cvt_pk_bf16_f32 v197, v210, v211
  v_mfma_f32_16x16x32_bf16 v[124:127], v[200:203], a[188:191], v[124:127]
  v_exp_f32 v212, v212
  v_mfma_f32_16x16x32_bf16 v[200:203], a[96:99], a[80:83], v[236:239]
  v_mfma_f32_16x16x32_bf16 v[200:203], a[100:103], a[84:87], v[200:203]
  v_exp_f32 v213, v213
  v_mfma_f32_16x16x32_bf16 v[200:203], a[104:107], a[88:91], v[200:203]
  v_cvt_pk_bf16_f32 v198, v212, v213
  v_mfma_f32_16x16x32_bf16 v[200:203], a[108:111], a[92:95], v[200:203]
  v_exp_f32 v214, v214
  v_mfma_f32_16x16x32_bf16 v[204:207], a[124:127], a[92:95], v[236:239]
  v_mfma_f32_16x16x32_bf16 v[204:207], a[120:123], a[88:91], v[204:207]
  v_exp_f32 v215, v215
  v_mfma_f32_16x16x32_bf16 v[204:207], a[116:119], a[84:87], v[204:207]
  v_cvt_pk_bf16_f32 v199, v214, v215
  v_mfma_f32_16x16x32_bf16 v[204:207], a[112:115], a[80:83], v[204:207]
  s_nop 0
  v_exp_f32 v200, v200
  v_smfmac_f32_16x16x64_bf16 a[244:247], a[228:231], v[192:199], v253
  ds_read_b128 a[96:99], v246 offset:32768
  v_mfma_f32_16x16x32_bf16 v[128:131], v[192:195], a[160:163], v[128:131]
  ds_read_b128 a[100:103], v247 offset:32768
  v_mfma_f32_16x16x32_bf16 v[128:131], v[196:199], a[192:195], v[128:131]
  v_exp_f32 v201, v201
  v_mfma_f32_16x16x32_bf16 v[132:135], v[196:199], a[196:199], v[132:135]
  ds_read_b128 a[104:107], v246 offset:36864
  v_cvt_pk_bf16_f32 v200, v200, v201
  v_mfma_f32_16x16x32_bf16 v[132:135], v[192:195], a[164:167], v[132:135]
  v_exp_f32 v202, v202
  v_mfma_f32_16x16x32_bf16 v[136:139], v[192:195], a[168:171], v[136:139]
  ds_read_b128 a[108:111], v247 offset:36864
  v_mfma_f32_16x16x32_bf16 v[136:139], v[196:199], a[200:203], v[136:139]
  v_exp_f32 v203, v203
  v_mfma_f32_16x16x32_bf16 v[140:143], v[196:199], a[204:207], v[140:143]
  ds_read_b128 a[112:115], v246 offset:34816
  v_cvt_pk_bf16_f32 v201, v202, v203
  v_mfma_f32_16x16x32_bf16 v[140:143], v[192:195], a[172:175], v[140:143]
  v_exp_f32 v204, v204
  v_mfma_f32_16x16x32_bf16 v[208:211], a[128:131], a[80:83], v[236:239]
  ds_read_b128 a[116:119], v247 offset:34816
  v_mfma_f32_16x16x32_bf16 v[208:211], a[132:135], a[84:87], v[208:211]
  v_exp_f32 v205, v205
  v_mfma_f32_16x16x32_bf16 v[208:211], a[136:139], a[88:91], v[208:211]
  ds_read_b128 a[120:123], v246 offset:38912
  v_cvt_pk_bf16_f32 v202, v204, v205
  v_mfma_f32_16x16x32_bf16 v[208:211], a[140:143], a[92:95], v[208:211]
  v_exp_f32 v206, v206
  v_mfma_f32_16x16x32_bf16 v[212:215], a[156:159], a[92:95], v[236:239]
  ds_read_b128 a[124:127], v247 offset:38912
  v_mfma_f32_16x16x32_bf16 v[212:215], a[152:155], a[88:91], v[212:215]
  v_exp_f32 v207, v207
  v_mfma_f32_16x16x32_bf16 v[212:215], a[148:151], a[84:87], v[212:215]
  v_cvt_pk_bf16_f32 v203, v206, v207
  v_mfma_f32_16x16x32_bf16 v[212:215], a[144:147], a[80:83], v[212:215]
  v_exp_f32 v208, v208
  v_mfma_f32_16x16x32_bf16 v[144:147], v[192:195], a[176:179], v[144:147]
  v_mfma_f32_16x16x32_bf16 v[144:147], v[196:199], a[208:211], v[144:147]
  s_waitcnt lgkmcnt(2)
  buffer_store_dwordx4 a[248:251], v245, s[28:31], s42 offen offset:128 nt
  v_exp_f32 v209, v209
  v_mfma_f32_16x16x32_bf16 v[148:151], v[196:199], a[212:215], v[148:151]
  s_add_u32 s42, s42, 2048
  v_cvt_pk_bf16_f32 v204, v208, v209
  v_mfma_f32_16x16x32_bf16 v[148:151], v[192:195], a[180:183], v[148:151]
  v_exp_f32 v210, v210
  v_mfma_f32_16x16x32_bf16 v[152:155], v[192:195], a[184:187], v[152:155]
  v_mfma_f32_16x16x32_bf16 v[152:155], v[196:199], a[216:219], v[152:155]
  v_exp_f32 v211, v211
  v_mfma_f32_16x16x32_bf16 v[156:159], v[196:199], a[220:223], v[156:159]
  v_cvt_pk_bf16_f32 v205, v210, v211
  v_mfma_f32_16x16x32_bf16 v[156:159], v[192:195], a[188:191], v[156:159]
  s_cmp_eq_u32 s34, 46
  v_exp_f32 v212, v212
  s_waitcnt lgkmcnt(7)
  v_mfma_f32_16x16x32_bf16 v[192:195], a[96:99], a[0:3], v[216:219]
  s_cbranch_scc0 L_loopB
  s_waitcnt lgkmcnt(7)
  s_waitcnt lgkmcnt(6)
  ds_read_b128 a[128:131], v246 offset:49152
  v_mfma_f32_16x16x32_bf16 v[192:195], a[100:103], a[4:7], v[192:195]
  s_waitcnt lgkmcnt(6)
  v_exp_f32 v213, v213
  v_mfma_f32_16x16x32_bf16 v[192:195], a[104:107], a[8:11], v[192:195]
  s_waitcnt lgkmcnt(5)
  ds_read_b128 a[132:135], v247 offset:49152
  v_cvt_pk_bf16_f32 v206, v212, v213
  v_mfma_f32_16x16x32_bf16 v[192:195], a[108:111], a[12:15], v[192:195]
  s_waitcnt lgkmcnt(2)
  v_exp_f32 v214, v214
  v_mfma_f32_16x16x32_bf16 v[196:199], a[124:127], a[12:15], v[216:219]
  ds_read_b128 a[136:139], v246 offset:53248
  v_mfma_f32_16x16x32_bf16 v[196:199], a[120:123], a[8:11], v[196:199]
  v_exp_f32 v215, v215
  v_mfma_f32_16x16x32_bf16 v[196:199], a[116:119], a[4:7], v[196:199]
  ds_read_b128 a[140:143], v247 offset:53248
  v_cvt_pk_bf16_f32 v207, v214, v215
  v_mfma_f32_16x16x32_bf16 v[196:199], a[112:115], a[0:3], v[196:199]
  v_exp_f32 v192, v192
  v_smfmac_f32_16x16x64_bf16 a[244:247], a[232:235], v[200:207], v253
  ds_read_b128 a[144:147], v246 offset:51200
  v_mfma_f32_16x16x32_bf16 v[160:163], v[200:203], a[160:163], v[160:163]
  ds_read_b128 a[148:151], v247 offset:51200
  ds_read_b128 a[152:155], v246 offset:55296
  v_mfma_f32_16x16x32_bf16 v[160:163], v[204:207], a[192:195], v[160:163]
  v_exp_f32 v193, v193
  v_mfma_f32_16x16x32_bf16 v[164:167], v[204:207], a[196:199], v[164:167]
  ds_read_b128 a[156:159], v247 offset:55296
  v_cvt_pk_bf16_f32 v192, v192, v193
  v_mfma_f32_16x16x32_bf16 v[164:167], v[200:203], a[164:167], v[164:167]
  v_exp_f32 v194, v194
  v_mfma_f32_16x16x32_bf16 v[168:171], v[200:203], a[168:171], v[168:171]
  ds_read_b64_tr_b16 a[160:161], v248 offset:40960
  ds_read_b64_tr_b16 a[162:163], v248 offset:43008
  v_mfma_f32_16x16x32_bf16 v[168:171], v[204:207], a[200:203], v[168:171]
  v_exp_f32 v195, v195
  v_mfma_f32_16x16x32_bf16 v[172:175], v[204:207], a[204:207], v[172:175]
  ds_read_b64_tr_b16 a[192:193], v248 offset:57344
  v_cvt_pk_bf16_f32 v193, v194, v195
  v_mfma_f32_16x16x32_bf16 v[172:175], v[200:203], a[172:175], v[172:175]
  s_waitcnt lgkmcnt(6)
  v_exp_f32 v196, v196
  v_mfma_f32_16x16x32_bf16 v[208:211], a[128:131], a[0:3], v[216:219]
  ds_read_b64_tr_b16 a[194:195], v248 offset:59392
  ds_read_b64_tr_b16 a[164:165], v249 offset:40960
  v_mfma_f32_16x16x32_bf16 v[208:211], a[132:135], a[4:7], v[208:211]
  v_exp_f32 v197, v197
  v_mfma_f32_16x16x32_bf16 v[208:211], a[136:139], a[8:11], v[208:211]
  ds_read_b64_tr_b16 a[166:167], v249 offset:43008
  v_cvt_pk_bf16_f32 v194, v196, v197
  v_mfma_f32_16x16x32_bf16 v[208:211], a[140:143], a[12:15], v[208:211]
  s_waitcnt lgkmcnt(6)
  v_exp_f32 v198, v198
  v_mfma_f32_16x16x32_bf16 v[212:215], a[156:159], a[12:15], v[216:219]
  ds_read_b64_tr_b16 a[196:197], v249 offset:57344
  ds_read_b64_tr_b16 a[198:199], v249 offset:59392
  v_mfma_f32_16x16x32_bf16 v[212:215], a[152:155], a[8:11], v[212:215]
  v_exp_f32 v199, v199
  v_mfma_f32_16x16x32_bf16 v[212:215], a[148:151], a[4:7], v[212:215]
  ds_read_b64_tr_b16 a[168:169], v250 offset:40960
  v_cvt_pk_bf16_f32 v195, v198, v199
  v_mfma_f32_16x16x32_bf16 v[212:215], a[144:147], a[0:3], v[212:215]
  v_exp_f32 v208, v208
  v_mfma_f32_16x16x32_bf16 v[176:179], v[200:203], a[176:179], v[176:179]
  ds_read_b64_tr_b16 a[170:171], v250 offset:43008
  ds_read_b64_tr_b16 a[200:201], v250 offset:57344
  v_mfma_f32_16x16x32_bf16 v[176:179], v[204:207], a[208:211], v[176:179]
  v_exp_f32 v209, v209
  v_mfma_f32_16x16x32_bf16 v[180:183], v[204:207], a[212:215], v[180:183]
  ds_read_b64_tr_b16 a[202:203], v250 offset:59392
  v_cvt_pk_bf16_f32 v196, v208, v209
  v_mfma_f32_16x16x32_bf16 v[180:183], v[200:203], a[180:183], v[180:183]
  v_exp_f32 v210, v210
  v_mfma_f32_16x16x32_bf16 v[184:187], v[200:203], a[184:187], v[184:187]
  ds_read_b64_tr_b16 a[172:173], v251 offset:40960
  ds_read_b64_tr_b16 a[174:175], v251 offset:43008
  v_mfma_f32_16x16x32_bf16 v[184:187], v[204:207], a[216:219], v[184:187]
  v_exp_f32 v211, v211
  v_mfma_f32_16x16x32_bf16 v[188:191], v[204:207], a[220:223], v[188:191]
  ds_read_b64_tr_b16 a[204:205], v251 offset:57344
  v_cvt_pk_bf16_f32 v197, v210, v211
  v_mfma_f32_16x16x32_bf16 v[188:191], v[200:203], a[188:191], v[188:191]
  v_exp_f32 v212, v212
  v_mfma_f32_16x16x32_bf16 v[200:203], a[96:99], a[16:19], v[220:223]
  ds_read_b64_tr_b16 a[206:207], v251 offset:59392
  ds_read_b64_tr_b16 a[176:177], v248 offset:45056
  v_mfma_f32_16x16x32_bf16 v[200:203], a[100:103], a[20:23], v[200:203]
  v_exp_f32 v213, v213
  v_mfma_f32_16x16x32_bf16 v[200:203], a[104:107], a[24:27], v[200:203]
  ds_read_b64_tr_b16 a[178:179], v248 offset:47104
  v_cvt_pk_bf16_f32 v198, v212, v213
  v_mfma_f32_16x16x32_bf16 v[200:203], a[108:111], a[28:31], v[200:203]
  v_exp_f32 v214, v214
  v_mfma_f32_16x16x32_bf16 v[204:207], a[124:127], a[28:31], v[220:223]
  ds_read_b64_tr_b16 a[208:209], v248 offset:61440
  ds_read_b64_tr_b16 a[210:211], v248 offset:63488
  v_mfma_f32_16x16x32_bf16 v[204:207], a[120:123], a[24:27], v[204:207]
  v_exp_f32 v215, v215
  v_mfma_f32_16x16x32_bf16 v[204:207], a[116:119], a[20:23], v[204:207]
  ds_read_b64_tr_b16 a[180:181], v249 offset:45056
  v_cvt_pk_bf16_f32 v199, v214, v215
  v_mfma_f32_16x16x32_bf16 v[204:207], a[112:115], a[16:19], v[204:207]
  v_exp_f32 v200, v200
  v_smfmac_f32_16x16x64_bf16 a[236:239], a[228:231], v[192:199], v253
  s_waitcnt lgkmcnt(4)
  ds_read_b64_tr_b16 a[182:183], v249 offset:47104
  v_mfma_f32_16x16x32_bf16 v[0:3], v[192:195], a[160:163], v[0:3]
  ds_read_b64_tr_b16 a[212:213], v249 offset:61440
  ds_read_b64_tr_b16 a[214:215], v249 offset:63488
  v_mfma_f32_16x16x32_bf16 v[0:3], v[196:199], a[192:195], v[0:3]
  v_exp_f32 v201, v201
  v_mfma_f32_16x16x32_bf16 v[4:7], v[196:199], a[196:199], v[4:7]
  ds_read_b64_tr_b16 a[184:185], v250 offset:45056
  v_cvt_pk_bf16_f32 v200, v200, v201
  v_mfma_f32_16x16x32_bf16 v[4:7], v[192:195], a[164:167], v[4:7]
  v_exp_f32 v202, v202
  v_mfma_f32_16x16x32_bf16 v[8:11], v[192:195], a[168:171], v[8:11]
  ds_read_b64_tr_b16 a[186:187], v250 offset:47104
  ds_read_b64_tr_b16 a[216:217], v250 offset:61440
  v_mfma_f32_16x16x32_bf16 v[8:11], v[196:199], a[200:203], v[8:11]
  v_exp_f32 v203, v203
  v_mfma_f32_16x16x32_bf16 v[12:15], v[196:199], a[204:207], v[12:15]
  ds_read_b64_tr_b16 a[218:219], v250 offset:63488
  v_cvt_pk_bf16_f32 v201, v202, v203
  v_mfma_f32_16x16x32_bf16 v[12:15], v[192:195], a[172:175], v[12:15]
  v_exp_f32 v204, v204
  v_mfma_f32_16x16x32_bf16 v[208:211], a[128:131], a[16:19], v[220:223]
  ds_read_b64_tr_b16 a[188:189], v251 offset:45056
  ds_read_b64_tr_b16 a[190:191], v251 offset:47104
  v_mfma_f32_16x16x32_bf16 v[208:211], a[132:135], a[20:23], v[208:211]
  v_exp_f32 v205, v205
  v_mfma_f32_16x16x32_bf16 v[208:211], a[136:139], a[24:27], v[208:211]
  ds_read_b64_tr_b16 a[220:221], v251 offset:61440
  v_cvt_pk_bf16_f32 v202, v204, v205
  v_mfma_f32_16x16x32_bf16 v[208:211], a[140:143], a[28:31], v[208:211]
  v_exp_f32 v206, v206
  v_mfma_f32_16x16x32_bf16 v[212:215], a[156:159], a[28:31], v[220:223]
  ds_read_b64_tr_b16 a[222:223], v251 offset:63488
  v_mfma_f32_16x16x32_bf16 v[212:215], a[152:155], a[24:27], v[212:215]
  v_exp_f32 v207, v207
  v_mfma_f32_16x16x32_bf16 v[212:215], a[148:151], a[20:23], v[212:215]
  v_cvt_pk_bf16_f32 v203, v206, v207
  v_mfma_f32_16x16x32_bf16 v[212:215], a[144:147], a[16:19], v[212:215]
  s_waitcnt lgkmcnt(4)
  v_exp_f32 v208, v208
  v_mfma_f32_16x16x32_bf16 v[16:19], v[192:195], a[176:179], v[16:19]
  v_mfma_f32_16x16x32_bf16 v[16:19], v[196:199], a[208:211], v[16:19]
  v_exp_f32 v209, v209
  v_mfma_f32_16x16x32_bf16 v[20:23], v[196:199], a[212:215], v[20:23]
  v_cvt_pk_bf16_f32 v204, v208, v209
  v_mfma_f32_16x16x32_bf16 v[20:23], v[192:195], a[180:183], v[20:23]
  s_waitcnt lgkmcnt(0)
  v_exp_f32 v210, v210
  v_mfma_f32_16x16x32_bf16 v[24:27], v[192:195], a[184:187], v[24:27]
  L_cutE:
  v_mfma_f32_16x16x32_bf16 v[24:27], v[196:199], a[216:219], v[24:27]
  v_exp_f32 v211, v211
  v_mfma_f32_16x16x32_bf16 v[28:31], v[196:199], a[220:223], v[28:31]
  v_cvt_pk_bf16_f32 v205, v210, v211
  v_mfma_f32_16x16x32_bf16 v[28:31], v[192:195], a[188:191], v[28:31]
  v_exp_f32 v212, v212
  v_mfma_f32_16x16x32_bf16 v[192:195], a[96:99], a[32:35], v[224:227]
  ds_read_b64_tr_b16 a[248:249], v244 offset:0
  ds_read_b64_tr_b16 a[250:251], v244 offset:64
  v_mfma_f32_16x16x32_bf16 v[192:195], a[100:103], a[36:39], v[192:195]
  s_and_b32 s45, s35, 0x40000000
  v_exp_f32 v213, v213
  v_mfma_f32_16x16x32_bf16 v[192:195], a[104:107], a[40:43], v[192:195]
  v_cvt_pk_bf16_f32 v206, v212, v213
  v_mfma_f32_16x16x32_bf16 v[192:195], a[108:111], a[44:47], v[192:195]
  s_add_u32 s42, s42, s45
  v_exp_f32 v214, v214
  v_mfma_f32_16x16x32_bf16 v[196:199], a[124:127], a[44:47], v[224:227]
  v_mfma_f32_16x16x32_bf16 v[196:199], a[120:123], a[40:43], v[196:199]
  v_exp_f32 v215, v215
  v_mfma_f32_16x16x32_bf16 v[196:199], a[116:119], a[36:39], v[196:199]
  v_cvt_pk_bf16_f32 v207, v214, v215
  v_mfma_f32_16x16x32_bf16 v[196:199], a[112:115], a[32:35], v[196:199]
  v_exp_f32 v192, v192
  v_smfmac_f32_16x16x64_bf16 a[236:239], a[232:235], v[200:207], v253
  v_mfma_f32_16x16x32_bf16 v[32:35], v[200:203], a[160:163], v[32:35]
  v_mfma_f32_16x16x32_bf16 v[32:35], v[204:207], a[192:195], v[32:35]
  v_exp_f32 v193, v193
  v_mfma_f32_16x16x32_bf16 v[36:39], v[204:207], a[196:199], v[36:39]
  v_cvt_pk_bf16_f32 v192, v192, v193
  v_mfma_f32_16x16x32_bf16 v[36:39], v[200:203], a[164:167], v[36:39]
  v_exp_f32 v194, v194
  v_mfma_f32_16x16x32_bf16 v[40:43], v[200:203], a[168:171], v[40:43]
  v_mfma_f32_16x16x32_bf16 v[40:43], v[204:207], a[200:203], v[40:43]
  s_waitcnt lgkmcnt(0)
  buffer_store_dwordx4 a[248:251], v245, s[28:31], s42 offen offset:0 nt
  v_exp_f32 v195, v195
  v_mfma_f32_16x16x32_bf16 v[44:47], v[204:207], a[204:207], v[44:47]
  v_cvt_pk_bf16_f32 v193, v194, v195
  v_mfma_f32_16x16x32_bf16 v[44:47], v[200:203], a[172:175], v[44:47]
  v_exp_f32 v196, v196
  v_mfma_f32_16x16x32_bf16 v[208:211], a[128:131], a[32:35], v[224:227]
  ds_read_b64_tr_b16 a[248:249], v244 offset:12288
  ds_read_b64_tr_b16 a[250:251], v244 offset:12352
  v_mfma_f32_16x16x32_bf16 v[208:211], a[132:135], a[36:39], v[208:211]
  v_exp_f32 v197, v197
  v_mfma_f32_16x16x32_bf16 v[208:211], a[136:139], a[40:43], v[208:211]
  v_cvt_pk_bf16_f32 v194, v196, v197
  v_mfma_f32_16x16x32_bf16 v[208:211], a[140:143], a[44:47], v[208:211]
  v_exp_f32 v198, v198
  v_mfma_f32_16x16x32_bf16 v[212:215], a[156:159], a[44:47], v[224:227]
  v_mfma_f32_16x16x32_bf16 v[212:215], a[152:155], a[40:43], v[212:215]
  v_exp_f32 v199, v199
  v_mfma_f32_16x16x32_bf16 v[212:215], a[148:151], a[36:39], v[212:215]
  v_cvt_pk_bf16_f32 v195, v198, v199
  v_mfma_f32_16x16x32_bf16 v[212:215], a[144:147], a[32:35], v[212:215]
  s_nop 0
  v_exp_f32 v208, v208
  v_mfma_f32_16x16x32_bf16 v[48:51], v[200:203], a[176:179], v[48:51]
  v_mfma_f32_16x16x32_bf16 v[48:51], v[204:207], a[208:211], v[48:51]
  v_exp_f32 v209, v209
  v_mfma_f32_16x16x32_bf16 v[52:55], v[204:207], a[212:215], v[52:55]
  v_cvt_pk_bf16_f32 v196, v208, v209
  v_mfma_f32_16x16x32_bf16 v[52:55], v[200:203], a[180:183], v[52:55]
  v_exp_f32 v210, v210
  v_mfma_f32_16x16x32_bf16 v[56:59], v[200:203], a[184:187], v[56:59]
  v_mfma_f32_16x16x32_bf16 v[56:59], v[204:207], a[216:219], v[56:59]
  v_exp_f32 v211, v211
  v_mfma_f32_16x16x32_bf16 v[60:63], v[204:207], a[220:223], v[60:63]
  v_cvt_pk_bf16_f32 v197, v210, v211
  v_mfma_f32_16x16x32_bf16 v[60:63], v[200:203], a[188:191], v[60:63]
  v_exp_f32 v212, v212
  v_mfma_f32_16x16x32_bf16 v[200:203], a[96:99], a[48:51], v[228:231]
  v_mfma_f32_16x16x32_bf16 v[200:203], a[100:103], a[52:55], v[200:203]
  s_waitcnt lgkmcnt(0)
  buffer_store_dwordx4 a[248:251], v245, s[28:31], s42 offen offset:128 nt
  v_exp_f32 v213, v213
  v_mfma_f32_16x16x32_bf16 v[200:203], a[104:107], a[56:59], v[200:203]
  v_cvt_pk_bf16_f32 v198, v212, v213
  v_mfma_f32_16x16x32_bf16 v[200:203], a[108:111], a[60:63], v[200:203]
  v_exp_f32 v214, v214
  v_mfma_f32_16x16x32_bf16 v[204:207], a[124:127], a[60:63], v[228:231]
  ds_read_b64_tr_b16 a[248:249], v244 offset:1024
  ds_read_b64_tr_b16 a[250:251], v244 offset:1088
  v_mfma_f32_16x16x32_bf16 v[204:207], a[120:123], a[56:59], v[204:207]
  v_exp_f32 v215, v215
  v_mfma_f32_16x16x32_bf16 v[204:207], a[116:119], a[52:55], v[204:207]
  v_cvt_pk_bf16_f32 v199, v214, v215
  v_mfma_f32_16x16x32_bf16 v[204:207], a[112:115], a[48:51], v[204:207]
  v_exp_f32 v200, v200
  v_smfmac_f32_16x16x64_bf16 a[240:243], a[228:231], v[192:199], v253
  v_mfma_f32_16x16x32_bf16 v[64:67], v[192:195], a[160:163], v[64:67]
  v_mfma_f32_16x16x32_bf16 v[64:67], v[196:199], a[192:195], v[64:67]
  v_exp_f32 v201, v201
  v_mfma_f32_16x16x32_bf16 v[68:71], v[196:199], a[196:199], v[68:71]
  v_cvt_pk_bf16_f32 v200, v200, v201
  v_mfma_f32_16x16x32_bf16 v[68:71], v[192:195], a[164:167], v[68:71]
  v_exp_f32 v202, v202
  v_mfma_f32_16x16x32_bf16 v[72:75], v[192:195], a[168:171], v[72:75]
  v_mfma_f32_16x16x32_bf16 v[72:75], v[196:199], a[200:203], v[72:75]
  v_exp_f32 v203, v203
  v_mfma_f32_16x16x32_bf16 v[76:79], v[196:199], a[204:207], v[76:79]
  v_cvt_pk_bf16_f32 v201, v202, v203
  v_mfma_f32_16x16x32_bf16 v[76:79], v[192:195], a[172:175], v[76:79]
  v_exp_f32 v204, v204
  v_mfma_f32_16x16x32_bf16 v[208:211], a[128:131], a[48:51], v[228:231]
  v_mfma_f32_16x16x32_bf16 v[208:211], a[132:135], a[52:55], v[208:211]
  v_exp_f32 v205, v205
  v_mfma_f32_16x16x32_bf16 v[208:211], a[136:139], a[56:59], v[208:211]
  v_cvt_pk_bf16_f32 v202, v204, v205
  v_mfma_f32_16x16x32_bf16 v[208:211], a[140:143], a[60:63], v[208:211]
  v_exp_f32 v206, v206
  v_mfma_f32_16x16x32_bf16 v[212:215], a[156:159], a[60:63], v[228:231]
  v_mfma_f32_16x16x32_bf16 v[212:215], a[152:155], a[56:59], v[212:215]
  v_exp_f32 v207, v207
  v_mfma_f32_16x16x32_bf16 v[212:215], a[148:151], a[52:55], v[212:215]
  v_cvt_pk_bf16_f32 v203, v206, v207
  v_mfma_f32_16x16x32_bf16 v[212:215], a[144:147], a[48:51], v[212:215]
  s_nop 0
  v_exp_f32 v208, v208
  v_mfma_f32_16x16x32_bf16 v[80:83], v[192:195], a[176:179], v[80:83]
  v_mfma_f32_16x16x32_bf16 v[80:83], v[196:199], a[208:211], v[80:83]
  s_waitcnt lgkmcnt(0)
  buffer_store_dwordx4 a[248:251], v245, s[28:31], s42 offen offset:2048 nt
  v_exp_f32 v209, v209
  v_mfma_f32_16x16x32_bf16 v[84:87], v[196:199], a[212:215], v[84:87]
  v_cvt_pk_bf16_f32 v204, v208, v209
  v_mfma_f32_16x16x32_bf16 v[84:87], v[192:195], a[180:183], v[84:87]
  v_exp_f32 v210, v210
  v_mfma_f32_16x16x32_bf16 v[88:91], v[192:195], a[184:187], v[88:91]
  ds_read_b64_tr_b16 a[248:249], v244 offset:13312
  ds_read_b64_tr_b16 a[250:251], v244 offset:13376
  v_mfma_f32_16x16x32_bf16 v[88:91], v[196:199], a[216:219], v[88:91]
  v_exp_f32 v211, v211
  v_mfma_f32_16x16x32_bf16 v[92:95], v[196:199], a[220:223], v[92:95]
  v_cvt_pk_bf16_f32 v205, v210, v211
  v_add_u32 v244, 2048, v244
  v_mfma_f32_16x16x32_bf16 v[92:95], v[192:195], a[188:191], v[92:95]
  v_exp_f32 v212, v212
  v_mfma_f32_16x16x32_bf16 v[192:195], a[96:99], a[64:67], v[232:235]
  v_mfma_f32_16x16x32_bf16 v[192:195], a[100:103], a[68:71], v[192:195]
  v_exp_f32 v213, v213
  v_mfma_f32_16x16x32_bf16 v[192:195], a[104:107], a[72:75], v[192:195]
  v_cvt_pk_bf16_f32 v206, v212, v213
  v_mfma_f32_16x16x32_bf16 v[192:195], a[108:111], a[76:79], v[192:195]
  v_exp_f32 v214, v214
  v_mfma_f32_16x16x32_bf16 v[196:199], a[124:127], a[76:79], v[232:235]
  v_mfma_f32_16x16x32_bf16 v[196:199], a[120:123], a[72:75], v[196:199]
  v_exp_f32 v215, v215
  v_mfma_f32_16x16x32_bf16 v[196:199], a[116:119], a[68:71], v[196:199]
  v_cvt_pk_bf16_f32 v207, v214, v215
  v_mfma_f32_16x16x32_bf16 v[196:199], a[112:115], a[64:67], v[196:199]
  s_nop 0
  v_exp_f32 v192, v192
  v_smfmac_f32_16x16x64_bf16 a[240:243], a[232:235], v[200:207], v253
  v_mfma_f32_16x16x32_bf16 v[96:99], v[200:203], a[160:163], v[96:99]
  v_mfma_f32_16x16x32_bf16 v[96:99], v[204:207], a[192:195], v[96:99]
  v_exp_f32 v193, v193
  v_mfma_f32_16x16x32_bf16 v[100:103], v[204:207], a[196:199], v[100:103]
  v_cvt_pk_bf16_f32 v192, v192, v193
  v_mfma_f32_16x16x32_bf16 v[100:103], v[200:203], a[164:167], v[100:103]
  v_exp_f32 v194, v194
  v_mfma_f32_16x16x32_bf16 v[104:107], v[200:203], a[168:171], v[104:107]
  v_mfma_f32_16x16x32_bf16 v[104:107], v[204:207], a[200:203], v[104:107]
  v_exp_f32 v195, v195
  v_mfma_f32_16x16x32_bf16 v[108:111], v[204:207], a[204:207], v[108:111]
  v_cvt_pk_bf16_f32 v193, v194, v195
  v_mfma_f32_16x16x32_bf16 v[108:111], v[200:203], a[172:175], v[108:111]
  v_exp_f32 v196, v196
  v_mfma_f32_16x16x32_bf16 v[208:211], a[128:131], a[64:67], v[232:235]
  v_mfma_f32_16x16x32_bf16 v[208:211], a[132:135], a[68:71], v[208:211]
  v_exp_f32 v197, v197
  v_mfma_f32_16x16x32_bf16 v[208:211], a[136:139], a[72:75], v[208:211]
  v_cvt_pk_bf16_f32 v194, v196, v197
  v_mfma_f32_16x16x32_bf16 v[208:211], a[140:143], a[76:79], v[208:211]
  s_waitcnt lgkmcnt(0)
  buffer_store_dwordx4 a[248:251], v245, s[28:31], s42 offen offset:2176 nt
  v_exp_f32 v198, v198
  v_mfma_f32_16x16x32_bf16 v[212:215], a[156:159], a[76:79], v[232:235]
  s_add_u32 s42, s42, 4096
  v_mfma_f32_16x16x32_bf16 v[212:215], a[152:155], a[72:75], v[212:215]
  v_exp_f32 v199, v199
  v_mfma_f32_16x16x32_bf16 v[212:215], a[148:151], a[68:71], v[212:215]
  v_cvt_pk_bf16_f32 v195, v198, v199
  v_mfma_f32_16x16x32_bf16 v[212:215], a[144:147], a[64:67], v[212:215]
  v_exp_f32 v208, v208
  v_mfma_f32_16x16x32_bf16 v[112:115], v[200:203], a[176:179], v[112:115]
  v_mfma_f32_16x16x32_bf16 v[112:115], v[204:207], a[208:211], v[112:115]
  v_exp_f32 v209, v209
  v_mfma_f32_16x16x32_bf16 v[116:119], v[204:207], a[212:215], v[116:119]
  v_cvt_pk_bf16_f32 v196, v208, v209
  v_mfma_f32_16x16x32_bf16 v[116:119], v[200:203], a[180:183], v[116:119]
  v_exp_f32 v210, v210
  v_mfma_f32_16x16x32_bf16 v[120:123], v[200:203], a[184:187], v[120:123]
  v_mfma_f32_16x16x32_bf16 v[120:123], v[204:207], a[216:219], v[120:123]
  v_exp_f32 v211, v211
  v_mfma_f32_16x16x32_bf16 v[124:127], v[204:207], a[220:223], v[124:127]
  v_cvt_pk_bf16_f32 v197, v210, v211
  v_mfma_f32_16x16x32_bf16 v[124:127], v[200:203], a[188:191], v[124:127]
  v_exp_f32 v212, v212
  v_mfma_f32_16x16x32_bf16 v[200:203], a[96:99], a[80:83], v[236:239]
  v_mfma_f32_16x16x32_bf16 v[200:203], a[100:103], a[84:87], v[200:203]
  v_exp_f32 v213, v213
  v_mfma_f32_16x16x32_bf16 v[200:203], a[104:107], a[88:91], v[200:203]
  v_cvt_pk_bf16_f32 v198, v212, v213
  v_mfma_f32_16x16x32_bf16 v[200:203], a[108:111], a[92:95], v[200:203]
  s_waitcnt vmcnt(6)
  v_exp_f32 v214, v214
  v_mfma_f32_16x16x32_bf16 v[204:207], a[124:127], a[92:95], v[236:239]
  s_barrier
  v_mfma_f32_16x16x32_bf16 v[204:207], a[120:123], a[88:91], v[204:207]
  v_exp_f32 v215, v215
  v_mfma_f32_16x16x32_bf16 v[204:207], a[116:119], a[84:87], v[204:207]
  v_cvt_pk_bf16_f32 v199, v214, v215
  v_mfma_f32_16x16x32_bf16 v[204:207], a[112:115], a[80:83], v[204:207]
  v_exp_f32 v200, v200
  v_smfmac_f32_16x16x64_bf16 a[244:247], a[228:231], v[192:199], v253
  s_add_u32 s28, s10, s58
  ds_read_b128 a[96:99], v246 offset:0
  v_mfma_f32_16x16x32_bf16 v[128:131], v[192:195], a[160:163], v[128:131]
  s_addc_u32 s29, s11, 0
  ds_read_b128 a[100:103], v247 offset:0
  v_mfma_f32_16x16x32_bf16 v[128:131], v[196:199], a[192:195], v[128:131]
  s_lshl_b32 s42, s59, 8
  v_exp_f32 v201, v201
  v_mfma_f32_16x16x32_bf16 v[132:135], v[196:199], a[196:199], v[132:135]
  ds_read_b128 a[104:107], v246 offset:4096
  v_cvt_pk_bf16_f32 v200, v200, v201
  v_mfma_f32_16x16x32_bf16 v[132:135], v[192:195], a[164:167], v[132:135]
  v_exp_f32 v202, v202
  v_mfma_f32_16x16x32_bf16 v[136:139], v[192:195], a[168:171], v[136:139]
  ds_read_b128 a[108:111], v247 offset:4096
  v_and_b32 v244, 0x3ff, v244
  v_mfma_f32_16x16x32_bf16 v[136:139], v[196:199], a[200:203], v[136:139]
  v_exp_f32 v203, v203
  v_mfma_f32_16x16x32_bf16 v[140:143], v[196:199], a[204:207], v[140:143]
  ds_read_b128 a[112:115], v246 offset:2048
  v_cvt_pk_bf16_f32 v201, v202, v203
  v_mfma_f32_16x16x32_bf16 v[140:143], v[192:195], a[172:175], v[140:143]
  v_exp_f32 v204, v204
  v_mfma_f32_16x16x32_bf16 v[208:211], a[128:131], a[80:83], v[236:239]
  ds_read_b128 a[116:119], v247 offset:2048
  v_add_u32 v244, s49, v244
  v_mfma_f32_16x16x32_bf16 v[208:211], a[132:135], a[84:87], v[208:211]
  v_exp_f32 v205, v205
  v_mfma_f32_16x16x32_bf16 v[208:211], a[136:139], a[88:91], v[208:211]
  ds_read_b128 a[120:123], v246 offset:6144
  v_cvt_pk_bf16_f32 v202, v204, v205
  v_mfma_f32_16x16x32_bf16 v[208:211], a[140:143], a[92:95], v[208:211]
  v_exp_f32 v206, v206
  v_mfma_f32_16x16x32_bf16 v[212:215], a[156:159], a[92:95], v[236:239]
  ds_read_b128 a[124:127], v247 offset:6144
  v_mfma_f32_16x16x32_bf16 v[212:215], a[152:155], a[88:91], v[212:215]
  v_exp_f32 v207, v207
  v_mfma_f32_16x16x32_bf16 v[212:215], a[148:151], a[84:87], v[212:215]
  v_cvt_pk_bf16_f32 v203, v206, v207
  v_mfma_f32_16x16x32_bf16 v[212:215], a[144:147], a[80:83], v[212:215]
  v_exp_f32 v208, v208
  v_mfma_f32_16x16x32_bf16 v[144:147], v[192:195], a[176:179], v[144:147]
  v_mfma_f32_16x16x32_bf16 v[144:147], v[196:199], a[208:211], v[144:147]
  v_exp_f32 v209, v209
  v_mfma_f32_16x16x32_bf16 v[148:151], v[196:199], a[212:215], v[148:151]
  v_cvt_pk_bf16_f32 v204, v208, v209
  v_mfma_f32_16x16x32_bf16 v[148:151], v[192:195], a[180:183], v[148:151]
  v_exp_f32 v210, v210
  v_mfma_f32_16x16x32_bf16 v[152:155], v[192:195], a[184:187], v[152:155]
  v_mfma_f32_16x16x32_bf16 v[152:155], v[196:199], a[216:219], v[152:155]
  v_exp_f32 v211, v211
  v_mfma_f32_16x16x32_bf16 v[156:159], v[196:199], a[220:223], v[156:159]
  v_cvt_pk_bf16_f32 v205, v210, v211
  v_mfma_f32_16x16x32_bf16 v[156:159], v[192:195], a[188:191], v[156:159]
  s_waitcnt lgkmcnt(0)
  v_exp_f32 v212, v212
  v_mfma_f32_16x16x32_bf16 v[192:195], a[96:99], a[0:3], v[216:219]
  ds_read_b128 a[128:131], v246 offset:16384
  v_mfma_f32_16x16x32_bf16 v[192:195], a[100:103], a[4:7], v[192:195]
  v_exp_f32 v213, v213
  v_mfma_f32_16x16x32_bf16 v[192:195], a[104:107], a[8:11], v[192:195]
  ds_read_b128 a[132:135], v247 offset:16384
  v_cvt_pk_bf16_f32 v206, v212, v213
  v_mfma_f32_16x16x32_bf16 v[192:195], a[108:111], a[12:15], v[192:195]
  v_exp_f32 v214, v214
  v_mfma_f32_16x16x32_bf16 v[196:199], a[124:127], a[12:15], v[216:219]
  ds_read_b128 a[136:139], v246 offset:20480
  v_mfma_f32_16x16x32_bf16 v[196:199], a[120:123], a[8:11], v[196:199]
  v_exp_f32 v215, v215
  v_mfma_f32_16x16x32_bf16 v[196:199], a[116:119], a[4:7], v[196:199]
  ds_read_b128 a[140:143], v247 offset:20480
  v_cvt_pk_bf16_f32 v207, v214, v215
  v_mfma_f32_16x16x32_bf16 v[196:199], a[112:115], a[0:3], v[196:199]
  v_exp_f32 v192, v192
  v_smfmac_f32_16x16x64_bf16 a[244:247], a[232:235], v[200:207], v253
  ds_read_b128 a[144:147], v246 offset:18432
  v_mfma_f32_16x16x32_bf16 v[160:163], v[200:203], a[160:163], v[160:163]
  ds_read_b128 a[148:151], v247 offset:18432
  ds_read_b128 a[152:155], v246 offset:22528
  v_mfma_f32_16x16x32_bf16 v[160:163], v[204:207], a[192:195], v[160:163]
  v_exp_f32 v193, v193
  v_mfma_f32_16x16x32_bf16 v[164:167], v[204:207], a[196:199], v[164:167]
  ds_read_b128 a[156:159], v247 offset:22528
  v_cvt_pk_bf16_f32 v192, v192, v193
  v_mfma_f32_16x16x32_bf16 v[164:167], v[200:203], a[164:167], v[164:167]
  v_exp_f32 v194, v194
  v_mfma_f32_16x16x32_bf16 v[168:171], v[200:203], a[168:171], v[168:171]
  ds_read_b64_tr_b16 a[160:161], v248 offset:8192
  ds_read_b64_tr_b16 a[162:163], v248 offset:10240
  v_mfma_f32_16x16x32_bf16 v[168:171], v[204:207], a[200:203], v[168:171]
  v_exp_f32 v195, v195
  v_mfma_f32_16x16x32_bf16 v[172:175], v[204:207], a[204:207], v[172:175]
  ds_read_b64_tr_b16 a[192:193], v248 offset:24576
  v_cvt_pk_bf16_f32 v193, v194, v195
  v_mfma_f32_16x16x32_bf16 v[172:175], v[200:203], a[172:175], v[172:175]
  s_waitcnt lgkmcnt(6)
  v_exp_f32 v196, v196
  v_mfma_f32_16x16x32_bf16 v[208:211], a[128:131], a[0:3], v[216:219]
  ds_read_b64_tr_b16 a[194:195], v248 offset:26624
  ds_read_b64_tr_b16 a[164:165], v249 offset:8192
  v_mfma_f32_16x16x32_bf16 v[208:211], a[132:135], a[4:7], v[208:211]
  v_exp_f32 v197, v197
  v_mfma_f32_16x16x32_bf16 v[208:211], a[136:139], a[8:11], v[208:211]
  ds_read_b64_tr_b16 a[166:167], v249 offset:10240
  v_cvt_pk_bf16_f32 v194, v196, v197
  v_mfma_f32_16x16x32_bf16 v[208:211], a[140:143], a[12:15], v[208:211]
  s_waitcnt lgkmcnt(6)
  v_exp_f32 v198, v198
  v_mfma_f32_16x16x32_bf16 v[212:215], a[156:159], a[12:15], v[216:219]
  ds_read_b64_tr_b16 a[196:197], v249 offset:24576
  ds_read_b64_tr_b16 a[198:199], v249 offset:26624
  v_mfma_f32_16x16x32_bf16 v[212:215], a[152:155], a[8:11], v[212:215]
  v_exp_f32 v199, v199
  v_mfma_f32_16x16x32_bf16 v[212:215], a[148:151], a[4:7], v[212:215]
  ds_read_b64_tr_b16 a[168:169], v250 offset:8192
  v_cvt_pk_bf16_f32 v195, v198, v199
  v_mfma_f32_16x16x32_bf16 v[212:215], a[144:147], a[0:3], v[212:215]
  v_exp_f32 v208, v208
  v_mfma_f32_16x16x32_bf16 v[176:179], v[200:203], a[176:179], v[176:179]
  ds_read_b64_tr_b16 a[170:171], v250 offset:10240
  ds_read_b64_tr_b16 a[200:201], v250 offset:24576
  v_mfma_f32_16x16x32_bf16 v[176:179], v[204:207], a[208:211], v[176:179]
  v_exp_f32 v209, v209
  v_mfma_f32_16x16x32_bf16 v[180:183], v[204:207], a[212:215], v[180:183]
  ds_read_b64_tr_b16 a[202:203], v250 offset:26624
  v_cvt_pk_bf16_f32 v196, v208, v209
  v_mfma_f32_16x16x32_bf16 v[180:183], v[200:203], a[180:183], v[180:183]
  v_exp_f32 v210, v210
  v_mfma_f32_16x16x32_bf16 v[184:187], v[200:203], a[184:187], v[184:187]
  ds_read_b64_tr_b16 a[172:173], v251 offset:8192
  ds_read_b64_tr_b16 a[174:175], v251 offset:10240
  v_mfma_f32_16x16x32_bf16 v[184:187], v[204:207], a[216:219], v[184:187]
  v_exp_f32 v211, v211
  v_mfma_f32_16x16x32_bf16 v[188:191], v[204:207], a[220:223], v[188:191]
  ds_read_b64_tr_b16 a[204:205], v251 offset:24576
  v_cvt_pk_bf16_f32 v197, v210, v211
  v_mfma_f32_16x16x32_bf16 v[188:191], v[200:203], a[188:191], v[188:191]
  v_exp_f32 v212, v212
  v_mfma_f32_16x16x32_bf16 v[200:203], a[96:99], a[16:19], v[220:223]
  ds_read_b64_tr_b16 a[206:207], v251 offset:26624
  ds_read_b64_tr_b16 a[176:177], v248 offset:12288
  v_mfma_f32_16x16x32_bf16 v[200:203], a[100:103], a[20:23], v[200:203]
  v_exp_f32 v213, v213
  v_mfma_f32_16x16x32_bf16 v[200:203], a[104:107], a[24:27], v[200:203]
  ds_read_b64_tr_b16 a[178:179], v248 offset:14336
  v_cvt_pk_bf16_f32 v198, v212, v213
  v_mfma_f32_16x16x32_bf16 v[200:203], a[108:111], a[28:31], v[200:203]
  v_exp_f32 v214, v214
  v_mfma_f32_16x16x32_bf16 v[204:207], a[124:127], a[28:31], v[220:223]
  ds_read_b64_tr_b16 a[208:209], v248 offset:28672
  ds_read_b64_tr_b16 a[210:211], v248 offset:30720
  v_mfma_f32_16x16x32_bf16 v[204:207], a[120:123], a[24:27], v[204:207]
  v_exp_f32 v215, v215
  v_mfma_f32_16x16x32_bf16 v[204:207], a[116:119], a[20:23], v[204:207]
  ds_read_b64_tr_b16 a[180:181], v249 offset:12288
  v_cvt_pk_bf16_f32 v199, v214, v215
  v_mfma_f32_16x16x32_bf16 v[204:207], a[112:115], a[16:19], v[204:207]
  v_exp_f32 v200, v200
  v_smfmac_f32_16x16x64_bf16 a[236:239], a[228:231], v[192:199], v253
  s_waitcnt lgkmcnt(4)
  ds_read_b64_tr_b16 a[182:183], v249 offset:14336
  v_mfma_f32_16x16x32_bf16 v[0:3], v[192:195], a[160:163], v[0:3]
  ds_read_b64_tr_b16 a[212:213], v249 offset:28672
  ds_read_b64_tr_b16 a[214:215], v249 offset:30720
  v_mfma_f32_16x16x32_bf16 v[0:3], v[196:199], a[192:195], v[0:3]
  v_exp_f32 v201, v201
  v_mfma_f32_16x16x32_bf16 v[4:7], v[196:199], a[196:199], v[4:7]
  ds_read_b64_tr_b16 a[184:185], v250 offset:12288
  v_cvt_pk_bf16_f32 v200, v200, v201
  v_mfma_f32_16x16x32_bf16 v[4:7], v[192:195], a[164:167], v[4:7]
  v_exp_f32 v202, v202
  v_accvgpr_read_b32 v254, a236
  v_mfma_f32_16x16x32_bf16 v[8:11], v[192:195], a[168:171], v[8:11]
  ds_read_b64_tr_b16 a[186:187], v250 offset:14336
  ds_read_b64_tr_b16 a[216:217], v250 offset:28672
  v_accvgpr_read_b32 v216, a237
  v_add_f32 v254, v216, v254
  v_mfma_f32_16x16x32_bf16 v[8:11], v[196:199], a[200:203], v[8:11]
  v_exp_f32 v203, v203
  v_cmp_nge_f32 vcc, s43, v254
  v_mfma_f32_16x16x32_bf16 v[12:15], v[196:199], a[204:207], v[12:15]
  ds_read_b64_tr_b16 a[218:219], v250 offset:30720
  v_cvt_pk_bf16_f32 v201, v202, v203
  v_rcp_f32 v254, v254
  s_or_b64 s[46:47], s[46:47], vcc
  v_mfma_f32_16x16x32_bf16 v[12:15], v[192:195], a[172:175], v[12:15]
  v_exp_f32 v204, v204
  v_mov_b32 v219, v254
  s_nop 1
  v_mov_b32_dpp v219, v254 row_ror:12 row_mask:0x2 bank_mask:0xf
  v_mfma_f32_16x16x32_bf16 v[208:211], a[128:131], a[16:19], v[220:223]
  ds_read_b64_tr_b16 a[188:189], v251 offset:12288
  ds_read_b64_tr_b16 a[190:191], v251 offset:14336
  v_mov_b32_dpp v219, v254 row_ror:8 row_mask:0x4 bank_mask:0xf
  v_mfma_f32_16x16x32_bf16 v[208:211], a[132:135], a[20:23], v[208:211]
  v_exp_f32 v205, v205
  v_mov_b32_dpp v219, v254 row_ror:4 row_mask:0x8 bank_mask:0xf
  s_nop 1
  v_mov_b32_dpp v216, v219 row_newbcast:0 row_mask:0xf bank_mask:0xf
  v_mfma_f32_16x16x32_bf16 v[208:211], a[136:139], a[24:27], v[208:211]
  ds_read_b64_tr_b16 a[220:221], v251 offset:28672
  v_cvt_pk_bf16_f32 v202, v204, v205
  v_mov_b32_dpp v217, v219 row_newbcast:1 row_mask:0xf bank_mask:0xf
  v_mfma_f32_16x16x32_bf16 v[208:211], a[140:143], a[28:31], v[208:211]
  v_exp_f32 v206, v206
  v_mov_b32_dpp v218, v219 row_newbcast:2 row_mask:0xf bank_mask:0xf
  v_mov_b32_dpp v219, v219 row_newbcast:3 row_mask:0xf bank_mask:0xf
  v_mfma_f32_16x16x32_bf16 v[212:215], a[156:159], a[28:31], v[220:223]
  ds_read_b64_tr_b16 a[222:223], v251 offset:30720
  v_pk_mul_f32 v[0:1], v[0:1], v[216:217]
  v_pk_mul_f32 v[2:3], v[2:3], v[218:219]
  v_pk_mul_f32 v[4:5], v[4:5], v[216:217]
  v_pk_mul_f32 v[6:7], v[6:7], v[218:219]
  v_pk_mul_f32 v[8:9], v[8:9], v[216:217]
  v_pk_mul_f32 v[10:11], v[10:11], v[218:219]
  v_pk_mul_f32 v[12:13], v[12:13], v[216:217]
  v_pk_mul_f32 v[14:15], v[14:15], v[218:219]
  v_mfma_f32_16x16x32_bf16 v[212:215], a[152:155], a[24:27], v[212:215]
  v_exp_f32 v207, v207
  v_cvt_pk_bf16_f32 v13, v9, v13
  v_mfma_f32_16x16x32_bf16 v[212:215], a[148:151], a[20:23], v[212:215]
  v_cvt_pk_bf16_f32 v203, v206, v207
  v_cvt_pk_bf16_f32 v9, v8, v12
  v_mfma_f32_16x16x32_bf16 v[212:215], a[144:147], a[16:19], v[212:215]
  s_waitcnt lgkmcnt(4)
  v_exp_f32 v208, v208
  v_cvt_pk_bf16_f32 v8, v0, v4
  v_mfma_f32_16x16x32_bf16 v[16:19], v[192:195], a[176:179], v[16:19]
  v_cvt_pk_bf16_f32 v12, v1, v5
  v_cvt_pk_bf16_f32 v15, v11, v15
  v_mfma_f32_16x16x32_bf16 v[16:19], v[196:199], a[208:211], v[16:19]
  v_exp_f32 v209, v209
  v_cvt_pk_bf16_f32 v11, v10, v14
  v_mfma_f32_16x16x32_bf16 v[20:23], v[196:199], a[212:215], v[20:23]
  v_cvt_pk_bf16_f32 v204, v208, v209
  v_cvt_pk_bf16_f32 v10, v2, v6
  v_mfma_f32_16x16x32_bf16 v[20:23], v[192:195], a[180:183], v[20:23]
  v_exp_f32 v210, v210
  v_mfma_f32_16x16x32_bf16 v[24:27], v[192:195], a[184:187], v[24:27]
  ds_write_b128 v255, v[8:11] offset:0
  v_cvt_pk_bf16_f32 v14, v3, v7
  v_mfma_f32_16x16x32_bf16 v[24:27], v[196:199], a[216:219], v[24:27]
  s_waitcnt lgkmcnt(1)
  v_exp_f32 v211, v211
  v_mfma_f32_16x16x32_bf16 v[28:31], v[196:199], a[220:223], v[28:31]
  ds_write_b128 v255, v[12:15] offset:256
  v_cvt_pk_bf16_f32 v205, v210, v211
  v_mfma_f32_16x16x32_bf16 v[28:31], v[192:195], a[188:191], v[28:31]
  v_exp_f32 v212, v212
  v_mfma_f32_16x16x32_bf16 v[192:195], a[96:99], a[32:35], v[224:227]
  ds_read_b64_tr_b16 v[0:1], v244 offset:0
  ds_read_b64_tr_b16 v[2:3], v244 offset:64
  ds_read_b64_tr_b16 v[4:5], v244 offset:1024
  v_mfma_f32_16x16x32_bf16 v[192:195], a[100:103], a[36:39], v[192:195]
  ds_read_b64_tr_b16 v[6:7], v244 offset:1088
  v_exp_f32 v213, v213
  v_mfma_f32_16x16x32_bf16 v[192:195], a[104:107], a[40:43], v[192:195]
  v_cvt_pk_bf16_f32 v206, v212, v213
  v_mfma_f32_16x16x32_bf16 v[192:195], a[108:111], a[44:47], v[192:195]
  v_exp_f32 v214, v214
  v_mfma_f32_16x16x32_bf16 v[196:199], a[124:127], a[44:47], v[224:227]
  v_pk_mul_f32 v[16:17], v[16:17], v[216:217]
  v_pk_mul_f32 v[18:19], v[18:19], v[218:219]
  v_pk_mul_f32 v[20:21], v[20:21], v[216:217]
  v_pk_mul_f32 v[22:23], v[22:23], v[218:219]
  v_pk_mul_f32 v[24:25], v[24:25], v[216:217]
  v_pk_mul_f32 v[26:27], v[26:27], v[218:219]
  v_pk_mul_f32 v[28:29], v[28:29], v[216:217]
  v_pk_mul_f32 v[30:31], v[30:31], v[218:219]
  v_cvt_pk_bf16_f32 v29, v25, v29
  v_cvt_pk_bf16_f32 v25, v24, v28
  v_mfma_f32_16x16x32_bf16 v[196:199], a[120:123], a[40:43], v[196:199]
  v_exp_f32 v215, v215
  v_mfma_f32_16x16x32_bf16 v[196:199], a[116:119], a[36:39], v[196:199]
  v_cvt_pk_bf16_f32 v207, v214, v215
  v_cvt_pk_bf16_f32 v24, v16, v20
  v_cvt_pk_bf16_f32 v28, v17, v21
  v_mfma_f32_16x16x32_bf16 v[196:199], a[112:115], a[32:35], v[196:199]
  v_exp_f32 v192, v192
  v_cvt_pk_bf16_f32 v31, v27, v31
  v_smfmac_f32_16x16x64_bf16 a[236:239], a[232:235], v[200:207], v253
  v_cvt_pk_bf16_f32 v27, v26, v30
  v_mfma_f32_16x16x32_bf16 v[32:35], v[200:203], a[160:163], v[32:35]
  s_waitcnt lgkmcnt(0)
  buffer_store_dwordx4 v[0:3], v245, s[28:31], s42 offen offset:0 nt
  v_cvt_pk_bf16_f32 v26, v18, v22
  v_mfma_f32_16x16x32_bf16 v[32:35], v[204:207], a[192:195], v[32:35]
  v_exp_f32 v193, v193
  v_mfma_f32_16x16x32_bf16 v[36:39], v[204:207], a[196:199], v[36:39]
  ds_write_b128 v255, v[24:27] offset:12288
  v_cvt_pk_bf16_f32 v192, v192, v193
  v_mfma_f32_16x16x32_bf16 v[36:39], v[200:203], a[164:167], v[36:39]
  v_exp_f32 v194, v194
  v_cvt_pk_bf16_f32 v30, v19, v23
  v_accvgpr_read_b32 v254, a238
  v_mfma_f32_16x16x32_bf16 v[40:43], v[200:203], a[168:171], v[40:43]
  ds_write_b128 v255, v[28:31] offset:12544
  v_accvgpr_read_b32 v220, a239
  v_mfma_f32_16x16x32_bf16 v[40:43], v[204:207], a[200:203], v[40:43]
  v_exp_f32 v195, v195
  v_add_f32 v254, v220, v254
  v_cmp_nge_f32 vcc, s43, v254
  v_mfma_f32_16x16x32_bf16 v[44:47], v[204:207], a[204:207], v[44:47]
  ds_read_b64_tr_b16 v[16:17], v244 offset:12288
  ds_read_b64_tr_b16 v[18:19], v244 offset:12352
  v_cvt_pk_bf16_f32 v193, v194, v195
  v_mfma_f32_16x16x32_bf16 v[44:47], v[200:203], a[172:175], v[44:47]
  ds_read_b64_tr_b16 v[20:21], v244 offset:13312
  v_exp_f32 v196, v196
  v_rcp_f32 v254, v254
  s_or_b64 s[46:47], s[46:47], vcc
  v_mov_b32 v223, v254
  v_mfma_f32_16x16x32_bf16 v[208:211], a[128:131], a[32:35], v[224:227]
  buffer_store_dwordx4 v[4:7], v245, s[28:31], s42 offen offset:2048 nt
  ds_read_b64_tr_b16 v[22:23], v244 offset:13376
  v_mov_b32_dpp v223, v254 row_ror:12 row_mask:0x2 bank_mask:0xf
  v_mfma_f32_16x16x32_bf16 v[208:211], a[132:135], a[36:39], v[208:211]
  v_exp_f32 v197, v197
  v_mov_b32_dpp v223, v254 row_ror:8 row_mask:0x4 bank_mask:0xf
  s_nop 1
  v_mov_b32_dpp v223, v254 row_ror:4 row_mask:0x8 bank_mask:0xf
  v_mfma_f32_16x16x32_bf16 v[208:211], a[136:139], a[40:43], v[208:211]
  v_cvt_pk_bf16_f32 v194, v196, v197
  v_mov_b32_dpp v220, v223 row_newbcast:0 row_mask:0xf bank_mask:0xf
  v_mov_b32_dpp v221, v223 row_newbcast:1 row_mask:0xf bank_mask:0xf
  v_mfma_f32_16x16x32_bf16 v[208:211], a[140:143], a[44:47], v[208:211]
  v_exp_f32 v198, v198
  v_mov_b32_dpp v222, v223 row_newbcast:2 row_mask:0xf bank_mask:0xf
  v_mov_b32_dpp v223, v223 row_newbcast:3 row_mask:0xf bank_mask:0xf
  v_mfma_f32_16x16x32_bf16 v[212:215], a[156:159], a[44:47], v[224:227]
  v_pk_mul_f32 v[32:33], v[32:33], v[220:221]
  v_pk_mul_f32 v[34:35], v[34:35], v[222:223]
  v_pk_mul_f32 v[36:37], v[36:37], v[220:221]
  v_pk_mul_f32 v[38:39], v[38:39], v[222:223]
  v_pk_mul_f32 v[40:41], v[40:41], v[220:221]
  v_pk_mul_f32 v[42:43], v[42:43], v[222:223]
  v_pk_mul_f32 v[44:45], v[44:45], v[220:221]
  v_pk_mul_f32 v[46:47], v[46:47], v[222:223]
  v_cvt_pk_bf16_f32 v45, v41, v45
  v_mfma_f32_16x16x32_bf16 v[212:215], a[152:155], a[40:43], v[212:215]
  v_exp_f32 v199, v199
  v_cvt_pk_bf16_f32 v41, v40, v44
  v_mfma_f32_16x16x32_bf16 v[212:215], a[148:151], a[36:39], v[212:215]
  v_cvt_pk_bf16_f32 v195, v198, v199
  v_cvt_pk_bf16_f32 v40, v32, v36
  v_mfma_f32_16x16x32_bf16 v[212:215], a[144:147], a[32:35], v[212:215]
  v_exp_f32 v208, v208
  v_cvt_pk_bf16_f32 v44, v33, v37
  v_mfma_f32_16x16x32_bf16 v[48:51], v[200:203], a[176:179], v[48:51]
  s_waitcnt lgkmcnt(0)
  buffer_store_dwordx4 v[16:19], v245, s[28:31], s42 offen offset:128 nt
  v_cvt_pk_bf16_f32 v47, v43, v47
  v_mfma_f32_16x16x32_bf16 v[48:51], v[204:207], a[208:211], v[48:51]
  v_exp_f32 v209, v209
  v_mfma_f32_16x16x32_bf16 v[52:55], v[204:207], a[212:215], v[52:55]
  v_cvt_pk_bf16_f32 v196, v208, v209
  v_cvt_pk_bf16_f32 v43, v42, v46
  v_cvt_pk_bf16_f32 v42, v34, v38
  v_mfma_f32_16x16x32_bf16 v[52:55], v[200:203], a[180:183], v[52:55]
  v_exp_f32 v210, v210
  v_mfma_f32_16x16x32_bf16 v[56:59], v[200:203], a[184:187], v[56:59]
  ds_write_b128 v255, v[40:43] offset:2048
  v_cvt_pk_bf16_f32 v46, v35, v39
  v_mfma_f32_16x16x32_bf16 v[56:59], v[204:207], a[216:219], v[56:59]
  v_exp_f32 v211, v211
  v_mfma_f32_16x16x32_bf16 v[60:63], v[204:207], a[220:223], v[60:63]
  ds_write_b128 v255, v[44:47] offset:2304
  v_cvt_pk_bf16_f32 v197, v210, v211
  v_mfma_f32_16x16x32_bf16 v[60:63], v[200:203], a[188:191], v[60:63]
  v_exp_f32 v212, v212
  v_mfma_f32_16x16x32_bf16 v[200:203], a[96:99], a[48:51], v[228:231]
  buffer_store_dwordx4 v[20:23], v245, s[28:31], s42 offen offset:2176 nt
  ds_read_b64_tr_b16 v[32:33], v244 offset:2048
  v_mfma_f32_16x16x32_bf16 v[200:203], a[100:103], a[52:55], v[200:203]
  s_add_u32 s42, s42, 4096
  ds_read_b64_tr_b16 v[34:35], v244 offset:2112
  v_exp_f32 v213, v213
  v_mfma_f32_16x16x32_bf16 v[200:203], a[104:107], a[56:59], v[200:203]
  ds_read_b64_tr_b16 v[36:37], v244 offset:3072
  ds_read_b64_tr_b16 v[38:39], v244 offset:3136
  v_cvt_pk_bf16_f32 v198, v212, v213
  v_mfma_f32_16x16x32_bf16 v[200:203], a[108:111], a[60:63], v[200:203]
  v_exp_f32 v214, v214
  v_mfma_f32_16x16x32_bf16 v[204:207], a[124:127], a[60:63], v[228:231]
  v_pk_mul_f32 v[48:49], v[48:49], v[220:221]
  v_pk_mul_f32 v[50:51], v[50:51], v[222:223]
  v_pk_mul_f32 v[52:53], v[52:53], v[220:221]
  v_pk_mul_f32 v[54:55], v[54:55], v[222:223]
  v_pk_mul_f32 v[56:57], v[56:57], v[220:221]
  v_pk_mul_f32 v[58:59], v[58:59], v[222:223]
  v_pk_mul_f32 v[60:61], v[60:61], v[220:221]
  v_pk_mul_f32 v[62:63], v[62:63], v[222:223]
  v_cvt_pk_bf16_f32 v61, v57, v61
  v_cvt_pk_bf16_f32 v57, v56, v60
  v_mfma_f32_16x16x32_bf16 v[204:207], a[120:123], a[56:59], v[204:207]
  v_exp_f32 v215, v215
  v_mfma_f32_16x16x32_bf16 v[204:207], a[116:119], a[52:55], v[204:207]
  v_cvt_pk_bf16_f32 v199, v214, v215
  v_cvt_pk_bf16_f32 v56, v48, v52
  v_cvt_pk_bf16_f32 v60, v49, v53
  v_mfma_f32_16x16x32_bf16 v[204:207], a[112:115], a[48:51], v[204:207]
  v_exp_f32 v200, v200
  v_cvt_pk_bf16_f32 v63, v59, v63
  v_smfmac_f32_16x16x64_bf16 a[240:243], a[228:231], v[192:199], v253
  v_cvt_pk_bf16_f32 v59, v58, v62
  v_mfma_f32_16x16x32_bf16 v[64:67], v[192:195], a[160:163], v[64:67]
  s_waitcnt lgkmcnt(2)
  buffer_store_dwordx4 v[32:35], v245, s[28:31], s42 offen offset:0 nt
  v_cvt_pk_bf16_f32 v58, v50, v54
  v_mfma_f32_16x16x32_bf16 v[64:67], v[196:199], a[192:195], v[64:67]
  v_exp_f32 v201, v201
  v_mfma_f32_16x16x32_bf16 v[68:71], v[196:199], a[196:199], v[68:71]
  ds_write_b128 v255, v[56:59] offset:14336
  v_cvt_pk_bf16_f32 v200, v200, v201
  v_mfma_f32_16x16x32_bf16 v[68:71], v[192:195], a[164:167], v[68:71]
  v_exp_f32 v202, v202
  v_cvt_pk_bf16_f32 v62, v51, v55
  v_accvgpr_read_b32 v254, a240
  v_mfma_f32_16x16x32_bf16 v[72:75], v[192:195], a[168:171], v[72:75]
  ds_write_b128 v255, v[60:63] offset:14592
  v_accvgpr_read_b32 v224, a241
  v_mfma_f32_16x16x32_bf16 v[72:75], v[196:199], a[200:203], v[72:75]
  v_exp_f32 v203, v203
  v_add_f32 v254, v224, v254
  v_cmp_nge_f32 vcc, s43, v254
  v_mfma_f32_16x16x32_bf16 v[76:79], v[196:199], a[204:207], v[76:79]
  ds_read_b64_tr_b16 v[48:49], v244 offset:14336
  ds_read_b64_tr_b16 v[50:51], v244 offset:14400
  v_cvt_pk_bf16_f32 v201, v202, v203
  v_mfma_f32_16x16x32_bf16 v[76:79], v[192:195], a[172:175], v[76:79]
  ds_read_b64_tr_b16 v[52:53], v244 offset:15360
  v_exp_f32 v204, v204
  v_rcp_f32 v254, v254
  s_or_b64 s[46:47], s[46:47], vcc
  v_mov_b32 v227, v254
  v_mfma_f32_16x16x32_bf16 v[208:211], a[128:131], a[48:51], v[228:231]
  s_waitcnt lgkmcnt(5)
  buffer_store_dwordx4 v[36:39], v245, s[28:31], s42 offen offset:2048 nt
  ds_read_b64_tr_b16 v[54:55], v244 offset:15424
  v_mov_b32_dpp v227, v254 row_ror:12 row_mask:0x2 bank_mask:0xf
  v_mfma_f32_16x16x32_bf16 v[208:211], a[132:135], a[52:55], v[208:211]
  v_exp_f32 v205, v205
  v_mov_b32_dpp v227, v254 row_ror:8 row_mask:0x4 bank_mask:0xf
  s_nop 1
  v_mov_b32_dpp v227, v254 row_ror:4 row_mask:0x8 bank_mask:0xf
  v_mfma_f32_16x16x32_bf16 v[208:211], a[136:139], a[56:59], v[208:211]
  v_cvt_pk_bf16_f32 v202, v204, v205
  v_mov_b32_dpp v224, v227 row_newbcast:0 row_mask:0xf bank_mask:0xf
  v_mov_b32_dpp v225, v227 row_newbcast:1 row_mask:0xf bank_mask:0xf
  v_mfma_f32_16x16x32_bf16 v[208:211], a[140:143], a[60:63], v[208:211]
  v_exp_f32 v206, v206
  v_mov_b32_dpp v226, v227 row_newbcast:2 row_mask:0xf bank_mask:0xf
  v_mov_b32_dpp v227, v227 row_newbcast:3 row_mask:0xf bank_mask:0xf
  v_mfma_f32_16x16x32_bf16 v[212:215], a[156:159], a[60:63], v[228:231]
  v_pk_mul_f32 v[64:65], v[64:65], v[224:225]
  v_pk_mul_f32 v[66:67], v[66:67], v[226:227]
  v_pk_mul_f32 v[68:69], v[68:69], v[224:225]
  v_pk_mul_f32 v[70:71], v[70:71], v[226:227]
  v_pk_mul_f32 v[72:73], v[72:73], v[224:225]
  v_pk_mul_f32 v[74:75], v[74:75], v[226:227]
  v_pk_mul_f32 v[76:77], v[76:77], v[224:225]
  v_pk_mul_f32 v[78:79], v[78:79], v[226:227]
  v_cvt_pk_bf16_f32 v77, v73, v77
  v_mfma_f32_16x16x32_bf16 v[212:215], a[152:155], a[56:59], v[212:215]
  v_exp_f32 v207, v207
  v_cvt_pk_bf16_f32 v73, v72, v76
  v_mfma_f32_16x16x32_bf16 v[212:215], a[148:151], a[52:55], v[212:215]
  v_cvt_pk_bf16_f32 v203, v206, v207
  v_cvt_pk_bf16_f32 v72, v64, v68
  v_mfma_f32_16x16x32_bf16 v[212:215], a[144:147], a[48:51], v[212:215]
  v_exp_f32 v208, v208
  v_cvt_pk_bf16_f32 v76, v65, v69
  v_mfma_f32_16x16x32_bf16 v[80:83], v[192:195], a[176:179], v[80:83]
  s_waitcnt lgkmcnt(0)
  buffer_store_dwordx4 v[48:51], v245, s[28:31], s42 offen offset:128 nt
  v_cvt_pk_bf16_f32 v79, v75, v79
  v_mfma_f32_16x16x32_bf16 v[80:83], v[196:199], a[208:211], v[80:83]
  v_exp_f32 v209, v209
  v_mfma_f32_16x16x32_bf16 v[84:87], v[196:199], a[212:215], v[84:87]
  v_cvt_pk_bf16_f32 v204, v208, v209
  v_cvt_pk_bf16_f32 v75, v74, v78
  v_cvt_pk_bf16_f32 v74, v66, v70
  v_mfma_f32_16x16x32_bf16 v[84:87], v[192:195], a[180:183], v[84:87]
  v_exp_f32 v210, v210
  v_mfma_f32_16x16x32_bf16 v[88:91], v[192:195], a[184:187], v[88:91]
  ds_write_b128 v255, v[72:75] offset:4096
  v_cvt_pk_bf16_f32 v78, v67, v71
  v_mfma_f32_16x16x32_bf16 v[88:91], v[196:199], a[216:219], v[88:91]
  v_exp_f32 v211, v211
  v_mfma_f32_16x16x32_bf16 v[92:95], v[196:199], a[220:223], v[92:95]
  ds_write_b128 v255, v[76:79] offset:4352
  v_cvt_pk_bf16_f32 v205, v210, v211
  v_mfma_f32_16x16x32_bf16 v[92:95], v[192:195], a[188:191], v[92:95]
  v_exp_f32 v212, v212
  v_mfma_f32_16x16x32_bf16 v[192:195], a[96:99], a[64:67], v[232:235]
  buffer_store_dwordx4 v[52:55], v245, s[28:31], s42 offen offset:2176 nt
  ds_read_b64_tr_b16 v[64:65], v244 offset:4096
  v_mfma_f32_16x16x32_bf16 v[192:195], a[100:103], a[68:71], v[192:195]
  s_add_u32 s42, s42, 4096
  ds_read_b64_tr_b16 v[66:67], v244 offset:4160
  v_exp_f32 v213, v213
  v_mfma_f32_16x16x32_bf16 v[192:195], a[104:107], a[72:75], v[192:195]
  ds_read_b64_tr_b16 v[68:69], v244 offset:5120
  ds_read_b64_tr_b16 v[70:71], v244 offset:5184
  v_cvt_pk_bf16_f32 v206, v212, v213
  v_mfma_f32_16x16x32_bf16 v[192:195], a[108:111], a[76:79], v[192:195]
  v_exp_f32 v214, v214
  v_mfma_f32_16x16x32_bf16 v[196:199], a[124:127], a[76:79], v[232:235]
  v_pk_mul_f32 v[80:81], v[80:81], v[224:225]
  v_pk_mul_f32 v[82:83], v[82:83], v[226:227]
  v_pk_mul_f32 v[84:85], v[84:85], v[224:225]
  v_pk_mul_f32 v[86:87], v[86:87], v[226:227]
  v_pk_mul_f32 v[88:89], v[88:89], v[224:225]
  v_pk_mul_f32 v[90:91], v[90:91], v[226:227]
  v_pk_mul_f32 v[92:93], v[92:93], v[224:225]
  v_pk_mul_f32 v[94:95], v[94:95], v[226:227]
  v_cvt_pk_bf16_f32 v93, v89, v93
  v_cvt_pk_bf16_f32 v89, v88, v92
  v_mfma_f32_16x16x32_bf16 v[196:199], a[120:123], a[72:75], v[196:199]
  v_exp_f32 v215, v215
  v_mfma_f32_16x16x32_bf16 v[196:199], a[116:119], a[68:71], v[196:199]
  v_cvt_pk_bf16_f32 v207, v214, v215
  v_cvt_pk_bf16_f32 v88, v80, v84
  v_cvt_pk_bf16_f32 v92, v81, v85
  v_mfma_f32_16x16x32_bf16 v[196:199], a[112:115], a[64:67], v[196:199]
  v_exp_f32 v192, v192
  v_cvt_pk_bf16_f32 v95, v91, v95
  v_smfmac_f32_16x16x64_bf16 a[240:243], a[232:235], v[200:207], v253
  v_cvt_pk_bf16_f32 v91, v90, v94
  v_mfma_f32_16x16x32_bf16 v[96:99], v[200:203], a[160:163], v[96:99]
  s_waitcnt lgkmcnt(2)
  buffer_store_dwordx4 v[64:67], v245, s[28:31], s42 offen offset:0 nt
  v_cvt_pk_bf16_f32 v90, v82, v86
  v_mfma_f32_16x16x32_bf16 v[96:99], v[204:207], a[192:195], v[96:99]
  v_exp_f32 v193, v193
  v_mfma_f32_16x16x32_bf16 v[100:103], v[204:207], a[196:199], v[100:103]
  ds_write_b128 v255, v[88:91] offset:16384
  v_cvt_pk_bf16_f32 v192, v192, v193
  v_mfma_f32_16x16x32_bf16 v[100:103], v[200:203], a[164:167], v[100:103]
  v_exp_f32 v194, v194
  v_cvt_pk_bf16_f32 v94, v83, v87
  v_accvgpr_read_b32 v254, a242
  v_mfma_f32_16x16x32_bf16 v[104:107], v[200:203], a[168:171], v[104:107]
  ds_write_b128 v255, v[92:95] offset:16640
  v_accvgpr_read_b32 v228, a243
  v_mfma_f32_16x16x32_bf16 v[104:107], v[204:207], a[200:203], v[104:107]
  v_exp_f32 v195, v195
  v_add_f32 v254, v228, v254
  v_cmp_nge_f32 vcc, s43, v254
  v_mfma_f32_16x16x32_bf16 v[108:111], v[204:207], a[204:207], v[108:111]
  ds_read_b64_tr_b16 v[80:81], v244 offset:16384
  ds_read_b64_tr_b16 v[82:83], v244 offset:16448
  v_cvt_pk_bf16_f32 v193, v194, v195
  v_mfma_f32_16x16x32_bf16 v[108:111], v[200:203], a[172:175], v[108:111]
  ds_read_b64_tr_b16 v[84:85], v244 offset:17408
  v_exp_f32 v196, v196
  v_rcp_f32 v254, v254
  s_or_b64 s[46:47], s[46:47], vcc
  v_mov_b32 v231, v254
  v_mfma_f32_16x16x32_bf16 v[208:211], a[128:131], a[64:67], v[232:235]
  s_waitcnt lgkmcnt(5)
  buffer_store_dwordx4 v[68:71], v245, s[28:31], s42 offen offset:2048 nt
  ds_read_b64_tr_b16 v[86:87], v244 offset:17472
  v_mov_b32_dpp v231, v254 row_ror:12 row_mask:0x2 bank_mask:0xf
  v_mfma_f32_16x16x32_bf16 v[208:211], a[132:135], a[68:71], v[208:211]
  v_exp_f32 v197, v197
  v_mov_b32_dpp v231, v254 row_ror:8 row_mask:0x4 bank_mask:0xf
  s_nop 1
  v_mov_b32_dpp v231, v254 row_ror:4 row_mask:0x8 bank_mask:0xf
  v_mfma_f32_16x16x32_bf16 v[208:211], a[136:139], a[72:75], v[208:211]
  v_cvt_pk_bf16_f32 v194, v196, v197
  v_mov_b32_dpp v228, v231 row_newbcast:0 row_mask:0xf bank_mask:0xf
  v_mov_b32_dpp v229, v231 row_newbcast:1 row_mask:0xf bank_mask:0xf
  v_mfma_f32_16x16x32_bf16 v[208:211], a[140:143], a[76:79], v[208:211]
  v_exp_f32 v198, v198
  v_mov_b32_dpp v230, v231 row_newbcast:2 row_mask:0xf bank_mask:0xf
  v_mov_b32_dpp v231, v231 row_newbcast:3 row_mask:0xf bank_mask:0xf
  v_mfma_f32_16x16x32_bf16 v[212:215], a[156:159], a[76:79], v[232:235]
  v_pk_mul_f32 v[96:97], v[96:97], v[228:229]
  v_pk_mul_f32 v[98:99], v[98:99], v[230:231]
  v_pk_mul_f32 v[100:101], v[100:101], v[228:229]
  v_pk_mul_f32 v[102:103], v[102:103], v[230:231]
  v_pk_mul_f32 v[104:105], v[104:105], v[228:229]
  v_pk_mul_f32 v[106:107], v[106:107], v[230:231]
  v_pk_mul_f32 v[108:109], v[108:109], v[228:229]
  v_pk_mul_f32 v[110:111], v[110:111], v[230:231]
  v_cvt_pk_bf16_f32 v109, v105, v109
  v_mfma_f32_16x16x32_bf16 v[212:215], a[152:155], a[72:75], v[212:215]
  v_exp_f32 v199, v199
  v_cvt_pk_bf16_f32 v105, v104, v108
  v_mfma_f32_16x16x32_bf16 v[212:215], a[148:151], a[68:71], v[212:215]
  v_cvt_pk_bf16_f32 v195, v198, v199
  v_cvt_pk_bf16_f32 v104, v96, v100
  v_mfma_f32_16x16x32_bf16 v[212:215], a[144:147], a[64:67], v[212:215]
  v_exp_f32 v208, v208
  v_cvt_pk_bf16_f32 v108, v97, v101
  v_mfma_f32_16x16x32_bf16 v[112:115], v[200:203], a[176:179], v[112:115]
  s_waitcnt lgkmcnt(0)
  buffer_store_dwordx4 v[80:83], v245, s[28:31], s42 offen offset:128 nt
  v_cvt_pk_bf16_f32 v111, v107, v111
  v_mfma_f32_16x16x32_bf16 v[112:115], v[204:207], a[208:211], v[112:115]
  v_exp_f32 v209, v209
  v_mfma_f32_16x16x32_bf16 v[116:119], v[204:207], a[212:215], v[116:119]
  v_cvt_pk_bf16_f32 v196, v208, v209
  v_cvt_pk_bf16_f32 v107, v106, v110
  v_cvt_pk_bf16_f32 v106, v98, v102
  v_mfma_f32_16x16x32_bf16 v[116:119], v[200:203], a[180:183], v[116:119]
  v_exp_f32 v210, v210
  v_mfma_f32_16x16x32_bf16 v[120:123], v[200:203], a[184:187], v[120:123]
  ds_write_b128 v255, v[104:107] offset:6144
  v_cvt_pk_bf16_f32 v110, v99, v103
  v_mfma_f32_16x16x32_bf16 v[120:123], v[204:207], a[216:219], v[120:123]
  v_exp_f32 v211, v211
  v_mfma_f32_16x16x32_bf16 v[124:127], v[204:207], a[220:223], v[124:127]
  ds_write_b128 v255, v[108:111] offset:6400
  v_cvt_pk_bf16_f32 v197, v210, v211
  v_mfma_f32_16x16x32_bf16 v[124:127], v[200:203], a[188:191], v[124:127]
  v_exp_f32 v212, v212
  v_mfma_f32_16x16x32_bf16 v[200:203], a[96:99], a[80:83], v[236:239]
  buffer_store_dwordx4 v[84:87], v245, s[28:31], s42 offen offset:2176 nt
  ds_read_b64_tr_b16 v[96:97], v244 offset:6144
  v_mfma_f32_16x16x32_bf16 v[200:203], a[100:103], a[84:87], v[200:203]
  s_add_u32 s42, s42, 4096
  ds_read_b64_tr_b16 v[98:99], v244 offset:6208
  v_exp_f32 v213, v213
  v_mfma_f32_16x16x32_bf16 v[200:203], a[104:107], a[88:91], v[200:203]
  ds_read_b64_tr_b16 v[100:101], v244 offset:7168
  ds_read_b64_tr_b16 v[102:103], v244 offset:7232
  v_cvt_pk_bf16_f32 v198, v212, v213
  v_mfma_f32_16x16x32_bf16 v[200:203], a[108:111], a[92:95], v[200:203]
  v_exp_f32 v214, v214
  v_mfma_f32_16x16x32_bf16 v[204:207], a[124:127], a[92:95], v[236:239]
  v_pk_mul_f32 v[112:113], v[112:113], v[228:229]
  v_pk_mul_f32 v[114:115], v[114:115], v[230:231]
  v_pk_mul_f32 v[116:117], v[116:117], v[228:229]
  v_pk_mul_f32 v[118:119], v[118:119], v[230:231]
  v_pk_mul_f32 v[120:121], v[120:121], v[228:229]
  v_pk_mul_f32 v[122:123], v[122:123], v[230:231]
  v_pk_mul_f32 v[124:125], v[124:125], v[228:229]
  v_pk_mul_f32 v[126:127], v[126:127], v[230:231]
  v_cvt_pk_bf16_f32 v125, v121, v125
  v_cvt_pk_bf16_f32 v121, v120, v124
  v_mfma_f32_16x16x32_bf16 v[204:207], a[120:123], a[88:91], v[204:207]
  v_exp_f32 v215, v215
  v_mfma_f32_16x16x32_bf16 v[204:207], a[116:119], a[84:87], v[204:207]
  v_cvt_pk_bf16_f32 v199, v214, v215
  v_cvt_pk_bf16_f32 v120, v112, v116
  v_cvt_pk_bf16_f32 v124, v113, v117
  v_mfma_f32_16x16x32_bf16 v[204:207], a[112:115], a[80:83], v[204:207]
  v_exp_f32 v200, v200
  v_cvt_pk_bf16_f32 v127, v123, v127
  v_smfmac_f32_16x16x64_bf16 a[244:247], a[228:231], v[192:199], v253
  v_cvt_pk_bf16_f32 v123, v122, v126
  v_mfma_f32_16x16x32_bf16 v[128:131], v[192:195], a[160:163], v[128:131]
  s_waitcnt lgkmcnt(2)
  buffer_store_dwordx4 v[96:99], v245, s[28:31], s42 offen offset:0 nt
  v_cvt_pk_bf16_f32 v122, v114, v118
  v_mfma_f32_16x16x32_bf16 v[128:131], v[196:199], a[192:195], v[128:131]
  v_exp_f32 v201, v201
  v_mfma_f32_16x16x32_bf16 v[132:135], v[196:199], a[196:199], v[132:135]
  ds_write_b128 v255, v[120:123] offset:18432
  v_cvt_pk_bf16_f32 v200, v200, v201
  v_mfma_f32_16x16x32_bf16 v[132:135], v[192:195], a[164:167], v[132:135]
  v_exp_f32 v202, v202
  v_cvt_pk_bf16_f32 v126, v115, v119
  v_accvgpr_read_b32 v254, a244
  v_mfma_f32_16x16x32_bf16 v[136:139], v[192:195], a[168:171], v[136:139]
  ds_write_b128 v255, v[124:127] offset:18688
  v_accvgpr_read_b32 v232, a245
  v_mfma_f32_16x16x32_bf16 v[136:139], v[196:199], a[200:203], v[136:139]
  v_exp_f32 v203, v203
  v_add_f32 v254, v232, v254
  v_cmp_nge_f32 vcc, s43, v254
  v_mfma_f32_16x16x32_bf16 v[140:143], v[196:199], a[204:207], v[140:143]
  ds_read_b64_tr_b16 v[112:113], v244 offset:18432
  ds_read_b64_tr_b16 v[114:115], v244 offset:18496
  v_cvt_pk_bf16_f32 v201, v202, v203
  v_mfma_f32_16x16x32_bf16 v[140:143], v[192:195], a[172:175], v[140:143]
  ds_read_b64_tr_b16 v[116:117], v244 offset:19456
  v_exp_f32 v204, v204
  v_rcp_f32 v254, v254
  s_or_b64 s[46:47], s[46:47], vcc
  v_mov_b32 v235, v254
  v_mfma_f32_16x16x32_bf16 v[208:211], a[128:131], a[80:83], v[236:239]
  s_waitcnt lgkmcnt(5)
  buffer_store_dwordx4 v[100:103], v245, s[28:31], s42 offen offset:2048 nt
  ds_read_b64_tr_b16 v[118:119], v244 offset:19520
  v_mov_b32_dpp v235, v254 row_ror:12 row_mask:0x2 bank_mask:0xf
  v_mfma_f32_16x16x32_bf16 v[208:211], a[132:135], a[84:87], v[208:211]
  v_exp_f32 v205, v205
  v_mov_b32_dpp v235, v254 row_ror:8 row_mask:0x4 bank_mask:0xf
  s_nop 1
  v_mov_b32_dpp v235, v254 row_ror:4 row_mask:0x8 bank_mask:0xf
  v_mfma_f32_16x16x32_bf16 v[208:211], a[136:139], a[88:91], v[208:211]
  v_cvt_pk_bf16_f32 v202, v204, v205
  v_mov_b32_dpp v232, v235 row_newbcast:0 row_mask:0xf bank_mask:0xf
  v_mov_b32_dpp v233, v235 row_newbcast:1 row_mask:0xf bank_mask:0xf
  v_mfma_f32_16x16x32_bf16 v[208:211], a[140:143], a[92:95], v[208:211]
  v_exp_f32 v206, v206
  v_mov_b32_dpp v234, v235 row_newbcast:2 row_mask:0xf bank_mask:0xf
  v_mov_b32_dpp v235, v235 row_newbcast:3 row_mask:0xf bank_mask:0xf
  v_mfma_f32_16x16x32_bf16 v[212:215], a[156:159], a[92:95], v[236:239]
  v_pk_mul_f32 v[128:129], v[128:129], v[232:233]
  v_pk_mul_f32 v[130:131], v[130:131], v[234:235]
  v_pk_mul_f32 v[132:133], v[132:133], v[232:233]
  v_pk_mul_f32 v[134:135], v[134:135], v[234:235]
  v_pk_mul_f32 v[136:137], v[136:137], v[232:233]
  v_pk_mul_f32 v[138:139], v[138:139], v[234:235]
  v_pk_mul_f32 v[140:141], v[140:141], v[232:233]
  v_pk_mul_f32 v[142:143], v[142:143], v[234:235]
  v_cvt_pk_bf16_f32 v141, v137, v141
  v_mfma_f32_16x16x32_bf16 v[212:215], a[152:155], a[88:91], v[212:215]
  v_exp_f32 v207, v207
  v_cvt_pk_bf16_f32 v137, v136, v140
  v_mfma_f32_16x16x32_bf16 v[212:215], a[148:151], a[84:87], v[212:215]
  v_cvt_pk_bf16_f32 v203, v206, v207
  v_cvt_pk_bf16_f32 v136, v128, v132
  v_mfma_f32_16x16x32_bf16 v[212:215], a[144:147], a[80:83], v[212:215]
  v_exp_f32 v208, v208
  v_cvt_pk_bf16_f32 v140, v129, v133
  v_mfma_f32_16x16x32_bf16 v[144:147], v[192:195], a[176:179], v[144:147]
  s_waitcnt lgkmcnt(0)
  buffer_store_dwordx4 v[112:115], v245, s[28:31], s42 offen offset:128 nt
  v_cvt_pk_bf16_f32 v143, v139, v143
  v_mfma_f32_16x16x32_bf16 v[144:147], v[196:199], a[208:211], v[144:147]
  v_exp_f32 v209, v209
  v_mfma_f32_16x16x32_bf16 v[148:151], v[196:199], a[212:215], v[148:151]
  v_cvt_pk_bf16_f32 v204, v208, v209
  v_cvt_pk_bf16_f32 v139, v138, v142
  v_cvt_pk_bf16_f32 v138, v130, v134
  v_mfma_f32_16x16x32_bf16 v[148:151], v[192:195], a[180:183], v[148:151]
  v_exp_f32 v210, v210
  v_mfma_f32_16x16x32_bf16 v[152:155], v[192:195], a[184:187], v[152:155]
  ds_write_b128 v255, v[136:139] offset:8192
  v_cvt_pk_bf16_f32 v142, v131, v135
  v_mfma_f32_16x16x32_bf16 v[152:155], v[196:199], a[216:219], v[152:155]
  v_exp_f32 v211, v211
  v_mfma_f32_16x16x32_bf16 v[156:159], v[196:199], a[220:223], v[156:159]
  ds_write_b128 v255, v[140:143] offset:8448
  v_cvt_pk_bf16_f32 v205, v210, v211
  v_mfma_f32_16x16x32_bf16 v[156:159], v[192:195], a[188:191], v[156:159]
  v_exp_f32 v212, v212
  buffer_store_dwordx4 v[116:119], v245, s[28:31], s42 offen offset:2176 nt
  ds_read_b64_tr_b16 v[128:129], v244 offset:8192
  s_add_u32 s42, s42, 4096
  ds_read_b64_tr_b16 v[130:131], v244 offset:8256
  v_exp_f32 v213, v213
  ds_read_b64_tr_b16 v[132:133], v244 offset:9216
  ds_read_b64_tr_b16 v[134:135], v244 offset:9280
  v_cvt_pk_bf16_f32 v206, v212, v213
  v_exp_f32 v214, v214
  v_pk_mul_f32 v[144:145], v[144:145], v[232:233]
  v_pk_mul_f32 v[146:147], v[146:147], v[234:235]
  v_pk_mul_f32 v[148:149], v[148:149], v[232:233]
  v_pk_mul_f32 v[150:151], v[150:151], v[234:235]
  v_pk_mul_f32 v[152:153], v[152:153], v[232:233]
  v_pk_mul_f32 v[154:155], v[154:155], v[234:235]
  v_pk_mul_f32 v[156:157], v[156:157], v[232:233]
  v_pk_mul_f32 v[158:159], v[158:159], v[234:235]
  v_cvt_pk_bf16_f32 v157, v153, v157
  v_exp_f32 v215, v215
  s_nop 0
  v_cvt_pk_bf16_f32 v207, v214, v215
  v_cvt_pk_bf16_f32 v153, v152, v156
  v_cvt_pk_bf16_f32 v152, v144, v148
  v_cvt_pk_bf16_f32 v156, v145, v149
  v_smfmac_f32_16x16x64_bf16 a[244:247], a[232:235], v[200:207], v253
  v_cvt_pk_bf16_f32 v159, v155, v159
  v_mfma_f32_16x16x32_bf16 v[160:163], v[200:203], a[160:163], v[160:163]
  s_waitcnt lgkmcnt(2)
  buffer_store_dwordx4 v[128:131], v245, s[28:31], s42 offen offset:0 nt
  v_mfma_f32_16x16x32_bf16 v[160:163], v[204:207], a[192:195], v[160:163]
  v_cvt_pk_bf16_f32 v155, v154, v158
  v_cvt_pk_bf16_f32 v154, v146, v150
  v_mfma_f32_16x16x32_bf16 v[164:167], v[204:207], a[196:199], v[164:167]
  ds_write_b128 v255, v[152:155] offset:20480
  v_mfma_f32_16x16x32_bf16 v[164:167], v[200:203], a[164:167], v[164:167]
  v_cvt_pk_bf16_f32 v158, v147, v151
  s_nop 0
  v_accvgpr_read_b32 v254, a246
  v_mfma_f32_16x16x32_bf16 v[168:171], v[200:203], a[168:171], v[168:171]
  ds_write_b128 v255, v[156:159] offset:20736
  v_accvgpr_read_b32 v236, a247
  v_mfma_f32_16x16x32_bf16 v[168:171], v[204:207], a[200:203], v[168:171]
  v_add_f32 v254, v236, v254
  v_cmp_nge_f32 vcc, s43, v254
  v_mfma_f32_16x16x32_bf16 v[172:175], v[204:207], a[204:207], v[172:175]
  s_waitcnt lgkmcnt(2)
  buffer_store_dwordx4 v[132:135], v245, s[28:31], s42 offen offset:2048 nt
  v_mfma_f32_16x16x32_bf16 v[172:175], v[200:203], a[172:175], v[172:175]
  ds_read_b64_tr_b16 v[144:145], v244 offset:20480
  ds_read_b64_tr_b16 v[146:147], v244 offset:20544
  v_rcp_f32 v254, v254
  s_or_b64 s[46:47], s[46:47], vcc
  v_mfma_f32_16x16x32_bf16 v[176:179], v[200:203], a[176:179], v[176:179]
  ds_read_b64_tr_b16 v[148:149], v244 offset:21504
  ds_read_b64_tr_b16 v[150:151], v244 offset:21568
  v_mfma_f32_16x16x32_bf16 v[176:179], v[204:207], a[208:211], v[176:179]
  v_mov_b32 v239, v254
  s_nop 1
  v_mov_b32_dpp v239, v254 row_ror:12 row_mask:0x2 bank_mask:0xf
  s_nop 1
  v_mov_b32_dpp v239, v254 row_ror:8 row_mask:0x4 bank_mask:0xf
  v_mfma_f32_16x16x32_bf16 v[180:183], v[204:207], a[212:215], v[180:183]
  s_nop 0
  v_mov_b32_dpp v239, v254 row_ror:4 row_mask:0x8 bank_mask:0xf
  s_nop 1
  v_mov_b32_dpp v236, v239 row_newbcast:0 row_mask:0xf bank_mask:0xf
  v_mfma_f32_16x16x32_bf16 v[180:183], v[200:203], a[180:183], v[180:183]
  v_mov_b32_dpp v237, v239 row_newbcast:1 row_mask:0xf bank_mask:0xf
  v_mov_b32_dpp v238, v239 row_newbcast:2 row_mask:0xf bank_mask:0xf
  v_mov_b32_dpp v239, v239 row_newbcast:3 row_mask:0xf bank_mask:0xf
  v_mfma_f32_16x16x32_bf16 v[184:187], v[200:203], a[184:187], v[184:187]
  v_mfma_f32_16x16x32_bf16 v[184:187], v[204:207], a[216:219], v[184:187]
  v_mfma_f32_16x16x32_bf16 v[188:191], v[204:207], a[220:223], v[188:191]
  v_mfma_f32_16x16x32_bf16 v[188:191], v[200:203], a[188:191], v[188:191]
  s_waitcnt lgkmcnt(2)
  buffer_store_dwordx4 v[144:147], v245, s[28:31], s42 offen offset:128 nt
  s_waitcnt lgkmcnt(0)
  buffer_store_dwordx4 v[148:151], v245, s[28:31], s42 offen offset:2176 nt
  s_add_u32 s42, s42, 4096
  s_and_b32 s45, s39, 0x40000000
  s_add_u32 s42, s42, s45
  v_pk_mul_f32 v[160:161], v[160:161], v[236:237]
  v_pk_mul_f32 v[162:163], v[162:163], v[238:239]
  v_pk_mul_f32 v[164:165], v[164:165], v[236:237]
  v_pk_mul_f32 v[166:167], v[166:167], v[238:239]
  v_pk_mul_f32 v[168:169], v[168:169], v[236:237]
  v_pk_mul_f32 v[170:171], v[170:171], v[238:239]
  v_pk_mul_f32 v[172:173], v[172:173], v[236:237]
  v_pk_mul_f32 v[174:175], v[174:175], v[238:239]
  v_cvt_pk_bf16_f32 v173, v169, v173
  v_cvt_pk_bf16_f32 v169, v168, v172
  v_cvt_pk_bf16_f32 v168, v160, v164
  v_cvt_pk_bf16_f32 v172, v161, v165
  v_cvt_pk_bf16_f32 v175, v171, v175
  v_cvt_pk_bf16_f32 v171, v170, v174
  v_cvt_pk_bf16_f32 v170, v162, v166
  ds_write_b128 v255, v[168:171] offset:10240
  v_cvt_pk_bf16_f32 v174, v163, v167
  ds_write_b128 v255, v[172:175] offset:10496
  ds_read_b64_tr_b16 v[160:161], v244 offset:10240
  ds_read_b64_tr_b16 v[162:163], v244 offset:10304
  ds_read_b64_tr_b16 v[164:165], v244 offset:11264
  ds_read_b64_tr_b16 v[166:167], v244 offset:11328
  v_pk_mul_f32 v[176:177], v[176:177], v[236:237]
  v_pk_mul_f32 v[178:179], v[178:179], v[238:239]
  v_pk_mul_f32 v[180:181], v[180:181], v[236:237]
  v_pk_mul_f32 v[182:183], v[182:183], v[238:239]
  v_pk_mul_f32 v[184:185], v[184:185], v[236:237]
  v_pk_mul_f32 v[186:187], v[186:187], v[238:239]
  v_pk_mul_f32 v[188:189], v[188:189], v[236:237]
  v_pk_mul_f32 v[190:191], v[190:191], v[238:239]
  v_cvt_pk_bf16_f32 v189, v185, v189
  v_cvt_pk_bf16_f32 v185, v184, v188
  v_cvt_pk_bf16_f32 v184, v176, v180
  v_cvt_pk_bf16_f32 v188, v177, v181
  v_cvt_pk_bf16_f32 v191, v187, v191
  v_cvt_pk_bf16_f32 v187, v186, v190
  v_cvt_pk_bf16_f32 v186, v178, v182
  ds_write_b128 v255, v[184:187] offset:22528
  v_cvt_pk_bf16_f32 v190, v179, v183
  ds_write_b128 v255, v[188:191] offset:22784
  ds_read_b64_tr_b16 v[176:177], v244 offset:22528
  ds_read_b64_tr_b16 v[178:179], v244 offset:22592
  ds_read_b64_tr_b16 v[180:181], v244 offset:23552
  ds_read_b64_tr_b16 v[182:183], v244 offset:23616
  s_waitcnt lgkmcnt(8)
  buffer_store_dwordx4 v[160:163], v245, s[28:31], s42 offen offset:0 nt
  s_waitcnt lgkmcnt(6)
  buffer_store_dwordx4 v[164:167], v245, s[28:31], s42 offen offset:2048 nt
  s_waitcnt lgkmcnt(2)
  buffer_store_dwordx4 v[176:179], v245, s[28:31], s42 offen offset:128 nt
  s_waitcnt lgkmcnt(0)
  buffer_store_dwordx4 v[180:183], v245, s[28:31], s42 offen offset:2176 nt
  s_cmp_lg_u64 s[46:47], 0
  s_cselect_b32 s45, 2, 0
  s_or_b32 s51, s51, s45
  s_mov_b64 s[46:47], 0
  s_cmp_eq_u32 s51, 0
  s_cbranch_scc1 L_done
  s_waitcnt vmcnt(0) lgkmcnt(0)
  s_add_u32 s55, s49, 4096
  v_add_u32 v40, s55, v246
  v_add_u32 v41, s55, v247
  s_add_u32 s55, s49, 16384
  v_add_u32 v42, s55, v248
  v_add_u32 v43, s55, v249
  v_add_u32 v44, s55, v250
  v_add_u32 v45, s55, v251
  v_and_b32 v46, 0x7ff, v252
  v_add_u32 v38, s49, v246
  v_add_u32 v39, s49, v247
  v_mov_b32 v212, 0
  v_mov_b32 v213, 0
  v_mov_b32 v214, 0
  v_mov_b32 v215, 0
  v_and_b32 v244, 0x3ff, v244
  v_add_u32 v244, s49, v244
  s_mov_b32 s50, 0
L_s_item:
  s_bitcmp1_b32 s51, s50
  s_cbranch_scc0 L_s_next
  s_cmp_eq_u32 s50, 0
  s_cselect_b32 s53, s56, s58
  s_cselect_b32 s54, s57, s59
  s_add_u32 s24, s4, s53
  s_addc_u32 s25, s5, 0
  s_mov_b32 s26, 188416
  s_add_u32 s28, s10, s53
  s_addc_u32 s29, s11, 0
  s_lshl_b32 s42, s54, 8
  s_cmp_eq_u32 s50, 0
  s_cselect_b32 s62, s35, s39
  s_and_b32 s62, s62, 1
L_s_qb:
  s_add_u32 m0, s49, 0
  s_add_u32 s55, s42, 0
  buffer_load_dwordx4 v46, s[24:27], s55 offen lds
  s_add_u32 m0, s49, 12288
  s_add_u32 s55, s42, 128
  buffer_load_dwordx4 v46, s[24:27], s55 offen lds
  s_add_u32 m0, s49, 1024
  s_add_u32 s55, s42, 2048
  buffer_load_dwordx4 v46, s[24:27], s55 offen lds
  s_add_u32 m0, s49, 13312
  s_add_u32 s55, s42, 2176
  buffer_load_dwordx4 v46, s[24:27], s55 offen lds
  s_waitcnt vmcnt(0)
  ds_read_b128 v[64:67], v38 offset:0
  ds_read_b128 v[68:71], v39 offset:0
  ds_read_b128 v[72:75], v38 offset:12288
  ds_read_b128 v[76:79], v39 offset:12288
  s_waitcnt lgkmcnt(0)
  v_lshlrev_b32 v80, 16, v64
  v_and_b32 v81, 0xffff0000, v64
  v_pk_mul_f32 v[80:81], v[80:81], s[40:41]
  v_cvt_pk_bf16_f32 v64, v80, v81
  v_accvgpr_write_b32 a0, v64
  v_lshlrev_b32 v80, 16, v65
  v_and_b32 v81, 0xffff0000, v65
  v_pk_mul_f32 v[80:81], v[80:81], s[40:41]
  v_cvt_pk_bf16_f32 v65, v80, v81
  v_accvgpr_write_b32 a1, v65
  v_lshlrev_b32 v80, 16, v66
  v_and_b32 v81, 0xffff0000, v66
  v_pk_mul_f32 v[80:81], v[80:81], s[40:41]
  v_cvt_pk_bf16_f32 v66, v80, v81
  v_accvgpr_write_b32 a2, v66
  v_lshlrev_b32 v80, 16, v67
  v_and_b32 v81, 0xffff0000, v67
  v_pk_mul_f32 v[80:81], v[80:81], s[40:41]
  v_cvt_pk_bf16_f32 v67, v80, v81
  v_accvgpr_write_b32 a3, v67
  v_lshlrev_b32 v80, 16, v68
  v_and_b32 v81, 0xffff0000, v68
  v_pk_mul_f32 v[80:81], v[80:81], s[40:41]
  v_cvt_pk_bf16_f32 v68, v80, v81
  v_accvgpr_write_b32 a4, v68
  v_lshlrev_b32 v80, 16, v69
  v_and_b32 v81, 0xffff0000, v69
  v_pk_mul_f32 v[80:81], v[80:81], s[40:41]
  v_cvt_pk_bf16_f32 v69, v80, v81
  v_accvgpr_write_b32 a5, v69
  v_lshlrev_b32 v80, 16, v70
  v_and_b32 v81, 0xffff0000, v70
  v_pk_mul_f32 v[80:81], v[80:81], s[40:41]
  v_cvt_pk_bf16_f32 v70, v80, v81
  v_accvgpr_write_b32 a6, v70
  v_lshlrev_b32 v80, 16, v71
  v_and_b32 v81, 0xffff0000, v71
  v_pk_mul_f32 v[80:81], v[80:81], s[40:41]
  v_cvt_pk_bf16_f32 v71, v80, v81
  v_accvgpr_write_b32 a7, v71
  v_lshlrev_b32 v80, 16, v72
  v_and_b32 v81, 0xffff0000, v72
  v_pk_mul_f32 v[80:81], v[80:81], s[40:41]
  v_cvt_pk_bf16_f32 v72, v80, v81
  v_accvgpr_write_b32 a8, v72
  v_lshlrev_b32 v80, 16, v73
  v_and_b32 v81, 0xffff0000, v73
  v_pk_mul_f32 v[80:81], v[80:81], s[40:41]
  v_cvt_pk_bf16_f32 v73, v80, v81
  v_accvgpr_write_b32 a9, v73
  v_lshlrev_b32 v80, 16, v74
  v_and_b32 v81, 0xffff0000, v74
  v_pk_mul_f32 v[80:81], v[80:81], s[40:41]
  v_cvt_pk_bf16_f32 v74, v80, v81
  v_accvgpr_write_b32 a10, v74
  v_lshlrev_b32 v80, 16, v75
  v_and_b32 v81, 0xffff0000, v75
  v_pk_mul_f32 v[80:81], v[80:81], s[40:41]
  v_cvt_pk_bf16_f32 v75, v80, v81
  v_accvgpr_write_b32 a11, v75
  v_lshlrev_b32 v80, 16, v76
  v_and_b32 v81, 0xffff0000, v76
  v_pk_mul_f32 v[80:81], v[80:81], s[40:41]
  v_cvt_pk_bf16_f32 v76, v80, v81
  v_accvgpr_write_b32 a12, v76
  v_lshlrev_b32 v80, 16, v77
  v_and_b32 v81, 0xffff0000, v77
  v_pk_mul_f32 v[80:81], v[80:81], s[40:41]
  v_cvt_pk_bf16_f32 v77, v80, v81
  v_accvgpr_write_b32 a13, v77
  v_lshlrev_b32 v80, 16, v78
  v_and_b32 v81, 0xffff0000, v78
  v_pk_mul_f32 v[80:81], v[80:81], s[40:41]
  v_cvt_pk_bf16_f32 v78, v80, v81
  v_accvgpr_write_b32 a14, v78
  v_lshlrev_b32 v80, 16, v79
  v_and_b32 v81, 0xffff0000, v79
  v_pk_mul_f32 v[80:81], v[80:81], s[40:41]
  v_cvt_pk_bf16_f32 v79, v80, v81
  v_accvgpr_write_b32 a15, v79
  v_mov_b32 v48, 0xff800000
  s_mov_b32 s61, s53
  s_mov_b32 s63, 0
L_s_p1:
  s_add_u32 m0, s49, 4096
  s_add_u32 s55, s61, 0
  buffer_load_dwordx4 v46, s[16:19], s55 offen lds
  s_add_u32 m0, s49, 8192
  s_add_u32 s55, s61, 128
  buffer_load_dwordx4 v46, s[16:19], s55 offen lds
  s_add_u32 m0, s49, 5120
  s_add_u32 s55, s61, 2048
  buffer_load_dwordx4 v46, s[16:19], s55 offen lds
  s_add_u32 m0, s49, 9216
  s_add_u32 s55, s61, 2176
  buffer_load_dwordx4 v46, s[16:19], s55 offen lds
  s_add_u32 m0, s49, 6144
  s_add_u32 s55, s61, 4096
  buffer_load_dwordx4 v46, s[16:19], s55 offen lds
  s_add_u32 m0, s49, 10240
  s_add_u32 s55, s61, 4224
  buffer_load_dwordx4 v46, s[16:19], s55 offen lds
  s_add_u32 m0, s49, 7168
  s_add_u32 s55, s61, 6144
  buffer_load_dwordx4 v46, s[16:19], s55 offen lds
  s_add_u32 m0, s49, 11264
  s_add_u32 s55, s61, 6272
  buffer_load_dwordx4 v46, s[16:19], s55 offen lds
  s_waitcnt vmcnt(0)
  ds_read_b128 a[96:99], v40 offset:0
  ds_read_b128 a[100:103], v41 offset:0
  ds_read_b128 a[104:107], v40 offset:4096
  ds_read_b128 a[108:111], v41 offset:4096
  ds_read_b128 a[112:115], v40 offset:2048
  ds_read_b128 a[116:119], v41 offset:2048
  ds_read_b128 a[120:123], v40 offset:6144
  ds_read_b128 a[124:127], v41 offset:6144
  s_waitcnt lgkmcnt(0)
  v_mfma_f32_16x16x32_bf16 v[192:195], a[96:99], a[0:3], 0
  v_mfma_f32_16x16x32_bf16 v[192:195], a[100:103], a[4:7], v[192:195]
  v_mfma_f32_16x16x32_bf16 v[192:195], a[104:107], a[8:11], v[192:195]
  v_mfma_f32_16x16x32_bf16 v[192:195], a[108:111], a[12:15], v[192:195]
  v_mfma_f32_16x16x32_bf16 v[196:199], a[112:115], a[0:3], 0
  v_mfma_f32_16x16x32_bf16 v[196:199], a[116:119], a[4:7], v[196:199]
  v_mfma_f32_16x16x32_bf16 v[196:199], a[120:123], a[8:11], v[196:199]
  v_mfma_f32_16x16x32_bf16 v[196:199], a[124:127], a[12:15], v[196:199]
  s_nop 7
  v_max3_f32 v48, v48, v192, v193
  v_max3_f32 v48, v48, v194, v195
  v_max3_f32 v48, v48, v196, v197
  v_max3_f32 v48, v48, v198, v199
  s_add_u32 s61, s61, 8192
  s_add_u32 s63, s63, 1
  s_cmp_lt_u32 s63, 23
  s_cbranch_scc1 L_s_p1
  v_mov_b32 v49, v48
  v_mov_b32 v50, v48
  v_mov_b32 v51, v48
  v_max3_f32 v48, v48, v49, v50
  v_max_f32 v48, v48, v51
  v_mov_b32 v49, v48
  s_nop 1
  v_permlane16_swap_b32 v48, v49
  v_max_f32 v48, v48, v49
  v_mov_b32 v49, v48
  s_nop 1
  v_permlane32_swap_b32 v48, v49
  v_min_f32 v219, -v48, -v49
  v_subrev_f32 v216, 0x40a00000, v219
  v_subrev_f32 v217, 0x40a00000, v219
  v_subrev_f32 v218, 0x40a00000, v219
  v_subrev_f32 v219, 0x40a00000, v219
  v_mov_b32 v0, 0
  v_mov_b32 v1, 0
  v_mov_b32 v2, 0
  v_mov_b32 v3, 0
  v_mov_b32 v4, 0
  v_mov_b32 v5, 0
  v_mov_b32 v6, 0
  v_mov_b32 v7, 0
  v_mov_b32 v8, 0
  v_mov_b32 v9, 0
  v_mov_b32 v10, 0
  v_mov_b32 v11, 0
  v_mov_b32 v12, 0
  v_mov_b32 v13, 0
  v_mov_b32 v14, 0
  v_mov_b32 v15, 0
  v_mov_b32 v16, 0
  v_mov_b32 v17, 0
  v_mov_b32 v18, 0
  v_mov_b32 v19, 0
  v_mov_b32 v20, 0
  v_mov_b32 v21, 0
  v_mov_b32 v22, 0
  v_mov_b32 v23, 0
  v_mov_b32 v24, 0
  v_mov_b32 v25, 0
  v_mov_b32 v26, 0
  v_mov_b32 v27, 0
  v_mov_b32 v28, 0
  v_mov_b32 v29, 0
  v_mov_b32 v30, 0
  v_mov_b32 v31, 0
  v_accvgpr_write_b32 a236, 0
  v_accvgpr_write_b32 a237, 0
  v_accvgpr_write_b32 a238, 0
  v_accvgpr_write_b32 a239, 0
  s_mov_b32 s61, s53
  s_mov_b32 s63, 0
L_s_p2:
  s_add_u32 m0, s49, 4096
  s_add_u32 s55, s61, 0
  buffer_load_dwordx4 v46, s[16:19], s55 offen lds
  s_add_u32 m0, s49, 8192
  s_add_u32 s55, s61, 128
  buffer_load_dwordx4 v46, s[16:19], s55 offen lds
  s_add_u32 m0, s49, 5120
  s_add_u32 s55, s61, 2048
  buffer_load_dwordx4 v46, s[16:19], s55 offen lds
  s_add_u32 m0, s49, 9216
  s_add_u32 s55, s61, 2176
  buffer_load_dwordx4 v46, s[16:19], s55 offen lds
  s_add_u32 m0, s49, 6144
  s_add_u32 s55, s61, 4096
  buffer_load_dwordx4 v46, s[16:19], s55 offen lds
  s_add_u32 m0, s49, 10240
  s_add_u32 s55, s61, 4224
  buffer_load_dwordx4 v46, s[16:19], s55 offen lds
  s_add_u32 m0, s49, 7168
  s_add_u32 s55, s61, 6144
  buffer_load_dwordx4 v46, s[16:19], s55 offen lds
  s_add_u32 m0, s49, 11264
  s_add_u32 s55, s61, 6272
  buffer_load_dwordx4 v46, s[16:19], s55 offen lds
  s_add_u32 m0, s49, 16384
  s_add_u32 s55, s61, 0
  buffer_load_dwordx4 v46, s[20:23], s55 offen lds
  s_add_u32 m0, s49, 20480
  s_add_u32 s55, s61, 128
  buffer_load_dwordx4 v46, s[20:23], s55 offen lds
  s_add_u32 m0, s49, 17408
  s_add_u32 s55, s61, 2048
  buffer_load_dwordx4 v46, s[20:23], s55 offen lds
  s_add_u32 m0, s49, 21504
  s_add_u32 s55, s61, 2176
  buffer_load_dwordx4 v46, s[20:23], s55 offen lds
  s_add_u32 m0, s49, 18432
  s_add_u32 s55, s61, 4096
  buffer_load_dwordx4 v46, s[20:23], s55 offen lds
  s_add_u32 m0, s49, 22528
  s_add_u32 s55, s61, 4224
  buffer_load_dwordx4 v46, s[20:23], s55 offen lds
  s_add_u32 m0, s49, 19456
  s_add_u32 s55, s61, 6144
  buffer_load_dwordx4 v46, s[20:23], s55 offen lds
  s_add_u32 m0, s49, 23552
  s_add_u32 s55, s61, 6272
  buffer_load_dwordx4 v46, s[20:23], s55 offen lds
  s_waitcnt vmcnt(0)
  ds_read_b128 a[96:99], v40 offset:0
  ds_read_b128 a[100:103], v41 offset:0
  ds_read_b128 a[104:107], v40 offset:4096
  ds_read_b128 a[108:111], v41 offset:4096
  ds_read_b128 a[112:115], v40 offset:2048
  ds_read_b128 a[116:119], v41 offset:2048
  ds_read_b128 a[120:123], v40 offset:6144
  ds_read_b128 a[124:127], v41 offset:6144
  s_waitcnt lgkmcnt(0)
  ds_read_b64_tr_b16 a[160:161], v42 offset:0
  ds_read_b64_tr_b16 a[162:163], v42 offset:2048
  ds_read_b64_tr_b16 a[164:165], v43 offset:0
  ds_read_b64_tr_b16 a[166:167], v43 offset:2048
  ds_read_b64_tr_b16 a[168:169], v44 offset:0
  ds_read_b64_tr_b16 a[170:171], v44 offset:2048
  ds_read_b64_tr_b16 a[172:173], v45 offset:0
  ds_read_b64_tr_b16 a[174:175], v45 offset:2048
  s_waitcnt lgkmcnt(0)
  ds_read_b64_tr_b16 a[176:177], v42 offset:4096
  ds_read_b64_tr_b16 a[178:179], v42 offset:6144
  ds_read_b64_tr_b16 a[180:181], v43 offset:4096
  ds_read_b64_tr_b16 a[182:183], v43 offset:6144
  ds_read_b64_tr_b16 a[184:185], v44 offset:4096
  ds_read_b64_tr_b16 a[186:187], v44 offset:6144
  ds_read_b64_tr_b16 a[188:189], v45 offset:4096
  ds_read_b64_tr_b16 a[190:191], v45 offset:6144
  v_mfma_f32_16x16x32_bf16 v[192:195], a[96:99], a[0:3], v[216:219]
  v_mfma_f32_16x16x32_bf16 v[192:195], a[100:103], a[4:7], v[192:195]
  v_mfma_f32_16x16x32_bf16 v[192:195], a[104:107], a[8:11], v[192:195]
  v_mfma_f32_16x16x32_bf16 v[192:195], a[108:111], a[12:15], v[192:195]
  v_mfma_f32_16x16x32_bf16 v[196:199], a[112:115], a[0:3], v[216:219]
  v_mfma_f32_16x16x32_bf16 v[196:199], a[116:119], a[4:7], v[196:199]
  v_mfma_f32_16x16x32_bf16 v[196:199], a[120:123], a[8:11], v[196:199]
  v_mfma_f32_16x16x32_bf16 v[196:199], a[124:127], a[12:15], v[196:199]
  s_nop 7
  v_exp_f32 v192, v192
  v_exp_f32 v193, v193
  v_exp_f32 v194, v194
  v_exp_f32 v195, v195
  v_exp_f32 v196, v196
  v_exp_f32 v197, v197
  v_exp_f32 v198, v198
  v_exp_f32 v199, v199
  s_nop 0
  v_cvt_pk_bf16_f32 v208, v192, v193
  v_cvt_pk_bf16_f32 v209, v194, v195
  v_cvt_pk_bf16_f32 v210, v196, v197
  v_cvt_pk_bf16_f32 v211, v198, v199
  s_waitcnt lgkmcnt(0)
  s_nop 0
  v_mfma_f32_16x16x32_bf16 v[0:3], v[208:211], a[160:163], v[0:3]
  v_mfma_f32_16x16x32_bf16 v[4:7], v[208:211], a[164:167], v[4:7]
  v_mfma_f32_16x16x32_bf16 v[8:11], v[208:211], a[168:171], v[8:11]
  v_mfma_f32_16x16x32_bf16 v[12:15], v[208:211], a[172:175], v[12:15]
  v_mfma_f32_16x16x32_bf16 v[16:19], v[208:211], a[176:179], v[16:19]
  v_mfma_f32_16x16x32_bf16 v[20:23], v[208:211], a[180:183], v[20:23]
  v_mfma_f32_16x16x32_bf16 v[24:27], v[208:211], a[184:187], v[24:27]
  v_mfma_f32_16x16x32_bf16 v[28:31], v[208:211], a[188:191], v[28:31]
  v_smfmac_f32_16x16x64_bf16 a[236:239], a[224:227], v[208:215], v253
  s_add_u32 s61, s61, 8192
  s_add_u32 s63, s63, 1
  s_cmp_lt_u32 s63, 23
  s_cbranch_scc1 L_s_p2
  s_nop 11
  v_accvgpr_read_b32 v254, a236
  v_accvgpr_read_b32 v240, a237
  v_add_f32 v254, v240, v254
  v_cmp_nge_f32 vcc, s43, v254
  v_rcp_f32 v254, v254
  s_or_b64 s[46:47], s[46:47], vcc
  v_mov_b32 v243, v254
  s_nop 1
  v_mov_b32_dpp v243, v254 row_ror:12 row_mask:0x2 bank_mask:0xf
  s_nop 1
  v_mov_b32_dpp v243, v254 row_ror:8 row_mask:0x4 bank_mask:0xf
  s_nop 1
  v_mov_b32_dpp v243, v254 row_ror:4 row_mask:0x8 bank_mask:0xf
  s_nop 1
  v_mov_b32_dpp v240, v243 row_newbcast:0 row_mask:0xf bank_mask:0xf
  v_mov_b32_dpp v241, v243 row_newbcast:1 row_mask:0xf bank_mask:0xf
  v_mov_b32_dpp v242, v243 row_newbcast:2 row_mask:0xf bank_mask:0xf
  v_mov_b32_dpp v243, v243 row_newbcast:3 row_mask:0xf bank_mask:0xf
  v_pk_mul_f32 v[0:1], v[0:1], v[240:241]
  v_pk_mul_f32 v[2:3], v[2:3], v[242:243]
  v_pk_mul_f32 v[4:5], v[4:5], v[240:241]
  v_pk_mul_f32 v[6:7], v[6:7], v[242:243]
  v_pk_mul_f32 v[8:9], v[8:9], v[240:241]
  v_pk_mul_f32 v[10:11], v[10:11], v[242:243]
  v_pk_mul_f32 v[12:13], v[12:13], v[240:241]
  v_pk_mul_f32 v[14:15], v[14:15], v[242:243]
  v_pk_mul_f32 v[16:17], v[16:17], v[240:241]
  v_pk_mul_f32 v[18:19], v[18:19], v[242:243]
  v_pk_mul_f32 v[20:21], v[20:21], v[240:241]
  v_pk_mul_f32 v[22:23], v[22:23], v[242:243]
  v_pk_mul_f32 v[24:25], v[24:25], v[240:241]
  v_pk_mul_f32 v[26:27], v[26:27], v[242:243]
  v_pk_mul_f32 v[28:29], v[28:29], v[240:241]
  v_pk_mul_f32 v[30:31], v[30:31], v[242:243]
  v_cvt_pk_bf16_f32 v13, v9, v13
  v_cvt_pk_bf16_f32 v9, v8, v12
  v_cvt_pk_bf16_f32 v8, v0, v4
  v_cvt_pk_bf16_f32 v12, v1, v5
  v_cvt_pk_bf16_f32 v15, v11, v15
  v_cvt_pk_bf16_f32 v11, v10, v14
  v_cvt_pk_bf16_f32 v10, v2, v6
  ds_write_b128 v255, v[8:11] offset:0
  v_cvt_pk_bf16_f32 v14, v3, v7
  v_cvt_pk_bf16_f32 v29, v25, v29
  v_cvt_pk_bf16_f32 v25, v24, v28
  v_cvt_pk_bf16_f32 v24, v16, v20
  ds_write_b128 v255, v[12:15] offset:256
  v_cvt_pk_bf16_f32 v28, v17, v21
  v_cvt_pk_bf16_f32 v31, v27, v31
  v_cvt_pk_bf16_f32 v27, v26, v30
  v_cvt_pk_bf16_f32 v26, v18, v22
  ds_write_b128 v255, v[24:27] offset:12288
  v_cvt_pk_bf16_f32 v30, v19, v23
  ds_write_b128 v255, v[28:31] offset:12544
  ds_read_b64_tr_b16 v[0:1], v244 offset:0
  ds_read_b64_tr_b16 v[2:3], v244 offset:64
  ds_read_b64_tr_b16 v[4:5], v244 offset:12288
  ds_read_b64_tr_b16 v[6:7], v244 offset:12352
  ds_read_b64_tr_b16 v[16:17], v244 offset:1024
  ds_read_b64_tr_b16 v[18:19], v244 offset:1088
  ds_read_b64_tr_b16 v[20:21], v244 offset:13312
  ds_read_b64_tr_b16 v[22:23], v244 offset:13376
  s_waitcnt lgkmcnt(0)
  buffer_store_dwordx4 v[0:3], v245, s[28:31], s42 offen offset:0 nt
  buffer_store_dwordx4 v[4:7], v245, s[28:31], s42 offen offset:128 nt
  buffer_store_dwordx4 v[16:19], v245, s[28:31], s42 offen offset:2048 nt
  buffer_store_dwordx4 v[20:23], v245, s[28:31], s42 offen offset:2176 nt
  s_waitcnt vmcnt(0)
  s_add_u32 s42, s42, 4096
  s_add_u32 s62, s62, 1
  s_cmp_lt_u32 s62, 6
  s_cbranch_scc1 L_s_qb
L_s_next:
  s_add_u32 s50, s50, 1
  s_cmp_lt_u32 s50, 2
  s_cbranch_scc1 L_s_item
L_done:
L_exit:
  s_endpgm
L_hA:
  s_bitcmp1_b32 s32, 0
  s_cbranch_scc1 L_hA_help
  s_mov_b32 s48, 0
  s_add_u32 s45, s49, 34816
  v_and_b32 v244, 0x3ff, v255
  v_add_u32 v244, s45, v244
L_hA_own:
  v_mfma_f32_16x16x32_bf16 v[24:27], v[196:199], a[216:219], v[24:27]
  v_exp_f32 v211, v211
  v_mfma_f32_16x16x32_bf16 v[28:31], v[196:199], a[220:223], v[28:31]
  v_cvt_pk_bf16_f32 v205, v210, v211
  v_mfma_f32_16x16x32_bf16 v[28:31], v[192:195], a[188:191], v[28:31]
  v_exp_f32 v212, v212
  v_mfma_f32_16x16x32_bf16 v[192:195], a[96:99], a[32:35], v[224:227]
  ds_read_b128 v[240:243], v255 offset:0
  v_mfma_f32_16x16x32_bf16 v[192:195], a[100:103], a[36:39], v[192:195]
  v_exp_f32 v213, v213
  v_mfma_f32_16x16x32_bf16 v[192:195], a[104:107], a[40:43], v[192:195]
  v_cvt_pk_bf16_f32 v206, v212, v213
  v_mfma_f32_16x16x32_bf16 v[192:195], a[108:111], a[44:47], v[192:195]
  s_add_u32 m0, s38, 32768
  v_exp_f32 v214, v214
  v_mfma_f32_16x16x32_bf16 v[196:199], a[124:127], a[44:47], v[224:227]
  buffer_load_dwordx4 v252, s[16:19], s33 offen nt lds
  v_mfma_f32_16x16x32_bf16 v[196:199], a[120:123], a[40:43], v[196:199]
  v_exp_f32 v215, v215
  v_mfma_f32_16x16x32_bf16 v[196:199], a[116:119], a[36:39], v[196:199]
  v_cvt_pk_bf16_f32 v207, v214, v215
  v_mfma_f32_16x16x32_bf16 v[196:199], a[112:115], a[32:35], v[196:199]
  v_exp_f32 v192, v192
  v_smfmac_f32_16x16x64_bf16 a[236:239], a[232:235], v[200:207], v253
  s_waitcnt lgkmcnt(0)
  v_lshlrev_b32 v254, 16, v240
  v_mfma_f32_16x16x32_bf16 v[32:35], v[200:203], a[160:163], v[32:35]
  v_and_b32 v240, 0xffff0000, v240
  v_mul_f32 v254, s40, v254
  v_mfma_f32_16x16x32_bf16 v[32:35], v[204:207], a[192:195], v[32:35]
  v_exp_f32 v193, v193
  v_mfma_f32_16x16x32_bf16 v[36:39], v[204:207], a[196:199], v[36:39]
  v_cvt_pk_bf16_f32 v192, v192, v193
  v_mul_f32 v240, s40, v240
  v_mfma_f32_16x16x32_bf16 v[36:39], v[200:203], a[164:167], v[36:39]
  s_add_u32 m0, s38, 36736
  v_exp_f32 v194, v194
  v_mfma_f32_16x16x32_bf16 v[40:43], v[200:203], a[168:171], v[40:43]
  buffer_load_dwordx4 v252, s[16:19], s33 offen offset:128 nt lds
  v_mfma_f32_16x16x32_bf16 v[40:43], v[204:207], a[200:203], v[40:43]
  v_exp_f32 v195, v195
  v_mfma_f32_16x16x32_bf16 v[44:47], v[204:207], a[204:207], v[44:47]
  v_cvt_pk_bf16_f32 v193, v194, v195
  v_cvt_pk_bf16_f32 v240, v254, v240
  v_mfma_f32_16x16x32_bf16 v[44:47], v[200:203], a[172:175], v[44:47]
  v_exp_f32 v196, v196
  v_mfma_f32_16x16x32_bf16 v[208:211], a[128:131], a[32:35], v[224:227]
  v_lshlrev_b32 v254, 16, v241
  v_and_b32 v241, 0xffff0000, v241
  v_mfma_f32_16x16x32_bf16 v[208:211], a[132:135], a[36:39], v[208:211]
  v_exp_f32 v197, v197
  v_mfma_f32_16x16x32_bf16 v[208:211], a[136:139], a[40:43], v[208:211]
  v_cvt_pk_bf16_f32 v194, v196, v197
  v_mul_f32 v254, s40, v254
  v_mfma_f32_16x16x32_bf16 v[208:211], a[140:143], a[44:47], v[208:211]
  s_add_u32 m0, s38, 40960
  v_exp_f32 v198, v198
  v_mfma_f32_16x16x32_bf16 v[212:215], a[156:159], a[44:47], v[224:227]
  buffer_load_dwordx4 v252, s[20:23], s33 offen nt lds
  v_mfma_f32_16x16x32_bf16 v[212:215], a[152:155], a[40:43], v[212:215]
  v_exp_f32 v199, v199
  v_mfma_f32_16x16x32_bf16 v[212:215], a[148:151], a[36:39], v[212:215]
  v_cvt_pk_bf16_f32 v195, v198, v199
  v_mul_f32 v241, s40, v241
  v_mfma_f32_16x16x32_bf16 v[212:215], a[144:147], a[32:35], v[212:215]
  v_exp_f32 v208, v208
  v_mfma_f32_16x16x32_bf16 v[48:51], v[200:203], a[176:179], v[48:51]
  v_cvt_pk_bf16_f32 v241, v254, v241
  v_lshlrev_b32 v254, 16, v242
  v_mfma_f32_16x16x32_bf16 v[48:51], v[204:207], a[208:211], v[48:51]
  v_exp_f32 v209, v209
  v_mfma_f32_16x16x32_bf16 v[52:55], v[204:207], a[212:215], v[52:55]
  v_cvt_pk_bf16_f32 v196, v208, v209
  v_and_b32 v242, 0xffff0000, v242
  v_mfma_f32_16x16x32_bf16 v[52:55], v[200:203], a[180:183], v[52:55]
  s_add_u32 m0, s38, 44928
  v_exp_f32 v210, v210
  v_mfma_f32_16x16x32_bf16 v[56:59], v[200:203], a[184:187], v[56:59]
  buffer_load_dwordx4 v252, s[20:23], s33 offen offset:128 nt lds
  v_mfma_f32_16x16x32_bf16 v[56:59], v[204:207], a[216:219], v[56:59]
  s_add_u32 s34, s34, 1
  v_exp_f32 v211, v211
  v_mfma_f32_16x16x32_bf16 v[60:63], v[204:207], a[220:223], v[60:63]
  s_add_u32 s33, s33, 8192
  v_cvt_pk_bf16_f32 v197, v210, v211
  v_mul_f32 v254, s40, v254
  v_mfma_f32_16x16x32_bf16 v[60:63], v[200:203], a[188:191], v[60:63]
  v_exp_f32 v212, v212
  v_mfma_f32_16x16x32_bf16 v[200:203], a[96:99], a[48:51], v[228:231]
  v_mul_f32 v242, s40, v242
  v_cvt_pk_bf16_f32 v242, v254, v242
  v_mfma_f32_16x16x32_bf16 v[200:203], a[100:103], a[52:55], v[200:203]
  v_exp_f32 v213, v213
  v_mfma_f32_16x16x32_bf16 v[200:203], a[104:107], a[56:59], v[200:203]
  v_cvt_pk_bf16_f32 v198, v212, v213
  v_lshlrev_b32 v254, 16, v243
  v_mfma_f32_16x16x32_bf16 v[200:203], a[108:111], a[60:63], v[200:203]
  s_add_u32 m0, s38, 49152
  v_exp_f32 v214, v214
  v_mfma_f32_16x16x32_bf16 v[204:207], a[124:127], a[60:63], v[228:231]
  buffer_load_dwordx4 v252, s[16:19], s33 offen nt lds
  v_mfma_f32_16x16x32_bf16 v[204:207], a[120:123], a[56:59], v[204:207]
  v_exp_f32 v215, v215
  v_mfma_f32_16x16x32_bf16 v[204:207], a[116:119], a[52:55], v[204:207]
  v_cvt_pk_bf16_f32 v199, v214, v215
  v_and_b32 v243, 0xffff0000, v243
  v_mfma_f32_16x16x32_bf16 v[204:207], a[112:115], a[48:51], v[204:207]
  v_exp_f32 v200, v200
  v_smfmac_f32_16x16x64_bf16 a[240:243], a[228:231], v[192:199], v253
  v_mul_f32 v254, s40, v254
  v_mfma_f32_16x16x32_bf16 v[64:67], v[192:195], a[160:163], v[64:67]
  v_mul_f32 v243, s40, v243
  v_cvt_pk_bf16_f32 v243, v254, v243
  v_mfma_f32_16x16x32_bf16 v[64:67], v[196:199], a[192:195], v[64:67]
  v_exp_f32 v201, v201
  v_mfma_f32_16x16x32_bf16 v[68:71], v[196:199], a[196:199], v[68:71]
  ds_write_b128 v255, v[240:243] offset:0
  v_cvt_pk_bf16_f32 v200, v200, v201
  v_mfma_f32_16x16x32_bf16 v[68:71], v[192:195], a[164:167], v[68:71]
  s_add_u32 m0, s38, 53120
  v_exp_f32 v202, v202
  v_mfma_f32_16x16x32_bf16 v[72:75], v[192:195], a[168:171], v[72:75]
  buffer_load_dwordx4 v252, s[16:19], s33 offen offset:128 nt lds
  v_mfma_f32_16x16x32_bf16 v[72:75], v[196:199], a[200:203], v[72:75]
  v_exp_f32 v203, v203
  v_mfma_f32_16x16x32_bf16 v[76:79], v[196:199], a[204:207], v[76:79]
  ds_read_b128 v[240:243], v255 offset:12288
  v_cvt_pk_bf16_f32 v201, v202, v203
  v_mfma_f32_16x16x32_bf16 v[76:79], v[192:195], a[172:175], v[76:79]
  v_exp_f32 v204, v204
  v_mfma_f32_16x16x32_bf16 v[208:211], a[128:131], a[48:51], v[228:231]
  v_mfma_f32_16x16x32_bf16 v[208:211], a[132:135], a[52:55], v[208:211]
  v_exp_f32 v205, v205
  v_mfma_f32_16x16x32_bf16 v[208:211], a[136:139], a[56:59], v[208:211]
  v_cvt_pk_bf16_f32 v202, v204, v205
  v_mfma_f32_16x16x32_bf16 v[208:211], a[140:143], a[60:63], v[208:211]
  s_add_u32 m0, s38, 57344
  v_exp_f32 v206, v206
  v_mfma_f32_16x16x32_bf16 v[212:215], a[156:159], a[60:63], v[228:231]
  buffer_load_dwordx4 v252, s[20:23], s33 offen nt lds
  v_mfma_f32_16x16x32_bf16 v[212:215], a[152:155], a[56:59], v[212:215]
  v_exp_f32 v207, v207
  v_mfma_f32_16x16x32_bf16 v[212:215], a[148:151], a[52:55], v[212:215]
  v_cvt_pk_bf16_f32 v203, v206, v207
  s_waitcnt lgkmcnt(0)
  v_lshlrev_b32 v254, 16, v240
  v_mfma_f32_16x16x32_bf16 v[212:215], a[144:147], a[48:51], v[212:215]
  v_exp_f32 v208, v208
  v_mfma_f32_16x16x32_bf16 v[80:83], v[192:195], a[176:179], v[80:83]
  v_and_b32 v240, 0xffff0000, v240
  v_mul_f32 v254, s40, v254
  v_mfma_f32_16x16x32_bf16 v[80:83], v[196:199], a[208:211], v[80:83]
  v_exp_f32 v209, v209
  v_mfma_f32_16x16x32_bf16 v[84:87], v[196:199], a[212:215], v[84:87]
  v_cvt_pk_bf16_f32 v204, v208, v209
  v_mul_f32 v240, s40, v240
  v_mfma_f32_16x16x32_bf16 v[84:87], v[192:195], a[180:183], v[84:87]
  s_add_u32 m0, s38, 61312
  v_exp_f32 v210, v210
  v_mfma_f32_16x16x32_bf16 v[88:91], v[192:195], a[184:187], v[88:91]
  buffer_load_dwordx4 v252, s[20:23], s33 offen offset:128 nt lds
  v_mfma_f32_16x16x32_bf16 v[88:91], v[196:199], a[216:219], v[88:91]
  s_add_u32 s34, s34, 1
  v_exp_f32 v211, v211
  v_mfma_f32_16x16x32_bf16 v[92:95], v[196:199], a[220:223], v[92:95]
  s_add_u32 s33, s33, 8192
  v_cvt_pk_bf16_f32 v205, v210, v211
  v_cvt_pk_bf16_f32 v240, v254, v240
  v_mfma_f32_16x16x32_bf16 v[92:95], v[192:195], a[188:191], v[92:95]
  s_waitcnt vmcnt(8)
  v_exp_f32 v212, v212
  v_mfma_f32_16x16x32_bf16 v[192:195], a[96:99], a[64:67], v[232:235]
  s_barrier
  v_mfma_f32_16x16x32_bf16 v[192:195], a[100:103], a[68:71], v[192:195]
  v_exp_f32 v213, v213
  v_mfma_f32_16x16x32_bf16 v[192:195], a[104:107], a[72:75], v[192:195]
  v_cvt_pk_bf16_f32 v206, v212, v213
  v_lshlrev_b32 v254, 16, v241
  v_mfma_f32_16x16x32_bf16 v[192:195], a[108:111], a[76:79], v[192:195]
  s_mov_b32 m0, s37
  v_exp_f32 v214, v214
  v_mfma_f32_16x16x32_bf16 v[196:199], a[124:127], a[76:79], v[232:235]
  buffer_load_dwordx4 v252, s[24:27], s36 offen nt lds
  v_mfma_f32_16x16x32_bf16 v[196:199], a[120:123], a[72:75], v[196:199]
  v_exp_f32 v215, v215
  v_mfma_f32_16x16x32_bf16 v[196:199], a[116:119], a[68:71], v[196:199]
  v_cvt_pk_bf16_f32 v207, v214, v215
  v_and_b32 v241, 0xffff0000, v241
  v_mfma_f32_16x16x32_bf16 v[196:199], a[112:115], a[64:67], v[196:199]
  v_exp_f32 v192, v192
  v_smfmac_f32_16x16x64_bf16 a[240:243], a[232:235], v[200:207], v253
  v_mul_f32 v254, s40, v254
  v_mfma_f32_16x16x32_bf16 v[96:99], v[200:203], a[160:163], v[96:99]
  v_mul_f32 v241, s40, v241
  v_cvt_pk_bf16_f32 v241, v254, v241
  v_mfma_f32_16x16x32_bf16 v[96:99], v[204:207], a[192:195], v[96:99]
  v_exp_f32 v193, v193
  v_mfma_f32_16x16x32_bf16 v[100:103], v[204:207], a[196:199], v[100:103]
  v_cvt_pk_bf16_f32 v192, v192, v193
  v_lshlrev_b32 v254, 16, v242
  v_mfma_f32_16x16x32_bf16 v[100:103], v[200:203], a[164:167], v[100:103]
  v_exp_f32 v194, v194
  v_mfma_f32_16x16x32_bf16 v[104:107], v[200:203], a[168:171], v[104:107]
  ds_read_b128 a[96:99], v246 offset:0
  v_and_b32 v242, 0xffff0000, v242
  v_mfma_f32_16x16x32_bf16 v[104:107], v[204:207], a[200:203], v[104:107]
  v_exp_f32 v195, v195
  v_mfma_f32_16x16x32_bf16 v[108:111], v[204:207], a[204:207], v[108:111]
  ds_read_b128 a[100:103], v247 offset:0
  v_cvt_pk_bf16_f32 v193, v194, v195
  v_mfma_f32_16x16x32_bf16 v[108:111], v[200:203], a[172:175], v[108:111]
  v_exp_f32 v196, v196
  v_mfma_f32_16x16x32_bf16 v[208:211], a[128:131], a[64:67], v[232:235]
  ds_read_b128 a[104:107], v246 offset:4096
  v_mul_f32 v254, s40, v254
  v_mfma_f32_16x16x32_bf16 v[208:211], a[132:135], a[68:71], v[208:211]
  v_exp_f32 v197, v197
  v_mfma_f32_16x16x32_bf16 v[208:211], a[136:139], a[72:75], v[208:211]
  ds_read_b128 a[248:251], v244 offset:0
  v_cvt_pk_bf16_f32 v194, v196, v197
  v_mfma_f32_16x16x32_bf16 v[208:211], a[140:143], a[76:79], v[208:211]
  s_add_u32 m0, s37, 12160
  v_exp_f32 v198, v198
  v_mfma_f32_16x16x32_bf16 v[212:215], a[156:159], a[76:79], v[232:235]
  buffer_load_dwordx4 v252, s[24:27], s36 offen offset:128 nt lds
  v_mfma_f32_16x16x32_bf16 v[212:215], a[152:155], a[72:75], v[212:215]
  s_add_u32 s37, s37, 1024
  v_exp_f32 v199, v199
  v_mfma_f32_16x16x32_bf16 v[212:215], a[148:151], a[68:71], v[212:215]
  s_add_u32 s36, s36, 2048
  ds_read_b128 a[252:255], v244 offset:1024
  v_cvt_pk_bf16_f32 v195, v198, v199
  v_mfma_f32_16x16x32_bf16 v[212:215], a[144:147], a[64:67], v[212:215]
  v_exp_f32 v208, v208
  v_mfma_f32_16x16x32_bf16 v[112:115], v[200:203], a[176:179], v[112:115]
  ds_read_b128 a[108:111], v247 offset:4096
  v_mul_f32 v242, s40, v242
  v_mfma_f32_16x16x32_bf16 v[112:115], v[204:207], a[208:211], v[112:115]
  v_exp_f32 v209, v209
  v_mfma_f32_16x16x32_bf16 v[116:119], v[204:207], a[212:215], v[116:119]
  ds_read_b128 a[112:115], v246 offset:2048
  v_cvt_pk_bf16_f32 v196, v208, v209
  v_mfma_f32_16x16x32_bf16 v[116:119], v[200:203], a[180:183], v[116:119]
  v_exp_f32 v210, v210
  v_mfma_f32_16x16x32_bf16 v[120:123], v[200:203], a[184:187], v[120:123]
  ds_read_b128 a[116:119], v247 offset:2048
  v_cvt_pk_bf16_f32 v242, v254, v242
  v_mfma_f32_16x16x32_bf16 v[120:123], v[204:207], a[216:219], v[120:123]
  v_exp_f32 v211, v211
  v_mfma_f32_16x16x32_bf16 v[124:127], v[204:207], a[220:223], v[124:127]
  ds_read_b128 a[120:123], v246 offset:6144
  v_cvt_pk_bf16_f32 v197, v210, v211
  v_mfma_f32_16x16x32_bf16 v[124:127], v[200:203], a[188:191], v[124:127]
  s_waitcnt lgkmcnt(4)
  v_exp_f32 v212, v212
  v_smfmac_f32_16x16x64_bf16 a[244:247], a[232:235], a[248:255], v253
  ds_read_b128 a[124:127], v247 offset:6144
  v_mfma_f32_16x16x32_bf16 v[160:163], a[248:251], a[160:163], v[160:163]
  v_lshlrev_b32 v254, 16, v243
  v_and_b32 v243, 0xffff0000, v243
  v_mfma_f32_16x16x32_bf16 v[160:163], a[252:255], a[192:195], v[160:163]
  v_mul_f32 v254, s40, v254
  v_mul_f32 v243, s40, v243
  v_mfma_f32_16x16x32_bf16 v[164:167], a[252:255], a[196:199], v[164:167]
  v_cvt_pk_bf16_f32 v243, v254, v243
  v_mfma_f32_16x16x32_bf16 v[164:167], a[248:251], a[164:167], v[164:167]
  ds_write_b128 v255, v[240:243] offset:12288
  v_mfma_f32_16x16x32_bf16 v[168:171], a[248:251], a[168:171], v[168:171]
  v_add_u32 v255, 1024, v255
  v_mfma_f32_16x16x32_bf16 v[168:171], a[252:255], a[200:203], v[168:171]
  v_mfma_f32_16x16x32_bf16 v[172:175], a[252:255], a[204:207], v[172:175]
  v_mfma_f32_16x16x32_bf16 v[172:175], a[248:251], a[172:175], v[172:175]
  v_mfma_f32_16x16x32_bf16 v[176:179], a[248:251], a[176:179], v[176:179]
  v_mfma_f32_16x16x32_bf16 v[176:179], a[252:255], a[208:211], v[176:179]
  v_mfma_f32_16x16x32_bf16 v[180:183], a[252:255], a[212:215], v[180:183]
  v_mfma_f32_16x16x32_bf16 v[180:183], a[248:251], a[180:183], v[180:183]
  v_mfma_f32_16x16x32_bf16 v[184:187], a[248:251], a[184:187], v[184:187]
  v_mfma_f32_16x16x32_bf16 v[184:187], a[252:255], a[216:219], v[184:187]
  v_mfma_f32_16x16x32_bf16 v[188:191], a[252:255], a[220:223], v[188:191]
  v_mfma_f32_16x16x32_bf16 v[188:191], a[248:251], a[188:191], v[188:191]
  v_mfma_f32_16x16x32_bf16 v[200:203], a[96:99], a[0:3], v[216:219]
  ds_read_b128 a[128:131], v246 offset:16384
  v_mfma_f32_16x16x32_bf16 v[200:203], a[100:103], a[4:7], v[200:203]
  v_exp_f32 v213, v213
  v_mfma_f32_16x16x32_bf16 v[200:203], a[104:107], a[8:11], v[200:203]
  s_waitcnt lgkmcnt(1)
  ds_read_b128 a[132:135], v247 offset:16384
  v_cvt_pk_bf16_f32 v198, v212, v213
  v_mfma_f32_16x16x32_bf16 v[200:203], a[108:111], a[12:15], v[200:203]
  v_exp_f32 v214, v214
  v_mfma_f32_16x16x32_bf16 v[204:207], a[124:127], a[12:15], v[216:219]
  ds_read_b128 a[136:139], v246 offset:20480
  v_mfma_f32_16x16x32_bf16 v[204:207], a[120:123], a[8:11], v[204:207]
  v_exp_f32 v215, v215
  v_mfma_f32_16x16x32_bf16 v[204:207], a[116:119], a[4:7], v[204:207]
  ds_read_b128 a[140:143], v247 offset:20480
  v_cvt_pk_bf16_f32 v199, v214, v215
  v_mfma_f32_16x16x32_bf16 v[204:207], a[112:115], a[0:3], v[204:207]
  v_exp_f32 v200, v200
  v_smfmac_f32_16x16x64_bf16 a[244:247], a[228:231], v[192:199], v253
  ds_read_b128 a[144:147], v246 offset:18432
  v_mfma_f32_16x16x32_bf16 v[128:131], v[192:195], a[160:163], v[128:131]
  ds_read_b128 a[148:151], v247 offset:18432
  ds_read_b128 a[152:155], v246 offset:22528
  v_mfma_f32_16x16x32_bf16 v[128:131], v[196:199], a[192:195], v[128:131]
  v_exp_f32 v201, v201
  v_mfma_f32_16x16x32_bf16 v[132:135], v[196:199], a[196:199], v[132:135]
  ds_read_b128 a[156:159], v247 offset:22528
  v_cvt_pk_bf16_f32 v200, v200, v201
  v_mfma_f32_16x16x32_bf16 v[132:135], v[192:195], a[164:167], v[132:135]
  v_exp_f32 v202, v202
  v_mfma_f32_16x16x32_bf16 v[136:139], v[192:195], a[168:171], v[136:139]
  ds_read_b64_tr_b16 a[160:161], v248 offset:8192
  ds_read_b64_tr_b16 a[162:163], v248 offset:10240
  v_mfma_f32_16x16x32_bf16 v[136:139], v[196:199], a[200:203], v[136:139]
  v_exp_f32 v203, v203
  v_mfma_f32_16x16x32_bf16 v[140:143], v[196:199], a[204:207], v[140:143]
  ds_read_b64_tr_b16 a[192:193], v248 offset:24576
  v_cvt_pk_bf16_f32 v201, v202, v203
  v_mfma_f32_16x16x32_bf16 v[140:143], v[192:195], a[172:175], v[140:143]
  s_waitcnt lgkmcnt(6)
  v_exp_f32 v204, v204
  v_mfma_f32_16x16x32_bf16 v[208:211], a[128:131], a[0:3], v[216:219]
  ds_read_b64_tr_b16 a[194:195], v248 offset:26624
  ds_read_b64_tr_b16 a[164:165], v249 offset:8192
  v_mfma_f32_16x16x32_bf16 v[208:211], a[132:135], a[4:7], v[208:211]
  v_exp_f32 v205, v205
  v_mfma_f32_16x16x32_bf16 v[208:211], a[136:139], a[8:11], v[208:211]
  ds_read_b64_tr_b16 a[166:167], v249 offset:10240
  v_cvt_pk_bf16_f32 v202, v204, v205
  v_mfma_f32_16x16x32_bf16 v[208:211], a[140:143], a[12:15], v[208:211]
  s_waitcnt lgkmcnt(6)
  v_exp_f32 v206, v206
  v_mfma_f32_16x16x32_bf16 v[212:215], a[156:159], a[12:15], v[216:219]
  ds_read_b64_tr_b16 a[196:197], v249 offset:24576
  ds_read_b64_tr_b16 a[198:199], v249 offset:26624
  v_mfma_f32_16x16x32_bf16 v[212:215], a[152:155], a[8:11], v[212:215]
  v_exp_f32 v207, v207
  v_mfma_f32_16x16x32_bf16 v[212:215], a[148:151], a[4:7], v[212:215]
  ds_read_b64_tr_b16 a[168:169], v250 offset:8192
  v_cvt_pk_bf16_f32 v203, v206, v207
  v_mfma_f32_16x16x32_bf16 v[212:215], a[144:147], a[0:3], v[212:215]
  v_exp_f32 v208, v208
  v_mfma_f32_16x16x32_bf16 v[144:147], v[192:195], a[176:179], v[144:147]
  ds_read_b64_tr_b16 a[170:171], v250 offset:10240
  ds_read_b64_tr_b16 a[200:201], v250 offset:24576
  v_mfma_f32_16x16x32_bf16 v[144:147], v[196:199], a[208:211], v[144:147]
  v_exp_f32 v209, v209
  v_mfma_f32_16x16x32_bf16 v[148:151], v[196:199], a[212:215], v[148:151]
  ds_read_b64_tr_b16 a[202:203], v250 offset:26624
  v_cvt_pk_bf16_f32 v204, v208, v209
  v_mfma_f32_16x16x32_bf16 v[148:151], v[192:195], a[180:183], v[148:151]
  v_exp_f32 v210, v210
  v_mfma_f32_16x16x32_bf16 v[152:155], v[192:195], a[184:187], v[152:155]
  ds_read_b64_tr_b16 a[172:173], v251 offset:8192
  ds_read_b64_tr_b16 a[174:175], v251 offset:10240
  v_mfma_f32_16x16x32_bf16 v[152:155], v[196:199], a[216:219], v[152:155]
  v_exp_f32 v211, v211
  v_mfma_f32_16x16x32_bf16 v[156:159], v[196:199], a[220:223], v[156:159]
  ds_read_b64_tr_b16 a[204:205], v251 offset:24576
  v_cvt_pk_bf16_f32 v205, v210, v211
  v_mfma_f32_16x16x32_bf16 v[156:159], v[192:195], a[188:191], v[156:159]
  v_exp_f32 v212, v212
  v_mfma_f32_16x16x32_bf16 v[192:195], a[96:99], a[16:19], v[220:223]
  ds_read_b64_tr_b16 a[206:207], v251 offset:26624
  ds_read_b64_tr_b16 a[176:177], v248 offset:12288
  v_mfma_f32_16x16x32_bf16 v[192:195], a[100:103], a[20:23], v[192:195]
  v_exp_f32 v213, v213
  v_mfma_f32_16x16x32_bf16 v[192:195], a[104:107], a[24:27], v[192:195]
  ds_read_b64_tr_b16 a[178:179], v248 offset:14336
  v_cvt_pk_bf16_f32 v206, v212, v213
  v_mfma_f32_16x16x32_bf16 v[192:195], a[108:111], a[28:31], v[192:195]
  v_exp_f32 v214, v214
  v_mfma_f32_16x16x32_bf16 v[196:199], a[124:127], a[28:31], v[220:223]
  ds_read_b64_tr_b16 a[208:209], v248 offset:28672
  ds_read_b64_tr_b16 a[210:211], v248 offset:30720
  v_mfma_f32_16x16x32_bf16 v[196:199], a[120:123], a[24:27], v[196:199]
  v_exp_f32 v215, v215
  v_mfma_f32_16x16x32_bf16 v[196:199], a[116:119], a[20:23], v[196:199]
  ds_read_b64_tr_b16 a[180:181], v249 offset:12288
  v_cvt_pk_bf16_f32 v207, v214, v215
  v_mfma_f32_16x16x32_bf16 v[196:199], a[112:115], a[16:19], v[196:199]
  v_exp_f32 v192, v192
  v_smfmac_f32_16x16x64_bf16 a[236:239], a[228:231], v[200:207], v253
  s_waitcnt lgkmcnt(4)
  ds_read_b64_tr_b16 a[182:183], v249 offset:14336
  v_mfma_f32_16x16x32_bf16 v[0:3], v[200:203], a[160:163], v[0:3]
  ds_read_b64_tr_b16 a[212:213], v249 offset:28672
  ds_read_b64_tr_b16 a[214:215], v249 offset:30720
  v_mfma_f32_16x16x32_bf16 v[0:3], v[204:207], a[192:195], v[0:3]
  v_exp_f32 v193, v193
  v_mfma_f32_16x16x32_bf16 v[4:7], v[204:207], a[196:199], v[4:7]
  ds_read_b64_tr_b16 a[184:185], v250 offset:12288
  v_cvt_pk_bf16_f32 v192, v192, v193
  v_mfma_f32_16x16x32_bf16 v[4:7], v[200:203], a[164:167], v[4:7]
  v_exp_f32 v194, v194
  v_mfma_f32_16x16x32_bf16 v[8:11], v[200:203], a[168:171], v[8:11]
  ds_read_b64_tr_b16 a[186:187], v250 offset:14336
  ds_read_b64_tr_b16 a[216:217], v250 offset:28672
  v_mfma_f32_16x16x32_bf16 v[8:11], v[204:207], a[200:203], v[8:11]
  v_exp_f32 v195, v195
  v_mfma_f32_16x16x32_bf16 v[12:15], v[204:207], a[204:207], v[12:15]
  ds_read_b64_tr_b16 a[218:219], v250 offset:30720
  v_cvt_pk_bf16_f32 v193, v194, v195
  v_mfma_f32_16x16x32_bf16 v[12:15], v[200:203], a[172:175], v[12:15]
  v_exp_f32 v196, v196
  v_mfma_f32_16x16x32_bf16 v[208:211], a[128:131], a[16:19], v[220:223]
  ds_read_b64_tr_b16 a[188:189], v251 offset:12288
  ds_read_b64_tr_b16 a[190:191], v251 offset:14336
  v_mfma_f32_16x16x32_bf16 v[208:211], a[132:135], a[20:23], v[208:211]
  v_exp_f32 v197, v197
  v_mfma_f32_16x16x32_bf16 v[208:211], a[136:139], a[24:27], v[208:211]
  ds_read_b64_tr_b16 a[220:221], v251 offset:28672
  v_cvt_pk_bf16_f32 v194, v196, v197
  v_mfma_f32_16x16x32_bf16 v[208:211], a[140:143], a[28:31], v[208:211]
  v_exp_f32 v198, v198
  v_mfma_f32_16x16x32_bf16 v[212:215], a[156:159], a[28:31], v[220:223]
  ds_read_b64_tr_b16 a[222:223], v251 offset:30720
  v_mfma_f32_16x16x32_bf16 v[212:215], a[152:155], a[24:27], v[212:215]
  v_exp_f32 v199, v199
  v_mfma_f32_16x16x32_bf16 v[212:215], a[148:151], a[20:23], v[212:215]
  v_cvt_pk_bf16_f32 v195, v198, v199
  v_mfma_f32_16x16x32_bf16 v[212:215], a[144:147], a[16:19], v[212:215]
  s_waitcnt lgkmcnt(4)
  v_exp_f32 v208, v208
  v_mfma_f32_16x16x32_bf16 v[16:19], v[200:203], a[176:179], v[16:19]
  v_mfma_f32_16x16x32_bf16 v[16:19], v[204:207], a[208:211], v[16:19]
  v_exp_f32 v209, v209
  v_mfma_f32_16x16x32_bf16 v[20:23], v[204:207], a[212:215], v[20:23]
  v_cvt_pk_bf16_f32 v196, v208, v209
  v_mfma_f32_16x16x32_bf16 v[20:23], v[200:203], a[180:183], v[20:23]
  s_waitcnt vmcnt(10) lgkmcnt(0)
  v_exp_f32 v210, v210
  v_mfma_f32_16x16x32_bf16 v[24:27], v[200:203], a[184:187], v[24:27]
  s_barrier
  v_mfma_f32_16x16x32_bf16 v[24:27], v[204:207], a[216:219], v[24:27]
  v_exp_f32 v211, v211
  v_mfma_f32_16x16x32_bf16 v[28:31], v[204:207], a[220:223], v[28:31]
  v_cvt_pk_bf16_f32 v197, v210, v211
  v_mfma_f32_16x16x32_bf16 v[28:31], v[200:203], a[188:191], v[28:31]
  v_exp_f32 v212, v212
  v_mfma_f32_16x16x32_bf16 v[200:203], a[96:99], a[32:35], v[224:227]
  ds_read_b128 v[240:243], v255 offset:0
  v_mfma_f32_16x16x32_bf16 v[200:203], a[100:103], a[36:39], v[200:203]
  v_exp_f32 v213, v213
  v_mfma_f32_16x16x32_bf16 v[200:203], a[104:107], a[40:43], v[200:203]
  v_cvt_pk_bf16_f32 v198, v212, v213
  v_mfma_f32_16x16x32_bf16 v[200:203], a[108:111], a[44:47], v[200:203]
  s_add_u32 m0, s38, 0
  v_exp_f32 v214, v214
  v_mfma_f32_16x16x32_bf16 v[204:207], a[124:127], a[44:47], v[224:227]
  buffer_load_dwordx4 v252, s[16:19], s33 offen nt lds
  v_mfma_f32_16x16x32_bf16 v[204:207], a[120:123], a[40:43], v[204:207]
  v_exp_f32 v215, v215
  v_mfma_f32_16x16x32_bf16 v[204:207], a[116:119], a[36:39], v[204:207]
  v_cvt_pk_bf16_f32 v199, v214, v215
  v_mfma_f32_16x16x32_bf16 v[204:207], a[112:115], a[32:35], v[204:207]
  v_exp_f32 v200, v200
  v_smfmac_f32_16x16x64_bf16 a[236:239], a[232:235], v[192:199], v253
  s_waitcnt lgkmcnt(0)
  v_lshlrev_b32 v254, 16, v240
  v_mfma_f32_16x16x32_bf16 v[32:35], v[192:195], a[160:163], v[32:35]
  v_and_b32 v240, 0xffff0000, v240
  v_mul_f32 v254, s40, v254
  v_mfma_f32_16x16x32_bf16 v[32:35], v[196:199], a[192:195], v[32:35]
  v_exp_f32 v201, v201
  v_mfma_f32_16x16x32_bf16 v[36:39], v[196:199], a[196:199], v[36:39]
  v_cvt_pk_bf16_f32 v200, v200, v201
  v_mul_f32 v240, s40, v240
  v_mfma_f32_16x16x32_bf16 v[36:39], v[192:195], a[164:167], v[36:39]
  s_add_u32 m0, s38, 3968
  v_exp_f32 v202, v202
  v_mfma_f32_16x16x32_bf16 v[40:43], v[192:195], a[168:171], v[40:43]
  buffer_load_dwordx4 v252, s[16:19], s33 offen offset:128 nt lds
  v_mfma_f32_16x16x32_bf16 v[40:43], v[196:199], a[200:203], v[40:43]
  v_exp_f32 v203, v203
  v_mfma_f32_16x16x32_bf16 v[44:47], v[196:199], a[204:207], v[44:47]
  v_cvt_pk_bf16_f32 v201, v202, v203
  v_cvt_pk_bf16_f32 v240, v254, v240
  v_mfma_f32_16x16x32_bf16 v[44:47], v[192:195], a[172:175], v[44:47]
  v_exp_f32 v204, v204
  v_mfma_f32_16x16x32_bf16 v[208:211], a[128:131], a[32:35], v[224:227]
  v_lshlrev_b32 v254, 16, v241
  v_and_b32 v241, 0xffff0000, v241
  v_mfma_f32_16x16x32_bf16 v[208:211], a[132:135], a[36:39], v[208:211]
  v_exp_f32 v205, v205
  v_mfma_f32_16x16x32_bf16 v[208:211], a[136:139], a[40:43], v[208:211]
  v_cvt_pk_bf16_f32 v202, v204, v205
  v_mul_f32 v254, s40, v254
  v_mfma_f32_16x16x32_bf16 v[208:211], a[140:143], a[44:47], v[208:211]
  s_add_u32 m0, s38, 8192
  v_exp_f32 v206, v206
  v_mfma_f32_16x16x32_bf16 v[212:215], a[156:159], a[44:47], v[224:227]
  buffer_load_dwordx4 v252, s[20:23], s33 offen nt lds
  v_mfma_f32_16x16x32_bf16 v[212:215], a[152:155], a[40:43], v[212:215]
  v_exp_f32 v207, v207
  v_mfma_f32_16x16x32_bf16 v[212:215], a[148:151], a[36:39], v[212:215]
  v_cvt_pk_bf16_f32 v203, v206, v207
  v_mul_f32 v241, s40, v241
  v_mfma_f32_16x16x32_bf16 v[212:215], a[144:147], a[32:35], v[212:215]
  v_exp_f32 v208, v208
  v_mfma_f32_16x16x32_bf16 v[48:51], v[192:195], a[176:179], v[48:51]
  v_cvt_pk_bf16_f32 v241, v254, v241
  v_lshlrev_b32 v254, 16, v242
  v_mfma_f32_16x16x32_bf16 v[48:51], v[196:199], a[208:211], v[48:51]
  v_exp_f32 v209, v209
  v_mfma_f32_16x16x32_bf16 v[52:55], v[196:199], a[212:215], v[52:55]
  v_cvt_pk_bf16_f32 v204, v208, v209
  v_and_b32 v242, 0xffff0000, v242
  v_mfma_f32_16x16x32_bf16 v[52:55], v[192:195], a[180:183], v[52:55]
  s_add_u32 m0, s38, 12160
  v_exp_f32 v210, v210
  v_mfma_f32_16x16x32_bf16 v[56:59], v[192:195], a[184:187], v[56:59]
  buffer_load_dwordx4 v252, s[20:23], s33 offen offset:128 nt lds
  v_mfma_f32_16x16x32_bf16 v[56:59], v[196:199], a[216:219], v[56:59]
  s_add_u32 s34, s34, 1
  v_exp_f32 v211, v211
  v_mfma_f32_16x16x32_bf16 v[60:63], v[196:199], a[220:223], v[60:63]
  s_add_u32 s33, s33, 8192
  v_cvt_pk_bf16_f32 v205, v210, v211
  v_mul_f32 v254, s40, v254
  v_mfma_f32_16x16x32_bf16 v[60:63], v[192:195], a[188:191], v[60:63]
  v_exp_f32 v212, v212
  v_mfma_f32_16x16x32_bf16 v[192:195], a[96:99], a[48:51], v[228:231]
  v_mul_f32 v242, s40, v242
  v_cvt_pk_bf16_f32 v242, v254, v242
  v_mfma_f32_16x16x32_bf16 v[192:195], a[100:103], a[52:55], v[192:195]
  v_exp_f32 v213, v213
  v_mfma_f32_16x16x32_bf16 v[192:195], a[104:107], a[56:59], v[192:195]
  v_cvt_pk_bf16_f32 v206, v212, v213
  v_lshlrev_b32 v254, 16, v243
  v_mfma_f32_16x16x32_bf16 v[192:195], a[108:111], a[60:63], v[192:195]
  s_add_u32 m0, s38, 16384
  v_exp_f32 v214, v214
  v_mfma_f32_16x16x32_bf16 v[196:199], a[124:127], a[60:63], v[228:231]
  buffer_load_dwordx4 v252, s[16:19], s33 offen nt lds
  v_mfma_f32_16x16x32_bf16 v[196:199], a[120:123], a[56:59], v[196:199]
  v_exp_f32 v215, v215
  v_mfma_f32_16x16x32_bf16 v[196:199], a[116:119], a[52:55], v[196:199]
  v_cvt_pk_bf16_f32 v207, v214, v215
  v_and_b32 v243, 0xffff0000, v243
  v_mfma_f32_16x16x32_bf16 v[196:199], a[112:115], a[48:51], v[196:199]
  v_exp_f32 v192, v192
  v_smfmac_f32_16x16x64_bf16 a[240:243], a[228:231], v[200:207], v253
  v_mul_f32 v254, s40, v254
  v_mfma_f32_16x16x32_bf16 v[64:67], v[200:203], a[160:163], v[64:67]
  v_mul_f32 v243, s40, v243
  v_cvt_pk_bf16_f32 v243, v254, v243
  v_mfma_f32_16x16x32_bf16 v[64:67], v[204:207], a[192:195], v[64:67]
  v_exp_f32 v193, v193
  v_mfma_f32_16x16x32_bf16 v[68:71], v[204:207], a[196:199], v[68:71]
  ds_write_b128 v255, v[240:243] offset:0
  v_cvt_pk_bf16_f32 v192, v192, v193
  v_mfma_f32_16x16x32_bf16 v[68:71], v[200:203], a[164:167], v[68:71]
  s_add_u32 m0, s38, 20352
  v_exp_f32 v194, v194
  v_mfma_f32_16x16x32_bf16 v[72:75], v[200:203], a[168:171], v[72:75]
  buffer_load_dwordx4 v252, s[16:19], s33 offen offset:128 nt lds
  v_mfma_f32_16x16x32_bf16 v[72:75], v[204:207], a[200:203], v[72:75]
  v_exp_f32 v195, v195
  v_mfma_f32_16x16x32_bf16 v[76:79], v[204:207], a[204:207], v[76:79]
  ds_read_b128 v[240:243], v255 offset:12288
  v_cvt_pk_bf16_f32 v193, v194, v195
  v_mfma_f32_16x16x32_bf16 v[76:79], v[200:203], a[172:175], v[76:79]
  v_exp_f32 v196, v196
  v_mfma_f32_16x16x32_bf16 v[208:211], a[128:131], a[48:51], v[228:231]
  v_mfma_f32_16x16x32_bf16 v[208:211], a[132:135], a[52:55], v[208:211]
  v_exp_f32 v197, v197
  v_mfma_f32_16x16x32_bf16 v[208:211], a[136:139], a[56:59], v[208:211]
  v_cvt_pk_bf16_f32 v194, v196, v197
  v_mfma_f32_16x16x32_bf16 v[208:211], a[140:143], a[60:63], v[208:211]
  s_add_u32 m0, s38, 24576
  v_exp_f32 v198, v198
  v_mfma_f32_16x16x32_bf16 v[212:215], a[156:159], a[60:63], v[228:231]
  buffer_load_dwordx4 v252, s[20:23], s33 offen nt lds
  v_mfma_f32_16x16x32_bf16 v[212:215], a[152:155], a[56:59], v[212:215]
  v_exp_f32 v199, v199
  v_mfma_f32_16x16x32_bf16 v[212:215], a[148:151], a[52:55], v[212:215]
  v_cvt_pk_bf16_f32 v195, v198, v199
  s_waitcnt lgkmcnt(0)
  v_lshlrev_b32 v254, 16, v240
  v_mfma_f32_16x16x32_bf16 v[212:215], a[144:147], a[48:51], v[212:215]
  v_exp_f32 v208, v208
  v_mfma_f32_16x16x32_bf16 v[80:83], v[200:203], a[176:179], v[80:83]
  v_and_b32 v240, 0xffff0000, v240
  v_mul_f32 v254, s40, v254
  v_mfma_f32_16x16x32_bf16 v[80:83], v[204:207], a[208:211], v[80:83]
  v_exp_f32 v209, v209
  v_mfma_f32_16x16x32_bf16 v[84:87], v[204:207], a[212:215], v[84:87]
  v_cvt_pk_bf16_f32 v196, v208, v209
  v_mul_f32 v240, s40, v240
  v_mfma_f32_16x16x32_bf16 v[84:87], v[200:203], a[180:183], v[84:87]
  s_add_u32 m0, s38, 28544
  v_exp_f32 v210, v210
  v_mfma_f32_16x16x32_bf16 v[88:91], v[200:203], a[184:187], v[88:91]
  buffer_load_dwordx4 v252, s[20:23], s33 offen offset:128 nt lds
  v_mfma_f32_16x16x32_bf16 v[88:91], v[204:207], a[216:219], v[88:91]
  s_add_u32 s34, s34, 1
  v_exp_f32 v211, v211
  v_mfma_f32_16x16x32_bf16 v[92:95], v[204:207], a[220:223], v[92:95]
  s_add_u32 s33, s33, 8192
  v_cvt_pk_bf16_f32 v197, v210, v211
  v_cvt_pk_bf16_f32 v240, v254, v240
  v_mfma_f32_16x16x32_bf16 v[92:95], v[200:203], a[188:191], v[92:95]
  s_waitcnt vmcnt(8)
  v_exp_f32 v212, v212
  v_mfma_f32_16x16x32_bf16 v[200:203], a[96:99], a[64:67], v[232:235]
  s_barrier
  v_mfma_f32_16x16x32_bf16 v[200:203], a[100:103], a[68:71], v[200:203]
  v_exp_f32 v213, v213
  v_mfma_f32_16x16x32_bf16 v[200:203], a[104:107], a[72:75], v[200:203]
  v_cvt_pk_bf16_f32 v198, v212, v213
  v_lshlrev_b32 v254, 16, v241
  v_mfma_f32_16x16x32_bf16 v[200:203], a[108:111], a[76:79], v[200:203]
  s_mov_b32 m0, s37
  v_exp_f32 v214, v214
  v_mfma_f32_16x16x32_bf16 v[204:207], a[124:127], a[76:79], v[232:235]
  buffer_load_dwordx4 v252, s[24:27], s36 offen nt lds
  v_mfma_f32_16x16x32_bf16 v[204:207], a[120:123], a[72:75], v[204:207]
  v_exp_f32 v215, v215
  v_mfma_f32_16x16x32_bf16 v[204:207], a[116:119], a[68:71], v[204:207]
  v_cvt_pk_bf16_f32 v199, v214, v215
  v_and_b32 v241, 0xffff0000, v241
  v_mfma_f32_16x16x32_bf16 v[204:207], a[112:115], a[64:67], v[204:207]
  v_exp_f32 v200, v200
  v_smfmac_f32_16x16x64_bf16 a[240:243], a[232:235], v[192:199], v253
  v_mul_f32 v254, s40, v254
  v_mfma_f32_16x16x32_bf16 v[96:99], v[192:195], a[160:163], v[96:99]
  v_mul_f32 v241, s40, v241
  v_cvt_pk_bf16_f32 v241, v254, v241
  v_mfma_f32_16x16x32_bf16 v[96:99], v[196:199], a[192:195], v[96:99]
  v_exp_f32 v201, v201
  v_mfma_f32_16x16x32_bf16 v[100:103], v[196:199], a[196:199], v[100:103]
  v_cvt_pk_bf16_f32 v200, v200, v201
  v_lshlrev_b32 v254, 16, v242
  v_mfma_f32_16x16x32_bf16 v[100:103], v[192:195], a[164:167], v[100:103]
  v_exp_f32 v202, v202
  v_mfma_f32_16x16x32_bf16 v[104:107], v[192:195], a[168:171], v[104:107]
  ds_read_b128 a[96:99], v246 offset:32768
  v_and_b32 v242, 0xffff0000, v242
  v_mfma_f32_16x16x32_bf16 v[104:107], v[196:199], a[200:203], v[104:107]
  v_exp_f32 v203, v203
  v_mfma_f32_16x16x32_bf16 v[108:111], v[196:199], a[204:207], v[108:111]
  ds_read_b128 a[100:103], v247 offset:32768
  v_cvt_pk_bf16_f32 v201, v202, v203
  v_mfma_f32_16x16x32_bf16 v[108:111], v[192:195], a[172:175], v[108:111]
  v_exp_f32 v204, v204
  v_mfma_f32_16x16x32_bf16 v[208:211], a[128:131], a[64:67], v[232:235]
  ds_read_b128 a[104:107], v246 offset:36864
  v_mul_f32 v254, s40, v254
  v_mfma_f32_16x16x32_bf16 v[208:211], a[132:135], a[68:71], v[208:211]
  v_exp_f32 v205, v205
  v_mfma_f32_16x16x32_bf16 v[208:211], a[136:139], a[72:75], v[208:211]
  ds_read_b128 a[248:251], v244 offset:0
  v_cvt_pk_bf16_f32 v202, v204, v205
  v_mfma_f32_16x16x32_bf16 v[208:211], a[140:143], a[76:79], v[208:211]
  s_add_u32 m0, s37, 12160
  v_exp_f32 v206, v206
  v_mfma_f32_16x16x32_bf16 v[212:215], a[156:159], a[76:79], v[232:235]
  buffer_load_dwordx4 v252, s[24:27], s36 offen offset:128 nt lds
  v_mfma_f32_16x16x32_bf16 v[212:215], a[152:155], a[72:75], v[212:215]
  s_add_u32 s37, s37, 1024
  v_exp_f32 v207, v207
  v_mfma_f32_16x16x32_bf16 v[212:215], a[148:151], a[68:71], v[212:215]
  s_add_u32 s36, s36, 2048
  ds_read_b128 a[252:255], v244 offset:1024
  v_cvt_pk_bf16_f32 v203, v206, v207
  v_mfma_f32_16x16x32_bf16 v[212:215], a[144:147], a[64:67], v[212:215]
  v_exp_f32 v208, v208
  v_mfma_f32_16x16x32_bf16 v[112:115], v[192:195], a[176:179], v[112:115]
  ds_read_b128 a[108:111], v247 offset:36864
  v_mul_f32 v242, s40, v242
  v_mfma_f32_16x16x32_bf16 v[112:115], v[196:199], a[208:211], v[112:115]
  v_exp_f32 v209, v209
  v_mfma_f32_16x16x32_bf16 v[116:119], v[196:199], a[212:215], v[116:119]
  ds_read_b128 a[112:115], v246 offset:34816
  v_cvt_pk_bf16_f32 v204, v208, v209
  v_mfma_f32_16x16x32_bf16 v[116:119], v[192:195], a[180:183], v[116:119]
  v_exp_f32 v210, v210
  v_mfma_f32_16x16x32_bf16 v[120:123], v[192:195], a[184:187], v[120:123]
  ds_read_b128 a[116:119], v247 offset:34816
  v_cvt_pk_bf16_f32 v242, v254, v242
  v_mfma_f32_16x16x32_bf16 v[120:123], v[196:199], a[216:219], v[120:123]
  v_exp_f32 v211, v211
  v_mfma_f32_16x16x32_bf16 v[124:127], v[196:199], a[220:223], v[124:127]
  ds_read_b128 a[120:123], v246 offset:38912
  v_cvt_pk_bf16_f32 v205, v210, v211
  v_mfma_f32_16x16x32_bf16 v[124:127], v[192:195], a[188:191], v[124:127]
  s_waitcnt lgkmcnt(4)
  v_exp_f32 v212, v212
  v_smfmac_f32_16x16x64_bf16 a[244:247], a[232:235], a[248:255], v253
  ds_read_b128 a[124:127], v247 offset:38912
  v_mfma_f32_16x16x32_bf16 v[160:163], a[248:251], a[160:163], v[160:163]
  v_lshlrev_b32 v254, 16, v243
  v_and_b32 v243, 0xffff0000, v243
  v_mfma_f32_16x16x32_bf16 v[160:163], a[252:255], a[192:195], v[160:163]
  v_mul_f32 v254, s40, v254
  v_mul_f32 v243, s40, v243
  v_mfma_f32_16x16x32_bf16 v[164:167], a[252:255], a[196:199], v[164:167]
  v_cvt_pk_bf16_f32 v243, v254, v243
  v_mfma_f32_16x16x32_bf16 v[164:167], a[248:251], a[164:167], v[164:167]
  ds_write_b128 v255, v[240:243] offset:12288
  v_mfma_f32_16x16x32_bf16 v[168:171], a[248:251], a[168:171], v[168:171]
  v_add_u32 v255, 1024, v255
  v_mfma_f32_16x16x32_bf16 v[168:171], a[252:255], a[200:203], v[168:171]
  v_mfma_f32_16x16x32_bf16 v[172:175], a[252:255], a[204:207], v[172:175]
  v_mfma_f32_16x16x32_bf16 v[172:175], a[248:251], a[172:175], v[172:175]
  v_mfma_f32_16x16x32_bf16 v[176:179], a[248:251], a[176:179], v[176:179]
  v_mfma_f32_16x16x32_bf16 v[176:179], a[252:255], a[208:211], v[176:179]
  v_mfma_f32_16x16x32_bf16 v[180:183], a[252:255], a[212:215], v[180:183]
  v_mfma_f32_16x16x32_bf16 v[180:183], a[248:251], a[180:183], v[180:183]
  v_mfma_f32_16x16x32_bf16 v[184:187], a[248:251], a[184:187], v[184:187]
  v_mfma_f32_16x16x32_bf16 v[184:187], a[252:255], a[216:219], v[184:187]
  v_mfma_f32_16x16x32_bf16 v[188:191], a[252:255], a[220:223], v[188:191]
  v_mfma_f32_16x16x32_bf16 v[188:191], a[248:251], a[188:191], v[188:191]
  v_mfma_f32_16x16x32_bf16 v[192:195], a[96:99], a[0:3], v[216:219]
  ds_read_b128 a[128:131], v246 offset:49152
  v_mfma_f32_16x16x32_bf16 v[192:195], a[100:103], a[4:7], v[192:195]
  v_exp_f32 v213, v213
  v_mfma_f32_16x16x32_bf16 v[192:195], a[104:107], a[8:11], v[192:195]
  s_waitcnt lgkmcnt(1)
  ds_read_b128 a[132:135], v247 offset:49152
  v_cvt_pk_bf16_f32 v206, v212, v213
  v_mfma_f32_16x16x32_bf16 v[192:195], a[108:111], a[12:15], v[192:195]
  v_exp_f32 v214, v214
  v_mfma_f32_16x16x32_bf16 v[196:199], a[124:127], a[12:15], v[216:219]
  ds_read_b128 a[136:139], v246 offset:53248
  v_mfma_f32_16x16x32_bf16 v[196:199], a[120:123], a[8:11], v[196:199]
  v_exp_f32 v215, v215
  v_mfma_f32_16x16x32_bf16 v[196:199], a[116:119], a[4:7], v[196:199]
  ds_read_b128 a[140:143], v247 offset:53248
  v_cvt_pk_bf16_f32 v207, v214, v215
  v_mfma_f32_16x16x32_bf16 v[196:199], a[112:115], a[0:3], v[196:199]
  v_exp_f32 v192, v192
  v_smfmac_f32_16x16x64_bf16 a[244:247], a[228:231], v[200:207], v253
  ds_read_b128 a[144:147], v246 offset:51200
  v_mfma_f32_16x16x32_bf16 v[128:131], v[200:203], a[160:163], v[128:131]
  ds_read_b128 a[148:151], v247 offset:51200
  ds_read_b128 a[152:155], v246 offset:55296
  v_mfma_f32_16x16x32_bf16 v[128:131], v[204:207], a[192:195], v[128:131]
  v_exp_f32 v193, v193
  v_mfma_f32_16x16x32_bf16 v[132:135], v[204:207], a[196:199], v[132:135]
  ds_read_b128 a[156:159], v247 offset:55296
  v_cvt_pk_bf16_f32 v192, v192, v193
  v_mfma_f32_16x16x32_bf16 v[132:135], v[200:203], a[164:167], v[132:135]
  v_exp_f32 v194, v194
  v_mfma_f32_16x16x32_bf16 v[136:139], v[200:203], a[168:171], v[136:139]
  ds_read_b64_tr_b16 a[160:161], v248 offset:40960
  ds_read_b64_tr_b16 a[162:163], v248 offset:43008
  v_mfma_f32_16x16x32_bf16 v[136:139], v[204:207], a[200:203], v[136:139]
  v_exp_f32 v195, v195
  v_mfma_f32_16x16x32_bf16 v[140:143], v[204:207], a[204:207], v[140:143]
  ds_read_b64_tr_b16 a[192:193], v248 offset:57344
  v_cvt_pk_bf16_f32 v193, v194, v195
  v_mfma_f32_16x16x32_bf16 v[140:143], v[200:203], a[172:175], v[140:143]
  s_waitcnt lgkmcnt(6)
  v_exp_f32 v196, v196
  v_mfma_f32_16x16x32_bf16 v[208:211], a[128:131], a[0:3], v[216:219]
  ds_read_b64_tr_b16 a[194:195], v248 offset:59392
  ds_read_b64_tr_b16 a[164:165], v249 offset:40960
  v_mfma_f32_16x16x32_bf16 v[208:211], a[132:135], a[4:7], v[208:211]
  v_exp_f32 v197, v197
  v_mfma_f32_16x16x32_bf16 v[208:211], a[136:139], a[8:11], v[208:211]
  ds_read_b64_tr_b16 a[166:167], v249 offset:43008
  v_cvt_pk_bf16_f32 v194, v196, v197
  v_mfma_f32_16x16x32_bf16 v[208:211], a[140:143], a[12:15], v[208:211]
  s_waitcnt lgkmcnt(6)
  v_exp_f32 v198, v198
  v_mfma_f32_16x16x32_bf16 v[212:215], a[156:159], a[12:15], v[216:219]
  ds_read_b64_tr_b16 a[196:197], v249 offset:57344
  ds_read_b64_tr_b16 a[198:199], v249 offset:59392
  v_mfma_f32_16x16x32_bf16 v[212:215], a[152:155], a[8:11], v[212:215]
  v_exp_f32 v199, v199
  v_mfma_f32_16x16x32_bf16 v[212:215], a[148:151], a[4:7], v[212:215]
  ds_read_b64_tr_b16 a[168:169], v250 offset:40960
  v_cvt_pk_bf16_f32 v195, v198, v199
  v_mfma_f32_16x16x32_bf16 v[212:215], a[144:147], a[0:3], v[212:215]
  v_exp_f32 v208, v208
  v_mfma_f32_16x16x32_bf16 v[144:147], v[200:203], a[176:179], v[144:147]
  ds_read_b64_tr_b16 a[170:171], v250 offset:43008
  ds_read_b64_tr_b16 a[200:201], v250 offset:57344
  v_mfma_f32_16x16x32_bf16 v[144:147], v[204:207], a[208:211], v[144:147]
  v_exp_f32 v209, v209
  v_mfma_f32_16x16x32_bf16 v[148:151], v[204:207], a[212:215], v[148:151]
  ds_read_b64_tr_b16 a[202:203], v250 offset:59392
  v_cvt_pk_bf16_f32 v196, v208, v209
  v_mfma_f32_16x16x32_bf16 v[148:151], v[200:203], a[180:183], v[148:151]
  v_exp_f32 v210, v210
  v_mfma_f32_16x16x32_bf16 v[152:155], v[200:203], a[184:187], v[152:155]
  ds_read_b64_tr_b16 a[172:173], v251 offset:40960
  ds_read_b64_tr_b16 a[174:175], v251 offset:43008
  v_mfma_f32_16x16x32_bf16 v[152:155], v[204:207], a[216:219], v[152:155]
  v_exp_f32 v211, v211
  v_mfma_f32_16x16x32_bf16 v[156:159], v[204:207], a[220:223], v[156:159]
  ds_read_b64_tr_b16 a[204:205], v251 offset:57344
  v_cvt_pk_bf16_f32 v197, v210, v211
  v_mfma_f32_16x16x32_bf16 v[156:159], v[200:203], a[188:191], v[156:159]
  v_exp_f32 v212, v212
  v_mfma_f32_16x16x32_bf16 v[200:203], a[96:99], a[16:19], v[220:223]
  ds_read_b64_tr_b16 a[206:207], v251 offset:59392
  ds_read_b64_tr_b16 a[176:177], v248 offset:45056
  v_mfma_f32_16x16x32_bf16 v[200:203], a[100:103], a[20:23], v[200:203]
  v_exp_f32 v213, v213
  v_mfma_f32_16x16x32_bf16 v[200:203], a[104:107], a[24:27], v[200:203]
  ds_read_b64_tr_b16 a[178:179], v248 offset:47104
  v_cvt_pk_bf16_f32 v198, v212, v213
  v_mfma_f32_16x16x32_bf16 v[200:203], a[108:111], a[28:31], v[200:203]
  v_exp_f32 v214, v214
  v_mfma_f32_16x16x32_bf16 v[204:207], a[124:127], a[28:31], v[220:223]
  ds_read_b64_tr_b16 a[208:209], v248 offset:61440
  ds_read_b64_tr_b16 a[210:211], v248 offset:63488
  v_mfma_f32_16x16x32_bf16 v[204:207], a[120:123], a[24:27], v[204:207]
  v_exp_f32 v215, v215
  v_mfma_f32_16x16x32_bf16 v[204:207], a[116:119], a[20:23], v[204:207]
  ds_read_b64_tr_b16 a[180:181], v249 offset:45056
  v_cvt_pk_bf16_f32 v199, v214, v215
  v_mfma_f32_16x16x32_bf16 v[204:207], a[112:115], a[16:19], v[204:207]
  v_exp_f32 v200, v200
  v_smfmac_f32_16x16x64_bf16 a[236:239], a[228:231], v[192:199], v253
  s_waitcnt lgkmcnt(4)
  ds_read_b64_tr_b16 a[182:183], v249 offset:47104
  v_mfma_f32_16x16x32_bf16 v[0:3], v[192:195], a[160:163], v[0:3]
  ds_read_b64_tr_b16 a[212:213], v249 offset:61440
  ds_read_b64_tr_b16 a[214:215], v249 offset:63488
  v_mfma_f32_16x16x32_bf16 v[0:3], v[196:199], a[192:195], v[0:3]
  v_exp_f32 v201, v201
  v_mfma_f32_16x16x32_bf16 v[4:7], v[196:199], a[196:199], v[4:7]
  ds_read_b64_tr_b16 a[184:185], v250 offset:45056
  v_cvt_pk_bf16_f32 v200, v200, v201
  v_mfma_f32_16x16x32_bf16 v[4:7], v[192:195], a[164:167], v[4:7]
  v_exp_f32 v202, v202
  v_mfma_f32_16x16x32_bf16 v[8:11], v[192:195], a[168:171], v[8:11]
  ds_read_b64_tr_b16 a[186:187], v250 offset:47104
  ds_read_b64_tr_b16 a[216:217], v250 offset:61440
  v_mfma_f32_16x16x32_bf16 v[8:11], v[196:199], a[200:203], v[8:11]
  v_exp_f32 v203, v203
  v_mfma_f32_16x16x32_bf16 v[12:15], v[196:199], a[204:207], v[12:15]
  ds_read_b64_tr_b16 a[218:219], v250 offset:63488
  v_cvt_pk_bf16_f32 v201, v202, v203
  v_mfma_f32_16x16x32_bf16 v[12:15], v[192:195], a[172:175], v[12:15]
  v_exp_f32 v204, v204
  v_mfma_f32_16x16x32_bf16 v[208:211], a[128:131], a[16:19], v[220:223]
  ds_read_b64_tr_b16 a[188:189], v251 offset:45056
  ds_read_b64_tr_b16 a[190:191], v251 offset:47104
  v_mfma_f32_16x16x32_bf16 v[208:211], a[132:135], a[20:23], v[208:211]
  v_exp_f32 v205, v205
  v_mfma_f32_16x16x32_bf16 v[208:211], a[136:139], a[24:27], v[208:211]
  ds_read_b64_tr_b16 a[220:221], v251 offset:61440
  v_cvt_pk_bf16_f32 v202, v204, v205
  v_mfma_f32_16x16x32_bf16 v[208:211], a[140:143], a[28:31], v[208:211]
  v_exp_f32 v206, v206
  v_mfma_f32_16x16x32_bf16 v[212:215], a[156:159], a[28:31], v[220:223]
  ds_read_b64_tr_b16 a[222:223], v251 offset:63488
  v_mfma_f32_16x16x32_bf16 v[212:215], a[152:155], a[24:27], v[212:215]
  v_exp_f32 v207, v207
  v_mfma_f32_16x16x32_bf16 v[212:215], a[148:151], a[20:23], v[212:215]
  v_cvt_pk_bf16_f32 v203, v206, v207
  v_mfma_f32_16x16x32_bf16 v[212:215], a[144:147], a[16:19], v[212:215]
  s_waitcnt lgkmcnt(4)
  v_exp_f32 v208, v208
  v_mfma_f32_16x16x32_bf16 v[16:19], v[192:195], a[176:179], v[16:19]
  v_mfma_f32_16x16x32_bf16 v[16:19], v[196:199], a[208:211], v[16:19]
  v_exp_f32 v209, v209
  v_mfma_f32_16x16x32_bf16 v[20:23], v[196:199], a[212:215], v[20:23]
  s_cmp_eq_u32 s34, 22
  v_cvt_pk_bf16_f32 v204, v208, v209
  v_mfma_f32_16x16x32_bf16 v[20:23], v[192:195], a[180:183], v[20:23]
  s_waitcnt vmcnt(10) lgkmcnt(0)
  v_exp_f32 v210, v210
  v_mfma_f32_16x16x32_bf16 v[24:27], v[192:195], a[184:187], v[24:27]
  s_barrier
  s_cbranch_scc0 L_hA_own
  v_add_u32 v244, s49, v246
  s_waitcnt vmcnt(2)
  s_barrier
  s_branch L_cutA
L_hA_help:
  v_accvgpr_read_b32 v239, a255
  v_subrev_f32 v236, 0x40a00000, v239
  v_subrev_f32 v237, 0x40a00000, v239
  v_subrev_f32 v238, 0x40a00000, v239
  v_subrev_f32 v239, 0x40a00000, v239
  s_mov_b32 s48, 0
  s_add_u32 s45, s49, 10240
  v_and_b32 v244, 0x3ff, v255
  v_add_u32 v244, s45, v244
L_hA_hl:
  v_mfma_f32_16x16x32_bf16 v[24:27], v[196:199], a[216:219], v[24:27]
  v_exp_f32 v211, v211
  v_mfma_f32_16x16x32_bf16 v[28:31], v[196:199], a[220:223], v[28:31]
  v_cvt_pk_bf16_f32 v205, v210, v211
  v_mfma_f32_16x16x32_bf16 v[28:31], v[192:195], a[188:191], v[28:31]
  v_exp_f32 v212, v212
  v_mfma_f32_16x16x32_bf16 v[192:195], a[96:99], a[80:83], v[236:239]
  ds_read_b128 v[240:243], v255 offset:0
  v_mfma_f32_16x16x32_bf16 v[192:195], a[100:103], a[84:87], v[192:195]
  v_exp_f32 v213, v213
  v_mfma_f32_16x16x32_bf16 v[192:195], a[104:107], a[88:91], v[192:195]
  v_cvt_pk_bf16_f32 v206, v212, v213
  v_mfma_f32_16x16x32_bf16 v[192:195], a[108:111], a[92:95], v[192:195]
  s_add_u32 m0, s38, 32768
  v_exp_f32 v214, v214
  v_mfma_f32_16x16x32_bf16 v[196:199], a[124:127], a[92:95], v[236:239]
  buffer_load_dwordx4 v252, s[16:19], s33 offen nt lds
  v_mfma_f32_16x16x32_bf16 v[196:199], a[120:123], a[88:91], v[196:199]
  v_exp_f32 v215, v215
  v_mfma_f32_16x16x32_bf16 v[196:199], a[116:119], a[84:87], v[196:199]
  v_cvt_pk_bf16_f32 v207, v214, v215
  v_mfma_f32_16x16x32_bf16 v[196:199], a[112:115], a[80:83], v[196:199]
  v_exp_f32 v192, v192
  v_smfmac_f32_16x16x64_bf16 a[236:239], a[232:235], v[200:207], v253
  s_waitcnt lgkmcnt(0)
  v_lshlrev_b32 v254, 16, v240
  v_mfma_f32_16x16x32_bf16 v[32:35], v[200:203], a[160:163], v[32:35]
  v_and_b32 v240, 0xffff0000, v240
  v_mul_f32 v254, s40, v254
  v_mfma_f32_16x16x32_bf16 v[32:35], v[204:207], a[192:195], v[32:35]
  v_exp_f32 v193, v193
  v_mfma_f32_16x16x32_bf16 v[36:39], v[204:207], a[196:199], v[36:39]
  v_cvt_pk_bf16_f32 v192, v192, v193
  v_mul_f32 v240, s40, v240
  v_mfma_f32_16x16x32_bf16 v[36:39], v[200:203], a[164:167], v[36:39]
  s_add_u32 m0, s38, 36736
  v_exp_f32 v194, v194
  v_mfma_f32_16x16x32_bf16 v[40:43], v[200:203], a[168:171], v[40:43]
  buffer_load_dwordx4 v252, s[16:19], s33 offen offset:128 nt lds
  v_mfma_f32_16x16x32_bf16 v[40:43], v[204:207], a[200:203], v[40:43]
  v_exp_f32 v195, v195
  v_mfma_f32_16x16x32_bf16 v[44:47], v[204:207], a[204:207], v[44:47]
  v_cvt_pk_bf16_f32 v193, v194, v195
  v_cvt_pk_bf16_f32 v240, v254, v240
  v_mfma_f32_16x16x32_bf16 v[44:47], v[200:203], a[172:175], v[44:47]
  v_exp_f32 v196, v196
  v_lshlrev_b32 v254, 16, v241
  v_mfma_f32_16x16x32_bf16 v[208:211], a[128:131], a[80:83], v[236:239]
  v_and_b32 v241, 0xffff0000, v241
  v_mul_f32 v254, s40, v254
  v_mfma_f32_16x16x32_bf16 v[208:211], a[132:135], a[84:87], v[208:211]
  v_exp_f32 v197, v197
  v_mfma_f32_16x16x32_bf16 v[208:211], a[136:139], a[88:91], v[208:211]
  v_cvt_pk_bf16_f32 v194, v196, v197
  v_mul_f32 v241, s40, v241
  v_mfma_f32_16x16x32_bf16 v[208:211], a[140:143], a[92:95], v[208:211]
  s_add_u32 m0, s38, 40960
  v_exp_f32 v198, v198
  v_mfma_f32_16x16x32_bf16 v[212:215], a[156:159], a[92:95], v[236:239]
  buffer_load_dwordx4 v252, s[20:23], s33 offen nt lds
  v_mfma_f32_16x16x32_bf16 v[212:215], a[152:155], a[88:91], v[212:215]
  v_exp_f32 v199, v199
  v_mfma_f32_16x16x32_bf16 v[212:215], a[148:151], a[84:87], v[212:215]
  v_cvt_pk_bf16_f32 v195, v198, v199
  v_cvt_pk_bf16_f32 v241, v254, v241
  v_mfma_f32_16x16x32_bf16 v[212:215], a[144:147], a[80:83], v[212:215]
  v_exp_f32 v208, v208
  v_mfma_f32_16x16x32_bf16 v[48:51], v[200:203], a[176:179], v[48:51]
  v_lshlrev_b32 v254, 16, v242
  v_and_b32 v242, 0xffff0000, v242
  v_mfma_f32_16x16x32_bf16 v[48:51], v[204:207], a[208:211], v[48:51]
  v_exp_f32 v209, v209
  v_mul_f32 v254, s40, v254
  v_mfma_f32_16x16x32_bf16 v[52:55], v[204:207], a[212:215], v[52:55]
  v_cvt_pk_bf16_f32 v196, v208, v209
  v_mul_f32 v242, s40, v242
  v_mfma_f32_16x16x32_bf16 v[52:55], v[200:203], a[180:183], v[52:55]
  s_add_u32 m0, s38, 44928
  v_exp_f32 v210, v210
  v_mfma_f32_16x16x32_bf16 v[56:59], v[200:203], a[184:187], v[56:59]
  buffer_load_dwordx4 v252, s[20:23], s33 offen offset:128 nt lds
  v_mfma_f32_16x16x32_bf16 v[56:59], v[204:207], a[216:219], v[56:59]
  s_add_u32 s34, s34, 1
  v_exp_f32 v211, v211
  v_mfma_f32_16x16x32_bf16 v[60:63], v[204:207], a[220:223], v[60:63]
  s_add_u32 s33, s33, 8192
  v_cvt_pk_bf16_f32 v197, v210, v211
  v_cvt_pk_bf16_f32 v242, v254, v242
  v_mfma_f32_16x16x32_bf16 v[60:63], v[200:203], a[188:191], v[60:63]
  v_exp_f32 v212, v212
  v_mfma_f32_16x16x32_bf16 v[200:203], a[96:99], a[32:35], v[224:227]
  ds_write_b128 v244, v[192:195] offset:0
  v_mfma_f32_16x16x32_bf16 v[200:203], a[100:103], a[36:39], v[200:203]
  v_exp_f32 v213, v213
  v_mfma_f32_16x16x32_bf16 v[200:203], a[104:107], a[40:43], v[200:203]
  v_cvt_pk_bf16_f32 v198, v212, v213
  v_lshlrev_b32 v254, 16, v243
  v_mfma_f32_16x16x32_bf16 v[200:203], a[108:111], a[44:47], v[200:203]
  s_add_u32 m0, s38, 49152
  v_exp_f32 v214, v214
  v_and_b32 v243, 0xffff0000, v243
  v_mfma_f32_16x16x32_bf16 v[204:207], a[124:127], a[44:47], v[224:227]
  buffer_load_dwordx4 v252, s[16:19], s33 offen nt lds
  v_mfma_f32_16x16x32_bf16 v[204:207], a[120:123], a[40:43], v[204:207]
  v_exp_f32 v215, v215
  v_mfma_f32_16x16x32_bf16 v[204:207], a[116:119], a[36:39], v[204:207]
  v_cvt_pk_bf16_f32 v199, v214, v215
  v_mul_f32 v254, s40, v254
  v_mfma_f32_16x16x32_bf16 v[204:207], a[112:115], a[32:35], v[204:207]
  v_exp_f32 v200, v200
  v_mfma_f32_16x16x32_bf16 v[208:211], a[128:131], a[32:35], v[224:227]
  ds_write_b128 v244, v[196:199] offset:1024
  v_mfma_f32_16x16x32_bf16 v[208:211], a[132:135], a[36:39], v[208:211]
  v_exp_f32 v201, v201
  v_mfma_f32_16x16x32_bf16 v[208:211], a[136:139], a[40:43], v[208:211]
  v_exp_f32 v202, v202
  v_mfma_f32_16x16x32_bf16 v[208:211], a[140:143], a[44:47], v[208:211]
  v_exp_f32 v203, v203
  v_mfma_f32_16x16x32_bf16 v[212:215], a[156:159], a[44:47], v[224:227]
  v_cvt_pk_bf16_f32 v200, v200, v201
  v_cvt_pk_bf16_f32 v201, v202, v203
  v_mfma_f32_16x16x32_bf16 v[212:215], a[152:155], a[40:43], v[212:215]
  v_exp_f32 v204, v204
  v_mul_f32 v243, s40, v243
  v_mfma_f32_16x16x32_bf16 v[212:215], a[148:151], a[36:39], v[212:215]
  v_exp_f32 v205, v205
  v_mfma_f32_16x16x32_bf16 v[212:215], a[144:147], a[32:35], v[212:215]
  v_exp_f32 v206, v206
  v_mfma_f32_16x16x32_bf16 v[192:195], a[96:99], a[48:51], v[228:231]
  v_exp_f32 v207, v207
  v_mfma_f32_16x16x32_bf16 v[192:195], a[100:103], a[52:55], v[192:195]
  v_cvt_pk_bf16_f32 v202, v204, v205
  v_cvt_pk_bf16_f32 v203, v206, v207
  v_mfma_f32_16x16x32_bf16 v[192:195], a[104:107], a[56:59], v[192:195]
  s_add_u32 m0, s38, 53120
  v_exp_f32 v208, v208
  v_mfma_f32_16x16x32_bf16 v[192:195], a[108:111], a[60:63], v[192:195]
  buffer_load_dwordx4 v252, s[16:19], s33 offen offset:128 nt lds
  v_mfma_f32_16x16x32_bf16 v[196:199], a[124:127], a[60:63], v[228:231]
  v_exp_f32 v209, v209
  v_mfma_f32_16x16x32_bf16 v[196:199], a[120:123], a[56:59], v[196:199]
  v_exp_f32 v210, v210
  v_mfma_f32_16x16x32_bf16 v[196:199], a[116:119], a[52:55], v[196:199]
  v_exp_f32 v211, v211
  v_mfma_f32_16x16x32_bf16 v[196:199], a[112:115], a[48:51], v[196:199]
  v_cvt_pk_bf16_f32 v204, v208, v209
  v_cvt_pk_bf16_f32 v205, v210, v211
  v_cvt_pk_bf16_f32 v243, v254, v243
  v_mfma_f32_16x16x32_bf16 v[64:67], v[200:203], a[160:163], v[64:67]
  ds_write_b128 v255, v[240:243] offset:0
  v_exp_f32 v212, v212
  v_mfma_f32_16x16x32_bf16 v[68:71], v[200:203], a[164:167], v[68:71]
  v_exp_f32 v213, v213
  v_mfma_f32_16x16x32_bf16 v[72:75], v[200:203], a[168:171], v[72:75]
  ds_read_b128 v[240:243], v255 offset:12288
  v_exp_f32 v214, v214
  v_mfma_f32_16x16x32_bf16 v[76:79], v[200:203], a[172:175], v[76:79]
  v_exp_f32 v215, v215
  v_mfma_f32_16x16x32_bf16 v[80:83], v[200:203], a[176:179], v[80:83]
  v_cvt_pk_bf16_f32 v206, v212, v213
  v_cvt_pk_bf16_f32 v207, v214, v215
  v_mfma_f32_16x16x32_bf16 v[84:87], v[200:203], a[180:183], v[84:87]
  s_waitcnt vmcnt(6) lgkmcnt(2)
  v_exp_f32 v192, v192
  v_mfma_f32_16x16x32_bf16 v[88:91], v[200:203], a[184:187], v[88:91]
  s_barrier
  v_mfma_f32_16x16x32_bf16 v[92:95], v[200:203], a[188:191], v[92:95]
  v_exp_f32 v193, v193
  v_mfma_f32_16x16x32_bf16 v[208:211], a[128:131], a[48:51], v[228:231]
  v_exp_f32 v194, v194
  v_mfma_f32_16x16x32_bf16 v[208:211], a[132:135], a[52:55], v[208:211]
  v_exp_f32 v195, v195
  v_mfma_f32_16x16x32_bf16 v[208:211], a[136:139], a[56:59], v[208:211]
  v_cvt_pk_bf16_f32 v192, v192, v193
  v_cvt_pk_bf16_f32 v193, v194, v195
  v_mfma_f32_16x16x32_bf16 v[208:211], a[140:143], a[60:63], v[208:211]
  v_exp_f32 v196, v196
  v_mfma_f32_16x16x32_bf16 v[212:215], a[156:159], a[60:63], v[228:231]
  v_exp_f32 v197, v197
  v_mfma_f32_16x16x32_bf16 v[212:215], a[152:155], a[56:59], v[212:215]
  v_exp_f32 v198, v198
  v_mfma_f32_16x16x32_bf16 v[212:215], a[148:151], a[52:55], v[212:215]
  v_exp_f32 v199, v199
  v_mfma_f32_16x16x32_bf16 v[212:215], a[144:147], a[48:51], v[212:215]
  v_cvt_pk_bf16_f32 v194, v196, v197
  v_cvt_pk_bf16_f32 v195, v198, v199
  v_smfmac_f32_16x16x64_bf16 a[240:243], a[228:231], v[200:207], v253
  s_add_u32 m0, s38, 57344
  s_waitcnt lgkmcnt(0)
  v_lshlrev_b32 v254, 16, v240
  v_mfma_f32_16x16x32_bf16 v[64:67], v[204:207], a[192:195], v[64:67]
  buffer_load_dwordx4 v252, s[20:23], s33 offen nt lds
  v_mfma_f32_16x16x32_bf16 v[68:71], v[204:207], a[196:199], v[68:71]
  v_exp_f32 v208, v208
  v_mfma_f32_16x16x32_bf16 v[72:75], v[204:207], a[200:203], v[72:75]
  v_exp_f32 v209, v209
  v_mfma_f32_16x16x32_bf16 v[76:79], v[204:207], a[204:207], v[76:79]
  v_exp_f32 v210, v210
  v_mfma_f32_16x16x32_bf16 v[80:83], v[204:207], a[208:211], v[80:83]
  v_exp_f32 v211, v211
  v_mfma_f32_16x16x32_bf16 v[84:87], v[204:207], a[212:215], v[84:87]
  v_cvt_pk_bf16_f32 v196, v208, v209
  v_cvt_pk_bf16_f32 v197, v210, v211
  v_mfma_f32_16x16x32_bf16 v[88:91], v[204:207], a[216:219], v[88:91]
  s_add_u32 m0, s38, 61312
  v_exp_f32 v212, v212
  v_mfma_f32_16x16x32_bf16 v[92:95], v[204:207], a[220:223], v[92:95]
  buffer_load_dwordx4 v252, s[20:23], s33 offen offset:128 nt lds
  v_mfma_f32_16x16x32_bf16 v[200:203], a[96:99], a[64:67], v[232:235]
  s_add_u32 s34, s34, 1
  v_exp_f32 v213, v213
  v_mfma_f32_16x16x32_bf16 v[200:203], a[100:103], a[68:71], v[200:203]
  s_add_u32 s33, s33, 8192
  v_exp_f32 v214, v214
  v_mfma_f32_16x16x32_bf16 v[200:203], a[104:107], a[72:75], v[200:203]
  v_exp_f32 v215, v215
  v_mfma_f32_16x16x32_bf16 v[200:203], a[108:111], a[76:79], v[200:203]
  v_cvt_pk_bf16_f32 v198, v212, v213
  v_cvt_pk_bf16_f32 v199, v214, v215
  v_and_b32 v240, 0xffff0000, v240
  v_mfma_f32_16x16x32_bf16 v[204:207], a[124:127], a[76:79], v[232:235]
  v_mul_f32 v254, s40, v254
  v_mul_f32 v240, s40, v240
  v_mfma_f32_16x16x32_bf16 v[204:207], a[120:123], a[72:75], v[204:207]
  v_cvt_pk_bf16_f32 v240, v254, v240
  v_lshlrev_b32 v254, 16, v241
  v_mfma_f32_16x16x32_bf16 v[204:207], a[116:119], a[68:71], v[204:207]
  v_and_b32 v241, 0xffff0000, v241
  v_mul_f32 v254, s40, v254
  v_mfma_f32_16x16x32_bf16 v[204:207], a[112:115], a[64:67], v[204:207]
  v_exp_f32 v200, v200
  v_smfmac_f32_16x16x64_bf16 a[240:243], a[232:235], v[192:199], v253
  ds_read_b128 a[96:99], v246 offset:0
  v_mfma_f32_16x16x32_bf16 v[96:99], v[192:195], a[160:163], v[96:99]
  ds_read_b128 a[100:103], v247 offset:0
  v_mul_f32 v241, s40, v241
  v_mfma_f32_16x16x32_bf16 v[96:99], v[196:199], a[192:195], v[96:99]
  v_exp_f32 v201, v201
  v_mfma_f32_16x16x32_bf16 v[100:103], v[196:199], a[196:199], v[100:103]
  ds_read_b128 a[104:107], v246 offset:4096
  v_cvt_pk_bf16_f32 v200, v200, v201
  v_mfma_f32_16x16x32_bf16 v[100:103], v[192:195], a[164:167], v[100:103]
  s_mov_b32 m0, s37
  v_exp_f32 v202, v202
  v_mfma_f32_16x16x32_bf16 v[104:107], v[192:195], a[168:171], v[104:107]
  buffer_load_dwordx4 v252, s[24:27], s36 offen nt lds
  v_mfma_f32_16x16x32_bf16 v[104:107], v[196:199], a[200:203], v[104:107]
  v_exp_f32 v203, v203
  v_mfma_f32_16x16x32_bf16 v[108:111], v[196:199], a[204:207], v[108:111]
  ds_read_b128 a[108:111], v247 offset:4096
  v_cvt_pk_bf16_f32 v201, v202, v203
  v_mfma_f32_16x16x32_bf16 v[108:111], v[192:195], a[172:175], v[108:111]
  v_exp_f32 v204, v204
  v_mfma_f32_16x16x32_bf16 v[208:211], a[128:131], a[64:67], v[232:235]
  ds_read_b128 a[112:115], v246 offset:2048
  v_cvt_pk_bf16_f32 v241, v254, v241
  v_mfma_f32_16x16x32_bf16 v[208:211], a[132:135], a[68:71], v[208:211]
  v_exp_f32 v205, v205
  v_mfma_f32_16x16x32_bf16 v[208:211], a[136:139], a[72:75], v[208:211]
  ds_read_b128 a[116:119], v247 offset:2048
  v_cvt_pk_bf16_f32 v202, v204, v205
  v_mfma_f32_16x16x32_bf16 v[208:211], a[140:143], a[76:79], v[208:211]
  s_add_u32 m0, s37, 12160
  v_exp_f32 v206, v206
  v_mfma_f32_16x16x32_bf16 v[212:215], a[156:159], a[76:79], v[232:235]
  buffer_load_dwordx4 v252, s[24:27], s36 offen offset:128 nt lds
  v_mfma_f32_16x16x32_bf16 v[212:215], a[152:155], a[72:75], v[212:215]
  s_add_u32 s37, s37, 1024
  v_exp_f32 v207, v207
  v_mfma_f32_16x16x32_bf16 v[212:215], a[148:151], a[68:71], v[212:215]
  s_add_u32 s36, s36, 2048
  ds_read_b128 a[120:123], v246 offset:6144
  v_cvt_pk_bf16_f32 v203, v206, v207
  v_lshlrev_b32 v254, 16, v242
  v_mfma_f32_16x16x32_bf16 v[212:215], a[144:147], a[64:67], v[212:215]
  v_exp_f32 v208, v208
  v_mfma_f32_16x16x32_bf16 v[112:115], v[192:195], a[176:179], v[112:115]
  ds_read_b128 a[124:127], v247 offset:6144
  v_and_b32 v242, 0xffff0000, v242
  v_mfma_f32_16x16x32_bf16 v[112:115], v[196:199], a[208:211], v[112:115]
  v_exp_f32 v209, v209
  v_mfma_f32_16x16x32_bf16 v[116:119], v[196:199], a[212:215], v[116:119]
  v_cvt_pk_bf16_f32 v204, v208, v209
  v_mul_f32 v254, s40, v254
  v_mfma_f32_16x16x32_bf16 v[116:119], v[192:195], a[180:183], v[116:119]
  v_exp_f32 v210, v210
  v_mfma_f32_16x16x32_bf16 v[120:123], v[192:195], a[184:187], v[120:123]
  v_mul_f32 v242, s40, v242
  v_cvt_pk_bf16_f32 v242, v254, v242
  v_mfma_f32_16x16x32_bf16 v[120:123], v[196:199], a[216:219], v[120:123]
  v_exp_f32 v211, v211
  v_mfma_f32_16x16x32_bf16 v[124:127], v[196:199], a[220:223], v[124:127]
  v_cvt_pk_bf16_f32 v205, v210, v211
  v_lshlrev_b32 v254, 16, v243
  v_mfma_f32_16x16x32_bf16 v[124:127], v[192:195], a[188:191], v[124:127]
  s_waitcnt lgkmcnt(1)
  v_exp_f32 v212, v212
  v_mfma_f32_16x16x32_bf16 v[192:195], a[96:99], a[0:3], v[216:219]
  ds_read_b128 a[128:131], v246 offset:16384
  v_and_b32 v243, 0xffff0000, v243
  v_mfma_f32_16x16x32_bf16 v[192:195], a[100:103], a[4:7], v[192:195]
  v_exp_f32 v213, v213
  v_mfma_f32_16x16x32_bf16 v[192:195], a[104:107], a[8:11], v[192:195]
  ds_read_b128 a[132:135], v247 offset:16384
  v_cvt_pk_bf16_f32 v206, v212, v213
  v_mfma_f32_16x16x32_bf16 v[192:195], a[108:111], a[12:15], v[192:195]
  s_waitcnt lgkmcnt(2)
  v_exp_f32 v214, v214
  v_mfma_f32_16x16x32_bf16 v[196:199], a[124:127], a[12:15], v[216:219]
  ds_read_b128 a[136:139], v246 offset:20480
  v_mul_f32 v254, s40, v254
  v_mfma_f32_16x16x32_bf16 v[196:199], a[120:123], a[8:11], v[196:199]
  v_exp_f32 v215, v215
  v_mfma_f32_16x16x32_bf16 v[196:199], a[116:119], a[4:7], v[196:199]
  ds_read_b128 a[140:143], v247 offset:20480
  v_cvt_pk_bf16_f32 v207, v214, v215
  v_mfma_f32_16x16x32_bf16 v[196:199], a[112:115], a[0:3], v[196:199]
  v_exp_f32 v192, v192
  v_smfmac_f32_16x16x64_bf16 a[244:247], a[228:231], v[200:207], v253
  ds_read_b128 a[144:147], v246 offset:18432
  v_mfma_f32_16x16x32_bf16 v[128:131], v[200:203], a[160:163], v[128:131]
  ds_read_b128 a[148:151], v247 offset:18432
  ds_read_b128 a[152:155], v246 offset:22528
  v_mfma_f32_16x16x32_bf16 v[128:131], v[204:207], a[192:195], v[128:131]
  v_exp_f32 v193, v193
  v_mul_f32 v243, s40, v243
  v_mfma_f32_16x16x32_bf16 v[132:135], v[204:207], a[196:199], v[132:135]
  ds_read_b128 a[156:159], v247 offset:22528
  v_cvt_pk_bf16_f32 v192, v192, v193
  v_mfma_f32_16x16x32_bf16 v[132:135], v[200:203], a[164:167], v[132:135]
  v_exp_f32 v194, v194
  v_mfma_f32_16x16x32_bf16 v[136:139], v[200:203], a[168:171], v[136:139]
  ds_read_b64_tr_b16 a[160:161], v248 offset:8192
  ds_read_b64_tr_b16 a[162:163], v248 offset:10240
  v_mfma_f32_16x16x32_bf16 v[136:139], v[204:207], a[200:203], v[136:139]
  v_exp_f32 v195, v195
  v_mfma_f32_16x16x32_bf16 v[140:143], v[204:207], a[204:207], v[140:143]
  ds_read_b64_tr_b16 a[192:193], v248 offset:24576
  v_cvt_pk_bf16_f32 v193, v194, v195
  v_mfma_f32_16x16x32_bf16 v[140:143], v[200:203], a[172:175], v[140:143]
  s_waitcnt lgkmcnt(6)
  v_exp_f32 v196, v196
  v_mfma_f32_16x16x32_bf16 v[208:211], a[128:131], a[0:3], v[216:219]
  ds_read_b64_tr_b16 a[194:195], v248 offset:26624
  ds_read_b64_tr_b16 a[164:165], v249 offset:8192
  v_mfma_f32_16x16x32_bf16 v[208:211], a[132:135], a[4:7], v[208:211]
  v_exp_f32 v197, v197
  v_mfma_f32_16x16x32_bf16 v[208:211], a[136:139], a[8:11], v[208:211]
  ds_read_b64_tr_b16 a[166:167], v249 offset:10240
  v_cvt_pk_bf16_f32 v194, v196, v197
  v_mfma_f32_16x16x32_bf16 v[208:211], a[140:143], a[12:15], v[208:211]
  s_waitcnt lgkmcnt(6)
  v_exp_f32 v198, v198
  v_mfma_f32_16x16x32_bf16 v[212:215], a[156:159], a[12:15], v[216:219]
  ds_read_b64_tr_b16 a[196:197], v249 offset:24576
  ds_read_b64_tr_b16 a[198:199], v249 offset:26624
  v_mfma_f32_16x16x32_bf16 v[212:215], a[152:155], a[8:11], v[212:215]
  v_exp_f32 v199, v199
  v_mfma_f32_16x16x32_bf16 v[212:215], a[148:151], a[4:7], v[212:215]
  ds_read_b64_tr_b16 a[168:169], v250 offset:8192
  v_cvt_pk_bf16_f32 v195, v198, v199
  v_mfma_f32_16x16x32_bf16 v[212:215], a[144:147], a[0:3], v[212:215]
  v_exp_f32 v208, v208
  v_mfma_f32_16x16x32_bf16 v[144:147], v[200:203], a[176:179], v[144:147]
  ds_read_b64_tr_b16 a[170:171], v250 offset:10240
  ds_read_b64_tr_b16 a[200:201], v250 offset:24576
  v_mfma_f32_16x16x32_bf16 v[144:147], v[204:207], a[208:211], v[144:147]
  v_exp_f32 v209, v209
  v_mfma_f32_16x16x32_bf16 v[148:151], v[204:207], a[212:215], v[148:151]
  ds_read_b64_tr_b16 a[202:203], v250 offset:26624
  v_cvt_pk_bf16_f32 v196, v208, v209
  v_mfma_f32_16x16x32_bf16 v[148:151], v[200:203], a[180:183], v[148:151]
  v_exp_f32 v210, v210
  v_mfma_f32_16x16x32_bf16 v[152:155], v[200:203], a[184:187], v[152:155]
  ds_read_b64_tr_b16 a[172:173], v251 offset:8192
  ds_read_b64_tr_b16 a[174:175], v251 offset:10240
  v_mfma_f32_16x16x32_bf16 v[152:155], v[204:207], a[216:219], v[152:155]
  v_exp_f32 v211, v211
  v_cvt_pk_bf16_f32 v243, v254, v243
  v_mfma_f32_16x16x32_bf16 v[156:159], v[204:207], a[220:223], v[156:159]
  ds_read_b64_tr_b16 a[204:205], v251 offset:24576
  ds_write_b128 v255, v[240:243] offset:12288
  v_cvt_pk_bf16_f32 v197, v210, v211
  v_mfma_f32_16x16x32_bf16 v[156:159], v[200:203], a[188:191], v[156:159]
  v_exp_f32 v212, v212
  v_add_u32 v255, 1024, v255
  v_mfma_f32_16x16x32_bf16 v[200:203], a[96:99], a[16:19], v[220:223]
  ds_read_b64_tr_b16 a[206:207], v251 offset:26624
  ds_read_b64_tr_b16 a[176:177], v248 offset:12288
  v_mfma_f32_16x16x32_bf16 v[200:203], a[100:103], a[20:23], v[200:203]
  v_exp_f32 v213, v213
  v_mfma_f32_16x16x32_bf16 v[200:203], a[104:107], a[24:27], v[200:203]
  ds_read_b64_tr_b16 a[178:179], v248 offset:14336
  v_cvt_pk_bf16_f32 v198, v212, v213
  v_mfma_f32_16x16x32_bf16 v[200:203], a[108:111], a[28:31], v[200:203]
  v_exp_f32 v214, v214
  v_mfma_f32_16x16x32_bf16 v[204:207], a[124:127], a[28:31], v[220:223]
  ds_read_b64_tr_b16 a[208:209], v248 offset:28672
  ds_read_b64_tr_b16 a[210:211], v248 offset:30720
  v_mfma_f32_16x16x32_bf16 v[204:207], a[120:123], a[24:27], v[204:207]
  v_exp_f32 v215, v215
  v_mfma_f32_16x16x32_bf16 v[204:207], a[116:119], a[20:23], v[204:207]
  ds_read_b64_tr_b16 a[180:181], v249 offset:12288
  v_cvt_pk_bf16_f32 v199, v214, v215
  v_mfma_f32_16x16x32_bf16 v[204:207], a[112:115], a[16:19], v[204:207]
  v_exp_f32 v200, v200
  v_smfmac_f32_16x16x64_bf16 a[236:239], a[228:231], v[192:199], v253
  s_waitcnt lgkmcnt(4)
  ds_read_b64_tr_b16 a[182:183], v249 offset:14336
  v_mfma_f32_16x16x32_bf16 v[0:3], v[192:195], a[160:163], v[0:3]
  ds_read_b64_tr_b16 a[212:213], v249 offset:28672
  ds_read_b64_tr_b16 a[214:215], v249 offset:30720
  v_mfma_f32_16x16x32_bf16 v[0:3], v[196:199], a[192:195], v[0:3]
  v_exp_f32 v201, v201
  v_mfma_f32_16x16x32_bf16 v[4:7], v[196:199], a[196:199], v[4:7]
  ds_read_b64_tr_b16 a[184:185], v250 offset:12288
  v_cvt_pk_bf16_f32 v200, v200, v201
  v_mfma_f32_16x16x32_bf16 v[4:7], v[192:195], a[164:167], v[4:7]
  v_exp_f32 v202, v202
  v_mfma_f32_16x16x32_bf16 v[8:11], v[192:195], a[168:171], v[8:11]
  ds_read_b64_tr_b16 a[186:187], v250 offset:14336
  ds_read_b64_tr_b16 a[216:217], v250 offset:28672
  v_mfma_f32_16x16x32_bf16 v[8:11], v[196:199], a[200:203], v[8:11]
  v_exp_f32 v203, v203
  v_mfma_f32_16x16x32_bf16 v[12:15], v[196:199], a[204:207], v[12:15]
  ds_read_b64_tr_b16 a[218:219], v250 offset:30720
  v_cvt_pk_bf16_f32 v201, v202, v203
  v_mfma_f32_16x16x32_bf16 v[12:15], v[192:195], a[172:175], v[12:15]
  v_exp_f32 v204, v204
  v_mfma_f32_16x16x32_bf16 v[208:211], a[128:131], a[16:19], v[220:223]
  ds_read_b64_tr_b16 a[188:189], v251 offset:12288
  ds_read_b64_tr_b16 a[190:191], v251 offset:14336
  v_mfma_f32_16x16x32_bf16 v[208:211], a[132:135], a[20:23], v[208:211]
  v_exp_f32 v205, v205
  v_mfma_f32_16x16x32_bf16 v[208:211], a[136:139], a[24:27], v[208:211]
  ds_read_b64_tr_b16 a[220:221], v251 offset:28672
  v_cvt_pk_bf16_f32 v202, v204, v205
  v_mfma_f32_16x16x32_bf16 v[208:211], a[140:143], a[28:31], v[208:211]
  v_exp_f32 v206, v206
  v_mfma_f32_16x16x32_bf16 v[212:215], a[156:159], a[28:31], v[220:223]
  ds_read_b64_tr_b16 a[222:223], v251 offset:30720
  v_mfma_f32_16x16x32_bf16 v[212:215], a[152:155], a[24:27], v[212:215]
  v_exp_f32 v207, v207
  v_mfma_f32_16x16x32_bf16 v[212:215], a[148:151], a[20:23], v[212:215]
  v_cvt_pk_bf16_f32 v203, v206, v207
  v_mfma_f32_16x16x32_bf16 v[212:215], a[144:147], a[16:19], v[212:215]
  s_waitcnt lgkmcnt(4)
  v_exp_f32 v208, v208
  v_mfma_f32_16x16x32_bf16 v[16:19], v[192:195], a[176:179], v[16:19]
  v_mfma_f32_16x16x32_bf16 v[16:19], v[196:199], a[208:211], v[16:19]
  v_exp_f32 v209, v209
  v_mfma_f32_16x16x32_bf16 v[20:23], v[196:199], a[212:215], v[20:23]
  v_cvt_pk_bf16_f32 v204, v208, v209
  v_mfma_f32_16x16x32_bf16 v[20:23], v[192:195], a[180:183], v[20:23]
  s_waitcnt vmcnt(10) lgkmcnt(0)
  v_exp_f32 v210, v210
  v_mfma_f32_16x16x32_bf16 v[24:27], v[192:195], a[184:187], v[24:27]
  s_barrier
  v_mfma_f32_16x16x32_bf16 v[24:27], v[196:199], a[216:219], v[24:27]
  v_exp_f32 v211, v211
  v_mfma_f32_16x16x32_bf16 v[28:31], v[196:199], a[220:223], v[28:31]
  v_cvt_pk_bf16_f32 v205, v210, v211
  v_mfma_f32_16x16x32_bf16 v[28:31], v[192:195], a[188:191], v[28:31]
  v_exp_f32 v212, v212
  v_mfma_f32_16x16x32_bf16 v[192:195], a[96:99], a[80:83], v[236:239]
  ds_read_b128 v[240:243], v255 offset:0
  v_mfma_f32_16x16x32_bf16 v[192:195], a[100:103], a[84:87], v[192:195]
  v_exp_f32 v213, v213
  v_mfma_f32_16x16x32_bf16 v[192:195], a[104:107], a[88:91], v[192:195]
  v_cvt_pk_bf16_f32 v206, v212, v213
  v_mfma_f32_16x16x32_bf16 v[192:195], a[108:111], a[92:95], v[192:195]
  s_add_u32 m0, s38, 0
  v_exp_f32 v214, v214
  v_mfma_f32_16x16x32_bf16 v[196:199], a[124:127], a[92:95], v[236:239]
  buffer_load_dwordx4 v252, s[16:19], s33 offen nt lds
  v_mfma_f32_16x16x32_bf16 v[196:199], a[120:123], a[88:91], v[196:199]
  v_exp_f32 v215, v215
  v_mfma_f32_16x16x32_bf16 v[196:199], a[116:119], a[84:87], v[196:199]
  v_cvt_pk_bf16_f32 v207, v214, v215
  v_mfma_f32_16x16x32_bf16 v[196:199], a[112:115], a[80:83], v[196:199]
  v_exp_f32 v192, v192
  v_smfmac_f32_16x16x64_bf16 a[236:239], a[232:235], v[200:207], v253
  s_waitcnt lgkmcnt(0)
  v_lshlrev_b32 v254, 16, v240
  v_mfma_f32_16x16x32_bf16 v[32:35], v[200:203], a[160:163], v[32:35]
  v_and_b32 v240, 0xffff0000, v240
  v_mul_f32 v254, s40, v254
  v_mfma_f32_16x16x32_bf16 v[32:35], v[204:207], a[192:195], v[32:35]
  v_exp_f32 v193, v193
  v_mfma_f32_16x16x32_bf16 v[36:39], v[204:207], a[196:199], v[36:39]
  v_cvt_pk_bf16_f32 v192, v192, v193
  v_mul_f32 v240, s40, v240
  v_mfma_f32_16x16x32_bf16 v[36:39], v[200:203], a[164:167], v[36:39]
  s_add_u32 m0, s38, 3968
  v_exp_f32 v194, v194
  v_mfma_f32_16x16x32_bf16 v[40:43], v[200:203], a[168:171], v[40:43]
  buffer_load_dwordx4 v252, s[16:19], s33 offen offset:128 nt lds
  v_mfma_f32_16x16x32_bf16 v[40:43], v[204:207], a[200:203], v[40:43]
  v_exp_f32 v195, v195
  v_mfma_f32_16x16x32_bf16 v[44:47], v[204:207], a[204:207], v[44:47]
  v_cvt_pk_bf16_f32 v193, v194, v195
  v_cvt_pk_bf16_f32 v240, v254, v240
  v_mfma_f32_16x16x32_bf16 v[44:47], v[200:203], a[172:175], v[44:47]
  v_exp_f32 v196, v196
  v_lshlrev_b32 v254, 16, v241
  v_mfma_f32_16x16x32_bf16 v[208:211], a[128:131], a[80:83], v[236:239]
  v_and_b32 v241, 0xffff0000, v241
  v_mul_f32 v254, s40, v254
  v_mfma_f32_16x16x32_bf16 v[208:211], a[132:135], a[84:87], v[208:211]
  v_exp_f32 v197, v197
  v_mfma_f32_16x16x32_bf16 v[208:211], a[136:139], a[88:91], v[208:211]
  v_cvt_pk_bf16_f32 v194, v196, v197
  v_mul_f32 v241, s40, v241
  v_mfma_f32_16x16x32_bf16 v[208:211], a[140:143], a[92:95], v[208:211]
  s_add_u32 m0, s38, 8192
  v_exp_f32 v198, v198
  v_mfma_f32_16x16x32_bf16 v[212:215], a[156:159], a[92:95], v[236:239]
  buffer_load_dwordx4 v252, s[20:23], s33 offen nt lds
  v_mfma_f32_16x16x32_bf16 v[212:215], a[152:155], a[88:91], v[212:215]
  v_exp_f32 v199, v199
  v_mfma_f32_16x16x32_bf16 v[212:215], a[148:151], a[84:87], v[212:215]
  v_cvt_pk_bf16_f32 v195, v198, v199
  v_cvt_pk_bf16_f32 v241, v254, v241
  v_mfma_f32_16x16x32_bf16 v[212:215], a[144:147], a[80:83], v[212:215]
  v_exp_f32 v208, v208
  v_mfma_f32_16x16x32_bf16 v[48:51], v[200:203], a[176:179], v[48:51]
  v_lshlrev_b32 v254, 16, v242
  v_and_b32 v242, 0xffff0000, v242
  v_mfma_f32_16x16x32_bf16 v[48:51], v[204:207], a[208:211], v[48:51]
  v_exp_f32 v209, v209
  v_mul_f32 v254, s40, v254
  v_mfma_f32_16x16x32_bf16 v[52:55], v[204:207], a[212:215], v[52:55]
  v_cvt_pk_bf16_f32 v196, v208, v209
  v_mul_f32 v242, s40, v242
  v_mfma_f32_16x16x32_bf16 v[52:55], v[200:203], a[180:183], v[52:55]
  s_add_u32 m0, s38, 12160
  v_exp_f32 v210, v210
  v_mfma_f32_16x16x32_bf16 v[56:59], v[200:203], a[184:187], v[56:59]
  buffer_load_dwordx4 v252, s[20:23], s33 offen offset:128 nt lds
  v_mfma_f32_16x16x32_bf16 v[56:59], v[204:207], a[216:219], v[56:59]
  s_add_u32 s34, s34, 1
  v_exp_f32 v211, v211
  v_mfma_f32_16x16x32_bf16 v[60:63], v[204:207], a[220:223], v[60:63]
  s_add_u32 s33, s33, 8192
  v_cvt_pk_bf16_f32 v197, v210, v211
  v_cvt_pk_bf16_f32 v242, v254, v242
  v_mfma_f32_16x16x32_bf16 v[60:63], v[200:203], a[188:191], v[60:63]
  v_exp_f32 v212, v212
  v_mfma_f32_16x16x32_bf16 v[200:203], a[96:99], a[32:35], v[224:227]
  ds_write_b128 v244, v[192:195] offset:0
  v_mfma_f32_16x16x32_bf16 v[200:203], a[100:103], a[36:39], v[200:203]
  v_exp_f32 v213, v213
  v_mfma_f32_16x16x32_bf16 v[200:203], a[104:107], a[40:43], v[200:203]
  v_cvt_pk_bf16_f32 v198, v212, v213
  v_lshlrev_b32 v254, 16, v243
  v_mfma_f32_16x16x32_bf16 v[200:203], a[108:111], a[44:47], v[200:203]
  s_add_u32 m0, s38, 16384
  v_exp_f32 v214, v214
  v_and_b32 v243, 0xffff0000, v243
  v_mfma_f32_16x16x32_bf16 v[204:207], a[124:127], a[44:47], v[224:227]
  buffer_load_dwordx4 v252, s[16:19], s33 offen nt lds
  v_mfma_f32_16x16x32_bf16 v[204:207], a[120:123], a[40:43], v[204:207]
  v_exp_f32 v215, v215
  v_mfma_f32_16x16x32_bf16 v[204:207], a[116:119], a[36:39], v[204:207]
  v_cvt_pk_bf16_f32 v199, v214, v215
  v_mul_f32 v254, s40, v254
  v_mfma_f32_16x16x32_bf16 v[204:207], a[112:115], a[32:35], v[204:207]
  v_exp_f32 v200, v200
  v_mfma_f32_16x16x32_bf16 v[208:211], a[128:131], a[32:35], v[224:227]
  ds_write_b128 v244, v[196:199] offset:1024
  v_mfma_f32_16x16x32_bf16 v[208:211], a[132:135], a[36:39], v[208:211]
  v_exp_f32 v201, v201
  v_mfma_f32_16x16x32_bf16 v[208:211], a[136:139], a[40:43], v[208:211]
  v_exp_f32 v202, v202
  v_mfma_f32_16x16x32_bf16 v[208:211], a[140:143], a[44:47], v[208:211]
  v_exp_f32 v203, v203
  v_mfma_f32_16x16x32_bf16 v[212:215], a[156:159], a[44:47], v[224:227]
  v_cvt_pk_bf16_f32 v200, v200, v201
  v_cvt_pk_bf16_f32 v201, v202, v203
  v_mfma_f32_16x16x32_bf16 v[212:215], a[152:155], a[40:43], v[212:215]
  v_exp_f32 v204, v204
  v_mul_f32 v243, s40, v243
  v_mfma_f32_16x16x32_bf16 v[212:215], a[148:151], a[36:39], v[212:215]
  v_exp_f32 v205, v205
  v_mfma_f32_16x16x32_bf16 v[212:215], a[144:147], a[32:35], v[212:215]
  v_exp_f32 v206, v206
  v_mfma_f32_16x16x32_bf16 v[192:195], a[96:99], a[48:51], v[228:231]
  v_exp_f32 v207, v207
  v_mfma_f32_16x16x32_bf16 v[192:195], a[100:103], a[52:55], v[192:195]
  v_cvt_pk_bf16_f32 v202, v204, v205
  v_cvt_pk_bf16_f32 v203, v206, v207
  v_mfma_f32_16x16x32_bf16 v[192:195], a[104:107], a[56:59], v[192:195]
  s_add_u32 m0, s38, 20352
  v_exp_f32 v208, v208
  v_mfma_f32_16x16x32_bf16 v[192:195], a[108:111], a[60:63], v[192:195]
  buffer_load_dwordx4 v252, s[16:19], s33 offen offset:128 nt lds
  v_mfma_f32_16x16x32_bf16 v[196:199], a[124:127], a[60:63], v[228:231]
  v_exp_f32 v209, v209
  v_mfma_f32_16x16x32_bf16 v[196:199], a[120:123], a[56:59], v[196:199]
  v_exp_f32 v210, v210
  v_mfma_f32_16x16x32_bf16 v[196:199], a[116:119], a[52:55], v[196:199]
  v_exp_f32 v211, v211
  v_mfma_f32_16x16x32_bf16 v[196:199], a[112:115], a[48:51], v[196:199]
  v_cvt_pk_bf16_f32 v204, v208, v209
  v_cvt_pk_bf16_f32 v205, v210, v211
  v_cvt_pk_bf16_f32 v243, v254, v243
  v_mfma_f32_16x16x32_bf16 v[64:67], v[200:203], a[160:163], v[64:67]
  ds_write_b128 v255, v[240:243] offset:0
  v_exp_f32 v212, v212
  v_mfma_f32_16x16x32_bf16 v[68:71], v[200:203], a[164:167], v[68:71]
  v_exp_f32 v213, v213
  v_mfma_f32_16x16x32_bf16 v[72:75], v[200:203], a[168:171], v[72:75]
  ds_read_b128 v[240:243], v255 offset:12288
  v_exp_f32 v214, v214
  v_mfma_f32_16x16x32_bf16 v[76:79], v[200:203], a[172:175], v[76:79]
  v_exp_f32 v215, v215
  v_mfma_f32_16x16x32_bf16 v[80:83], v[200:203], a[176:179], v[80:83]
  v_cvt_pk_bf16_f32 v206, v212, v213
  v_cvt_pk_bf16_f32 v207, v214, v215
  v_mfma_f32_16x16x32_bf16 v[84:87], v[200:203], a[180:183], v[84:87]
  s_waitcnt vmcnt(6) lgkmcnt(2)
  v_exp_f32 v192, v192
  v_mfma_f32_16x16x32_bf16 v[88:91], v[200:203], a[184:187], v[88:91]
  s_barrier
  v_mfma_f32_16x16x32_bf16 v[92:95], v[200:203], a[188:191], v[92:95]
  v_exp_f32 v193, v193
  v_mfma_f32_16x16x32_bf16 v[208:211], a[128:131], a[48:51], v[228:231]
  v_exp_f32 v194, v194
  v_mfma_f32_16x16x32_bf16 v[208:211], a[132:135], a[52:55], v[208:211]
  v_exp_f32 v195, v195
  v_mfma_f32_16x16x32_bf16 v[208:211], a[136:139], a[56:59], v[208:211]
  v_cvt_pk_bf16_f32 v192, v192, v193
  v_cvt_pk_bf16_f32 v193, v194, v195
  v_mfma_f32_16x16x32_bf16 v[208:211], a[140:143], a[60:63], v[208:211]
  v_exp_f32 v196, v196
  v_mfma_f32_16x16x32_bf16 v[212:215], a[156:159], a[60:63], v[228:231]
  v_exp_f32 v197, v197
  v_mfma_f32_16x16x32_bf16 v[212:215], a[152:155], a[56:59], v[212:215]
  v_exp_f32 v198, v198
  v_mfma_f32_16x16x32_bf16 v[212:215], a[148:151], a[52:55], v[212:215]
  v_exp_f32 v199, v199
  v_mfma_f32_16x16x32_bf16 v[212:215], a[144:147], a[48:51], v[212:215]
  v_cvt_pk_bf16_f32 v194, v196, v197
  v_cvt_pk_bf16_f32 v195, v198, v199
  v_smfmac_f32_16x16x64_bf16 a[240:243], a[228:231], v[200:207], v253
  s_add_u32 m0, s38, 24576
  s_waitcnt lgkmcnt(0)
  v_lshlrev_b32 v254, 16, v240
  v_mfma_f32_16x16x32_bf16 v[64:67], v[204:207], a[192:195], v[64:67]
  buffer_load_dwordx4 v252, s[20:23], s33 offen nt lds
  v_mfma_f32_16x16x32_bf16 v[68:71], v[204:207], a[196:199], v[68:71]
  v_exp_f32 v208, v208
  v_mfma_f32_16x16x32_bf16 v[72:75], v[204:207], a[200:203], v[72:75]
  v_exp_f32 v209, v209
  v_mfma_f32_16x16x32_bf16 v[76:79], v[204:207], a[204:207], v[76:79]
  v_exp_f32 v210, v210
  v_mfma_f32_16x16x32_bf16 v[80:83], v[204:207], a[208:211], v[80:83]
  v_exp_f32 v211, v211
  v_mfma_f32_16x16x32_bf16 v[84:87], v[204:207], a[212:215], v[84:87]
  v_cvt_pk_bf16_f32 v196, v208, v209
  v_cvt_pk_bf16_f32 v197, v210, v211
  v_mfma_f32_16x16x32_bf16 v[88:91], v[204:207], a[216:219], v[88:91]
  s_add_u32 m0, s38, 28544
  v_exp_f32 v212, v212
  v_mfma_f32_16x16x32_bf16 v[92:95], v[204:207], a[220:223], v[92:95]
  buffer_load_dwordx4 v252, s[20:23], s33 offen offset:128 nt lds
  v_mfma_f32_16x16x32_bf16 v[200:203], a[96:99], a[64:67], v[232:235]
  s_add_u32 s34, s34, 1
  v_exp_f32 v213, v213
  v_mfma_f32_16x16x32_bf16 v[200:203], a[100:103], a[68:71], v[200:203]
  s_add_u32 s33, s33, 8192
  v_exp_f32 v214, v214
  v_mfma_f32_16x16x32_bf16 v[200:203], a[104:107], a[72:75], v[200:203]
  v_exp_f32 v215, v215
  v_mfma_f32_16x16x32_bf16 v[200:203], a[108:111], a[76:79], v[200:203]
  v_cvt_pk_bf16_f32 v198, v212, v213
  v_cvt_pk_bf16_f32 v199, v214, v215
  v_and_b32 v240, 0xffff0000, v240
  v_mfma_f32_16x16x32_bf16 v[204:207], a[124:127], a[76:79], v[232:235]
  v_mul_f32 v254, s40, v254
  v_mul_f32 v240, s40, v240
  v_mfma_f32_16x16x32_bf16 v[204:207], a[120:123], a[72:75], v[204:207]
  v_cvt_pk_bf16_f32 v240, v254, v240
  v_lshlrev_b32 v254, 16, v241
  v_mfma_f32_16x16x32_bf16 v[204:207], a[116:119], a[68:71], v[204:207]
  v_and_b32 v241, 0xffff0000, v241
  v_mul_f32 v254, s40, v254
  v_mfma_f32_16x16x32_bf16 v[204:207], a[112:115], a[64:67], v[204:207]
  v_exp_f32 v200, v200
  v_smfmac_f32_16x16x64_bf16 a[240:243], a[232:235], v[192:199], v253
  ds_read_b128 a[96:99], v246 offset:32768
  v_mfma_f32_16x16x32_bf16 v[96:99], v[192:195], a[160:163], v[96:99]
  ds_read_b128 a[100:103], v247 offset:32768
  v_mul_f32 v241, s40, v241
  v_mfma_f32_16x16x32_bf16 v[96:99], v[196:199], a[192:195], v[96:99]
  v_exp_f32 v201, v201
  v_mfma_f32_16x16x32_bf16 v[100:103], v[196:199], a[196:199], v[100:103]
  ds_read_b128 a[104:107], v246 offset:36864
  v_cvt_pk_bf16_f32 v200, v200, v201
  v_mfma_f32_16x16x32_bf16 v[100:103], v[192:195], a[164:167], v[100:103]
  s_mov_b32 m0, s37
  v_exp_f32 v202, v202
  v_mfma_f32_16x16x32_bf16 v[104:107], v[192:195], a[168:171], v[104:107]
  buffer_load_dwordx4 v252, s[24:27], s36 offen nt lds
  v_mfma_f32_16x16x32_bf16 v[104:107], v[196:199], a[200:203], v[104:107]
  v_exp_f32 v203, v203
  v_mfma_f32_16x16x32_bf16 v[108:111], v[196:199], a[204:207], v[108:111]
  ds_read_b128 a[108:111], v247 offset:36864
  v_cvt_pk_bf16_f32 v201, v202, v203
  v_mfma_f32_16x16x32_bf16 v[108:111], v[192:195], a[172:175], v[108:111]
  v_exp_f32 v204, v204
  v_mfma_f32_16x16x32_bf16 v[208:211], a[128:131], a[64:67], v[232:235]
  ds_read_b128 a[112:115], v246 offset:34816
  v_cvt_pk_bf16_f32 v241, v254, v241
  v_mfma_f32_16x16x32_bf16 v[208:211], a[132:135], a[68:71], v[208:211]
  v_exp_f32 v205, v205
  v_mfma_f32_16x16x32_bf16 v[208:211], a[136:139], a[72:75], v[208:211]
  ds_read_b128 a[116:119], v247 offset:34816
  v_cvt_pk_bf16_f32 v202, v204, v205
  v_mfma_f32_16x16x32_bf16 v[208:211], a[140:143], a[76:79], v[208:211]
  s_add_u32 m0, s37, 12160
  v_exp_f32 v206, v206
  v_mfma_f32_16x16x32_bf16 v[212:215], a[156:159], a[76:79], v[232:235]
  buffer_load_dwordx4 v252, s[24:27], s36 offen offset:128 nt lds
  v_mfma_f32_16x16x32_bf16 v[212:215], a[152:155], a[72:75], v[212:215]
  s_add_u32 s37, s37, 1024
  v_exp_f32 v207, v207
  v_mfma_f32_16x16x32_bf16 v[212:215], a[148:151], a[68:71], v[212:215]
  s_add_u32 s36, s36, 2048
  ds_read_b128 a[120:123], v246 offset:38912
  v_cvt_pk_bf16_f32 v203, v206, v207
  v_lshlrev_b32 v254, 16, v242
  v_mfma_f32_16x16x32_bf16 v[212:215], a[144:147], a[64:67], v[212:215]
  v_exp_f32 v208, v208
  v_mfma_f32_16x16x32_bf16 v[112:115], v[192:195], a[176:179], v[112:115]
  ds_read_b128 a[124:127], v247 offset:38912
  v_and_b32 v242, 0xffff0000, v242
  v_mfma_f32_16x16x32_bf16 v[112:115], v[196:199], a[208:211], v[112:115]
  v_exp_f32 v209, v209
  v_mfma_f32_16x16x32_bf16 v[116:119], v[196:199], a[212:215], v[116:119]
  v_cvt_pk_bf16_f32 v204, v208, v209
  v_mul_f32 v254, s40, v254
  v_mfma_f32_16x16x32_bf16 v[116:119], v[192:195], a[180:183], v[116:119]
  v_exp_f32 v210, v210
  v_mfma_f32_16x16x32_bf16 v[120:123], v[192:195], a[184:187], v[120:123]
  v_mul_f32 v242, s40, v242
  v_cvt_pk_bf16_f32 v242, v254, v242
  v_mfma_f32_16x16x32_bf16 v[120:123], v[196:199], a[216:219], v[120:123]
  v_exp_f32 v211, v211
  v_mfma_f32_16x16x32_bf16 v[124:127], v[196:199], a[220:223], v[124:127]
  v_cvt_pk_bf16_f32 v205, v210, v211
  v_lshlrev_b32 v254, 16, v243
  v_mfma_f32_16x16x32_bf16 v[124:127], v[192:195], a[188:191], v[124:127]
  s_waitcnt lgkmcnt(1)
  v_exp_f32 v212, v212
  v_mfma_f32_16x16x32_bf16 v[192:195], a[96:99], a[0:3], v[216:219]
  ds_read_b128 a[128:131], v246 offset:49152
  v_and_b32 v243, 0xffff0000, v243
  v_mfma_f32_16x16x32_bf16 v[192:195], a[100:103], a[4:7], v[192:195]
  v_exp_f32 v213, v213
  v_mfma_f32_16x16x32_bf16 v[192:195], a[104:107], a[8:11], v[192:195]
  ds_read_b128 a[132:135], v247 offset:49152
  v_cvt_pk_bf16_f32 v206, v212, v213
  v_mfma_f32_16x16x32_bf16 v[192:195], a[108:111], a[12:15], v[192:195]
  s_waitcnt lgkmcnt(2)
  v_exp_f32 v214, v214
  v_mfma_f32_16x16x32_bf16 v[196:199], a[124:127], a[12:15], v[216:219]
  ds_read_b128 a[136:139], v246 offset:53248
  v_mul_f32 v254, s40, v254
  v_mfma_f32_16x16x32_bf16 v[196:199], a[120:123], a[8:11], v[196:199]
  v_exp_f32 v215, v215
  v_mfma_f32_16x16x32_bf16 v[196:199], a[116:119], a[4:7], v[196:199]
  ds_read_b128 a[140:143], v247 offset:53248
  v_cvt_pk_bf16_f32 v207, v214, v215
  v_mfma_f32_16x16x32_bf16 v[196:199], a[112:115], a[0:3], v[196:199]
  v_exp_f32 v192, v192
  v_smfmac_f32_16x16x64_bf16 a[244:247], a[228:231], v[200:207], v253
  ds_read_b128 a[144:147], v246 offset:51200
  v_mfma_f32_16x16x32_bf16 v[128:131], v[200:203], a[160:163], v[128:131]
  ds_read_b128 a[148:151], v247 offset:51200
  ds_read_b128 a[152:155], v246 offset:55296
  v_mfma_f32_16x16x32_bf16 v[128:131], v[204:207], a[192:195], v[128:131]
  v_exp_f32 v193, v193
  v_mul_f32 v243, s40, v243
  v_mfma_f32_16x16x32_bf16 v[132:135], v[204:207], a[196:199], v[132:135]
  ds_read_b128 a[156:159], v247 offset:55296
  v_cvt_pk_bf16_f32 v192, v192, v193
  v_mfma_f32_16x16x32_bf16 v[132:135], v[200:203], a[164:167], v[132:135]
  v_exp_f32 v194, v194
  v_mfma_f32_16x16x32_bf16 v[136:139], v[200:203], a[168:171], v[136:139]
  ds_read_b64_tr_b16 a[160:161], v248 offset:40960
  ds_read_b64_tr_b16 a[162:163], v248 offset:43008
  v_mfma_f32_16x16x32_bf16 v[136:139], v[204:207], a[200:203], v[136:139]
  v_exp_f32 v195, v195
  v_mfma_f32_16x16x32_bf16 v[140:143], v[204:207], a[204:207], v[140:143]
  ds_read_b64_tr_b16 a[192:193], v248 offset:57344
  v_cvt_pk_bf16_f32 v193, v194, v195
  v_mfma_f32_16x16x32_bf16 v[140:143], v[200:203], a[172:175], v[140:143]
  s_waitcnt lgkmcnt(6)
  v_exp_f32 v196, v196
  v_mfma_f32_16x16x32_bf16 v[208:211], a[128:131], a[0:3], v[216:219]
  ds_read_b64_tr_b16 a[194:195], v248 offset:59392
  ds_read_b64_tr_b16 a[164:165], v249 offset:40960
  v_mfma_f32_16x16x32_bf16 v[208:211], a[132:135], a[4:7], v[208:211]
  v_exp_f32 v197, v197
  v_mfma_f32_16x16x32_bf16 v[208:211], a[136:139], a[8:11], v[208:211]
  ds_read_b64_tr_b16 a[166:167], v249 offset:43008
  v_cvt_pk_bf16_f32 v194, v196, v197
  v_mfma_f32_16x16x32_bf16 v[208:211], a[140:143], a[12:15], v[208:211]
  s_waitcnt lgkmcnt(6)
  v_exp_f32 v198, v198
  v_mfma_f32_16x16x32_bf16 v[212:215], a[156:159], a[12:15], v[216:219]
  ds_read_b64_tr_b16 a[196:197], v249 offset:57344
  ds_read_b64_tr_b16 a[198:199], v249 offset:59392
  v_mfma_f32_16x16x32_bf16 v[212:215], a[152:155], a[8:11], v[212:215]
  v_exp_f32 v199, v199
  v_mfma_f32_16x16x32_bf16 v[212:215], a[148:151], a[4:7], v[212:215]
  ds_read_b64_tr_b16 a[168:169], v250 offset:40960
  v_cvt_pk_bf16_f32 v195, v198, v199
  v_mfma_f32_16x16x32_bf16 v[212:215], a[144:147], a[0:3], v[212:215]
  v_exp_f32 v208, v208
  v_mfma_f32_16x16x32_bf16 v[144:147], v[200:203], a[176:179], v[144:147]
  ds_read_b64_tr_b16 a[170:171], v250 offset:43008
  ds_read_b64_tr_b16 a[200:201], v250 offset:57344
  v_mfma_f32_16x16x32_bf16 v[144:147], v[204:207], a[208:211], v[144:147]
  v_exp_f32 v209, v209
  v_mfma_f32_16x16x32_bf16 v[148:151], v[204:207], a[212:215], v[148:151]
  ds_read_b64_tr_b16 a[202:203], v250 offset:59392
  v_cvt_pk_bf16_f32 v196, v208, v209
  v_mfma_f32_16x16x32_bf16 v[148:151], v[200:203], a[180:183], v[148:151]
  v_exp_f32 v210, v210
  v_mfma_f32_16x16x32_bf16 v[152:155], v[200:203], a[184:187], v[152:155]
  ds_read_b64_tr_b16 a[172:173], v251 offset:40960
  ds_read_b64_tr_b16 a[174:175], v251 offset:43008
  v_mfma_f32_16x16x32_bf16 v[152:155], v[204:207], a[216:219], v[152:155]
  v_exp_f32 v211, v211
  v_cvt_pk_bf16_f32 v243, v254, v243
  v_mfma_f32_16x16x32_bf16 v[156:159], v[204:207], a[220:223], v[156:159]
  ds_read_b64_tr_b16 a[204:205], v251 offset:57344
  ds_write_b128 v255, v[240:243] offset:12288
  v_cvt_pk_bf16_f32 v197, v210, v211
  v_mfma_f32_16x16x32_bf16 v[156:159], v[200:203], a[188:191], v[156:159]
  v_exp_f32 v212, v212
  v_add_u32 v255, 1024, v255
  v_mfma_f32_16x16x32_bf16 v[200:203], a[96:99], a[16:19], v[220:223]
  ds_read_b64_tr_b16 a[206:207], v251 offset:59392
  ds_read_b64_tr_b16 a[176:177], v248 offset:45056
  v_mfma_f32_16x16x32_bf16 v[200:203], a[100:103], a[20:23], v[200:203]
  v_exp_f32 v213, v213
  v_mfma_f32_16x16x32_bf16 v[200:203], a[104:107], a[24:27], v[200:203]
  ds_read_b64_tr_b16 a[178:179], v248 offset:47104
  v_cvt_pk_bf16_f32 v198, v212, v213
  v_mfma_f32_16x16x32_bf16 v[200:203], a[108:111], a[28:31], v[200:203]
  v_exp_f32 v214, v214
  v_mfma_f32_16x16x32_bf16 v[204:207], a[124:127], a[28:31], v[220:223]
  ds_read_b64_tr_b16 a[208:209], v248 offset:61440
  ds_read_b64_tr_b16 a[210:211], v248 offset:63488
  v_mfma_f32_16x16x32_bf16 v[204:207], a[120:123], a[24:27], v[204:207]
  v_exp_f32 v215, v215
  v_mfma_f32_16x16x32_bf16 v[204:207], a[116:119], a[20:23], v[204:207]
  ds_read_b64_tr_b16 a[180:181], v249 offset:45056
  v_cvt_pk_bf16_f32 v199, v214, v215
  v_mfma_f32_16x16x32_bf16 v[204:207], a[112:115], a[16:19], v[204:207]
  v_exp_f32 v200, v200
  v_smfmac_f32_16x16x64_bf16 a[236:239], a[228:231], v[192:199], v253
  s_waitcnt lgkmcnt(4)
  ds_read_b64_tr_b16 a[182:183], v249 offset:47104
  v_mfma_f32_16x16x32_bf16 v[0:3], v[192:195], a[160:163], v[0:3]
  ds_read_b64_tr_b16 a[212:213], v249 offset:61440
  ds_read_b64_tr_b16 a[214:215], v249 offset:63488
  v_mfma_f32_16x16x32_bf16 v[0:3], v[196:199], a[192:195], v[0:3]
  v_exp_f32 v201, v201
  v_mfma_f32_16x16x32_bf16 v[4:7], v[196:199], a[196:199], v[4:7]
  ds_read_b64_tr_b16 a[184:185], v250 offset:45056
  v_cvt_pk_bf16_f32 v200, v200, v201
  v_mfma_f32_16x16x32_bf16 v[4:7], v[192:195], a[164:167], v[4:7]
  v_exp_f32 v202, v202
  v_mfma_f32_16x16x32_bf16 v[8:11], v[192:195], a[168:171], v[8:11]
  ds_read_b64_tr_b16 a[186:187], v250 offset:47104
  ds_read_b64_tr_b16 a[216:217], v250 offset:61440
  v_mfma_f32_16x16x32_bf16 v[8:11], v[196:199], a[200:203], v[8:11]
  v_exp_f32 v203, v203
  v_mfma_f32_16x16x32_bf16 v[12:15], v[196:199], a[204:207], v[12:15]
  ds_read_b64_tr_b16 a[218:219], v250 offset:63488
  v_cvt_pk_bf16_f32 v201, v202, v203
  v_mfma_f32_16x16x32_bf16 v[12:15], v[192:195], a[172:175], v[12:15]
  v_exp_f32 v204, v204
  v_mfma_f32_16x16x32_bf16 v[208:211], a[128:131], a[16:19], v[220:223]
  ds_read_b64_tr_b16 a[188:189], v251 offset:45056
  ds_read_b64_tr_b16 a[190:191], v251 offset:47104
  v_mfma_f32_16x16x32_bf16 v[208:211], a[132:135], a[20:23], v[208:211]
  v_exp_f32 v205, v205
  v_mfma_f32_16x16x32_bf16 v[208:211], a[136:139], a[24:27], v[208:211]
  ds_read_b64_tr_b16 a[220:221], v251 offset:61440
  v_cvt_pk_bf16_f32 v202, v204, v205
  v_mfma_f32_16x16x32_bf16 v[208:211], a[140:143], a[28:31], v[208:211]
  v_exp_f32 v206, v206
  v_mfma_f32_16x16x32_bf16 v[212:215], a[156:159], a[28:31], v[220:223]
  ds_read_b64_tr_b16 a[222:223], v251 offset:63488
  v_mfma_f32_16x16x32_bf16 v[212:215], a[152:155], a[24:27], v[212:215]
  v_exp_f32 v207, v207
  v_mfma_f32_16x16x32_bf16 v[212:215], a[148:151], a[20:23], v[212:215]
  v_cvt_pk_bf16_f32 v203, v206, v207
  v_mfma_f32_16x16x32_bf16 v[212:215], a[144:147], a[16:19], v[212:215]
  s_waitcnt lgkmcnt(4)
  v_exp_f32 v208, v208
  v_mfma_f32_16x16x32_bf16 v[16:19], v[192:195], a[176:179], v[16:19]
  v_mfma_f32_16x16x32_bf16 v[16:19], v[196:199], a[208:211], v[16:19]
  v_exp_f32 v209, v209
  v_mfma_f32_16x16x32_bf16 v[20:23], v[196:199], a[212:215], v[20:23]
  s_cmp_eq_u32 s34, 22
  v_cvt_pk_bf16_f32 v204, v208, v209
  v_mfma_f32_16x16x32_bf16 v[20:23], v[192:195], a[180:183], v[20:23]
  s_waitcnt vmcnt(10) lgkmcnt(0)
  v_exp_f32 v210, v210
  v_mfma_f32_16x16x32_bf16 v[24:27], v[192:195], a[184:187], v[24:27]
  s_barrier
  s_cbranch_scc0 L_hA_hl
  v_mov_b32 v236, 0xf149f2ca
  v_mov_b32 v237, 0xf149f2ca
  v_mov_b32 v238, 0xf149f2ca
  v_mov_b32 v239, 0xf149f2ca
  v_add_u32 v244, s49, v246
  s_waitcnt vmcnt(2)
  s_barrier
  s_branch L_cutA
L_hB:
  s_bitcmp1_b32 s32, 0
  s_cbranch_scc1 L_hB_help
  s_mov_b32 s52, 0
  s_add_u32 s45, s49, 24576
  v_and_b32 v240, 0x7ff, v255
  v_add_u32 v240, s45, v240
L_hB_own:
  v_mfma_f32_16x16x32_bf16 v[24:27], v[196:199], a[216:219], v[24:27]
  v_exp_f32 v211, v211
  v_mfma_f32_16x16x32_bf16 v[28:31], v[196:199], a[220:223], v[28:31]
  v_cvt_pk_bf16_f32 v205, v210, v211
  v_mfma_f32_16x16x32_bf16 v[28:31], v[192:195], a[188:191], v[28:31]
  v_exp_f32 v212, v212
  v_mfma_f32_16x16x32_bf16 v[192:195], a[96:99], a[32:35], v[224:227]
  v_mfma_f32_16x16x32_bf16 v[192:195], a[100:103], a[36:39], v[192:195]
  v_exp_f32 v213, v213
  v_mfma_f32_16x16x32_bf16 v[192:195], a[104:107], a[40:43], v[192:195]
  v_cvt_pk_bf16_f32 v206, v212, v213
  v_mfma_f32_16x16x32_bf16 v[192:195], a[108:111], a[44:47], v[192:195]
  s_add_u32 m0, s38, 32768
  v_exp_f32 v214, v214
  v_mfma_f32_16x16x32_bf16 v[196:199], a[124:127], a[44:47], v[224:227]
  buffer_load_dwordx4 v252, s[16:19], s33 offen nt lds
  v_mfma_f32_16x16x32_bf16 v[196:199], a[120:123], a[40:43], v[196:199]
  v_exp_f32 v215, v215
  v_mfma_f32_16x16x32_bf16 v[196:199], a[116:119], a[36:39], v[196:199]
  v_cvt_pk_bf16_f32 v207, v214, v215
  v_mfma_f32_16x16x32_bf16 v[196:199], a[112:115], a[32:35], v[196:199]
  v_exp_f32 v192, v192
  v_smfmac_f32_16x16x64_bf16 a[236:239], a[232:235], v[200:207], v253
  ds_read_b64_tr_b16 a[248:249], v244 offset:0
  v_mfma_f32_16x16x32_bf16 v[32:35], v[200:203], a[160:163], v[32:35]
  ds_read_b64_tr_b16 a[250:251], v244 offset:64
  v_mfma_f32_16x16x32_bf16 v[32:35], v[204:207], a[192:195], v[32:35]
  v_exp_f32 v193, v193
  v_mfma_f32_16x16x32_bf16 v[36:39], v[204:207], a[196:199], v[36:39]
  v_cvt_pk_bf16_f32 v192, v192, v193
  v_mfma_f32_16x16x32_bf16 v[36:39], v[200:203], a[164:167], v[36:39]
  s_add_u32 m0, s38, 36736
  v_exp_f32 v194, v194
  v_mfma_f32_16x16x32_bf16 v[40:43], v[200:203], a[168:171], v[40:43]
  buffer_load_dwordx4 v252, s[16:19], s33 offen offset:128 nt lds
  v_mfma_f32_16x16x32_bf16 v[40:43], v[204:207], a[200:203], v[40:43]
  v_exp_f32 v195, v195
  v_mfma_f32_16x16x32_bf16 v[44:47], v[204:207], a[204:207], v[44:47]
  v_cvt_pk_bf16_f32 v193, v194, v195
  v_mfma_f32_16x16x32_bf16 v[44:47], v[200:203], a[172:175], v[44:47]
  v_exp_f32 v196, v196
  v_mfma_f32_16x16x32_bf16 v[208:211], a[128:131], a[32:35], v[224:227]
  v_mfma_f32_16x16x32_bf16 v[208:211], a[132:135], a[36:39], v[208:211]
  v_exp_f32 v197, v197
  v_mfma_f32_16x16x32_bf16 v[208:211], a[136:139], a[40:43], v[208:211]
  v_cvt_pk_bf16_f32 v194, v196, v197
  v_mfma_f32_16x16x32_bf16 v[208:211], a[140:143], a[44:47], v[208:211]
  s_add_u32 m0, s38, 40960
  v_exp_f32 v198, v198
  v_mfma_f32_16x16x32_bf16 v[212:215], a[156:159], a[44:47], v[224:227]
  buffer_load_dwordx4 v252, s[20:23], s33 offen nt lds
  v_mfma_f32_16x16x32_bf16 v[212:215], a[152:155], a[40:43], v[212:215]
  v_exp_f32 v199, v199
  v_mfma_f32_16x16x32_bf16 v[212:215], a[148:151], a[36:39], v[212:215]
  v_cvt_pk_bf16_f32 v195, v198, v199
  v_mfma_f32_16x16x32_bf16 v[212:215], a[144:147], a[32:35], v[212:215]
  v_exp_f32 v208, v208
  v_mfma_f32_16x16x32_bf16 v[48:51], v[200:203], a[176:179], v[48:51]
  v_mfma_f32_16x16x32_bf16 v[48:51], v[204:207], a[208:211], v[48:51]
  v_exp_f32 v209, v209
  v_mfma_f32_16x16x32_bf16 v[52:55], v[204:207], a[212:215], v[52:55]
  v_cvt_pk_bf16_f32 v196, v208, v209
  v_mfma_f32_16x16x32_bf16 v[52:55], v[200:203], a[180:183], v[52:55]
  s_add_u32 m0, s38, 44928
  v_exp_f32 v210, v210
  v_mfma_f32_16x16x32_bf16 v[56:59], v[200:203], a[184:187], v[56:59]
  buffer_load_dwordx4 v252, s[20:23], s33 offen offset:128 nt lds
  v_mfma_f32_16x16x32_bf16 v[56:59], v[204:207], a[216:219], v[56:59]
  s_add_u32 s34, s34, 1
  v_exp_f32 v211, v211
  v_mfma_f32_16x16x32_bf16 v[60:63], v[204:207], a[220:223], v[60:63]
  s_add_u32 s33, s33, 8192
  v_cvt_pk_bf16_f32 v197, v210, v211
  v_mfma_f32_16x16x32_bf16 v[60:63], v[200:203], a[188:191], v[60:63]
  v_exp_f32 v212, v212
  v_mfma_f32_16x16x32_bf16 v[200:203], a[96:99], a[48:51], v[228:231]
  v_mfma_f32_16x16x32_bf16 v[200:203], a[100:103], a[52:55], v[200:203]
  v_exp_f32 v213, v213
  v_mfma_f32_16x16x32_bf16 v[200:203], a[104:107], a[56:59], v[200:203]
  v_cvt_pk_bf16_f32 v198, v212, v213
  v_mfma_f32_16x16x32_bf16 v[200:203], a[108:111], a[60:63], v[200:203]
  s_add_u32 m0, s38, 49152
  v_exp_f32 v214, v214
  v_mfma_f32_16x16x32_bf16 v[204:207], a[124:127], a[60:63], v[228:231]
  buffer_load_dwordx4 v252, s[16:19], s33 offen nt lds
  v_mfma_f32_16x16x32_bf16 v[204:207], a[120:123], a[56:59], v[204:207]
  v_exp_f32 v215, v215
  v_mfma_f32_16x16x32_bf16 v[204:207], a[116:119], a[52:55], v[204:207]
  v_cvt_pk_bf16_f32 v199, v214, v215
  v_mfma_f32_16x16x32_bf16 v[204:207], a[112:115], a[48:51], v[204:207]
  v_exp_f32 v200, v200
  v_smfmac_f32_16x16x64_bf16 a[240:243], a[228:231], v[192:199], v253
  v_mfma_f32_16x16x32_bf16 v[64:67], v[192:195], a[160:163], v[64:67]
  v_mfma_f32_16x16x32_bf16 v[64:67], v[196:199], a[192:195], v[64:67]
  v_exp_f32 v201, v201
  v_mfma_f32_16x16x32_bf16 v[68:71], v[196:199], a[196:199], v[68:71]
  v_cvt_pk_bf16_f32 v200, v200, v201
  v_mfma_f32_16x16x32_bf16 v[68:71], v[192:195], a[164:167], v[68:71]
  s_add_u32 m0, s38, 53120
  v_exp_f32 v202, v202
  v_mfma_f32_16x16x32_bf16 v[72:75], v[192:195], a[168:171], v[72:75]
  buffer_load_dwordx4 v252, s[16:19], s33 offen offset:128 nt lds
  v_mfma_f32_16x16x32_bf16 v[72:75], v[196:199], a[200:203], v[72:75]
  v_exp_f32 v203, v203
  v_mfma_f32_16x16x32_bf16 v[76:79], v[196:199], a[204:207], v[76:79]
  v_cvt_pk_bf16_f32 v201, v202, v203
  v_mfma_f32_16x16x32_bf16 v[76:79], v[192:195], a[172:175], v[76:79]
  v_exp_f32 v204, v204
  v_mfma_f32_16x16x32_bf16 v[208:211], a[128:131], a[48:51], v[228:231]
  v_mfma_f32_16x16x32_bf16 v[208:211], a[132:135], a[52:55], v[208:211]
  v_exp_f32 v205, v205
  v_mfma_f32_16x16x32_bf16 v[208:211], a[136:139], a[56:59], v[208:211]
  v_cvt_pk_bf16_f32 v202, v204, v205
  v_mfma_f32_16x16x32_bf16 v[208:211], a[140:143], a[60:63], v[208:211]
  s_add_u32 m0, s38, 57344
  v_exp_f32 v206, v206
  v_mfma_f32_16x16x32_bf16 v[212:215], a[156:159], a[60:63], v[228:231]
  buffer_load_dwordx4 v252, s[20:23], s33 offen nt lds
  v_mfma_f32_16x16x32_bf16 v[212:215], a[152:155], a[56:59], v[212:215]
  v_exp_f32 v207, v207
  v_mfma_f32_16x16x32_bf16 v[212:215], a[148:151], a[52:55], v[212:215]
  v_cvt_pk_bf16_f32 v203, v206, v207
  v_mfma_f32_16x16x32_bf16 v[212:215], a[144:147], a[48:51], v[212:215]
  v_exp_f32 v208, v208
  v_mfma_f32_16x16x32_bf16 v[80:83], v[192:195], a[176:179], v[80:83]
  v_mfma_f32_16x16x32_bf16 v[80:83], v[196:199], a[208:211], v[80:83]
  v_exp_f32 v209, v209
  v_mfma_f32_16x16x32_bf16 v[84:87], v[196:199], a[212:215], v[84:87]
  v_cvt_pk_bf16_f32 v204, v208, v209
  v_mfma_f32_16x16x32_bf16 v[84:87], v[192:195], a[180:183], v[84:87]
  s_add_u32 m0, s38, 61312
  v_exp_f32 v210, v210
  v_mfma_f32_16x16x32_bf16 v[88:91], v[192:195], a[184:187], v[88:91]
  buffer_load_dwordx4 v252, s[20:23], s33 offen offset:128 nt lds
  v_mfma_f32_16x16x32_bf16 v[88:91], v[196:199], a[216:219], v[88:91]
  s_add_u32 s34, s34, 1
  v_exp_f32 v211, v211
  v_mfma_f32_16x16x32_bf16 v[92:95], v[196:199], a[220:223], v[92:95]
  s_add_u32 s33, s33, 8192
  v_cvt_pk_bf16_f32 v205, v210, v211
  v_mfma_f32_16x16x32_bf16 v[92:95], v[192:195], a[188:191], v[92:95]
  s_waitcnt vmcnt(8)
  v_exp_f32 v212, v212
  v_mfma_f32_16x16x32_bf16 v[192:195], a[96:99], a[64:67], v[232:235]
  s_barrier
  v_mfma_f32_16x16x32_bf16 v[192:195], a[100:103], a[68:71], v[192:195]
  s_waitcnt lgkmcnt(0)
  buffer_store_dwordx4 a[248:251], v245, s[28:31], s42 offen offset:0 nt
  v_exp_f32 v213, v213
  v_mfma_f32_16x16x32_bf16 v[192:195], a[104:107], a[72:75], v[192:195]
  v_cvt_pk_bf16_f32 v206, v212, v213
  v_mfma_f32_16x16x32_bf16 v[192:195], a[108:111], a[76:79], v[192:195]
  v_exp_f32 v214, v214
  v_mfma_f32_16x16x32_bf16 v[196:199], a[124:127], a[76:79], v[232:235]
  ds_read_b64_tr_b16 a[248:249], v244 offset:12288
  ds_read_b64_tr_b16 a[250:251], v244 offset:12352
  v_mfma_f32_16x16x32_bf16 v[196:199], a[120:123], a[72:75], v[196:199]
  v_exp_f32 v215, v215
  v_mfma_f32_16x16x32_bf16 v[196:199], a[116:119], a[68:71], v[196:199]
  v_cvt_pk_bf16_f32 v207, v214, v215
  v_add_u32 v244, 1024, v244
  v_mfma_f32_16x16x32_bf16 v[196:199], a[112:115], a[64:67], v[196:199]
  v_exp_f32 v192, v192
  v_smfmac_f32_16x16x64_bf16 a[240:243], a[232:235], v[200:207], v253
  v_mfma_f32_16x16x32_bf16 v[96:99], v[200:203], a[160:163], v[96:99]
  v_mfma_f32_16x16x32_bf16 v[96:99], v[204:207], a[192:195], v[96:99]
  v_exp_f32 v193, v193
  v_mfma_f32_16x16x32_bf16 v[100:103], v[204:207], a[196:199], v[100:103]
  v_cvt_pk_bf16_f32 v192, v192, v193
  v_mfma_f32_16x16x32_bf16 v[100:103], v[200:203], a[164:167], v[100:103]
  v_exp_f32 v194, v194
  v_mfma_f32_16x16x32_bf16 v[104:107], v[200:203], a[168:171], v[104:107]
  ds_read_b128 a[96:99], v246 offset:0
  v_mfma_f32_16x16x32_bf16 v[104:107], v[204:207], a[200:203], v[104:107]
  v_exp_f32 v195, v195
  v_mfma_f32_16x16x32_bf16 v[108:111], v[204:207], a[204:207], v[108:111]
  ds_read_b128 a[100:103], v247 offset:0
  v_cvt_pk_bf16_f32 v193, v194, v195
  v_mfma_f32_16x16x32_bf16 v[108:111], v[200:203], a[172:175], v[108:111]
  s_waitcnt lgkmcnt(2)
  buffer_store_dwordx4 a[248:251], v245, s[28:31], s42 offen offset:128 nt
  v_exp_f32 v196, v196
  v_mfma_f32_16x16x32_bf16 v[208:211], a[128:131], a[64:67], v[232:235]
  s_add_u32 s42, s42, 2048
  ds_read_b128 a[104:107], v246 offset:4096
  v_mfma_f32_16x16x32_bf16 v[208:211], a[132:135], a[68:71], v[208:211]
  v_exp_f32 v197, v197
  v_mfma_f32_16x16x32_bf16 v[208:211], a[136:139], a[72:75], v[208:211]
  ds_read_b128 a[248:251], v240 offset:0
  v_cvt_pk_bf16_f32 v194, v196, v197
  v_mfma_f32_16x16x32_bf16 v[208:211], a[140:143], a[76:79], v[208:211]
  v_exp_f32 v198, v198
  v_mfma_f32_16x16x32_bf16 v[212:215], a[156:159], a[76:79], v[232:235]
  ds_read_b128 a[252:255], v240 offset:256
  v_mfma_f32_16x16x32_bf16 v[212:215], a[152:155], a[72:75], v[212:215]
  v_exp_f32 v199, v199
  v_mfma_f32_16x16x32_bf16 v[212:215], a[148:151], a[68:71], v[212:215]
  ds_read_b128 a[108:111], v247 offset:4096
  v_cvt_pk_bf16_f32 v195, v198, v199
  v_mfma_f32_16x16x32_bf16 v[212:215], a[144:147], a[64:67], v[212:215]
  v_exp_f32 v208, v208
  v_mfma_f32_16x16x32_bf16 v[112:115], v[200:203], a[176:179], v[112:115]
  ds_read_b128 a[112:115], v246 offset:2048
  v_mfma_f32_16x16x32_bf16 v[112:115], v[204:207], a[208:211], v[112:115]
  v_exp_f32 v209, v209
  v_mfma_f32_16x16x32_bf16 v[116:119], v[204:207], a[212:215], v[116:119]
  ds_read_b128 a[116:119], v247 offset:2048
  v_cvt_pk_bf16_f32 v196, v208, v209
  v_mfma_f32_16x16x32_bf16 v[116:119], v[200:203], a[180:183], v[116:119]
  v_exp_f32 v210, v210
  v_mfma_f32_16x16x32_bf16 v[120:123], v[200:203], a[184:187], v[120:123]
  ds_read_b128 a[120:123], v246 offset:6144
  v_mfma_f32_16x16x32_bf16 v[120:123], v[204:207], a[216:219], v[120:123]
  v_exp_f32 v211, v211
  v_mfma_f32_16x16x32_bf16 v[124:127], v[204:207], a[220:223], v[124:127]
  ds_read_b128 a[124:127], v247 offset:6144
  v_cvt_pk_bf16_f32 v197, v210, v211
  v_mfma_f32_16x16x32_bf16 v[124:127], v[200:203], a[188:191], v[124:127]
  s_waitcnt lgkmcnt(4)
  v_exp_f32 v212, v212
  v_smfmac_f32_16x16x64_bf16 a[244:247], a[232:235], a[248:255], v253
  v_mfma_f32_16x16x32_bf16 v[160:163], a[248:251], a[160:163], v[160:163]
  v_mfma_f32_16x16x32_bf16 v[160:163], a[252:255], a[192:195], v[160:163]
  v_mfma_f32_16x16x32_bf16 v[164:167], a[252:255], a[196:199], v[164:167]
  v_mfma_f32_16x16x32_bf16 v[164:167], a[248:251], a[164:167], v[164:167]
  v_mfma_f32_16x16x32_bf16 v[168:171], a[248:251], a[168:171], v[168:171]
  v_mfma_f32_16x16x32_bf16 v[168:171], a[252:255], a[200:203], v[168:171]
  v_mfma_f32_16x16x32_bf16 v[172:175], a[252:255], a[204:207], v[172:175]
  v_mfma_f32_16x16x32_bf16 v[172:175], a[248:251], a[172:175], v[172:175]
  v_mfma_f32_16x16x32_bf16 v[176:179], a[248:251], a[176:179], v[176:179]
  v_mfma_f32_16x16x32_bf16 v[176:179], a[252:255], a[208:211], v[176:179]
  v_mfma_f32_16x16x32_bf16 v[180:183], a[252:255], a[212:215], v[180:183]
  v_mfma_f32_16x16x32_bf16 v[180:183], a[248:251], a[180:183], v[180:183]
  v_mfma_f32_16x16x32_bf16 v[184:187], a[248:251], a[184:187], v[184:187]
  v_mfma_f32_16x16x32_bf16 v[184:187], a[252:255], a[216:219], v[184:187]
  v_mfma_f32_16x16x32_bf16 v[188:191], a[252:255], a[220:223], v[188:191]
  v_mfma_f32_16x16x32_bf16 v[188:191], a[248:251], a[188:191], v[188:191]
  v_mfma_f32_16x16x32_bf16 v[200:203], a[96:99], a[0:3], v[216:219]
  ds_read_b128 a[128:131], v246 offset:16384
  v_mfma_f32_16x16x32_bf16 v[200:203], a[100:103], a[4:7], v[200:203]
  v_exp_f32 v213, v213
  v_mfma_f32_16x16x32_bf16 v[200:203], a[104:107], a[8:11], v[200:203]
  ds_read_b128 a[132:135], v247 offset:16384
  v_cvt_pk_bf16_f32 v198, v212, v213
  v_mfma_f32_16x16x32_bf16 v[200:203], a[108:111], a[12:15], v[200:203]
  s_waitcnt lgkmcnt(2)
  v_exp_f32 v214, v214
  v_mfma_f32_16x16x32_bf16 v[204:207], a[124:127], a[12:15], v[216:219]
  ds_read_b128 a[136:139], v246 offset:20480
  v_mfma_f32_16x16x32_bf16 v[204:207], a[120:123], a[8:11], v[204:207]
  v_exp_f32 v215, v215
  v_mfma_f32_16x16x32_bf16 v[204:207], a[116:119], a[4:7], v[204:207]
  ds_read_b128 a[140:143], v247 offset:20480
  v_cvt_pk_bf16_f32 v199, v214, v215
  v_mfma_f32_16x16x32_bf16 v[204:207], a[112:115], a[0:3], v[204:207]
  v_exp_f32 v200, v200
  v_smfmac_f32_16x16x64_bf16 a[244:247], a[228:231], v[192:199], v253
  ds_read_b128 a[144:147], v246 offset:18432
  v_mfma_f32_16x16x32_bf16 v[128:131], v[192:195], a[160:163], v[128:131]
  ds_read_b128 a[148:151], v247 offset:18432
  ds_read_b128 a[152:155], v246 offset:22528
  v_mfma_f32_16x16x32_bf16 v[128:131], v[196:199], a[192:195], v[128:131]
  v_exp_f32 v201, v201
  v_mfma_f32_16x16x32_bf16 v[132:135], v[196:199], a[196:199], v[132:135]
  ds_read_b128 a[156:159], v247 offset:22528
  v_cvt_pk_bf16_f32 v200, v200, v201
  v_mfma_f32_16x16x32_bf16 v[132:135], v[192:195], a[164:167], v[132:135]
  v_exp_f32 v202, v202
  v_mfma_f32_16x16x32_bf16 v[136:139], v[192:195], a[168:171], v[136:139]
  ds_read_b64_tr_b16 a[160:161], v248 offset:8192
  ds_read_b64_tr_b16 a[162:163], v248 offset:10240
  v_mfma_f32_16x16x32_bf16 v[136:139], v[196:199], a[200:203], v[136:139]
  v_exp_f32 v203, v203
  v_mfma_f32_16x16x32_bf16 v[140:143], v[196:199], a[204:207], v[140:143]
  ds_read_b64_tr_b16 a[192:193], v248 offset:24576
  v_cvt_pk_bf16_f32 v201, v202, v203
  v_mfma_f32_16x16x32_bf16 v[140:143], v[192:195], a[172:175], v[140:143]
  s_waitcnt lgkmcnt(6)
  v_exp_f32 v204, v204
  v_mfma_f32_16x16x32_bf16 v[208:211], a[128:131], a[0:3], v[216:219]
  ds_read_b64_tr_b16 a[194:195], v248 offset:26624
  ds_read_b64_tr_b16 a[164:165], v249 offset:8192
  v_mfma_f32_16x16x32_bf16 v[208:211], a[132:135], a[4:7], v[208:211]
  v_exp_f32 v205, v205
  v_mfma_f32_16x16x32_bf16 v[208:211], a[136:139], a[8:11], v[208:211]
  ds_read_b64_tr_b16 a[166:167], v249 offset:10240
  v_cvt_pk_bf16_f32 v202, v204, v205
  v_mfma_f32_16x16x32_bf16 v[208:211], a[140:143], a[12:15], v[208:211]
  s_waitcnt lgkmcnt(6)
  v_exp_f32 v206, v206
  v_mfma_f32_16x16x32_bf16 v[212:215], a[156:159], a[12:15], v[216:219]
  ds_read_b64_tr_b16 a[196:197], v249 offset:24576
  ds_read_b64_tr_b16 a[198:199], v249 offset:26624
  v_mfma_f32_16x16x32_bf16 v[212:215], a[152:155], a[8:11], v[212:215]
  v_exp_f32 v207, v207
  v_mfma_f32_16x16x32_bf16 v[212:215], a[148:151], a[4:7], v[212:215]
  ds_read_b64_tr_b16 a[168:169], v250 offset:8192
  v_cvt_pk_bf16_f32 v203, v206, v207
  v_mfma_f32_16x16x32_bf16 v[212:215], a[144:147], a[0:3], v[212:215]
  v_exp_f32 v208, v208
  v_mfma_f32_16x16x32_bf16 v[144:147], v[192:195], a[176:179], v[144:147]
  ds_read_b64_tr_b16 a[170:171], v250 offset:10240
  ds_read_b64_tr_b16 a[200:201], v250 offset:24576
  v_mfma_f32_16x16x32_bf16 v[144:147], v[196:199], a[208:211], v[144:147]
  v_exp_f32 v209, v209
  v_mfma_f32_16x16x32_bf16 v[148:151], v[196:199], a[212:215], v[148:151]
  ds_read_b64_tr_b16 a[202:203], v250 offset:26624
  v_cvt_pk_bf16_f32 v204, v208, v209
  v_mfma_f32_16x16x32_bf16 v[148:151], v[192:195], a[180:183], v[148:151]
  v_exp_f32 v210, v210
  v_mfma_f32_16x16x32_bf16 v[152:155], v[192:195], a[184:187], v[152:155]
  ds_read_b64_tr_b16 a[172:173], v251 offset:8192
  ds_read_b64_tr_b16 a[174:175], v251 offset:10240
  v_mfma_f32_16x16x32_bf16 v[152:155], v[196:199], a[216:219], v[152:155]
  v_exp_f32 v211, v211
  v_mfma_f32_16x16x32_bf16 v[156:159], v[196:199], a[220:223], v[156:159]
  ds_read_b64_tr_b16 a[204:205], v251 offset:24576
  v_cvt_pk_bf16_f32 v205, v210, v211
  v_mfma_f32_16x16x32_bf16 v[156:159], v[192:195], a[188:191], v[156:159]
  v_exp_f32 v212, v212
  v_mfma_f32_16x16x32_bf16 v[192:195], a[96:99], a[16:19], v[220:223]
  ds_read_b64_tr_b16 a[206:207], v251 offset:26624
  ds_read_b64_tr_b16 a[176:177], v248 offset:12288
  v_mfma_f32_16x16x32_bf16 v[192:195], a[100:103], a[20:23], v[192:195]
  v_exp_f32 v213, v213
  v_mfma_f32_16x16x32_bf16 v[192:195], a[104:107], a[24:27], v[192:195]
  ds_read_b64_tr_b16 a[178:179], v248 offset:14336
  v_cvt_pk_bf16_f32 v206, v212, v213
  v_mfma_f32_16x16x32_bf16 v[192:195], a[108:111], a[28:31], v[192:195]
  v_exp_f32 v214, v214
  v_mfma_f32_16x16x32_bf16 v[196:199], a[124:127], a[28:31], v[220:223]
  ds_read_b64_tr_b16 a[208:209], v248 offset:28672
  ds_read_b64_tr_b16 a[210:211], v248 offset:30720
  v_mfma_f32_16x16x32_bf16 v[196:199], a[120:123], a[24:27], v[196:199]
  v_exp_f32 v215, v215
  v_mfma_f32_16x16x32_bf16 v[196:199], a[116:119], a[20:23], v[196:199]
  ds_read_b64_tr_b16 a[180:181], v249 offset:12288
  v_cvt_pk_bf16_f32 v207, v214, v215
  v_mfma_f32_16x16x32_bf16 v[196:199], a[112:115], a[16:19], v[196:199]
  v_exp_f32 v192, v192
  v_smfmac_f32_16x16x64_bf16 a[236:239], a[228:231], v[200:207], v253
  s_waitcnt lgkmcnt(4)
  ds_read_b64_tr_b16 a[182:183], v249 offset:14336
  v_mfma_f32_16x16x32_bf16 v[0:3], v[200:203], a[160:163], v[0:3]
  ds_read_b64_tr_b16 a[212:213], v249 offset:28672
  ds_read_b64_tr_b16 a[214:215], v249 offset:30720
  v_mfma_f32_16x16x32_bf16 v[0:3], v[204:207], a[192:195], v[0:3]
  v_exp_f32 v193, v193
  v_mfma_f32_16x16x32_bf16 v[4:7], v[204:207], a[196:199], v[4:7]
  ds_read_b64_tr_b16 a[184:185], v250 offset:12288
  v_cvt_pk_bf16_f32 v192, v192, v193
  v_mfma_f32_16x16x32_bf16 v[4:7], v[200:203], a[164:167], v[4:7]
  v_exp_f32 v194, v194
  v_mfma_f32_16x16x32_bf16 v[8:11], v[200:203], a[168:171], v[8:11]
  ds_read_b64_tr_b16 a[186:187], v250 offset:14336
  ds_read_b64_tr_b16 a[216:217], v250 offset:28672
  v_mfma_f32_16x16x32_bf16 v[8:11], v[204:207], a[200:203], v[8:11]
  v_exp_f32 v195, v195
  v_mfma_f32_16x16x32_bf16 v[12:15], v[204:207], a[204:207], v[12:15]
  ds_read_b64_tr_b16 a[218:219], v250 offset:30720
  v_cvt_pk_bf16_f32 v193, v194, v195
  v_mfma_f32_16x16x32_bf16 v[12:15], v[200:203], a[172:175], v[12:15]
  v_exp_f32 v196, v196
  v_mfma_f32_16x16x32_bf16 v[208:211], a[128:131], a[16:19], v[220:223]
  ds_read_b64_tr_b16 a[188:189], v251 offset:12288
  ds_read_b64_tr_b16 a[190:191], v251 offset:14336
  v_mfma_f32_16x16x32_bf16 v[208:211], a[132:135], a[20:23], v[208:211]
  v_exp_f32 v197, v197
  v_mfma_f32_16x16x32_bf16 v[208:211], a[136:139], a[24:27], v[208:211]
  ds_read_b64_tr_b16 a[220:221], v251 offset:28672
  v_cvt_pk_bf16_f32 v194, v196, v197
  v_mfma_f32_16x16x32_bf16 v[208:211], a[140:143], a[28:31], v[208:211]
  v_exp_f32 v198, v198
  v_mfma_f32_16x16x32_bf16 v[212:215], a[156:159], a[28:31], v[220:223]
  ds_read_b64_tr_b16 a[222:223], v251 offset:30720
  v_mfma_f32_16x16x32_bf16 v[212:215], a[152:155], a[24:27], v[212:215]
  v_exp_f32 v199, v199
  v_mfma_f32_16x16x32_bf16 v[212:215], a[148:151], a[20:23], v[212:215]
  v_cvt_pk_bf16_f32 v195, v198, v199
  v_mfma_f32_16x16x32_bf16 v[212:215], a[144:147], a[16:19], v[212:215]
  s_waitcnt lgkmcnt(4)
  v_exp_f32 v208, v208
  v_mfma_f32_16x16x32_bf16 v[16:19], v[200:203], a[176:179], v[16:19]
  v_mfma_f32_16x16x32_bf16 v[16:19], v[204:207], a[208:211], v[16:19]
  v_exp_f32 v209, v209
  v_mfma_f32_16x16x32_bf16 v[20:23], v[204:207], a[212:215], v[20:23]
  v_cvt_pk_bf16_f32 v196, v208, v209
  v_mfma_f32_16x16x32_bf16 v[20:23], v[200:203], a[180:183], v[20:23]
  s_waitcnt lgkmcnt(0)
  v_exp_f32 v210, v210
  v_mfma_f32_16x16x32_bf16 v[24:27], v[200:203], a[184:187], v[24:27]
  s_barrier
  v_mfma_f32_16x16x32_bf16 v[24:27], v[204:207], a[216:219], v[24:27]
  v_exp_f32 v211, v211
  v_mfma_f32_16x16x32_bf16 v[28:31], v[204:207], a[220:223], v[28:31]
  v_cvt_pk_bf16_f32 v197, v210, v211
  v_mfma_f32_16x16x32_bf16 v[28:31], v[200:203], a[188:191], v[28:31]
  v_exp_f32 v212, v212
  v_mfma_f32_16x16x32_bf16 v[200:203], a[96:99], a[32:35], v[224:227]
  v_mfma_f32_16x16x32_bf16 v[200:203], a[100:103], a[36:39], v[200:203]
  v_exp_f32 v213, v213
  v_mfma_f32_16x16x32_bf16 v[200:203], a[104:107], a[40:43], v[200:203]
  v_cvt_pk_bf16_f32 v198, v212, v213
  v_mfma_f32_16x16x32_bf16 v[200:203], a[108:111], a[44:47], v[200:203]
  s_add_u32 m0, s38, 0
  v_exp_f32 v214, v214
  v_mfma_f32_16x16x32_bf16 v[204:207], a[124:127], a[44:47], v[224:227]
  buffer_load_dwordx4 v252, s[16:19], s33 offen nt lds
  v_mfma_f32_16x16x32_bf16 v[204:207], a[120:123], a[40:43], v[204:207]
  v_exp_f32 v215, v215
  v_mfma_f32_16x16x32_bf16 v[204:207], a[116:119], a[36:39], v[204:207]
  v_cvt_pk_bf16_f32 v199, v214, v215
  v_mfma_f32_16x16x32_bf16 v[204:207], a[112:115], a[32:35], v[204:207]
  v_exp_f32 v200, v200
  v_smfmac_f32_16x16x64_bf16 a[236:239], a[232:235], v[192:199], v253
  ds_read_b64_tr_b16 a[248:249], v244 offset:0
  v_mfma_f32_16x16x32_bf16 v[32:35], v[192:195], a[160:163], v[32:35]
  ds_read_b64_tr_b16 a[250:251], v244 offset:64
  v_mfma_f32_16x16x32_bf16 v[32:35], v[196:199], a[192:195], v[32:35]
  v_exp_f32 v201, v201
  v_mfma_f32_16x16x32_bf16 v[36:39], v[196:199], a[196:199], v[36:39]
  v_cvt_pk_bf16_f32 v200, v200, v201
  v_mfma_f32_16x16x32_bf16 v[36:39], v[192:195], a[164:167], v[36:39]
  s_add_u32 m0, s38, 3968
  v_exp_f32 v202, v202
  v_mfma_f32_16x16x32_bf16 v[40:43], v[192:195], a[168:171], v[40:43]
  buffer_load_dwordx4 v252, s[16:19], s33 offen offset:128 nt lds
  v_mfma_f32_16x16x32_bf16 v[40:43], v[196:199], a[200:203], v[40:43]
  v_exp_f32 v203, v203
  v_mfma_f32_16x16x32_bf16 v[44:47], v[196:199], a[204:207], v[44:47]
  v_cvt_pk_bf16_f32 v201, v202, v203
  v_mfma_f32_16x16x32_bf16 v[44:47], v[192:195], a[172:175], v[44:47]
  v_exp_f32 v204, v204
  v_mfma_f32_16x16x32_bf16 v[208:211], a[128:131], a[32:35], v[224:227]
  v_mfma_f32_16x16x32_bf16 v[208:211], a[132:135], a[36:39], v[208:211]
  v_exp_f32 v205, v205
  v_mfma_f32_16x16x32_bf16 v[208:211], a[136:139], a[40:43], v[208:211]
  v_cvt_pk_bf16_f32 v202, v204, v205
  v_mfma_f32_16x16x32_bf16 v[208:211], a[140:143], a[44:47], v[208:211]
  s_add_u32 m0, s38, 8192
  v_exp_f32 v206, v206
  v_mfma_f32_16x16x32_bf16 v[212:215], a[156:159], a[44:47], v[224:227]
  buffer_load_dwordx4 v252, s[20:23], s33 offen nt lds
  v_mfma_f32_16x16x32_bf16 v[212:215], a[152:155], a[40:43], v[212:215]
  v_exp_f32 v207, v207
  v_mfma_f32_16x16x32_bf16 v[212:215], a[148:151], a[36:39], v[212:215]
  v_cvt_pk_bf16_f32 v203, v206, v207
  v_mfma_f32_16x16x32_bf16 v[212:215], a[144:147], a[32:35], v[212:215]
  v_exp_f32 v208, v208
  v_mfma_f32_16x16x32_bf16 v[48:51], v[192:195], a[176:179], v[48:51]
  v_mfma_f32_16x16x32_bf16 v[48:51], v[196:199], a[208:211], v[48:51]
  v_exp_f32 v209, v209
  v_mfma_f32_16x16x32_bf16 v[52:55], v[196:199], a[212:215], v[52:55]
  v_cvt_pk_bf16_f32 v204, v208, v209
  v_mfma_f32_16x16x32_bf16 v[52:55], v[192:195], a[180:183], v[52:55]
  s_add_u32 m0, s38, 12160
  v_exp_f32 v210, v210
  v_mfma_f32_16x16x32_bf16 v[56:59], v[192:195], a[184:187], v[56:59]
  buffer_load_dwordx4 v252, s[20:23], s33 offen offset:128 nt lds
  v_mfma_f32_16x16x32_bf16 v[56:59], v[196:199], a[216:219], v[56:59]
  s_add_u32 s34, s34, 1
  v_exp_f32 v211, v211
  v_mfma_f32_16x16x32_bf16 v[60:63], v[196:199], a[220:223], v[60:63]
  s_add_u32 s33, s33, 8192
  v_cvt_pk_bf16_f32 v205, v210, v211
  v_mfma_f32_16x16x32_bf16 v[60:63], v[192:195], a[188:191], v[60:63]
  v_exp_f32 v212, v212
  v_mfma_f32_16x16x32_bf16 v[192:195], a[96:99], a[48:51], v[228:231]
  v_mfma_f32_16x16x32_bf16 v[192:195], a[100:103], a[52:55], v[192:195]
  v_exp_f32 v213, v213
  v_mfma_f32_16x16x32_bf16 v[192:195], a[104:107], a[56:59], v[192:195]
  v_cvt_pk_bf16_f32 v206, v212, v213
  v_mfma_f32_16x16x32_bf16 v[192:195], a[108:111], a[60:63], v[192:195]
  s_add_u32 m0, s38, 16384
  v_exp_f32 v214, v214
  v_mfma_f32_16x16x32_bf16 v[196:199], a[124:127], a[60:63], v[228:231]
  buffer_load_dwordx4 v252, s[16:19], s33 offen nt lds
  v_mfma_f32_16x16x32_bf16 v[196:199], a[120:123], a[56:59], v[196:199]
  v_exp_f32 v215, v215
  v_mfma_f32_16x16x32_bf16 v[196:199], a[116:119], a[52:55], v[196:199]
  v_cvt_pk_bf16_f32 v207, v214, v215
  v_mfma_f32_16x16x32_bf16 v[196:199], a[112:115], a[48:51], v[196:199]
  v_exp_f32 v192, v192
  v_smfmac_f32_16x16x64_bf16 a[240:243], a[228:231], v[200:207], v253
  v_mfma_f32_16x16x32_bf16 v[64:67], v[200:203], a[160:163], v[64:67]
  v_mfma_f32_16x16x32_bf16 v[64:67], v[204:207], a[192:195], v[64:67]
  v_exp_f32 v193, v193
  v_mfma_f32_16x16x32_bf16 v[68:71], v[204:207], a[196:199], v[68:71]
  v_cvt_pk_bf16_f32 v192, v192, v193
  v_mfma_f32_16x16x32_bf16 v[68:71], v[200:203], a[164:167], v[68:71]
  s_add_u32 m0, s38, 20352
  v_exp_f32 v194, v194
  v_mfma_f32_16x16x32_bf16 v[72:75], v[200:203], a[168:171], v[72:75]
  buffer_load_dwordx4 v252, s[16:19], s33 offen offset:128 nt lds
  v_mfma_f32_16x16x32_bf16 v[72:75], v[204:207], a[200:203], v[72:75]
  v_exp_f32 v195, v195
  v_mfma_f32_16x16x32_bf16 v[76:79], v[204:207], a[204:207], v[76:79]
  v_cvt_pk_bf16_f32 v193, v194, v195
  v_mfma_f32_16x16x32_bf16 v[76:79], v[200:203], a[172:175], v[76:79]
  v_exp_f32 v196, v196
  v_mfma_f32_16x16x32_bf16 v[208:211], a[128:131], a[48:51], v[228:231]
  v_mfma_f32_16x16x32_bf16 v[208:211], a[132:135], a[52:55], v[208:211]
  v_exp_f32 v197, v197
  v_mfma_f32_16x16x32_bf16 v[208:211], a[136:139], a[56:59], v[208:211]
  v_cvt_pk_bf16_f32 v194, v196, v197
  v_mfma_f32_16x16x32_bf16 v[208:211], a[140:143], a[60:63], v[208:211]
  s_add_u32 m0, s38, 24576
  v_exp_f32 v198, v198
  v_mfma_f32_16x16x32_bf16 v[212:215], a[156:159], a[60:63], v[228:231]
  buffer_load_dwordx4 v252, s[20:23], s33 offen nt lds
  v_mfma_f32_16x16x32_bf16 v[212:215], a[152:155], a[56:59], v[212:215]
  v_exp_f32 v199, v199
  v_mfma_f32_16x16x32_bf16 v[212:215], a[148:151], a[52:55], v[212:215]
  v_cvt_pk_bf16_f32 v195, v198, v199
  v_mfma_f32_16x16x32_bf16 v[212:215], a[144:147], a[48:51], v[212:215]
  v_exp_f32 v208, v208
  v_mfma_f32_16x16x32_bf16 v[80:83], v[200:203], a[176:179], v[80:83]
  v_mfma_f32_16x16x32_bf16 v[80:83], v[204:207], a[208:211], v[80:83]
  v_exp_f32 v209, v209
  v_mfma_f32_16x16x32_bf16 v[84:87], v[204:207], a[212:215], v[84:87]
  v_cvt_pk_bf16_f32 v196, v208, v209
  v_mfma_f32_16x16x32_bf16 v[84:87], v[200:203], a[180:183], v[84:87]
  s_add_u32 m0, s38, 28544
  v_exp_f32 v210, v210
  v_mfma_f32_16x16x32_bf16 v[88:91], v[200:203], a[184:187], v[88:91]
  buffer_load_dwordx4 v252, s[20:23], s33 offen offset:128 nt lds
  v_mfma_f32_16x16x32_bf16 v[88:91], v[204:207], a[216:219], v[88:91]
  s_add_u32 s34, s34, 1
  v_exp_f32 v211, v211
  v_mfma_f32_16x16x32_bf16 v[92:95], v[204:207], a[220:223], v[92:95]
  s_add_u32 s33, s33, 8192
  v_cvt_pk_bf16_f32 v197, v210, v211
  v_mfma_f32_16x16x32_bf16 v[92:95], v[200:203], a[188:191], v[92:95]
  s_waitcnt vmcnt(8)
  v_exp_f32 v212, v212
  v_mfma_f32_16x16x32_bf16 v[200:203], a[96:99], a[64:67], v[232:235]
  s_barrier
  v_mfma_f32_16x16x32_bf16 v[200:203], a[100:103], a[68:71], v[200:203]
  s_waitcnt lgkmcnt(0)
  buffer_store_dwordx4 a[248:251], v245, s[28:31], s42 offen offset:0 nt
  v_exp_f32 v213, v213
  v_mfma_f32_16x16x32_bf16 v[200:203], a[104:107], a[72:75], v[200:203]
  v_cvt_pk_bf16_f32 v198, v212, v213
  v_mfma_f32_16x16x32_bf16 v[200:203], a[108:111], a[76:79], v[200:203]
  v_exp_f32 v214, v214
  v_mfma_f32_16x16x32_bf16 v[204:207], a[124:127], a[76:79], v[232:235]
  ds_read_b64_tr_b16 a[248:249], v244 offset:12288
  ds_read_b64_tr_b16 a[250:251], v244 offset:12352
  v_mfma_f32_16x16x32_bf16 v[204:207], a[120:123], a[72:75], v[204:207]
  v_exp_f32 v215, v215
  v_mfma_f32_16x16x32_bf16 v[204:207], a[116:119], a[68:71], v[204:207]
  v_cvt_pk_bf16_f32 v199, v214, v215
  v_add_u32 v244, 1024, v244
  v_mfma_f32_16x16x32_bf16 v[204:207], a[112:115], a[64:67], v[204:207]
  v_exp_f32 v200, v200
  v_smfmac_f32_16x16x64_bf16 a[240:243], a[232:235], v[192:199], v253
  v_mfma_f32_16x16x32_bf16 v[96:99], v[192:195], a[160:163], v[96:99]
  v_mfma_f32_16x16x32_bf16 v[96:99], v[196:199], a[192:195], v[96:99]
  v_exp_f32 v201, v201
  v_mfma_f32_16x16x32_bf16 v[100:103], v[196:199], a[196:199], v[100:103]
  v_cvt_pk_bf16_f32 v200, v200, v201
  v_mfma_f32_16x16x32_bf16 v[100:103], v[192:195], a[164:167], v[100:103]
  v_exp_f32 v202, v202
  v_mfma_f32_16x16x32_bf16 v[104:107], v[192:195], a[168:171], v[104:107]
  ds_read_b128 a[96:99], v246 offset:32768
  v_mfma_f32_16x16x32_bf16 v[104:107], v[196:199], a[200:203], v[104:107]
  v_exp_f32 v203, v203
  v_mfma_f32_16x16x32_bf16 v[108:111], v[196:199], a[204:207], v[108:111]
  ds_read_b128 a[100:103], v247 offset:32768
  v_cvt_pk_bf16_f32 v201, v202, v203
  v_mfma_f32_16x16x32_bf16 v[108:111], v[192:195], a[172:175], v[108:111]
  s_waitcnt lgkmcnt(2)
  buffer_store_dwordx4 a[248:251], v245, s[28:31], s42 offen offset:128 nt
  v_exp_f32 v204, v204
  v_mfma_f32_16x16x32_bf16 v[208:211], a[128:131], a[64:67], v[232:235]
  s_add_u32 s42, s42, 2048
  ds_read_b128 a[104:107], v246 offset:36864
  v_mfma_f32_16x16x32_bf16 v[208:211], a[132:135], a[68:71], v[208:211]
  v_exp_f32 v205, v205
  v_mfma_f32_16x16x32_bf16 v[208:211], a[136:139], a[72:75], v[208:211]
  ds_read_b128 a[248:251], v240 offset:0
  v_cvt_pk_bf16_f32 v202, v204, v205
  v_mfma_f32_16x16x32_bf16 v[208:211], a[140:143], a[76:79], v[208:211]
  v_exp_f32 v206, v206
  v_mfma_f32_16x16x32_bf16 v[212:215], a[156:159], a[76:79], v[232:235]
  ds_read_b128 a[252:255], v240 offset:256
  v_mfma_f32_16x16x32_bf16 v[212:215], a[152:155], a[72:75], v[212:215]
  v_exp_f32 v207, v207
  v_mfma_f32_16x16x32_bf16 v[212:215], a[148:151], a[68:71], v[212:215]
  ds_read_b128 a[108:111], v247 offset:36864
  v_cvt_pk_bf16_f32 v203, v206, v207
  v_mfma_f32_16x16x32_bf16 v[212:215], a[144:147], a[64:67], v[212:215]
  v_exp_f32 v208, v208
  v_mfma_f32_16x16x32_bf16 v[112:115], v[192:195], a[176:179], v[112:115]
  ds_read_b128 a[112:115], v246 offset:34816
  v_mfma_f32_16x16x32_bf16 v[112:115], v[196:199], a[208:211], v[112:115]
  v_exp_f32 v209, v209
  v_mfma_f32_16x16x32_bf16 v[116:119], v[196:199], a[212:215], v[116:119]
  ds_read_b128 a[116:119], v247 offset:34816
  v_cvt_pk_bf16_f32 v204, v208, v209
  v_mfma_f32_16x16x32_bf16 v[116:119], v[192:195], a[180:183], v[116:119]
  v_exp_f32 v210, v210
  v_mfma_f32_16x16x32_bf16 v[120:123], v[192:195], a[184:187], v[120:123]
  ds_read_b128 a[120:123], v246 offset:38912
  v_mfma_f32_16x16x32_bf16 v[120:123], v[196:199], a[216:219], v[120:123]
  v_exp_f32 v211, v211
  v_mfma_f32_16x16x32_bf16 v[124:127], v[196:199], a[220:223], v[124:127]
  ds_read_b128 a[124:127], v247 offset:38912
  v_cvt_pk_bf16_f32 v205, v210, v211
  v_mfma_f32_16x16x32_bf16 v[124:127], v[192:195], a[188:191], v[124:127]
  s_waitcnt lgkmcnt(4)
  v_exp_f32 v212, v212
  v_smfmac_f32_16x16x64_bf16 a[244:247], a[232:235], a[248:255], v253
  v_mfma_f32_16x16x32_bf16 v[160:163], a[248:251], a[160:163], v[160:163]
  v_mfma_f32_16x16x32_bf16 v[160:163], a[252:255], a[192:195], v[160:163]
  v_mfma_f32_16x16x32_bf16 v[164:167], a[252:255], a[196:199], v[164:167]
  v_mfma_f32_16x16x32_bf16 v[164:167], a[248:251], a[164:167], v[164:167]
  v_mfma_f32_16x16x32_bf16 v[168:171], a[248:251], a[168:171], v[168:171]
  v_mfma_f32_16x16x32_bf16 v[168:171], a[252:255], a[200:203], v[168:171]
  v_mfma_f32_16x16x32_bf16 v[172:175], a[252:255], a[204:207], v[172:175]
  v_mfma_f32_16x16x32_bf16 v[172:175], a[248:251], a[172:175], v[172:175]
  v_mfma_f32_16x16x32_bf16 v[176:179], a[248:251], a[176:179], v[176:179]
  v_mfma_f32_16x16x32_bf16 v[176:179], a[252:255], a[208:211], v[176:179]
  v_mfma_f32_16x16x32_bf16 v[180:183], a[252:255], a[212:215], v[180:183]
  v_mfma_f32_16x16x32_bf16 v[180:183], a[248:251], a[180:183], v[180:183]
  v_mfma_f32_16x16x32_bf16 v[184:187], a[248:251], a[184:187], v[184:187]
  v_mfma_f32_16x16x32_bf16 v[184:187], a[252:255], a[216:219], v[184:187]
  v_mfma_f32_16x16x32_bf16 v[188:191], a[252:255], a[220:223], v[188:191]
  v_mfma_f32_16x16x32_bf16 v[188:191], a[248:251], a[188:191], v[188:191]
  v_mfma_f32_16x16x32_bf16 v[192:195], a[96:99], a[0:3], v[216:219]
  ds_read_b128 a[128:131], v246 offset:49152
  v_mfma_f32_16x16x32_bf16 v[192:195], a[100:103], a[4:7], v[192:195]
  v_exp_f32 v213, v213
  v_mfma_f32_16x16x32_bf16 v[192:195], a[104:107], a[8:11], v[192:195]
  ds_read_b128 a[132:135], v247 offset:49152
  v_cvt_pk_bf16_f32 v206, v212, v213
  v_mfma_f32_16x16x32_bf16 v[192:195], a[108:111], a[12:15], v[192:195]
  s_waitcnt lgkmcnt(2)
  v_exp_f32 v214, v214
  v_mfma_f32_16x16x32_bf16 v[196:199], a[124:127], a[12:15], v[216:219]
  ds_read_b128 a[136:139], v246 offset:53248
  v_mfma_f32_16x16x32_bf16 v[196:199], a[120:123], a[8:11], v[196:199]
  v_exp_f32 v215, v215
  v_mfma_f32_16x16x32_bf16 v[196:199], a[116:119], a[4:7], v[196:199]
  ds_read_b128 a[140:143], v247 offset:53248
  v_cvt_pk_bf16_f32 v207, v214, v215
  v_mfma_f32_16x16x32_bf16 v[196:199], a[112:115], a[0:3], v[196:199]
  v_exp_f32 v192, v192
  v_smfmac_f32_16x16x64_bf16 a[244:247], a[228:231], v[200:207], v253
  ds_read_b128 a[144:147], v246 offset:51200
  v_mfma_f32_16x16x32_bf16 v[128:131], v[200:203], a[160:163], v[128:131]
  ds_read_b128 a[148:151], v247 offset:51200
  ds_read_b128 a[152:155], v246 offset:55296
  v_mfma_f32_16x16x32_bf16 v[128:131], v[204:207], a[192:195], v[128:131]
  v_exp_f32 v193, v193
  v_mfma_f32_16x16x32_bf16 v[132:135], v[204:207], a[196:199], v[132:135]
  ds_read_b128 a[156:159], v247 offset:55296
  v_cvt_pk_bf16_f32 v192, v192, v193
  v_mfma_f32_16x16x32_bf16 v[132:135], v[200:203], a[164:167], v[132:135]
  v_exp_f32 v194, v194
  v_mfma_f32_16x16x32_bf16 v[136:139], v[200:203], a[168:171], v[136:139]
  ds_read_b64_tr_b16 a[160:161], v248 offset:40960
  ds_read_b64_tr_b16 a[162:163], v248 offset:43008
  v_mfma_f32_16x16x32_bf16 v[136:139], v[204:207], a[200:203], v[136:139]
  v_exp_f32 v195, v195
  v_mfma_f32_16x16x32_bf16 v[140:143], v[204:207], a[204:207], v[140:143]
  ds_read_b64_tr_b16 a[192:193], v248 offset:57344
  v_cvt_pk_bf16_f32 v193, v194, v195
  v_mfma_f32_16x16x32_bf16 v[140:143], v[200:203], a[172:175], v[140:143]
  s_waitcnt lgkmcnt(6)
  v_exp_f32 v196, v196
  v_mfma_f32_16x16x32_bf16 v[208:211], a[128:131], a[0:3], v[216:219]
  ds_read_b64_tr_b16 a[194:195], v248 offset:59392
  ds_read_b64_tr_b16 a[164:165], v249 offset:40960
  v_mfma_f32_16x16x32_bf16 v[208:211], a[132:135], a[4:7], v[208:211]
  v_exp_f32 v197, v197
  v_mfma_f32_16x16x32_bf16 v[208:211], a[136:139], a[8:11], v[208:211]
  ds_read_b64_tr_b16 a[166:167], v249 offset:43008
  v_cvt_pk_bf16_f32 v194, v196, v197
  v_mfma_f32_16x16x32_bf16 v[208:211], a[140:143], a[12:15], v[208:211]
  s_waitcnt lgkmcnt(6)
  v_exp_f32 v198, v198
  v_mfma_f32_16x16x32_bf16 v[212:215], a[156:159], a[12:15], v[216:219]
  ds_read_b64_tr_b16 a[196:197], v249 offset:57344
  ds_read_b64_tr_b16 a[198:199], v249 offset:59392
  v_mfma_f32_16x16x32_bf16 v[212:215], a[152:155], a[8:11], v[212:215]
  v_exp_f32 v199, v199
  v_mfma_f32_16x16x32_bf16 v[212:215], a[148:151], a[4:7], v[212:215]
  ds_read_b64_tr_b16 a[168:169], v250 offset:40960
  v_cvt_pk_bf16_f32 v195, v198, v199
  v_mfma_f32_16x16x32_bf16 v[212:215], a[144:147], a[0:3], v[212:215]
  v_exp_f32 v208, v208
  v_mfma_f32_16x16x32_bf16 v[144:147], v[200:203], a[176:179], v[144:147]
  ds_read_b64_tr_b16 a[170:171], v250 offset:43008
  ds_read_b64_tr_b16 a[200:201], v250 offset:57344
  v_mfma_f32_16x16x32_bf16 v[144:147], v[204:207], a[208:211], v[144:147]
  v_exp_f32 v209, v209
  v_mfma_f32_16x16x32_bf16 v[148:151], v[204:207], a[212:215], v[148:151]
  ds_read_b64_tr_b16 a[202:203], v250 offset:59392
  v_cvt_pk_bf16_f32 v196, v208, v209
  v_mfma_f32_16x16x32_bf16 v[148:151], v[200:203], a[180:183], v[148:151]
  v_exp_f32 v210, v210
  v_mfma_f32_16x16x32_bf16 v[152:155], v[200:203], a[184:187], v[152:155]
  ds_read_b64_tr_b16 a[172:173], v251 offset:40960
  ds_read_b64_tr_b16 a[174:175], v251 offset:43008
  v_mfma_f32_16x16x32_bf16 v[152:155], v[204:207], a[216:219], v[152:155]
  v_exp_f32 v211, v211
  v_mfma_f32_16x16x32_bf16 v[156:159], v[204:207], a[220:223], v[156:159]
  ds_read_b64_tr_b16 a[204:205], v251 offset:57344
  v_cvt_pk_bf16_f32 v197, v210, v211
  v_mfma_f32_16x16x32_bf16 v[156:159], v[200:203], a[188:191], v[156:159]
  v_exp_f32 v212, v212
  v_mfma_f32_16x16x32_bf16 v[200:203], a[96:99], a[16:19], v[220:223]
  ds_read_b64_tr_b16 a[206:207], v251 offset:59392
  ds_read_b64_tr_b16 a[176:177], v248 offset:45056
  v_mfma_f32_16x16x32_bf16 v[200:203], a[100:103], a[20:23], v[200:203]
  v_exp_f32 v213, v213
  v_mfma_f32_16x16x32_bf16 v[200:203], a[104:107], a[24:27], v[200:203]
  ds_read_b64_tr_b16 a[178:179], v248 offset:47104
  v_cvt_pk_bf16_f32 v198, v212, v213
  v_mfma_f32_16x16x32_bf16 v[200:203], a[108:111], a[28:31], v[200:203]
  v_exp_f32 v214, v214
  v_mfma_f32_16x16x32_bf16 v[204:207], a[124:127], a[28:31], v[220:223]
  ds_read_b64_tr_b16 a[208:209], v248 offset:61440
  ds_read_b64_tr_b16 a[210:211], v248 offset:63488
  v_mfma_f32_16x16x32_bf16 v[204:207], a[120:123], a[24:27], v[204:207]
  v_exp_f32 v215, v215
  v_mfma_f32_16x16x32_bf16 v[204:207], a[116:119], a[20:23], v[204:207]
  ds_read_b64_tr_b16 a[180:181], v249 offset:45056
  v_cvt_pk_bf16_f32 v199, v214, v215
  v_mfma_f32_16x16x32_bf16 v[204:207], a[112:115], a[16:19], v[204:207]
  v_exp_f32 v200, v200
  v_smfmac_f32_16x16x64_bf16 a[236:239], a[228:231], v[192:199], v253
  s_waitcnt lgkmcnt(4)
  ds_read_b64_tr_b16 a[182:183], v249 offset:47104
  v_mfma_f32_16x16x32_bf16 v[0:3], v[192:195], a[160:163], v[0:3]
  ds_read_b64_tr_b16 a[212:213], v249 offset:61440
  ds_read_b64_tr_b16 a[214:215], v249 offset:63488
  v_mfma_f32_16x16x32_bf16 v[0:3], v[196:199], a[192:195], v[0:3]
  v_exp_f32 v201, v201
  v_mfma_f32_16x16x32_bf16 v[4:7], v[196:199], a[196:199], v[4:7]
  ds_read_b64_tr_b16 a[184:185], v250 offset:45056
  v_cvt_pk_bf16_f32 v200, v200, v201
  v_mfma_f32_16x16x32_bf16 v[4:7], v[192:195], a[164:167], v[4:7]
  v_exp_f32 v202, v202
  v_mfma_f32_16x16x32_bf16 v[8:11], v[192:195], a[168:171], v[8:11]
  ds_read_b64_tr_b16 a[186:187], v250 offset:47104
  ds_read_b64_tr_b16 a[216:217], v250 offset:61440
  v_mfma_f32_16x16x32_bf16 v[8:11], v[196:199], a[200:203], v[8:11]
  v_exp_f32 v203, v203
  v_mfma_f32_16x16x32_bf16 v[12:15], v[196:199], a[204:207], v[12:15]
  ds_read_b64_tr_b16 a[218:219], v250 offset:63488
  v_cvt_pk_bf16_f32 v201, v202, v203
  v_mfma_f32_16x16x32_bf16 v[12:15], v[192:195], a[172:175], v[12:15]
  v_exp_f32 v204, v204
  v_mfma_f32_16x16x32_bf16 v[208:211], a[128:131], a[16:19], v[220:223]
  ds_read_b64_tr_b16 a[188:189], v251 offset:45056
  ds_read_b64_tr_b16 a[190:191], v251 offset:47104
  v_mfma_f32_16x16x32_bf16 v[208:211], a[132:135], a[20:23], v[208:211]
  v_exp_f32 v205, v205
  v_mfma_f32_16x16x32_bf16 v[208:211], a[136:139], a[24:27], v[208:211]
  ds_read_b64_tr_b16 a[220:221], v251 offset:61440
  v_cvt_pk_bf16_f32 v202, v204, v205
  v_mfma_f32_16x16x32_bf16 v[208:211], a[140:143], a[28:31], v[208:211]
  v_exp_f32 v206, v206
  v_mfma_f32_16x16x32_bf16 v[212:215], a[156:159], a[28:31], v[220:223]
  ds_read_b64_tr_b16 a[222:223], v251 offset:63488
  v_mfma_f32_16x16x32_bf16 v[212:215], a[152:155], a[24:27], v[212:215]
  v_exp_f32 v207, v207
  v_mfma_f32_16x16x32_bf16 v[212:215], a[148:151], a[20:23], v[212:215]
  v_cvt_pk_bf16_f32 v203, v206, v207
  v_mfma_f32_16x16x32_bf16 v[212:215], a[144:147], a[16:19], v[212:215]
  s_waitcnt lgkmcnt(4)
  v_exp_f32 v208, v208
  v_mfma_f32_16x16x32_bf16 v[16:19], v[192:195], a[176:179], v[16:19]
  v_mfma_f32_16x16x32_bf16 v[16:19], v[196:199], a[208:211], v[16:19]
  v_exp_f32 v209, v209
  v_mfma_f32_16x16x32_bf16 v[20:23], v[196:199], a[212:215], v[20:23]
  s_cmp_eq_u32 s34, 46
  v_cvt_pk_bf16_f32 v204, v208, v209
  v_mfma_f32_16x16x32_bf16 v[20:23], v[192:195], a[180:183], v[20:23]
  s_waitcnt lgkmcnt(0)
  v_exp_f32 v210, v210
  v_mfma_f32_16x16x32_bf16 v[24:27], v[192:195], a[184:187], v[24:27]
  s_barrier
  s_cbranch_scc0 L_hB_own
  s_branch L_cutE
L_hB_help:
  v_accvgpr_read_b32 v239, a255
  v_subrev_f32 v236, 0x40a00000, v239
  v_subrev_f32 v237, 0x40a00000, v239
  v_subrev_f32 v238, 0x40a00000, v239
  v_subrev_f32 v239, 0x40a00000, v239
  s_mov_b32 s52, 0
  s_add_u32 s45, s49, 0
  v_and_b32 v240, 0x7ff, v255
  v_add_u32 v240, s45, v240
L_hB_hl:
  v_mfma_f32_16x16x32_bf16 v[24:27], v[196:199], a[216:219], v[24:27]
  v_exp_f32 v211, v211
  v_mfma_f32_16x16x32_bf16 v[28:31], v[196:199], a[220:223], v[28:31]
  v_cvt_pk_bf16_f32 v205, v210, v211
  v_mfma_f32_16x16x32_bf16 v[28:31], v[192:195], a[188:191], v[28:31]
  v_exp_f32 v212, v212
  v_mfma_f32_16x16x32_bf16 v[192:195], a[96:99], a[80:83], v[236:239]
  v_mfma_f32_16x16x32_bf16 v[192:195], a[100:103], a[84:87], v[192:195]
  v_exp_f32 v213, v213
  v_mfma_f32_16x16x32_bf16 v[192:195], a[104:107], a[88:91], v[192:195]
  v_cvt_pk_bf16_f32 v206, v212, v213
  v_mfma_f32_16x16x32_bf16 v[192:195], a[108:111], a[92:95], v[192:195]
  s_add_u32 m0, s38, 32768
  v_exp_f32 v214, v214
  v_mfma_f32_16x16x32_bf16 v[196:199], a[124:127], a[92:95], v[236:239]
  buffer_load_dwordx4 v252, s[16:19], s33 offen nt lds
  v_mfma_f32_16x16x32_bf16 v[196:199], a[120:123], a[88:91], v[196:199]
  v_exp_f32 v215, v215
  v_mfma_f32_16x16x32_bf16 v[196:199], a[116:119], a[84:87], v[196:199]
  v_cvt_pk_bf16_f32 v207, v214, v215
  v_mfma_f32_16x16x32_bf16 v[196:199], a[112:115], a[80:83], v[196:199]
  v_exp_f32 v192, v192
  v_smfmac_f32_16x16x64_bf16 a[236:239], a[232:235], v[200:207], v253
  ds_read_b64_tr_b16 a[248:249], v244 offset:0
  v_mfma_f32_16x16x32_bf16 v[32:35], v[200:203], a[160:163], v[32:35]
  ds_read_b64_tr_b16 a[250:251], v244 offset:64
  v_mfma_f32_16x16x32_bf16 v[32:35], v[204:207], a[192:195], v[32:35]
  v_exp_f32 v193, v193
  v_mfma_f32_16x16x32_bf16 v[36:39], v[204:207], a[196:199], v[36:39]
  v_cvt_pk_bf16_f32 v192, v192, v193
  v_mfma_f32_16x16x32_bf16 v[36:39], v[200:203], a[164:167], v[36:39]
  s_add_u32 m0, s38, 36736
  v_exp_f32 v194, v194
  v_mfma_f32_16x16x32_bf16 v[40:43], v[200:203], a[168:171], v[40:43]
  buffer_load_dwordx4 v252, s[16:19], s33 offen offset:128 nt lds
  v_mfma_f32_16x16x32_bf16 v[40:43], v[204:207], a[200:203], v[40:43]
  v_exp_f32 v195, v195
  v_mfma_f32_16x16x32_bf16 v[44:47], v[204:207], a[204:207], v[44:47]
  v_cvt_pk_bf16_f32 v193, v194, v195
  v_mfma_f32_16x16x32_bf16 v[44:47], v[200:203], a[172:175], v[44:47]
  v_exp_f32 v196, v196
  v_mfma_f32_16x16x32_bf16 v[208:211], a[128:131], a[80:83], v[236:239]
  v_mfma_f32_16x16x32_bf16 v[208:211], a[132:135], a[84:87], v[208:211]
  v_exp_f32 v197, v197
  v_mfma_f32_16x16x32_bf16 v[208:211], a[136:139], a[88:91], v[208:211]
  v_cvt_pk_bf16_f32 v194, v196, v197
  v_mfma_f32_16x16x32_bf16 v[208:211], a[140:143], a[92:95], v[208:211]
  s_add_u32 m0, s38, 40960
  v_exp_f32 v198, v198
  v_mfma_f32_16x16x32_bf16 v[212:215], a[156:159], a[92:95], v[236:239]
  buffer_load_dwordx4 v252, s[20:23], s33 offen nt lds
  v_mfma_f32_16x16x32_bf16 v[212:215], a[152:155], a[88:91], v[212:215]
  v_exp_f32 v199, v199
  v_mfma_f32_16x16x32_bf16 v[212:215], a[148:151], a[84:87], v[212:215]
  v_cvt_pk_bf16_f32 v195, v198, v199
  v_mfma_f32_16x16x32_bf16 v[212:215], a[144:147], a[80:83], v[212:215]
  v_exp_f32 v208, v208
  v_mfma_f32_16x16x32_bf16 v[48:51], v[200:203], a[176:179], v[48:51]
  v_mfma_f32_16x16x32_bf16 v[48:51], v[204:207], a[208:211], v[48:51]
  v_exp_f32 v209, v209
  v_mfma_f32_16x16x32_bf16 v[52:55], v[204:207], a[212:215], v[52:55]
  v_cvt_pk_bf16_f32 v196, v208, v209
  v_mfma_f32_16x16x32_bf16 v[52:55], v[200:203], a[180:183], v[52:55]
  s_add_u32 m0, s38, 44928
  v_exp_f32 v210, v210
  v_mfma_f32_16x16x32_bf16 v[56:59], v[200:203], a[184:187], v[56:59]
  buffer_load_dwordx4 v252, s[20:23], s33 offen offset:128 nt lds
  v_mfma_f32_16x16x32_bf16 v[56:59], v[204:207], a[216:219], v[56:59]
  s_add_u32 s34, s34, 1
  v_exp_f32 v211, v211
  v_mfma_f32_16x16x32_bf16 v[60:63], v[204:207], a[220:223], v[60:63]
  s_add_u32 s33, s33, 8192
  v_cvt_pk_bf16_f32 v197, v210, v211
  v_mfma_f32_16x16x32_bf16 v[60:63], v[200:203], a[188:191], v[60:63]
  v_exp_f32 v212, v212
  v_mfma_f32_16x16x32_bf16 v[200:203], a[96:99], a[32:35], v[224:227]
  ds_write_b128 v240, v[192:195] offset:0
  v_mfma_f32_16x16x32_bf16 v[200:203], a[100:103], a[36:39], v[200:203]
  v_exp_f32 v213, v213
  v_mfma_f32_16x16x32_bf16 v[200:203], a[104:107], a[40:43], v[200:203]
  v_cvt_pk_bf16_f32 v198, v212, v213
  v_mfma_f32_16x16x32_bf16 v[200:203], a[108:111], a[44:47], v[200:203]
  s_add_u32 m0, s38, 49152
  v_exp_f32 v214, v214
  v_mfma_f32_16x16x32_bf16 v[204:207], a[124:127], a[44:47], v[224:227]
  buffer_load_dwordx4 v252, s[16:19], s33 offen nt lds
  v_mfma_f32_16x16x32_bf16 v[204:207], a[120:123], a[40:43], v[204:207]
  v_exp_f32 v215, v215
  v_mfma_f32_16x16x32_bf16 v[204:207], a[116:119], a[36:39], v[204:207]
  v_cvt_pk_bf16_f32 v199, v214, v215
  v_mfma_f32_16x16x32_bf16 v[204:207], a[112:115], a[32:35], v[204:207]
  v_exp_f32 v200, v200
  v_mfma_f32_16x16x32_bf16 v[208:211], a[128:131], a[32:35], v[224:227]
  ds_write_b128 v240, v[196:199] offset:256
  v_mfma_f32_16x16x32_bf16 v[208:211], a[132:135], a[36:39], v[208:211]
  v_exp_f32 v201, v201
  v_mfma_f32_16x16x32_bf16 v[208:211], a[136:139], a[40:43], v[208:211]
  v_exp_f32 v202, v202
  v_mfma_f32_16x16x32_bf16 v[208:211], a[140:143], a[44:47], v[208:211]
  v_exp_f32 v203, v203
  v_mfma_f32_16x16x32_bf16 v[212:215], a[156:159], a[44:47], v[224:227]
  v_cvt_pk_bf16_f32 v200, v200, v201
  v_cvt_pk_bf16_f32 v201, v202, v203
  v_mfma_f32_16x16x32_bf16 v[212:215], a[152:155], a[40:43], v[212:215]
  v_exp_f32 v204, v204
  v_mfma_f32_16x16x32_bf16 v[212:215], a[148:151], a[36:39], v[212:215]
  v_exp_f32 v205, v205
  v_mfma_f32_16x16x32_bf16 v[212:215], a[144:147], a[32:35], v[212:215]
  v_exp_f32 v206, v206
  v_mfma_f32_16x16x32_bf16 v[192:195], a[96:99], a[48:51], v[228:231]
  v_exp_f32 v207, v207
  v_mfma_f32_16x16x32_bf16 v[192:195], a[100:103], a[52:55], v[192:195]
  v_cvt_pk_bf16_f32 v202, v204, v205
  v_cvt_pk_bf16_f32 v203, v206, v207
  v_mfma_f32_16x16x32_bf16 v[192:195], a[104:107], a[56:59], v[192:195]
  s_add_u32 m0, s38, 53120
  v_exp_f32 v208, v208
  v_mfma_f32_16x16x32_bf16 v[192:195], a[108:111], a[60:63], v[192:195]
  buffer_load_dwordx4 v252, s[16:19], s33 offen offset:128 nt lds
  v_mfma_f32_16x16x32_bf16 v[196:199], a[124:127], a[60:63], v[228:231]
  v_exp_f32 v209, v209
  v_mfma_f32_16x16x32_bf16 v[196:199], a[120:123], a[56:59], v[196:199]
  v_exp_f32 v210, v210
  v_mfma_f32_16x16x32_bf16 v[196:199], a[116:119], a[52:55], v[196:199]
  v_exp_f32 v211, v211
  v_mfma_f32_16x16x32_bf16 v[196:199], a[112:115], a[48:51], v[196:199]
  v_cvt_pk_bf16_f32 v204, v208, v209
  v_cvt_pk_bf16_f32 v205, v210, v211
  v_mfma_f32_16x16x32_bf16 v[64:67], v[200:203], a[160:163], v[64:67]
  v_exp_f32 v212, v212
  v_mfma_f32_16x16x32_bf16 v[68:71], v[200:203], a[164:167], v[68:71]
  v_exp_f32 v213, v213
  v_mfma_f32_16x16x32_bf16 v[72:75], v[200:203], a[168:171], v[72:75]
  v_exp_f32 v214, v214
  v_mfma_f32_16x16x32_bf16 v[76:79], v[200:203], a[172:175], v[76:79]
  v_exp_f32 v215, v215
  v_mfma_f32_16x16x32_bf16 v[80:83], v[200:203], a[176:179], v[80:83]
  v_cvt_pk_bf16_f32 v206, v212, v213
  v_cvt_pk_bf16_f32 v207, v214, v215
  v_mfma_f32_16x16x32_bf16 v[84:87], v[200:203], a[180:183], v[84:87]
  v_exp_f32 v192, v192
  v_mfma_f32_16x16x32_bf16 v[88:91], v[200:203], a[184:187], v[88:91]
  v_exp_f32 v193, v193
  v_mfma_f32_16x16x32_bf16 v[92:95], v[200:203], a[188:191], v[92:95]
  s_waitcnt vmcnt(6) lgkmcnt(0)
  v_exp_f32 v194, v194
  v_mfma_f32_16x16x32_bf16 v[208:211], a[128:131], a[48:51], v[228:231]
  s_barrier
  v_mfma_f32_16x16x32_bf16 v[208:211], a[132:135], a[52:55], v[208:211]
  v_exp_f32 v195, v195
  v_mfma_f32_16x16x32_bf16 v[208:211], a[136:139], a[56:59], v[208:211]
  v_cvt_pk_bf16_f32 v192, v192, v193
  v_cvt_pk_bf16_f32 v193, v194, v195
  v_mfma_f32_16x16x32_bf16 v[208:211], a[140:143], a[60:63], v[208:211]
  v_exp_f32 v196, v196
  v_mfma_f32_16x16x32_bf16 v[212:215], a[156:159], a[60:63], v[228:231]
  v_exp_f32 v197, v197
  v_mfma_f32_16x16x32_bf16 v[212:215], a[152:155], a[56:59], v[212:215]
  v_exp_f32 v198, v198
  v_mfma_f32_16x16x32_bf16 v[212:215], a[148:151], a[52:55], v[212:215]
  v_exp_f32 v199, v199
  v_mfma_f32_16x16x32_bf16 v[212:215], a[144:147], a[48:51], v[212:215]
  v_cvt_pk_bf16_f32 v194, v196, v197
  v_cvt_pk_bf16_f32 v195, v198, v199
  v_smfmac_f32_16x16x64_bf16 a[240:243], a[228:231], v[200:207], v253
  s_add_u32 m0, s38, 57344
  v_mfma_f32_16x16x32_bf16 v[64:67], v[204:207], a[192:195], v[64:67]
  buffer_load_dwordx4 v252, s[20:23], s33 offen nt lds
  v_mfma_f32_16x16x32_bf16 v[68:71], v[204:207], a[196:199], v[68:71]
  v_exp_f32 v208, v208
  v_mfma_f32_16x16x32_bf16 v[72:75], v[204:207], a[200:203], v[72:75]
  v_exp_f32 v209, v209
  v_mfma_f32_16x16x32_bf16 v[76:79], v[204:207], a[204:207], v[76:79]
  v_exp_f32 v210, v210
  v_mfma_f32_16x16x32_bf16 v[80:83], v[204:207], a[208:211], v[80:83]
  v_exp_f32 v211, v211
  v_mfma_f32_16x16x32_bf16 v[84:87], v[204:207], a[212:215], v[84:87]
  v_cvt_pk_bf16_f32 v196, v208, v209
  v_cvt_pk_bf16_f32 v197, v210, v211
  v_mfma_f32_16x16x32_bf16 v[88:91], v[204:207], a[216:219], v[88:91]
  s_add_u32 m0, s38, 61312
  v_exp_f32 v212, v212
  v_mfma_f32_16x16x32_bf16 v[92:95], v[204:207], a[220:223], v[92:95]
  buffer_load_dwordx4 v252, s[20:23], s33 offen offset:128 nt lds
  v_mfma_f32_16x16x32_bf16 v[200:203], a[96:99], a[64:67], v[232:235]
  s_add_u32 s34, s34, 1
  v_exp_f32 v213, v213
  v_mfma_f32_16x16x32_bf16 v[200:203], a[100:103], a[68:71], v[200:203]
  s_add_u32 s33, s33, 8192
  v_exp_f32 v214, v214
  v_mfma_f32_16x16x32_bf16 v[200:203], a[104:107], a[72:75], v[200:203]
  v_exp_f32 v215, v215
  v_mfma_f32_16x16x32_bf16 v[200:203], a[108:111], a[76:79], v[200:203]
  v_cvt_pk_bf16_f32 v198, v212, v213
  v_cvt_pk_bf16_f32 v199, v214, v215
  v_mfma_f32_16x16x32_bf16 v[204:207], a[124:127], a[76:79], v[232:235]
  v_mfma_f32_16x16x32_bf16 v[204:207], a[120:123], a[72:75], v[204:207]
  v_mfma_f32_16x16x32_bf16 v[204:207], a[116:119], a[68:71], v[204:207]
  v_mfma_f32_16x16x32_bf16 v[204:207], a[112:115], a[64:67], v[204:207]
  buffer_store_dwordx4 a[248:251], v245, s[28:31], s42 offen offset:0 nt
  s_nop 0
  v_exp_f32 v200, v200
  v_smfmac_f32_16x16x64_bf16 a[240:243], a[232:235], v[192:199], v253
  ds_read_b128 a[96:99], v246 offset:0
  v_mfma_f32_16x16x32_bf16 v[96:99], v[192:195], a[160:163], v[96:99]
  ds_read_b64_tr_b16 a[248:249], v244 offset:12288
  ds_read_b64_tr_b16 a[250:251], v244 offset:12352
  v_mfma_f32_16x16x32_bf16 v[96:99], v[196:199], a[192:195], v[96:99]
  v_exp_f32 v201, v201
  v_mfma_f32_16x16x32_bf16 v[100:103], v[196:199], a[196:199], v[100:103]
  v_cvt_pk_bf16_f32 v200, v200, v201
  v_add_u32 v244, 1024, v244
  v_mfma_f32_16x16x32_bf16 v[100:103], v[192:195], a[164:167], v[100:103]
  v_exp_f32 v202, v202
  v_mfma_f32_16x16x32_bf16 v[104:107], v[192:195], a[168:171], v[104:107]
  ds_read_b128 a[100:103], v247 offset:0
  v_mfma_f32_16x16x32_bf16 v[104:107], v[196:199], a[200:203], v[104:107]
  v_exp_f32 v203, v203
  v_mfma_f32_16x16x32_bf16 v[108:111], v[196:199], a[204:207], v[108:111]
  ds_read_b128 a[104:107], v246 offset:4096
  v_cvt_pk_bf16_f32 v201, v202, v203
  v_mfma_f32_16x16x32_bf16 v[108:111], v[192:195], a[172:175], v[108:111]
  v_exp_f32 v204, v204
  v_mfma_f32_16x16x32_bf16 v[208:211], a[128:131], a[64:67], v[232:235]
  ds_read_b128 a[108:111], v247 offset:4096
  v_mfma_f32_16x16x32_bf16 v[208:211], a[132:135], a[68:71], v[208:211]
  v_exp_f32 v205, v205
  v_mfma_f32_16x16x32_bf16 v[208:211], a[136:139], a[72:75], v[208:211]
  ds_read_b128 a[112:115], v246 offset:2048
  v_cvt_pk_bf16_f32 v202, v204, v205
  v_mfma_f32_16x16x32_bf16 v[208:211], a[140:143], a[76:79], v[208:211]
  v_exp_f32 v206, v206
  v_mfma_f32_16x16x32_bf16 v[212:215], a[156:159], a[76:79], v[232:235]
  ds_read_b128 a[116:119], v247 offset:2048
  v_mfma_f32_16x16x32_bf16 v[212:215], a[152:155], a[72:75], v[212:215]
  v_exp_f32 v207, v207
  v_mfma_f32_16x16x32_bf16 v[212:215], a[148:151], a[68:71], v[212:215]
  ds_read_b128 a[120:123], v246 offset:6144
  v_cvt_pk_bf16_f32 v203, v206, v207
  v_mfma_f32_16x16x32_bf16 v[212:215], a[144:147], a[64:67], v[212:215]
  v_exp_f32 v208, v208
  v_mfma_f32_16x16x32_bf16 v[112:115], v[192:195], a[176:179], v[112:115]
  ds_read_b128 a[124:127], v247 offset:6144
  v_mfma_f32_16x16x32_bf16 v[112:115], v[196:199], a[208:211], v[112:115]
  v_exp_f32 v209, v209
  v_mfma_f32_16x16x32_bf16 v[116:119], v[196:199], a[212:215], v[116:119]
  v_cvt_pk_bf16_f32 v204, v208, v209
  v_mfma_f32_16x16x32_bf16 v[116:119], v[192:195], a[180:183], v[116:119]
  s_waitcnt lgkmcnt(3)
  buffer_store_dwordx4 a[248:251], v245, s[28:31], s42 offen offset:128 nt
  v_exp_f32 v210, v210
  v_mfma_f32_16x16x32_bf16 v[120:123], v[192:195], a[184:187], v[120:123]
  s_add_u32 s42, s42, 2048
  v_mfma_f32_16x16x32_bf16 v[120:123], v[196:199], a[216:219], v[120:123]
  v_exp_f32 v211, v211
  v_mfma_f32_16x16x32_bf16 v[124:127], v[196:199], a[220:223], v[124:127]
  v_cvt_pk_bf16_f32 v205, v210, v211
  v_mfma_f32_16x16x32_bf16 v[124:127], v[192:195], a[188:191], v[124:127]
  v_exp_f32 v212, v212
  v_mfma_f32_16x16x32_bf16 v[192:195], a[96:99], a[0:3], v[216:219]
  ds_read_b128 a[128:131], v246 offset:16384
  v_mfma_f32_16x16x32_bf16 v[192:195], a[100:103], a[4:7], v[192:195]
  v_exp_f32 v213, v213
  v_mfma_f32_16x16x32_bf16 v[192:195], a[104:107], a[8:11], v[192:195]
  ds_read_b128 a[132:135], v247 offset:16384
  v_cvt_pk_bf16_f32 v206, v212, v213
  v_mfma_f32_16x16x32_bf16 v[192:195], a[108:111], a[12:15], v[192:195]
  s_waitcnt lgkmcnt(2)
  v_exp_f32 v214, v214
  v_mfma_f32_16x16x32_bf16 v[196:199], a[124:127], a[12:15], v[216:219]
  ds_read_b128 a[136:139], v246 offset:20480
  v_mfma_f32_16x16x32_bf16 v[196:199], a[120:123], a[8:11], v[196:199]
  v_exp_f32 v215, v215
  v_mfma_f32_16x16x32_bf16 v[196:199], a[116:119], a[4:7], v[196:199]
  ds_read_b128 a[140:143], v247 offset:20480
  v_cvt_pk_bf16_f32 v207, v214, v215
  v_mfma_f32_16x16x32_bf16 v[196:199], a[112:115], a[0:3], v[196:199]
  v_exp_f32 v192, v192
  v_smfmac_f32_16x16x64_bf16 a[244:247], a[228:231], v[200:207], v253
  ds_read_b128 a[144:147], v246 offset:18432
  v_mfma_f32_16x16x32_bf16 v[128:131], v[200:203], a[160:163], v[128:131]
  ds_read_b128 a[148:151], v247 offset:18432
  ds_read_b128 a[152:155], v246 offset:22528
  v_mfma_f32_16x16x32_bf16 v[128:131], v[204:207], a[192:195], v[128:131]
  v_exp_f32 v193, v193
  v_mfma_f32_16x16x32_bf16 v[132:135], v[204:207], a[196:199], v[132:135]
  ds_read_b128 a[156:159], v247 offset:22528
  v_cvt_pk_bf16_f32 v192, v192, v193
  v_mfma_f32_16x16x32_bf16 v[132:135], v[200:203], a[164:167], v[132:135]
  v_exp_f32 v194, v194
  v_mfma_f32_16x16x32_bf16 v[136:139], v[200:203], a[168:171], v[136:139]
  ds_read_b64_tr_b16 a[160:161], v248 offset:8192
  ds_read_b64_tr_b16 a[162:163], v248 offset:10240
  v_mfma_f32_16x16x32_bf16 v[136:139], v[204:207], a[200:203], v[136:139]
  v_exp_f32 v195, v195
  v_mfma_f32_16x16x32_bf16 v[140:143], v[204:207], a[204:207], v[140:143]
  ds_read_b64_tr_b16 a[192:193], v248 offset:24576
  v_cvt_pk_bf16_f32 v193, v194, v195
  v_mfma_f32_16x16x32_bf16 v[140:143], v[200:203], a[172:175], v[140:143]
  s_waitcnt lgkmcnt(6)
  v_exp_f32 v196, v196
  v_mfma_f32_16x16x32_bf16 v[208:211], a[128:131], a[0:3], v[216:219]
  ds_read_b64_tr_b16 a[194:195], v248 offset:26624
  ds_read_b64_tr_b16 a[164:165], v249 offset:8192
  v_mfma_f32_16x16x32_bf16 v[208:211], a[132:135], a[4:7], v[208:211]
  v_exp_f32 v197, v197
  v_mfma_f32_16x16x32_bf16 v[208:211], a[136:139], a[8:11], v[208:211]
  ds_read_b64_tr_b16 a[166:167], v249 offset:10240
  v_cvt_pk_bf16_f32 v194, v196, v197
  v_mfma_f32_16x16x32_bf16 v[208:211], a[140:143], a[12:15], v[208:211]
  s_waitcnt lgkmcnt(6)
  v_exp_f32 v198, v198
  v_mfma_f32_16x16x32_bf16 v[212:215], a[156:159], a[12:15], v[216:219]
  ds_read_b64_tr_b16 a[196:197], v249 offset:24576
  ds_read_b64_tr_b16 a[198:199], v249 offset:26624
  v_mfma_f32_16x16x32_bf16 v[212:215], a[152:155], a[8:11], v[212:215]
  v_exp_f32 v199, v199
  v_mfma_f32_16x16x32_bf16 v[212:215], a[148:151], a[4:7], v[212:215]
  ds_read_b64_tr_b16 a[168:169], v250 offset:8192
  v_cvt_pk_bf16_f32 v195, v198, v199
  v_mfma_f32_16x16x32_bf16 v[212:215], a[144:147], a[0:3], v[212:215]
  v_exp_f32 v208, v208
  v_mfma_f32_16x16x32_bf16 v[144:147], v[200:203], a[176:179], v[144:147]
  ds_read_b64_tr_b16 a[170:171], v250 offset:10240
  ds_read_b64_tr_b16 a[200:201], v250 offset:24576
  v_mfma_f32_16x16x32_bf16 v[144:147], v[204:207], a[208:211], v[144:147]
  v_exp_f32 v209, v209
  v_mfma_f32_16x16x32_bf16 v[148:151], v[204:207], a[212:215], v[148:151]
  ds_read_b64_tr_b16 a[202:203], v250 offset:26624
  v_cvt_pk_bf16_f32 v196, v208, v209
  v_mfma_f32_16x16x32_bf16 v[148:151], v[200:203], a[180:183], v[148:151]
  v_exp_f32 v210, v210
  v_mfma_f32_16x16x32_bf16 v[152:155], v[200:203], a[184:187], v[152:155]
  ds_read_b64_tr_b16 a[172:173], v251 offset:8192
  ds_read_b64_tr_b16 a[174:175], v251 offset:10240
  v_mfma_f32_16x16x32_bf16 v[152:155], v[204:207], a[216:219], v[152:155]
  v_exp_f32 v211, v211
  v_mfma_f32_16x16x32_bf16 v[156:159], v[204:207], a[220:223], v[156:159]
  ds_read_b64_tr_b16 a[204:205], v251 offset:24576
  v_cvt_pk_bf16_f32 v197, v210, v211
  v_mfma_f32_16x16x32_bf16 v[156:159], v[200:203], a[188:191], v[156:159]
  v_exp_f32 v212, v212
  v_mfma_f32_16x16x32_bf16 v[200:203], a[96:99], a[16:19], v[220:223]
  ds_read_b64_tr_b16 a[206:207], v251 offset:26624
  ds_read_b64_tr_b16 a[176:177], v248 offset:12288
  v_mfma_f32_16x16x32_bf16 v[200:203], a[100:103], a[20:23], v[200:203]
  v_exp_f32 v213, v213
  v_mfma_f32_16x16x32_bf16 v[200:203], a[104:107], a[24:27], v[200:203]
  ds_read_b64_tr_b16 a[178:179], v248 offset:14336
  v_cvt_pk_bf16_f32 v198, v212, v213
  v_mfma_f32_16x16x32_bf16 v[200:203], a[108:111], a[28:31], v[200:203]
  v_exp_f32 v214, v214
  v_mfma_f32_16x16x32_bf16 v[204:207], a[124:127], a[28:31], v[220:223]
  ds_read_b64_tr_b16 a[208:209], v248 offset:28672
  ds_read_b64_tr_b16 a[210:211], v248 offset:30720
  v_mfma_f32_16x16x32_bf16 v[204:207], a[120:123], a[24:27], v[204:207]
  v_exp_f32 v215, v215
  v_mfma_f32_16x16x32_bf16 v[204:207], a[116:119], a[20:23], v[204:207]
  ds_read_b64_tr_b16 a[180:181], v249 offset:12288
  v_cvt_pk_bf16_f32 v199, v214, v215
  v_mfma_f32_16x16x32_bf16 v[204:207], a[112:115], a[16:19], v[204:207]
  v_exp_f32 v200, v200
  v_smfmac_f32_16x16x64_bf16 a[236:239], a[228:231], v[192:199], v253
  s_waitcnt lgkmcnt(4)
  ds_read_b64_tr_b16 a[182:183], v249 offset:14336
  v_mfma_f32_16x16x32_bf16 v[0:3], v[192:195], a[160:163], v[0:3]
  ds_read_b64_tr_b16 a[212:213], v249 offset:28672
  ds_read_b64_tr_b16 a[214:215], v249 offset:30720
  v_mfma_f32_16x16x32_bf16 v[0:3], v[196:199], a[192:195], v[0:3]
  v_exp_f32 v201, v201
  v_mfma_f32_16x16x32_bf16 v[4:7], v[196:199], a[196:199], v[4:7]
  ds_read_b64_tr_b16 a[184:185], v250 offset:12288
  v_cvt_pk_bf16_f32 v200, v200, v201
  v_mfma_f32_16x16x32_bf16 v[4:7], v[192:195], a[164:167], v[4:7]
  v_exp_f32 v202, v202
  v_mfma_f32_16x16x32_bf16 v[8:11], v[192:195], a[168:171], v[8:11]
  ds_read_b64_tr_b16 a[186:187], v250 offset:14336
  ds_read_b64_tr_b16 a[216:217], v250 offset:28672
  v_mfma_f32_16x16x32_bf16 v[8:11], v[196:199], a[200:203], v[8:11]
  v_exp_f32 v203, v203
  v_mfma_f32_16x16x32_bf16 v[12:15], v[196:199], a[204:207], v[12:15]
  ds_read_b64_tr_b16 a[218:219], v250 offset:30720
  v_cvt_pk_bf16_f32 v201, v202, v203
  v_mfma_f32_16x16x32_bf16 v[12:15], v[192:195], a[172:175], v[12:15]
  v_exp_f32 v204, v204
  v_mfma_f32_16x16x32_bf16 v[208:211], a[128:131], a[16:19], v[220:223]
  ds_read_b64_tr_b16 a[188:189], v251 offset:12288
  ds_read_b64_tr_b16 a[190:191], v251 offset:14336
  v_mfma_f32_16x16x32_bf16 v[208:211], a[132:135], a[20:23], v[208:211]
  v_exp_f32 v205, v205
  v_mfma_f32_16x16x32_bf16 v[208:211], a[136:139], a[24:27], v[208:211]
  ds_read_b64_tr_b16 a[220:221], v251 offset:28672
  v_cvt_pk_bf16_f32 v202, v204, v205
  v_mfma_f32_16x16x32_bf16 v[208:211], a[140:143], a[28:31], v[208:211]
  v_exp_f32 v206, v206
  v_mfma_f32_16x16x32_bf16 v[212:215], a[156:159], a[28:31], v[220:223]
  ds_read_b64_tr_b16 a[222:223], v251 offset:30720
  v_mfma_f32_16x16x32_bf16 v[212:215], a[152:155], a[24:27], v[212:215]
  v_exp_f32 v207, v207
  v_mfma_f32_16x16x32_bf16 v[212:215], a[148:151], a[20:23], v[212:215]
  v_cvt_pk_bf16_f32 v203, v206, v207
  v_mfma_f32_16x16x32_bf16 v[212:215], a[144:147], a[16:19], v[212:215]
  s_waitcnt lgkmcnt(4)
  v_exp_f32 v208, v208
  v_mfma_f32_16x16x32_bf16 v[16:19], v[192:195], a[176:179], v[16:19]
  v_mfma_f32_16x16x32_bf16 v[16:19], v[196:199], a[208:211], v[16:19]
  v_exp_f32 v209, v209
  v_mfma_f32_16x16x32_bf16 v[20:23], v[196:199], a[212:215], v[20:23]
  v_cvt_pk_bf16_f32 v204, v208, v209
  v_mfma_f32_16x16x32_bf16 v[20:23], v[192:195], a[180:183], v[20:23]
  s_waitcnt lgkmcnt(0)
  v_exp_f32 v210, v210
  v_mfma_f32_16x16x32_bf16 v[24:27], v[192:195], a[184:187], v[24:27]
  s_barrier
  v_mfma_f32_16x16x32_bf16 v[24:27], v[196:199], a[216:219], v[24:27]
  v_exp_f32 v211, v211
  v_mfma_f32_16x16x32_bf16 v[28:31], v[196:199], a[220:223], v[28:31]
  v_cvt_pk_bf16_f32 v205, v210, v211
  v_mfma_f32_16x16x32_bf16 v[28:31], v[192:195], a[188:191], v[28:31]
  v_exp_f32 v212, v212
  v_mfma_f32_16x16x32_bf16 v[192:195], a[96:99], a[80:83], v[236:239]
  v_mfma_f32_16x16x32_bf16 v[192:195], a[100:103], a[84:87], v[192:195]
  v_exp_f32 v213, v213
  v_mfma_f32_16x16x32_bf16 v[192:195], a[104:107], a[88:91], v[192:195]
  v_cvt_pk_bf16_f32 v206, v212, v213
  v_mfma_f32_16x16x32_bf16 v[192:195], a[108:111], a[92:95], v[192:195]
  s_add_u32 m0, s38, 0
  v_exp_f32 v214, v214
  v_mfma_f32_16x16x32_bf16 v[196:199], a[124:127], a[92:95], v[236:239]
  buffer_load_dwordx4 v252, s[16:19], s33 offen nt lds
  v_mfma_f32_16x16x32_bf16 v[196:199], a[120:123], a[88:91], v[196:199]
  v_exp_f32 v215, v215
  v_mfma_f32_16x16x32_bf16 v[196:199], a[116:119], a[84:87], v[196:199]
  v_cvt_pk_bf16_f32 v207, v214, v215
  v_mfma_f32_16x16x32_bf16 v[196:199], a[112:115], a[80:83], v[196:199]
  v_exp_f32 v192, v192
  v_smfmac_f32_16x16x64_bf16 a[236:239], a[232:235], v[200:207], v253
  ds_read_b64_tr_b16 a[248:249], v244 offset:0
  v_mfma_f32_16x16x32_bf16 v[32:35], v[200:203], a[160:163], v[32:35]
  ds_read_b64_tr_b16 a[250:251], v244 offset:64
  v_mfma_f32_16x16x32_bf16 v[32:35], v[204:207], a[192:195], v[32:35]
  v_exp_f32 v193, v193
  v_mfma_f32_16x16x32_bf16 v[36:39], v[204:207], a[196:199], v[36:39]
  v_cvt_pk_bf16_f32 v192, v192, v193
  v_mfma_f32_16x16x32_bf16 v[36:39], v[200:203], a[164:167], v[36:39]
  s_add_u32 m0, s38, 3968
  v_exp_f32 v194, v194
  v_mfma_f32_16x16x32_bf16 v[40:43], v[200:203], a[168:171], v[40:43]
  buffer_load_dwordx4 v252, s[16:19], s33 offen offset:128 nt lds
  v_mfma_f32_16x16x32_bf16 v[40:43], v[204:207], a[200:203], v[40:43]
  v_exp_f32 v195, v195
  v_mfma_f32_16x16x32_bf16 v[44:47], v[204:207], a[204:207], v[44:47]
  v_cvt_pk_bf16_f32 v193, v194, v195
  v_mfma_f32_16x16x32_bf16 v[44:47], v[200:203], a[172:175], v[44:47]
  v_exp_f32 v196, v196
  v_mfma_f32_16x16x32_bf16 v[208:211], a[128:131], a[80:83], v[236:239]
  v_mfma_f32_16x16x32_bf16 v[208:211], a[132:135], a[84:87], v[208:211]
  v_exp_f32 v197, v197
  v_mfma_f32_16x16x32_bf16 v[208:211], a[136:139], a[88:91], v[208:211]
  v_cvt_pk_bf16_f32 v194, v196, v197
  v_mfma_f32_16x16x32_bf16 v[208:211], a[140:143], a[92:95], v[208:211]
  s_add_u32 m0, s38, 8192
  v_exp_f32 v198, v198
  v_mfma_f32_16x16x32_bf16 v[212:215], a[156:159], a[92:95], v[236:239]
  buffer_load_dwordx4 v252, s[20:23], s33 offen nt lds
  v_mfma_f32_16x16x32_bf16 v[212:215], a[152:155], a[88:91], v[212:215]
  v_exp_f32 v199, v199
  v_mfma_f32_16x16x32_bf16 v[212:215], a[148:151], a[84:87], v[212:215]
  v_cvt_pk_bf16_f32 v195, v198, v199
  v_mfma_f32_16x16x32_bf16 v[212:215], a[144:147], a[80:83], v[212:215]
  v_exp_f32 v208, v208
  v_mfma_f32_16x16x32_bf16 v[48:51], v[200:203], a[176:179], v[48:51]
  v_mfma_f32_16x16x32_bf16 v[48:51], v[204:207], a[208:211], v[48:51]
  v_exp_f32 v209, v209
  v_mfma_f32_16x16x32_bf16 v[52:55], v[204:207], a[212:215], v[52:55]
  v_cvt_pk_bf16_f32 v196, v208, v209
  v_mfma_f32_16x16x32_bf16 v[52:55], v[200:203], a[180:183], v[52:55]
  s_add_u32 m0, s38, 12160
  v_exp_f32 v210, v210
  v_mfma_f32_16x16x32_bf16 v[56:59], v[200:203], a[184:187], v[56:59]
  buffer_load_dwordx4 v252, s[20:23], s33 offen offset:128 nt lds
  v_mfma_f32_16x16x32_bf16 v[56:59], v[204:207], a[216:219], v[56:59]
  s_add_u32 s34, s34, 1
  v_exp_f32 v211, v211
  v_mfma_f32_16x16x32_bf16 v[60:63], v[204:207], a[220:223], v[60:63]
  s_add_u32 s33, s33, 8192
  v_cvt_pk_bf16_f32 v197, v210, v211
  v_mfma_f32_16x16x32_bf16 v[60:63], v[200:203], a[188:191], v[60:63]
  v_exp_f32 v212, v212
  v_mfma_f32_16x16x32_bf16 v[200:203], a[96:99], a[32:35], v[224:227]
  ds_write_b128 v240, v[192:195] offset:0
  v_mfma_f32_16x16x32_bf16 v[200:203], a[100:103], a[36:39], v[200:203]
  v_exp_f32 v213, v213
  v_mfma_f32_16x16x32_bf16 v[200:203], a[104:107], a[40:43], v[200:203]
  v_cvt_pk_bf16_f32 v198, v212, v213
  v_mfma_f32_16x16x32_bf16 v[200:203], a[108:111], a[44:47], v[200:203]
  s_add_u32 m0, s38, 16384
  v_exp_f32 v214, v214
  v_mfma_f32_16x16x32_bf16 v[204:207], a[124:127], a[44:47], v[224:227]
  buffer_load_dwordx4 v252, s[16:19], s33 offen nt lds
  v_mfma_f32_16x16x32_bf16 v[204:207], a[120:123], a[40:43], v[204:207]
  v_exp_f32 v215, v215
  v_mfma_f32_16x16x32_bf16 v[204:207], a[116:119], a[36:39], v[204:207]
  v_cvt_pk_bf16_f32 v199, v214, v215
  v_mfma_f32_16x16x32_bf16 v[204:207], a[112:115], a[32:35], v[204:207]
  v_exp_f32 v200, v200
  v_mfma_f32_16x16x32_bf16 v[208:211], a[128:131], a[32:35], v[224:227]
  ds_write_b128 v240, v[196:199] offset:256
  v_mfma_f32_16x16x32_bf16 v[208:211], a[132:135], a[36:39], v[208:211]
  v_exp_f32 v201, v201
  v_mfma_f32_16x16x32_bf16 v[208:211], a[136:139], a[40:43], v[208:211]
  v_exp_f32 v202, v202
  v_mfma_f32_16x16x32_bf16 v[208:211], a[140:143], a[44:47], v[208:211]
  v_exp_f32 v203, v203
  v_mfma_f32_16x16x32_bf16 v[212:215], a[156:159], a[44:47], v[224:227]
  v_cvt_pk_bf16_f32 v200, v200, v201
  v_cvt_pk_bf16_f32 v201, v202, v203
  v_mfma_f32_16x16x32_bf16 v[212:215], a[152:155], a[40:43], v[212:215]
  v_exp_f32 v204, v204
  v_mfma_f32_16x16x32_bf16 v[212:215], a[148:151], a[36:39], v[212:215]
  v_exp_f32 v205, v205
  v_mfma_f32_16x16x32_bf16 v[212:215], a[144:147], a[32:35], v[212:215]
  v_exp_f32 v206, v206
  v_mfma_f32_16x16x32_bf16 v[192:195], a[96:99], a[48:51], v[228:231]
  v_exp_f32 v207, v207
  v_mfma_f32_16x16x32_bf16 v[192:195], a[100:103], a[52:55], v[192:195]
  v_cvt_pk_bf16_f32 v202, v204, v205
  v_cvt_pk_bf16_f32 v203, v206, v207
  v_mfma_f32_16x16x32_bf16 v[192:195], a[104:107], a[56:59], v[192:195]
  s_add_u32 m0, s38, 20352
  v_exp_f32 v208, v208
  v_mfma_f32_16x16x32_bf16 v[192:195], a[108:111], a[60:63], v[192:195]
  buffer_load_dwordx4 v252, s[16:19], s33 offen offset:128 nt lds
  v_mfma_f32_16x16x32_bf16 v[196:199], a[124:127], a[60:63], v[228:231]
  v_exp_f32 v209, v209
  v_mfma_f32_16x16x32_bf16 v[196:199], a[120:123], a[56:59], v[196:199]
  v_exp_f32 v210, v210
  v_mfma_f32_16x16x32_bf16 v[196:199], a[116:119], a[52:55], v[196:199]
  v_exp_f32 v211, v211
  v_mfma_f32_16x16x32_bf16 v[196:199], a[112:115], a[48:51], v[196:199]
  v_cvt_pk_bf16_f32 v204, v208, v209
  v_cvt_pk_bf16_f32 v205, v210, v211
  v_mfma_f32_16x16x32_bf16 v[64:67], v[200:203], a[160:163], v[64:67]
  v_exp_f32 v212, v212
  v_mfma_f32_16x16x32_bf16 v[68:71], v[200:203], a[164:167], v[68:71]
  v_exp_f32 v213, v213
  v_mfma_f32_16x16x32_bf16 v[72:75], v[200:203], a[168:171], v[72:75]
  v_exp_f32 v214, v214
  v_mfma_f32_16x16x32_bf16 v[76:79], v[200:203], a[172:175], v[76:79]
  v_exp_f32 v215, v215
  v_mfma_f32_16x16x32_bf16 v[80:83], v[200:203], a[176:179], v[80:83]
  v_cvt_pk_bf16_f32 v206, v212, v213
  v_cvt_pk_bf16_f32 v207, v214, v215
  v_mfma_f32_16x16x32_bf16 v[84:87], v[200:203], a[180:183], v[84:87]
  v_exp_f32 v192, v192
  v_mfma_f32_16x16x32_bf16 v[88:91], v[200:203], a[184:187], v[88:91]
  v_exp_f32 v193, v193
  v_mfma_f32_16x16x32_bf16 v[92:95], v[200:203], a[188:191], v[92:95]
  s_waitcnt vmcnt(6) lgkmcnt(0)
  v_exp_f32 v194, v194
  v_mfma_f32_16x16x32_bf16 v[208:211], a[128:131], a[48:51], v[228:231]
  s_barrier
  v_mfma_f32_16x16x32_bf16 v[208:211], a[132:135], a[52:55], v[208:211]
  v_exp_f32 v195, v195
  v_mfma_f32_16x16x32_bf16 v[208:211], a[136:139], a[56:59], v[208:211]
  v_cvt_pk_bf16_f32 v192, v192, v193
  v_cvt_pk_bf16_f32 v193, v194, v195
  v_mfma_f32_16x16x32_bf16 v[208:211], a[140:143], a[60:63], v[208:211]
  v_exp_f32 v196, v196
  v_mfma_f32_16x16x32_bf16 v[212:215], a[156:159], a[60:63], v[228:231]
  v_exp_f32 v197, v197
  v_mfma_f32_16x16x32_bf16 v[212:215], a[152:155], a[56:59], v[212:215]
  v_exp_f32 v198, v198
  v_mfma_f32_16x16x32_bf16 v[212:215], a[148:151], a[52:55], v[212:215]
  v_exp_f32 v199, v199
  v_mfma_f32_16x16x32_bf16 v[212:215], a[144:147], a[48:51], v[212:215]
  v_cvt_pk_bf16_f32 v194, v196, v197
  v_cvt_pk_bf16_f32 v195, v198, v199
  v_smfmac_f32_16x16x64_bf16 a[240:243], a[228:231], v[200:207], v253
  s_add_u32 m0, s38, 24576
  v_mfma_f32_16x16x32_bf16 v[64:67], v[204:207], a[192:195], v[64:67]
  buffer_load_dwordx4 v252, s[20:23], s33 offen nt lds
  v_mfma_f32_16x16x32_bf16 v[68:71], v[204:207], a[196:199], v[68:71]
  v_exp_f32 v208, v208
  v_mfma_f32_16x16x32_bf16 v[72:75], v[204:207], a[200:203], v[72:75]
  v_exp_f32 v209, v209
  v_mfma_f32_16x16x32_bf16 v[76:79], v[204:207], a[204:207], v[76:79]
  v_exp_f32 v210, v210
  v_mfma_f32_16x16x32_bf16 v[80:83], v[204:207], a[208:211], v[80:83]
  v_exp_f32 v211, v211
  v_mfma_f32_16x16x32_bf16 v[84:87], v[204:207], a[212:215], v[84:87]
  v_cvt_pk_bf16_f32 v196, v208, v209
  v_cvt_pk_bf16_f32 v197, v210, v211
  v_mfma_f32_16x16x32_bf16 v[88:91], v[204:207], a[216:219], v[88:91]
  s_add_u32 m0, s38, 28544
  v_exp_f32 v212, v212
  v_mfma_f32_16x16x32_bf16 v[92:95], v[204:207], a[220:223], v[92:95]
  buffer_load_dwordx4 v252, s[20:23], s33 offen offset:128 nt lds
  v_mfma_f32_16x16x32_bf16 v[200:203], a[96:99], a[64:67], v[232:235]
  s_add_u32 s34, s34, 1
  v_exp_f32 v213, v213
  v_mfma_f32_16x16x32_bf16 v[200:203], a[100:103], a[68:71], v[200:203]
  s_add_u32 s33, s33, 8192
  v_exp_f32 v214, v214
  v_mfma_f32_16x16x32_bf16 v[200:203], a[104:107], a[72:75], v[200:203]
  v_exp_f32 v215, v215
  v_mfma_f32_16x16x32_bf16 v[200:203], a[108:111], a[76:79], v[200:203]
  v_cvt_pk_bf16_f32 v198, v212, v213
  v_cvt_pk_bf16_f32 v199, v214, v215
  v_mfma_f32_16x16x32_bf16 v[204:207], a[124:127], a[76:79], v[232:235]
  v_mfma_f32_16x16x32_bf16 v[204:207], a[120:123], a[72:75], v[204:207]
  v_mfma_f32_16x16x32_bf16 v[204:207], a[116:119], a[68:71], v[204:207]
  v_mfma_f32_16x16x32_bf16 v[204:207], a[112:115], a[64:67], v[204:207]
  buffer_store_dwordx4 a[248:251], v245, s[28:31], s42 offen offset:0 nt
  s_nop 0
  v_exp_f32 v200, v200
  v_smfmac_f32_16x16x64_bf16 a[240:243], a[232:235], v[192:199], v253
  ds_read_b128 a[96:99], v246 offset:32768
  v_mfma_f32_16x16x32_bf16 v[96:99], v[192:195], a[160:163], v[96:99]
  ds_read_b64_tr_b16 a[248:249], v244 offset:12288
  ds_read_b64_tr_b16 a[250:251], v244 offset:12352
  v_mfma_f32_16x16x32_bf16 v[96:99], v[196:199], a[192:195], v[96:99]
  v_exp_f32 v201, v201
  v_mfma_f32_16x16x32_bf16 v[100:103], v[196:199], a[196:199], v[100:103]
  v_cvt_pk_bf16_f32 v200, v200, v201
  v_add_u32 v244, 1024, v244
  v_mfma_f32_16x16x32_bf16 v[100:103], v[192:195], a[164:167], v[100:103]
  v_exp_f32 v202, v202
  v_mfma_f32_16x16x32_bf16 v[104:107], v[192:195], a[168:171], v[104:107]
  ds_read_b128 a[100:103], v247 offset:32768
  v_mfma_f32_16x16x32_bf16 v[104:107], v[196:199], a[200:203], v[104:107]
  v_exp_f32 v203, v203
  v_mfma_f32_16x16x32_bf16 v[108:111], v[196:199], a[204:207], v[108:111]
  ds_read_b128 a[104:107], v246 offset:36864
  v_cvt_pk_bf16_f32 v201, v202, v203
  v_mfma_f32_16x16x32_bf16 v[108:111], v[192:195], a[172:175], v[108:111]
  v_exp_f32 v204, v204
  v_mfma_f32_16x16x32_bf16 v[208:211], a[128:131], a[64:67], v[232:235]
  ds_read_b128 a[108:111], v247 offset:36864
  v_mfma_f32_16x16x32_bf16 v[208:211], a[132:135], a[68:71], v[208:211]
  v_exp_f32 v205, v205
  v_mfma_f32_16x16x32_bf16 v[208:211], a[136:139], a[72:75], v[208:211]
  ds_read_b128 a[112:115], v246 offset:34816
  v_cvt_pk_bf16_f32 v202, v204, v205
  v_mfma_f32_16x16x32_bf16 v[208:211], a[140:143], a[76:79], v[208:211]
  v_exp_f32 v206, v206
  v_mfma_f32_16x16x32_bf16 v[212:215], a[156:159], a[76:79], v[232:235]
  ds_read_b128 a[116:119], v247 offset:34816
  v_mfma_f32_16x16x32_bf16 v[212:215], a[152:155], a[72:75], v[212:215]
  v_exp_f32 v207, v207
  v_mfma_f32_16x16x32_bf16 v[212:215], a[148:151], a[68:71], v[212:215]
  ds_read_b128 a[120:123], v246 offset:38912
  v_cvt_pk_bf16_f32 v203, v206, v207
  v_mfma_f32_16x16x32_bf16 v[212:215], a[144:147], a[64:67], v[212:215]
  v_exp_f32 v208, v208
  v_mfma_f32_16x16x32_bf16 v[112:115], v[192:195], a[176:179], v[112:115]
  ds_read_b128 a[124:127], v247 offset:38912
  v_mfma_f32_16x16x32_bf16 v[112:115], v[196:199], a[208:211], v[112:115]
  v_exp_f32 v209, v209
  v_mfma_f32_16x16x32_bf16 v[116:119], v[196:199], a[212:215], v[116:119]
  v_cvt_pk_bf16_f32 v204, v208, v209
  v_mfma_f32_16x16x32_bf16 v[116:119], v[192:195], a[180:183], v[116:119]
  s_waitcnt lgkmcnt(3)
  buffer_store_dwordx4 a[248:251], v245, s[28:31], s42 offen offset:128 nt
  v_exp_f32 v210, v210
  v_mfma_f32_16x16x32_bf16 v[120:123], v[192:195], a[184:187], v[120:123]
  s_add_u32 s42, s42, 2048
  v_mfma_f32_16x16x32_bf16 v[120:123], v[196:199], a[216:219], v[120:123]
  v_exp_f32 v211, v211
  v_mfma_f32_16x16x32_bf16 v[124:127], v[196:199], a[220:223], v[124:127]
  v_cvt_pk_bf16_f32 v205, v210, v211
  v_mfma_f32_16x16x32_bf16 v[124:127], v[192:195], a[188:191], v[124:127]
  v_exp_f32 v212, v212
  v_mfma_f32_16x16x32_bf16 v[192:195], a[96:99], a[0:3], v[216:219]
  ds_read_b128 a[128:131], v246 offset:49152
  v_mfma_f32_16x16x32_bf16 v[192:195], a[100:103], a[4:7], v[192:195]
  v_exp_f32 v213, v213
  v_mfma_f32_16x16x32_bf16 v[192:195], a[104:107], a[8:11], v[192:195]
  ds_read_b128 a[132:135], v247 offset:49152
  v_cvt_pk_bf16_f32 v206, v212, v213
  v_mfma_f32_16x16x32_bf16 v[192:195], a[108:111], a[12:15], v[192:195]
  s_waitcnt lgkmcnt(2)
  v_exp_f32 v214, v214
  v_mfma_f32_16x16x32_bf16 v[196:199], a[124:127], a[12:15], v[216:219]
  ds_read_b128 a[136:139], v246 offset:53248
  v_mfma_f32_16x16x32_bf16 v[196:199], a[120:123], a[8:11], v[196:199]
  v_exp_f32 v215, v215
  v_mfma_f32_16x16x32_bf16 v[196:199], a[116:119], a[4:7], v[196:199]
  ds_read_b128 a[140:143], v247 offset:53248
  v_cvt_pk_bf16_f32 v207, v214, v215
  v_mfma_f32_16x16x32_bf16 v[196:199], a[112:115], a[0:3], v[196:199]
  v_exp_f32 v192, v192
  v_smfmac_f32_16x16x64_bf16 a[244:247], a[228:231], v[200:207], v253
  ds_read_b128 a[144:147], v246 offset:51200
  v_mfma_f32_16x16x32_bf16 v[128:131], v[200:203], a[160:163], v[128:131]
  ds_read_b128 a[148:151], v247 offset:51200
  ds_read_b128 a[152:155], v246 offset:55296
  v_mfma_f32_16x16x32_bf16 v[128:131], v[204:207], a[192:195], v[128:131]
  v_exp_f32 v193, v193
  v_mfma_f32_16x16x32_bf16 v[132:135], v[204:207], a[196:199], v[132:135]
  ds_read_b128 a[156:159], v247 offset:55296
  v_cvt_pk_bf16_f32 v192, v192, v193
  v_mfma_f32_16x16x32_bf16 v[132:135], v[200:203], a[164:167], v[132:135]
  v_exp_f32 v194, v194
  v_mfma_f32_16x16x32_bf16 v[136:139], v[200:203], a[168:171], v[136:139]
  ds_read_b64_tr_b16 a[160:161], v248 offset:40960
  ds_read_b64_tr_b16 a[162:163], v248 offset:43008
  v_mfma_f32_16x16x32_bf16 v[136:139], v[204:207], a[200:203], v[136:139]
  v_exp_f32 v195, v195
  v_mfma_f32_16x16x32_bf16 v[140:143], v[204:207], a[204:207], v[140:143]
  ds_read_b64_tr_b16 a[192:193], v248 offset:57344
  v_cvt_pk_bf16_f32 v193, v194, v195
  v_mfma_f32_16x16x32_bf16 v[140:143], v[200:203], a[172:175], v[140:143]
  s_waitcnt lgkmcnt(6)
  v_exp_f32 v196, v196
  v_mfma_f32_16x16x32_bf16 v[208:211], a[128:131], a[0:3], v[216:219]
  ds_read_b64_tr_b16 a[194:195], v248 offset:59392
  ds_read_b64_tr_b16 a[164:165], v249 offset:40960
  v_mfma_f32_16x16x32_bf16 v[208:211], a[132:135], a[4:7], v[208:211]
  v_exp_f32 v197, v197
  v_mfma_f32_16x16x32_bf16 v[208:211], a[136:139], a[8:11], v[208:211]
  ds_read_b64_tr_b16 a[166:167], v249 offset:43008
  v_cvt_pk_bf16_f32 v194, v196, v197
  v_mfma_f32_16x16x32_bf16 v[208:211], a[140:143], a[12:15], v[208:211]
  s_waitcnt lgkmcnt(6)
  v_exp_f32 v198, v198
  v_mfma_f32_16x16x32_bf16 v[212:215], a[156:159], a[12:15], v[216:219]
  ds_read_b64_tr_b16 a[196:197], v249 offset:57344
  ds_read_b64_tr_b16 a[198:199], v249 offset:59392
  v_mfma_f32_16x16x32_bf16 v[212:215], a[152:155], a[8:11], v[212:215]
  v_exp_f32 v199, v199
  v_mfma_f32_16x16x32_bf16 v[212:215], a[148:151], a[4:7], v[212:215]
  ds_read_b64_tr_b16 a[168:169], v250 offset:40960
  v_cvt_pk_bf16_f32 v195, v198, v199
  v_mfma_f32_16x16x32_bf16 v[212:215], a[144:147], a[0:3], v[212:215]
  v_exp_f32 v208, v208
  v_mfma_f32_16x16x32_bf16 v[144:147], v[200:203], a[176:179], v[144:147]
  ds_read_b64_tr_b16 a[170:171], v250 offset:43008
  ds_read_b64_tr_b16 a[200:201], v250 offset:57344
  v_mfma_f32_16x16x32_bf16 v[144:147], v[204:207], a[208:211], v[144:147]
  v_exp_f32 v209, v209
  v_mfma_f32_16x16x32_bf16 v[148:151], v[204:207], a[212:215], v[148:151]
  ds_read_b64_tr_b16 a[202:203], v250 offset:59392
  v_cvt_pk_bf16_f32 v196, v208, v209
  v_mfma_f32_16x16x32_bf16 v[148:151], v[200:203], a[180:183], v[148:151]
  v_exp_f32 v210, v210
  v_mfma_f32_16x16x32_bf16 v[152:155], v[200:203], a[184:187], v[152:155]
  ds_read_b64_tr_b16 a[172:173], v251 offset:40960
  ds_read_b64_tr_b16 a[174:175], v251 offset:43008
  v_mfma_f32_16x16x32_bf16 v[152:155], v[204:207], a[216:219], v[152:155]
  v_exp_f32 v211, v211
  v_mfma_f32_16x16x32_bf16 v[156:159], v[204:207], a[220:223], v[156:159]
  ds_read_b64_tr_b16 a[204:205], v251 offset:57344
  v_cvt_pk_bf16_f32 v197, v210, v211
  v_mfma_f32_16x16x32_bf16 v[156:159], v[200:203], a[188:191], v[156:159]
  v_exp_f32 v212, v212
  v_mfma_f32_16x16x32_bf16 v[200:203], a[96:99], a[16:19], v[220:223]
  ds_read_b64_tr_b16 a[206:207], v251 offset:59392
  ds_read_b64_tr_b16 a[176:177], v248 offset:45056
  v_mfma_f32_16x16x32_bf16 v[200:203], a[100:103], a[20:23], v[200:203]
  v_exp_f32 v213, v213
  v_mfma_f32_16x16x32_bf16 v[200:203], a[104:107], a[24:27], v[200:203]
  ds_read_b64_tr_b16 a[178:179], v248 offset:47104
  v_cvt_pk_bf16_f32 v198, v212, v213
  v_mfma_f32_16x16x32_bf16 v[200:203], a[108:111], a[28:31], v[200:203]
  v_exp_f32 v214, v214
  v_mfma_f32_16x16x32_bf16 v[204:207], a[124:127], a[28:31], v[220:223]
  ds_read_b64_tr_b16 a[208:209], v248 offset:61440
  ds_read_b64_tr_b16 a[210:211], v248 offset:63488
  v_mfma_f32_16x16x32_bf16 v[204:207], a[120:123], a[24:27], v[204:207]
  v_exp_f32 v215, v215
  v_mfma_f32_16x16x32_bf16 v[204:207], a[116:119], a[20:23], v[204:207]
  ds_read_b64_tr_b16 a[180:181], v249 offset:45056
  v_cvt_pk_bf16_f32 v199, v214, v215
  v_mfma_f32_16x16x32_bf16 v[204:207], a[112:115], a[16:19], v[204:207]
  v_exp_f32 v200, v200
  v_smfmac_f32_16x16x64_bf16 a[236:239], a[228:231], v[192:199], v253
  s_waitcnt lgkmcnt(4)
  ds_read_b64_tr_b16 a[182:183], v249 offset:47104
  v_mfma_f32_16x16x32_bf16 v[0:3], v[192:195], a[160:163], v[0:3]
  ds_read_b64_tr_b16 a[212:213], v249 offset:61440
  ds_read_b64_tr_b16 a[214:215], v249 offset:63488
  v_mfma_f32_16x16x32_bf16 v[0:3], v[196:199], a[192:195], v[0:3]
  v_exp_f32 v201, v201
  v_mfma_f32_16x16x32_bf16 v[4:7], v[196:199], a[196:199], v[4:7]
  ds_read_b64_tr_b16 a[184:185], v250 offset:45056
  v_cvt_pk_bf16_f32 v200, v200, v201
  v_mfma_f32_16x16x32_bf16 v[4:7], v[192:195], a[164:167], v[4:7]
  v_exp_f32 v202, v202
  v_mfma_f32_16x16x32_bf16 v[8:11], v[192:195], a[168:171], v[8:11]
  ds_read_b64_tr_b16 a[186:187], v250 offset:47104
  ds_read_b64_tr_b16 a[216:217], v250 offset:61440
  v_mfma_f32_16x16x32_bf16 v[8:11], v[196:199], a[200:203], v[8:11]
  v_exp_f32 v203, v203
  v_mfma_f32_16x16x32_bf16 v[12:15], v[196:199], a[204:207], v[12:15]
  ds_read_b64_tr_b16 a[218:219], v250 offset:63488
  v_cvt_pk_bf16_f32 v201, v202, v203
  v_mfma_f32_16x16x32_bf16 v[12:15], v[192:195], a[172:175], v[12:15]
  v_exp_f32 v204, v204
  v_mfma_f32_16x16x32_bf16 v[208:211], a[128:131], a[16:19], v[220:223]
  ds_read_b64_tr_b16 a[188:189], v251 offset:45056
  ds_read_b64_tr_b16 a[190:191], v251 offset:47104
  v_mfma_f32_16x16x32_bf16 v[208:211], a[132:135], a[20:23], v[208:211]
  v_exp_f32 v205, v205
  v_mfma_f32_16x16x32_bf16 v[208:211], a[136:139], a[24:27], v[208:211]
  ds_read_b64_tr_b16 a[220:221], v251 offset:61440
  v_cvt_pk_bf16_f32 v202, v204, v205
  v_mfma_f32_16x16x32_bf16 v[208:211], a[140:143], a[28:31], v[208:211]
  v_exp_f32 v206, v206
  v_mfma_f32_16x16x32_bf16 v[212:215], a[156:159], a[28:31], v[220:223]
  ds_read_b64_tr_b16 a[222:223], v251 offset:63488
  v_mfma_f32_16x16x32_bf16 v[212:215], a[152:155], a[24:27], v[212:215]
  v_exp_f32 v207, v207
  v_mfma_f32_16x16x32_bf16 v[212:215], a[148:151], a[20:23], v[212:215]
  v_cvt_pk_bf16_f32 v203, v206, v207
  v_mfma_f32_16x16x32_bf16 v[212:215], a[144:147], a[16:19], v[212:215]
  s_waitcnt lgkmcnt(4)
  v_exp_f32 v208, v208
  v_mfma_f32_16x16x32_bf16 v[16:19], v[192:195], a[176:179], v[16:19]
  v_mfma_f32_16x16x32_bf16 v[16:19], v[196:199], a[208:211], v[16:19]
  v_exp_f32 v209, v209
  v_mfma_f32_16x16x32_bf16 v[20:23], v[196:199], a[212:215], v[20:23]
  s_cmp_eq_u32 s34, 46
  v_cvt_pk_bf16_f32 v204, v208, v209
  v_mfma_f32_16x16x32_bf16 v[20:23], v[192:195], a[180:183], v[20:23]
  s_waitcnt lgkmcnt(0)
  v_exp_f32 v210, v210
  v_mfma_f32_16x16x32_bf16 v[24:27], v[192:195], a[184:187], v[24:27]
  s_barrier
  s_cbranch_scc0 L_hB_hl
  v_mov_b32 v236, 0xf149f2ca
  v_mov_b32 v237, 0xf149f2ca
  v_mov_b32 v238, 0xf149f2ca
  v_mov_b32 v239, 0xf149f2ca
  s_branch L_cutE
L_end:
  s_endpgm
.section .rodata,"a"
.p2align 6
.amdhsa_kernel standalone__gqa_softmax__near_ridge_kernel
  .amdhsa_next_free_vgpr 512
  .amdhsa_next_free_sgpr 102
  .amdhsa_accum_offset 256
  .amdhsa_group_segment_fixed_size 0
  .amdhsa_kernarg_size 48
  .amdhsa_user_sgpr_count 2
  .amdhsa_user_sgpr_kernarg_segment_ptr 1
  .amdhsa_system_sgpr_workgroup_id_x 1
.end_amdhsa_kernel
```
